```python
import torch

def _softmax(x, axis=-1):
    return torch.softmax(x, dim=axis)
def _gelu(x):
    return torch.nn.functional.gelu(x, approximate="tanh")
def _silu(x):
    return torch.nn.functional.silu(x)
def _sigmoid(x):
    return torch.sigmoid(x)
def _layernorm(x, axis=-1, eps=1e-5):
    m = x.mean(dim=axis, keepdim=True)
    v = x.var(dim=axis, keepdim=True, unbiased=False)
    return (x - m) / torch.sqrt(v + eps)
def _scatter_add(tgt, idx, src, axis=0):
    return tgt.clone().index_add_(axis, idx, src)
def _segment_sum(src, seg, n):
    out = torch.zeros((n,) + src.shape[1:], dtype=src.dtype)
    return out.index_add_(0, seg, src)
def _pad(x, pw):
    flat = tuple(v for pair in reversed(pw) for v in pair)
    return torch.nn.functional.pad(x, flat)

kernel_name = 'gated_mix__compressed_kv_cla__ssm_conv_s5__prompt'

def setup_inputs():

    _w = (lambda a: (lambda t: t.to(torch.bfloat16) if t.is_floating_point() else t)(torch.as_tensor(a)))
    def _A_setup():
        B, H, Sq, Sk, D, M = 1, 32, 2048, 2048, 128, 512
        Dc = 4 * D
        return {
            "x": _w((lambda *s: torch.randn(*s, dtype=torch.bfloat16) * 0.05)(B, Sq, M)),
            "c_kv": _w((lambda *s: torch.randn(*s, dtype=torch.bfloat16) * 0.4)(B, Sk, Dc)),
            "w_q": _w((lambda *s: torch.randn(*s, dtype=torch.bfloat16) * 6.4)(M, H, D) * (M ** -0.5)),
            "w_uk": _w((lambda *s: torch.randn(*s, dtype=torch.bfloat16) * 6.4)(Dc, H, D) * (Dc ** -0.5)),
            "w_uv": _w((lambda *s: torch.randn(*s, dtype=torch.bfloat16) * 0.4)(Dc, H, D) * (Dc ** -0.5)),
            "w_o": _w((lambda *s: torch.randn(*s, dtype=torch.bfloat16) * 0.4)(H, D, M) * ((H * D) ** -0.5)),
        }
    _A_in = _A_setup()

    def _B_setup():
        B, S, D = 1, 2048, 512
        P = D
        Lambda_re = -0.5 * (lambda _x: torch.exp(torch.as_tensor(_x)))((lambda *s: torch.randn(*s, dtype=torch.bfloat16) * 0.4)(P))
        Lambda_im = (lambda *s: torch.randn(*s, dtype=torch.bfloat16) * 0.4)(P) * 1.0
        B_re = (lambda *s: torch.randn(*s, dtype=torch.bfloat16) * 0.4)(P, D) * (D ** -0.5)
        B_im = (lambda *s: torch.randn(*s, dtype=torch.bfloat16) * 0.4)(P, D) * (D ** -0.5)
        C_re = (lambda *s: torch.randn(*s, dtype=torch.bfloat16) * 0.4)(D, P) * (P ** -0.5)
        C_im = (lambda *s: torch.randn(*s, dtype=torch.bfloat16) * 0.4)(D, P) * (P ** -0.5)
        log_dt = (lambda *s: torch.randn(*s, dtype=torch.bfloat16) * 0.4)(P) * 0.3 - 2.0
        Dskip = (lambda *s: torch.randn(*s, dtype=torch.bfloat16) * 0.05)(D)
        return {
            "x": _w((lambda *s: torch.randn(*s, dtype=torch.bfloat16) * 0.05)(B, S, D)),
            "Lambda_re": _w(Lambda_re),
            "Lambda_im": _w(Lambda_im),
            "B_re": _w(B_re),
            "B_im": _w(B_im),
            "C_re": _w(C_re),
            "C_im": _w(C_im),
            "log_dt": _w(log_dt),
            "Dskip": _w(Dskip),
        }
    _B_in = _B_setup()

    return {
        "A_x": _A_in["x"],
        "A_c_kv": _A_in["c_kv"],
        "A_w_q": _A_in["w_q"],
        "A_w_uk": _A_in["w_uk"],
        "A_w_uv": _A_in["w_uv"],
        "A_w_o": _A_in["w_o"],
        "B_x": _B_in["x"],
        "B_Lambda_re": _B_in["Lambda_re"],
        "B_Lambda_im": _B_in["Lambda_im"],
        "B_B_re": _B_in["B_re"],
        "B_B_im": _B_in["B_im"],
        "B_C_re": _B_in["C_re"],
        "B_C_im": _B_in["C_im"],
        "B_log_dt": _B_in["log_dt"],
        "B_Dskip": _B_in["Dskip"],
        "gate_w": _w((lambda *s: torch.randn(*s, dtype=torch.bfloat16) * 0.05)(512) * 16.0),
    }

def reference(A_x, A_c_kv, A_w_q, A_w_uk, A_w_uv, A_w_o, B_x, B_Lambda_re, B_Lambda_im, B_B_re, B_B_im, B_C_re, B_C_im, B_log_dt, B_Dskip, gate_w):
    def _A_ref(x, c_kv, w_q, w_uk, w_uv, w_o):
        B, Sq, M = x.shape[0], x.shape[1], x.shape[2]
        Sk = c_kv.shape[1]
        H, D = w_q.shape[1], w_q.shape[2]
        q = torch.einsum("bqm,mhd->bhqd", x, w_q)
        k = torch.einsum("bkc,chd->bhkd", c_kv, w_uk)
        v = torch.einsum("bkc,chd->bhkd", c_kv, w_uv)
        scores = torch.einsum("bhqd,bhkd->bhqk", q, k) * (D ** -0.5)
        off = Sk - Sq
        qi = torch.arange(Sq)[:, None]
        kj = torch.arange(Sk)[None, :]
        cmask = kj <= (qi + off)
        scores = torch.where(cmask[None, None], scores, -1e9)
        p = _softmax(scores, axis=-1)
        ctx = torch.einsum("bhqk,bhkd->bhqd", p, v)
        return torch.einsum("bhqd,hdm->bqm", ctx, w_o)

    def _B_ref(x, Lambda_re, Lambda_im, B_re, B_im, C_re, C_im, log_dt, Dskip):
        Bsz, L, H = x.shape
        Lam = Lambda_re + 1j * Lambda_im
        Bmat = B_re + 1j * B_im
        Cmat = C_re + 1j * C_im
        dt = torch.exp(log_dt)
        Lam_bar = torch.exp(dt * Lam)
        B_bar = ((Lam_bar - 1.0) / Lam)[:, None] * Bmat
        Bu = torch.einsum("bld,pd->blp", x + 0j, B_bar)
        h = torch.zeros_like(Bu[:, 0, :])
        hs = []
        for t in range(L):
            h = Lam_bar[None, :] * h + Bu[:, t, :]
            hs.append(h)
        hseq = torch.stack(hs, 1)
        y = 2.0 * torch.einsum("blp,dp->bld", hseq, Cmat).real + x * Dskip[None, None, :]
        return y

    x = A_x
    g = _sigmoid((x * gate_w).sum(-1, keepdims=True))
    a = _A_ref(x, A_c_kv, A_w_q, A_w_uk, A_w_uv, A_w_o)
    b = _B_ref(x, B_Lambda_re, B_Lambda_im, B_B_re, B_B_im, B_C_re, B_C_im, B_log_dt, B_Dskip)
    return g * a + (1 - g) * b
```

```asm
; @launch grid=(256,1,1) block=(256,1,1) lds=163840
.amdgcn_target "amdgcn-amd-amdhsa--gfx950"
.text
.globl gated_mix__compressed_kv_cla__ssm_conv_s5__prompt_kernel
.p2align 8
.type gated_mix__compressed_kv_cla__ssm_conv_s5__prompt_kernel,@function
gated_mix__compressed_kv_cla__ssm_conv_s5__prompt_kernel:
    s_cmp_ge_u32 s2, 256
    s_cbranch_scc1 A_end
    s_load_dwordx16 s[60:75], s[0:1], 0
    s_load_dwordx16 s[76:91], s[0:1], 64
    s_load_dwordx4 s[92:95], s[0:1], 136
    v_lshrrev_b32 v1, 6, v0
    v_and_b32 v0, 63, v0
    s_and_b32 s6, s2, 7
    v_readfirstlane_b32 s3, v1
    s_lshr_b32 s7, s2, 6
    s_lshl_b32 s6, s6, 2
    s_add_u32 s4, s6, s7
    s_bfe_u32 s5, s2, 0x30003
    v_lshlrev_b32 v1, 4, v0
    v_and_b32 v19, 15, v0
    s_getpc_b64 s[6:7]
A_pc:
    v_and_b32 v16, 31, v0
    v_lshlrev_b32 v16, 7, v16
    s_lshl_b32 s44, s5, 2
    s_add_u32 s44, s44, s3
    s_lshl_b32 s44, s44, 12
    v_add_u32 v16, s44, v16
    v_min_u32 v16, A_end-A_pc, v16
    v_mov_b32 v17, s7
    v_add_co_u32 v16, vcc, s6, v16
    s_nop 1
    v_addc_co_u32 v17, vcc, 0, v17, vcc
    global_load_dword v13, v[16:17], off
    v_lshrrev_b32 v23, 3, v0
    v_and_b32 v17, 6, v23
    v_and_b32 v18, 7, v0
    v_xor_b32 v17, v17, v18
    v_lshlrev_b32 v17, 4, v17
    v_lshl_add_u32 v2, v23, 10, v17
    v_and_b32 v16, 4, v23
    v_add_u32 v16, v16, v23
    v_lshl_add_u32 v4, v16, 10, v17
    v_lshl_add_u32 v3, v16, 13, v17
    s_lshl_b32 s42, s3, 13
    s_add_u32 s43, s42, 0x8000
    s_and_b32 s6, s3, 1
    s_lshr_b32 s7, s3, 1
    s_lshl_b32 s41, s6, 18
    s_lshl_b32 s40, s6, 2
    s_add_u32 s40, s40, s7
    s_lshl_b32 s40, s40, 3
    s_add_u32 s40, s40, s5
    s_lshl_b32 s40, s40, 15
    s_lshl_b32 s7, s4, 8
    s_add_u32 s41, s41, s7
    s_mul_i32 s45, s2, 1
    s_and_b32 s45, s45, 7
    s_lshl_b32 s6, s45, 7
    s_add_u32 s40, s40, s6
    s_lshl_b32 s6, s45, 19
    s_add_u32 s41, s41, s6
    s_waitcnt lgkmcnt(0)
    s_mov_b32 s12, s62
    s_mov_b32 s13, s63
    s_mov_b32 s14, 0x200000
    s_mov_b32 s15, 0x20000
    s_bitcmp1_b32 s3, 1
    s_cselect_b32 s6, s68, s66
    s_cselect_b32 s7, s69, s67
    s_mov_b32 s16, s6
    s_mov_b32 s17, s7
    s_mov_b32 s18, 0x400000
    s_mov_b32 s19, 0x20000
    s_add_u32 m0, s42, 0
    s_add_u32 s44, s40, 0
    buffer_load_dwordx4 v2, s[12:15], s44 offen lds
    s_add_u32 s44, s40, 7168
    buffer_load_dwordx4 v2, s[12:15], s44 offen offset:1024 lds
    s_add_u32 s44, s40, 14336
    buffer_load_dwordx4 v2, s[12:15], s44 offen offset:2048 lds
    s_add_u32 s44, s40, 21504
    buffer_load_dwordx4 v2, s[12:15], s44 offen offset:3072 lds
    s_add_u32 m0, s42, 4096
    s_add_u32 s44, s40, 524288
    buffer_load_dwordx4 v2, s[12:15], s44 offen lds
    s_add_u32 s44, s40, 531456
    buffer_load_dwordx4 v2, s[12:15], s44 offen offset:1024 lds
    s_add_u32 s44, s40, 538624
    buffer_load_dwordx4 v2, s[12:15], s44 offen offset:2048 lds
    s_add_u32 s44, s40, 545792
    buffer_load_dwordx4 v2, s[12:15], s44 offen offset:3072 lds
    s_add_u32 m0, s43, 0
    s_add_u32 s44, s41, 0
    buffer_load_dwordx4 v3, s[16:19], s44 offen lds
    s_add_u32 s44, s41, 31744
    buffer_load_dwordx4 v3, s[16:19], s44 offen offset:1024 lds
    s_add_u32 s44, s41, 129024
    buffer_load_dwordx4 v3, s[16:19], s44 offen offset:2048 lds
    s_add_u32 s44, s41, 160768
    buffer_load_dwordx4 v3, s[16:19], s44 offen offset:3072 lds
    s_add_u32 m0, s43, 4096
    s_add_u32 s44, s41, 128
    buffer_load_dwordx4 v3, s[16:19], s44 offen lds
    s_add_u32 s44, s41, 31872
    buffer_load_dwordx4 v3, s[16:19], s44 offen offset:1024 lds
    s_add_u32 s44, s41, 129152
    buffer_load_dwordx4 v3, s[16:19], s44 offen offset:2048 lds
    s_add_u32 s44, s41, 160896
    buffer_load_dwordx4 v3, s[16:19], s44 offen offset:3072 lds
    s_add_u32 s40, s40, 128
    s_bitset0_b32 s40, 10
    s_add_u32 s41, s41, 524288
    s_bitset0_b32 s41, 22
    s_xor_b32 s42, s42, 0x10000
    s_xor_b32 s43, s43, 0x10000
    s_lshr_b32 s44, s2, 3
    s_cmp_eq_u32 s3, 0
    s_cselect_b32 s36, s62, s60
    s_cselect_b32 s37, s63, s61
    s_cselect_b32 s59, 1, 2
    s_mov_b32 s58, 60
    s_cselect_b32 s58, 1016, s58
    s_lshl_b32 s59, s59, 7
    s_cmp_eq_u32 s3, 1
    s_cselect_b32 s51, 0, 128
    s_mov_b32 s99, 0x200000
    s_mov_b32 s39, 0x20000
    s_lshl_b32 s6, s44, 16
    v_lshl_add_u32 v14, v0, 10, s6
    s_cmp_eq_u32 s3, 3
    s_cbranch_scc0 A_pf0
    s_mov_b32 s99, 0x400000
    s_cmp_lt_u32 s44, 8
    s_cselect_b32 s6, s66, s68
    s_cselect_b32 s7, s67, s69
    s_cmp_lt_u32 s44, 16
    s_cselect_b32 s36, s6, s64
    s_cselect_b32 s37, s7, s65
    s_cselect_b32 s59, 1, 2
    s_cselect_b32 s58, 1016, s58
    s_lshl_b32 s59, s59, 19
    s_lshr_b32 s6, s44, 3
    s_cmp_eq_u32 s6, 2
    s_cselect_b32 s51, 0, 0x80000
    s_lshl_b32 s6, s5, 16
    s_and_b32 s7, s2, 7
    s_lshl_b32 s7, s7, 10
    s_add_u32 s6, s6, s7
    v_lshlrev_b32 v14, 7, v18
    v_lshl_add_u32 v14, v23, 13, v14
    v_add_u32 v14, s6, v14
A_pf0:
    s_mul_i32 s6, s45, s59
    s_add_u32 s51, s51, s6
    s_and_b32 s51, s51, 0x3803ff
    s_bitcmp1_b32 s58, 9
    s_cselect_b32 s38, s99, 0
    s_cselect_b32 s52, s59, 0
    buffer_load_dword v13, v14, s[36:39], s51 offen
    s_add_u32 s51, s51, s52
    s_and_b32 s51, s51, 0xffbffbff
    s_bitcmp1_b32 s58, 8
    s_cselect_b32 s38, s99, 0
    s_cselect_b32 s52, s59, 0
    buffer_load_dword v13, v14, s[36:39], s51 offen
    s_add_u32 s51, s51, s52
    s_and_b32 s51, s51, 0xffbffbff
    v_lshrrev_b32 v20, 4, v0
    v_lshlrev_b32 v21, 4, v20
    v_lshl_add_u32 v21, v19, 10, v21
    s_lshl_b32 s6, s4, 4
    v_add_u32 v22, s6, v19
    v_lshlrev_b32 v22, 1, v22
    s_bitcmp1_b32 s2, 3
    s_cselect_b32 s6, s84, s82
    s_cselect_b32 s7, s85, s83
    s_mov_b32 s32, s6
    s_mov_b32 s33, s7
    s_mov_b32 s34, 0x80000
    s_mov_b32 s35, 0x20000
    s_mov_b32 s20, s60
    s_mov_b32 s21, s61
    s_mov_b32 s22, 0x200000
    s_mov_b32 s23, 0x20000
    s_and_b32 s72, s2, 7
    s_lshl_b32 s72, s72, 2
    s_add_u32 s72, s72, s3
    s_lshl_b32 s72, s72, 14
    s_lshr_b32 s73, s2, 4
    s_lshl_b32 s73, s73, 6
    s_add_u32 s72, s72, s73
    s_lshl_b32 s44, s2, 13
    s_lshl_b32 s73, s3, 11
    s_add_u32 s73, s44, s73
    global_load_dwordx4 v[36:39], v1, s[90:91]
    global_load_ushort v40, v22, s[74:75]
    global_load_ushort v41, v22, s[76:77]
    global_load_ushort v42, v22, s[86:87]
    s_mov_b32 s8, s94
    s_mov_b32 s9, s95
    s_mov_b32 s10, 0x4800000
    s_mov_b32 s11, 0x20000
    s_mov_b32 s24, s64
    s_mov_b32 s25, s65
    s_mov_b32 s26, 0x400000
    s_mov_b32 s27, 0x20000
    s_mov_b32 s28, s92
    s_mov_b32 s29, s93
    s_mov_b32 s30, 0x100
    s_mov_b32 s31, 0x20000
    s_lshr_b32 s6, s3, 1
    s_and_b32 s7, s3, 1
    s_lshl_b32 s54, s6, 18
    s_lshl_b32 s44, s7, 7
    s_add_u32 s54, s54, s44
    s_lshl_b32 s44, s4, 8
    s_add_u32 s54, s54, s44
    s_lshl_b32 s55, s3, 12
    s_add_u32 s55, s55, 0x8000
    s_lshl_b32 s53, s5, 2
    s_add_u32 s53, s53, s3
    s_sub_u32 s47, 63, s53
    s_mov_b32 s96, s53
    s_mov_b32 s97, s47
    s_lshl_b32 s53, s53, 15
    s_lshl_b32 s47, s47, 15
    s_mul_i32 s48, s4, 1064960
    s_lshl_b32 s44, s7, 3
    s_add_u32 s44, s44, s5
    s_lshl_b32 s44, s44, 14
    s_add_u32 s46, s48, s44
    s_mul_i32 s44, s6, 24576
    s_add_u32 s46, s46, s44
    s_lshl_b32 s49, s3, 14
    s_add_u32 s48, s48, s49
    s_lshl_b32 s57, s6, 14
    s_lshl_b32 s56, s7, 14
    v_and_b32 v16, 6, v19
    v_xor_b32 v16, v16, v20
    v_lshlrev_b32 v16, 4, v16
    v_lshl_add_u32 v16, v19, 7, v16
    v_add_u32 v11, 131072, v16
    v_xor_b32 v12, 64, v11
    v_add_u32 v5, s56, v16
    v_xor_b32 v6, 64, v5
    v_bfe_u32 v16, v0, 2, 3
    v_and_b32 v17, 3, v0
    v_lshlrev_b32 v17, 3, v17
    v_lshl_add_u32 v17, v16, 7, v17
    v_lshrrev_b32 v18, 5, v0
    v_lshl_add_u32 v17, v18, 11, v17
    v_lshrrev_b32 v16, 1, v16
    v_lshl_add_u32 v17, v16, 5, v17
    s_add_u32 s6, s57, 0x8000
    v_xor_b32 v16, 0, v17
    v_add_u32 v7, s6, v16
    v_xor_b32 v16, 32, v17
    v_add_u32 v8, s6, v16
    v_xor_b32 v16, 64, v17
    v_add_u32 v9, s6, v16
    v_xor_b32 v16, 96, v17
    v_add_u32 v10, s6, v16
    s_lshl_b32 s6, s3, 13
    s_sub_u32 s56, s6, s56
    s_sub_u32 s56, s56, 0x10000
    s_sub_u32 s57, 0xffff0000, s57
    v_mov_b32 v46, 0
    v_mov_b32 v56, -1
    v_mov_b32 v57, -1
    v_mov_b32 v58, -1
    v_mov_b32 v59, -1
    s_lshl_b32 s60, s4, 5
    s_add_u32 s60, s60, s96
    s_lshl_b32 s60, s60, 13
    s_add_u32 s60, s60, 67108864
    s_mov_b32 s61, s60
    s_cmp_eq_u32 s3, 0
    s_cselect_b32 s50, 1, 0
    s_cselect_b32 s30, 256, 0
    s_mov_b32 s45, 5
    s_getreg_b32 s6, hwreg(HW_REG_XCC_ID, 0, 4)
    s_mul_i32 s7, s6, s6
    s_lshl_b32 s7, s7, 7
    s_add_u32 s7, s7, s6
    s_lshl_b32 s7, s7, 4
    s_add_u32 s7, s7, 1
    s_lshl_b32 s6, s4, 3
    v_mov_b32 v61, s7
    v_lshl_add_u32 v60, v0, 8, s6
    s_add_u32 m0, s42, 0
    s_add_u32 s44, s40, 0
    buffer_load_dwordx4 v2, s[12:15], s44 offen lds
    s_add_u32 s44, s40, 7168
    buffer_load_dwordx4 v2, s[12:15], s44 offen offset:1024 lds
    s_add_u32 s44, s40, 14336
    buffer_load_dwordx4 v2, s[12:15], s44 offen offset:2048 lds
    s_add_u32 s44, s40, 21504
    buffer_load_dwordx4 v2, s[12:15], s44 offen offset:3072 lds
    s_waitcnt vmcnt(10)
    s_barrier
    ds_read_b128 a[64:67], v5 offset:0
    ds_read_b64_tr_b16 a[0:1], v7 offset:0
    ds_read_b64_tr_b16 a[2:3], v7 offset:1024
    ds_read_b128 a[68:71], v5 offset:2048
    ds_read_b64_tr_b16 a[4:5], v8 offset:0
    ds_read_b64_tr_b16 a[6:7], v8 offset:1024
    ds_read_b128 a[72:75], v5 offset:4096
    ds_read_b64_tr_b16 a[8:9], v9 offset:0
    ds_read_b64_tr_b16 a[10:11], v9 offset:1024
    ds_read_b128 a[76:79], v5 offset:6144
    ds_read_b64_tr_b16 a[12:13], v10 offset:0
    ds_read_b64_tr_b16 a[14:15], v10 offset:1024
    ds_read_b128 a[80:83], v5 offset:8192
    ds_read_b64_tr_b16 a[16:17], v7 offset:4096
    ds_read_b64_tr_b16 a[18:19], v7 offset:5120
    ds_read_b128 a[84:87], v5 offset:10240
    ds_read_b64_tr_b16 a[20:21], v8 offset:4096
    ds_read_b64_tr_b16 a[22:23], v8 offset:5120
    ds_read_b128 a[88:91], v5 offset:12288
    ds_read_b64_tr_b16 a[24:25], v9 offset:4096
    ds_read_b64_tr_b16 a[26:27], v9 offset:5120
    ds_read_b128 a[92:95], v5 offset:14336
    ds_read_b64_tr_b16 a[28:29], v10 offset:4096
    ds_read_b64_tr_b16 a[30:31], v10 offset:5120
    s_waitcnt lgkmcnt(0)
    s_cmp_ge_u32 s3, 2
    s_cbranch_scc1 A_kv1
    v_mfma_f32_16x16x32_bf16 v[96:99], a[0:3], a[64:67], 0
    s_add_u32 m0, s42, 4096
    ds_read_b128 a[96:99], v6 offset:0
    v_mfma_f32_16x16x32_bf16 v[100:103], a[4:7], a[64:67], 0
    s_add_u32 s44, s40, 524288
    ds_read_b64_tr_b16 a[32:33], v7 offset:8192
    buffer_load_dwordx4 v2, s[12:15], s44 offen lds
    v_mfma_f32_16x16x32_bf16 v[104:107], a[8:11], a[64:67], 0
    s_add_u32 s44, s40, 531456
    v_mfma_f32_16x16x32_bf16 v[108:111], a[12:15], a[64:67], 0
    ds_read_b64_tr_b16 a[34:35], v7 offset:9216
    buffer_load_dwordx4 v2, s[12:15], s44 offen offset:1024 lds
    v_mfma_f32_16x16x32_bf16 v[112:115], a[16:19], a[64:67], 0
    s_add_u32 s44, s40, 538624
    v_mfma_f32_16x16x32_bf16 v[116:119], a[20:23], a[64:67], 0
    ds_read_b128 a[100:103], v6 offset:2048
    v_mfma_f32_16x16x32_bf16 v[120:123], a[24:27], a[64:67], 0
    v_mfma_f32_16x16x32_bf16 v[124:127], a[28:31], a[64:67], 0
    ds_read_b64_tr_b16 a[36:37], v8 offset:8192
    buffer_load_dwordx4 v2, s[12:15], s44 offen offset:2048 lds
    v_mfma_f32_16x16x32_bf16 v[128:131], a[0:3], a[68:71], 0
    s_add_u32 s44, s40, 545792
    v_mfma_f32_16x16x32_bf16 v[132:135], a[4:7], a[68:71], 0
    ds_read_b64_tr_b16 a[38:39], v8 offset:9216
    v_mfma_f32_16x16x32_bf16 v[136:139], a[8:11], a[68:71], 0
    v_xor_b32 v5, 0x10000, v5
    v_mfma_f32_16x16x32_bf16 v[140:143], a[12:15], a[68:71], 0
    ds_read_b128 a[104:107], v6 offset:4096
    buffer_load_dwordx4 v2, s[12:15], s44 offen offset:3072 lds
    v_mfma_f32_16x16x32_bf16 v[144:147], a[16:19], a[68:71], 0
    s_add_u32 m0, s43, 0
    ds_read_b64_tr_b16 a[40:41], v9 offset:8192
    v_mfma_f32_16x16x32_bf16 v[148:151], a[20:23], a[68:71], 0
    s_add_u32 s44, s41, 0
    v_mfma_f32_16x16x32_bf16 v[152:155], a[24:27], a[68:71], 0
    ds_read_b64_tr_b16 a[42:43], v9 offset:9216
    v_mfma_f32_16x16x32_bf16 v[156:159], a[28:31], a[68:71], 0
    buffer_load_dwordx4 v3, s[16:19], s44 offen lds
    v_mfma_f32_16x16x32_bf16 v[160:163], a[0:3], a[72:75], 0
    s_add_u32 s44, s41, 31744
    ds_read_b128 a[108:111], v6 offset:6144
    v_mfma_f32_16x16x32_bf16 v[164:167], a[4:7], a[72:75], 0
    v_mfma_f32_16x16x32_bf16 v[168:171], a[8:11], a[72:75], 0
    ds_read_b64_tr_b16 a[44:45], v10 offset:8192
    v_mfma_f32_16x16x32_bf16 v[172:175], a[12:15], a[72:75], 0
    buffer_load_dwordx4 v3, s[16:19], s44 offen offset:1024 lds
    v_mfma_f32_16x16x32_bf16 v[176:179], a[16:19], a[72:75], 0
    s_add_u32 s44, s41, 129024
    ds_read_b64_tr_b16 a[46:47], v10 offset:9216
    v_mfma_f32_16x16x32_bf16 v[180:183], a[20:23], a[72:75], 0
    v_mfma_f32_16x16x32_bf16 v[184:187], a[24:27], a[72:75], 0
    ds_read_b128 a[112:115], v6 offset:8192
    v_mfma_f32_16x16x32_bf16 v[188:191], a[28:31], a[72:75], 0
    ds_read_b64_tr_b16 a[48:49], v7 offset:12288
    buffer_load_dwordx4 v3, s[16:19], s44 offen offset:2048 lds
    v_mfma_f32_16x16x32_bf16 v[192:195], a[0:3], a[76:79], 0
    s_add_u32 s44, s41, 160768
    v_mfma_f32_16x16x32_bf16 v[196:199], a[4:7], a[76:79], 0
    ds_read_b64_tr_b16 a[50:51], v7 offset:13312
    v_mfma_f32_16x16x32_bf16 v[200:203], a[8:11], a[76:79], 0
    buffer_load_dwordx4 v3, s[16:19], s44 offen offset:3072 lds
    v_mfma_f32_16x16x32_bf16 v[204:207], a[12:15], a[76:79], 0
    s_add_u32 m0, s43, 4096
    ds_read_b128 a[116:119], v6 offset:10240
    v_mfma_f32_16x16x32_bf16 v[208:211], a[16:19], a[76:79], 0
    s_add_u32 s44, s41, 128
    v_mfma_f32_16x16x32_bf16 v[212:215], a[20:23], a[76:79], 0
    ds_read_b64_tr_b16 a[52:53], v8 offset:12288
    v_mfma_f32_16x16x32_bf16 v[216:219], a[24:27], a[76:79], 0
    buffer_load_dwordx4 v3, s[16:19], s44 offen lds
    v_mfma_f32_16x16x32_bf16 v[220:223], a[28:31], a[76:79], 0
    s_add_u32 s44, s41, 31872
    ds_read_b64_tr_b16 a[54:55], v8 offset:13312
    v_mfma_f32_16x16x32_bf16 v[224:227], a[0:3], a[80:83], 0
    v_mfma_f32_16x16x32_bf16 v[228:231], a[4:7], a[80:83], 0
    ds_read_b128 a[120:123], v6 offset:12288
    v_mfma_f32_16x16x32_bf16 v[232:235], a[8:11], a[80:83], 0
    ds_read_b64_tr_b16 a[56:57], v9 offset:12288
    buffer_load_dwordx4 v3, s[16:19], s44 offen offset:1024 lds
    v_mfma_f32_16x16x32_bf16 v[236:239], a[12:15], a[80:83], 0
    s_add_u32 s44, s41, 129152
    v_mfma_f32_16x16x32_bf16 v[240:243], a[16:19], a[80:83], 0
    ds_read_b64_tr_b16 a[58:59], v9 offset:13312
    v_mfma_f32_16x16x32_bf16 v[244:247], a[20:23], a[80:83], 0
    v_mfma_f32_16x16x32_bf16 v[248:251], a[24:27], a[80:83], 0
    ds_read_b128 a[124:127], v6 offset:14336
    buffer_load_dwordx4 v3, s[16:19], s44 offen offset:2048 lds
    v_mfma_f32_16x16x32_bf16 v[252:255], a[28:31], a[80:83], 0
    s_add_u32 s44, s41, 160896
    v_mfma_f32_16x16x32_bf16 a[128:131], a[0:3], a[84:87], 0
    ds_read_b64_tr_b16 a[60:61], v10 offset:12288
    v_mfma_f32_16x16x32_bf16 a[132:135], a[4:7], a[84:87], 0
    v_mfma_f32_16x16x32_bf16 a[136:139], a[8:11], a[84:87], 0
    ds_read_b64_tr_b16 a[62:63], v10 offset:13312
    buffer_load_dwordx4 v3, s[16:19], s44 offen offset:3072 lds
    v_mfma_f32_16x16x32_bf16 a[140:143], a[12:15], a[84:87], 0
    s_bitcmp1_b32 s58, 7
    s_cselect_b32 s38, s99, 0
    s_cselect_b32 s52, s59, 0
    v_mfma_f32_16x16x32_bf16 a[144:147], a[16:19], a[84:87], 0
    v_mfma_f32_16x16x32_bf16 a[148:151], a[20:23], a[84:87], 0
    v_mfma_f32_16x16x32_bf16 a[152:155], a[24:27], a[84:87], 0
    v_xor_b32 v7, 0x10000, v7
    v_xor_b32 v8, 0x10000, v8
    v_mfma_f32_16x16x32_bf16 a[156:159], a[28:31], a[84:87], 0
    v_xor_b32 v9, 0x10000, v9
    v_xor_b32 v10, 0x10000, v10
    v_mfma_f32_16x16x32_bf16 a[160:163], a[0:3], a[88:91], 0
    v_xor_b32 v6, 0x10000, v6
    buffer_load_dword v13, v14, s[36:39], s51 offen
    v_mfma_f32_16x16x32_bf16 a[164:167], a[4:7], a[88:91], 0
    s_add_u32 s51, s51, s52
    s_and_b32 s51, s51, 0xffbffbff
    v_mfma_f32_16x16x32_bf16 a[168:171], a[8:11], a[88:91], 0
    v_mfma_f32_16x16x32_bf16 a[172:175], a[12:15], a[88:91], 0
    s_waitcnt lgkmcnt(0)
    v_mfma_f32_16x16x32_bf16 a[176:179], a[16:19], a[88:91], 0
    v_mfma_f32_16x16x32_bf16 a[180:183], a[20:23], a[88:91], 0
    v_mfma_f32_16x16x32_bf16 a[184:187], a[24:27], a[88:91], 0
    s_barrier
    v_mfma_f32_16x16x32_bf16 a[188:191], a[28:31], a[88:91], 0
    s_add_u32 s40, s40, 128
    s_bitset0_b32 s40, 10
    v_mfma_f32_16x16x32_bf16 a[192:195], a[0:3], a[92:95], 0
    s_add_u32 s41, s41, 524288
    s_bitset0_b32 s41, 22
    v_mfma_f32_16x16x32_bf16 a[196:199], a[4:7], a[92:95], 0
    s_xor_b32 s42, s42, 0x10000
    v_mfma_f32_16x16x32_bf16 a[200:203], a[8:11], a[92:95], 0
    s_xor_b32 s43, s43, 0x10000
    buffer_atomic_add v61, v60, s[28:31], 0 offen sc1
    buffer_store_dwordx4 v[56:59], v1, s[8:11], s61 offen offset:2048 sc1
    v_mfma_f32_16x16x32_bf16 a[204:207], a[12:15], a[92:95], 0
    s_add_u32 s61, s61, 1024
    v_mfma_f32_16x16x32_bf16 a[208:211], a[16:19], a[92:95], 0
    s_add_u32 m0, s42, 0
    v_mfma_f32_16x16x32_bf16 a[212:215], a[20:23], a[92:95], 0
    s_add_u32 s44, s40, 0
    v_mfma_f32_16x16x32_bf16 a[216:219], a[24:27], a[92:95], 0
    buffer_load_dwordx4 v2, s[12:15], s44 offen lds
    v_mfma_f32_16x16x32_bf16 a[220:223], a[28:31], a[92:95], 0
    s_add_u32 s44, s40, 7168
    v_mfma_f32_16x16x32_bf16 v[96:99], a[32:35], a[96:99], v[96:99]
    v_mfma_f32_16x16x32_bf16 v[100:103], a[36:39], a[96:99], v[100:103]
    v_mfma_f32_16x16x32_bf16 v[104:107], a[40:43], a[96:99], v[104:107]
    buffer_load_dwordx4 v2, s[12:15], s44 offen offset:1024 lds
    v_mfma_f32_16x16x32_bf16 v[108:111], a[44:47], a[96:99], v[108:111]
    s_add_u32 s44, s40, 14336
    v_mfma_f32_16x16x32_bf16 v[112:115], a[48:51], a[96:99], v[112:115]
    v_mfma_f32_16x16x32_bf16 v[116:119], a[52:55], a[96:99], v[116:119]
    buffer_load_dwordx4 v2, s[12:15], s44 offen offset:2048 lds
    v_mfma_f32_16x16x32_bf16 v[120:123], a[56:59], a[96:99], v[120:123]
    s_add_u32 s44, s40, 21504
    v_mfma_f32_16x16x32_bf16 v[124:127], a[60:63], a[96:99], v[124:127]
    v_mfma_f32_16x16x32_bf16 v[128:131], a[32:35], a[100:103], v[128:131]
    v_mfma_f32_16x16x32_bf16 v[132:135], a[36:39], a[100:103], v[132:135]
    buffer_load_dwordx4 v2, s[12:15], s44 offen offset:3072 lds
    v_mfma_f32_16x16x32_bf16 v[136:139], a[40:43], a[100:103], v[136:139]
    s_add_u32 m0, s42, 4096
    v_mfma_f32_16x16x32_bf16 v[140:143], a[44:47], a[100:103], v[140:143]
    s_add_u32 s44, s40, 524288
    v_mfma_f32_16x16x32_bf16 v[144:147], a[48:51], a[100:103], v[144:147]
    v_mfma_f32_16x16x32_bf16 v[148:151], a[52:55], a[100:103], v[148:151]
    buffer_load_dwordx4 v2, s[12:15], s44 offen lds
    v_mfma_f32_16x16x32_bf16 v[152:155], a[56:59], a[100:103], v[152:155]
    s_add_u32 s44, s40, 531456
    v_mfma_f32_16x16x32_bf16 v[156:159], a[60:63], a[100:103], v[156:159]
    v_mfma_f32_16x16x32_bf16 v[160:163], a[32:35], a[104:107], v[160:163]
    buffer_load_dwordx4 v2, s[12:15], s44 offen offset:1024 lds
    v_mfma_f32_16x16x32_bf16 v[164:167], a[36:39], a[104:107], v[164:167]
    s_add_u32 s44, s40, 538624
    v_mfma_f32_16x16x32_bf16 v[168:171], a[40:43], a[104:107], v[168:171]
    v_mfma_f32_16x16x32_bf16 v[172:175], a[44:47], a[104:107], v[172:175]
    v_mfma_f32_16x16x32_bf16 v[176:179], a[48:51], a[104:107], v[176:179]
    buffer_load_dwordx4 v2, s[12:15], s44 offen offset:2048 lds
    v_mfma_f32_16x16x32_bf16 v[180:183], a[52:55], a[104:107], v[180:183]
    s_add_u32 s44, s40, 545792
    v_mfma_f32_16x16x32_bf16 v[184:187], a[56:59], a[104:107], v[184:187]
    v_mfma_f32_16x16x32_bf16 v[188:191], a[60:63], a[104:107], v[188:191]
    v_mfma_f32_16x16x32_bf16 v[192:195], a[32:35], a[108:111], v[192:195]
    buffer_load_dwordx4 v2, s[12:15], s44 offen offset:3072 lds
    v_mfma_f32_16x16x32_bf16 v[196:199], a[36:39], a[108:111], v[196:199]
    s_add_u32 m0, s43, 0
    v_mfma_f32_16x16x32_bf16 v[200:203], a[40:43], a[108:111], v[200:203]
    s_add_u32 s44, s41, 0
    v_mfma_f32_16x16x32_bf16 v[204:207], a[44:47], a[108:111], v[204:207]
    buffer_load_dwordx4 v3, s[16:19], s44 offen lds
    v_mfma_f32_16x16x32_bf16 v[208:211], a[48:51], a[108:111], v[208:211]
    s_add_u32 s44, s41, 31744
    v_mfma_f32_16x16x32_bf16 v[212:215], a[52:55], a[108:111], v[212:215]
    v_mfma_f32_16x16x32_bf16 v[216:219], a[56:59], a[108:111], v[216:219]
    v_mfma_f32_16x16x32_bf16 v[220:223], a[60:63], a[108:111], v[220:223]
    buffer_load_dwordx4 v3, s[16:19], s44 offen offset:1024 lds
    v_mfma_f32_16x16x32_bf16 v[224:227], a[32:35], a[112:115], v[224:227]
    s_add_u32 s44, s41, 129024
    v_mfma_f32_16x16x32_bf16 v[228:231], a[36:39], a[112:115], v[228:231]
    v_mfma_f32_16x16x32_bf16 v[232:235], a[40:43], a[112:115], v[232:235]
    v_mfma_f32_16x16x32_bf16 v[236:239], a[44:47], a[112:115], v[236:239]
    buffer_load_dwordx4 v3, s[16:19], s44 offen offset:2048 lds
    v_mfma_f32_16x16x32_bf16 v[240:243], a[48:51], a[112:115], v[240:243]
    s_waitcnt vmcnt(14)
    v_mfma_f32_16x16x32_bf16 v[244:247], a[52:55], a[112:115], v[244:247]
    s_barrier
    v_mfma_f32_16x16x32_bf16 v[248:251], a[56:59], a[112:115], v[248:251]
    s_add_u32 s44, s41, 160768
    v_mfma_f32_16x16x32_bf16 v[252:255], a[60:63], a[112:115], v[252:255]
    ds_read_b128 a[64:67], v5 offset:0
    ds_read_b64_tr_b16 a[0:1], v7 offset:0
    v_mfma_f32_16x16x32_bf16 a[128:131], a[32:35], a[116:119], a[128:131]
    ds_read_b64_tr_b16 a[2:3], v7 offset:1024
    buffer_load_dwordx4 v3, s[16:19], s44 offen offset:3072 lds
    v_mfma_f32_16x16x32_bf16 a[132:135], a[36:39], a[116:119], a[132:135]
    s_add_u32 m0, s43, 4096
    ds_read_b128 a[68:71], v5 offset:2048
    v_mfma_f32_16x16x32_bf16 a[136:139], a[40:43], a[116:119], a[136:139]
    s_add_u32 s44, s41, 128
    ds_read_b64_tr_b16 a[4:5], v8 offset:0
    ds_read_b64_tr_b16 a[6:7], v8 offset:1024
    v_mfma_f32_16x16x32_bf16 a[140:143], a[44:47], a[116:119], a[140:143]
    ds_read_b128 a[72:75], v5 offset:4096
    buffer_load_dwordx4 v3, s[16:19], s44 offen lds
    v_mfma_f32_16x16x32_bf16 a[144:147], a[48:51], a[116:119], a[144:147]
    s_add_u32 s44, s41, 31872
    ds_read_b64_tr_b16 a[8:9], v9 offset:0
    v_mfma_f32_16x16x32_bf16 a[148:151], a[52:55], a[116:119], a[148:151]
    ds_read_b64_tr_b16 a[10:11], v9 offset:1024
    v_mfma_f32_16x16x32_bf16 a[152:155], a[56:59], a[116:119], a[152:155]
    ds_read_b128 a[76:79], v5 offset:6144
    ds_read_b64_tr_b16 a[12:13], v10 offset:0
    v_mfma_f32_16x16x32_bf16 a[156:159], a[60:63], a[116:119], a[156:159]
    ds_read_b64_tr_b16 a[14:15], v10 offset:1024
    buffer_load_dwordx4 v3, s[16:19], s44 offen offset:1024 lds
    v_mfma_f32_16x16x32_bf16 a[160:163], a[32:35], a[120:123], a[160:163]
    s_add_u32 s44, s41, 129152
    ds_read_b128 a[80:83], v5 offset:8192
    v_mfma_f32_16x16x32_bf16 a[164:167], a[36:39], a[120:123], a[164:167]
    ds_read_b64_tr_b16 a[16:17], v7 offset:4096
    buffer_load_dwordx4 v3, s[16:19], s44 offen offset:2048 lds
    v_mfma_f32_16x16x32_bf16 a[168:171], a[40:43], a[120:123], a[168:171]
    s_add_u32 s44, s41, 160896
    ds_read_b64_tr_b16 a[18:19], v7 offset:5120
    ds_read_b128 a[84:87], v5 offset:10240
    v_mfma_f32_16x16x32_bf16 a[172:175], a[44:47], a[120:123], a[172:175]
    ds_read_b64_tr_b16 a[20:21], v8 offset:4096
    v_mfma_f32_16x16x32_bf16 a[176:179], a[48:51], a[120:123], a[176:179]
    ds_read_b64_tr_b16 a[22:23], v8 offset:5120
    v_mfma_f32_16x16x32_bf16 a[180:183], a[52:55], a[120:123], a[180:183]
    ds_read_b128 a[88:91], v5 offset:12288
    buffer_load_dwordx4 v3, s[16:19], s44 offen offset:3072 lds
    v_mfma_f32_16x16x32_bf16 a[184:187], a[56:59], a[120:123], a[184:187]
    s_bitcmp1_b32 s58, 6
    s_cselect_b32 s38, s99, 0
    s_cselect_b32 s52, s59, 0
    ds_read_b64_tr_b16 a[24:25], v9 offset:4096
    ds_read_b64_tr_b16 a[26:27], v9 offset:5120
    v_mfma_f32_16x16x32_bf16 a[188:191], a[60:63], a[120:123], a[188:191]
    ds_read_b128 a[92:95], v5 offset:14336
    v_mfma_f32_16x16x32_bf16 a[192:195], a[32:35], a[124:127], a[192:195]
    ds_read_b64_tr_b16 a[28:29], v10 offset:4096
    v_mfma_f32_16x16x32_bf16 a[196:199], a[36:39], a[124:127], a[196:199]
    ds_read_b64_tr_b16 a[30:31], v10 offset:5120
    buffer_load_dword v13, v14, s[36:39], s51 offen
    v_mfma_f32_16x16x32_bf16 a[200:203], a[40:43], a[124:127], a[200:203]
    s_add_u32 s51, s51, s52
    s_and_b32 s51, s51, 0xffbffbff
    v_mfma_f32_16x16x32_bf16 a[204:207], a[44:47], a[124:127], a[204:207]
    v_mfma_f32_16x16x32_bf16 a[208:211], a[48:51], a[124:127], a[208:211]
    v_mfma_f32_16x16x32_bf16 a[212:215], a[52:55], a[124:127], a[212:215]
    v_mfma_f32_16x16x32_bf16 a[216:219], a[56:59], a[124:127], a[216:219]
    v_mfma_f32_16x16x32_bf16 a[220:223], a[60:63], a[124:127], a[220:223]
    s_waitcnt lgkmcnt(0)
    .p2align 3
A_kvl0:
    v_mfma_f32_16x16x32_bf16 v[96:99], a[0:3], a[64:67], v[96:99]
    ds_read_b128 a[96:99], v6 offset:0
    v_mfma_f32_16x16x32_bf16 v[100:103], a[4:7], a[64:67], v[100:103]
    ds_read_b64_tr_b16 a[32:33], v7 offset:8192
    v_mfma_f32_16x16x32_bf16 v[104:107], a[8:11], a[64:67], v[104:107]
    s_bitcmp1_b32 s58, s45
    v_mfma_f32_16x16x32_bf16 v[108:111], a[12:15], a[64:67], v[108:111]
    s_cselect_b32 s38, s99, 0
    ds_read_b64_tr_b16 a[34:35], v7 offset:9216
    v_mfma_f32_16x16x32_bf16 v[112:115], a[16:19], a[64:67], v[112:115]
    s_cselect_b32 s52, s59, 0
    v_mfma_f32_16x16x32_bf16 v[116:119], a[20:23], a[64:67], v[116:119]
    ds_read_b128 a[100:103], v6 offset:2048
    v_mfma_f32_16x16x32_bf16 v[120:123], a[24:27], a[64:67], v[120:123]
    s_sub_u32 s45, s45, 1
    v_mfma_f32_16x16x32_bf16 v[124:127], a[28:31], a[64:67], v[124:127]
    ds_read_b64_tr_b16 a[36:37], v8 offset:8192
    v_mfma_f32_16x16x32_bf16 v[128:131], a[0:3], a[68:71], v[128:131]
    s_add_u32 s40, s40, 128
    s_bitset0_b32 s40, 10
    v_mfma_f32_16x16x32_bf16 v[132:135], a[4:7], a[68:71], v[132:135]
    s_add_u32 s41, s41, 524288
    s_bitset0_b32 s41, 22
    ds_read_b64_tr_b16 a[38:39], v8 offset:9216
    v_mfma_f32_16x16x32_bf16 v[136:139], a[8:11], a[68:71], v[136:139]
    s_xor_b32 s42, s42, 0x10000
    v_xor_b32 v5, 0x10000, v5
    v_mfma_f32_16x16x32_bf16 v[140:143], a[12:15], a[68:71], v[140:143]
    s_xor_b32 s43, s43, 0x10000
    ds_read_b128 a[104:107], v6 offset:4096
    v_mfma_f32_16x16x32_bf16 v[144:147], a[16:19], a[68:71], v[144:147]
    ds_read_b64_tr_b16 a[40:41], v9 offset:8192
    v_mfma_f32_16x16x32_bf16 v[148:151], a[20:23], a[68:71], v[148:151]
    v_mfma_f32_16x16x32_bf16 v[152:155], a[24:27], a[68:71], v[152:155]
    ds_read_b64_tr_b16 a[42:43], v9 offset:9216
    v_mfma_f32_16x16x32_bf16 v[156:159], a[28:31], a[68:71], v[156:159]
    v_mfma_f32_16x16x32_bf16 v[160:163], a[0:3], a[72:75], v[160:163]
    ds_read_b128 a[108:111], v6 offset:6144
    v_mfma_f32_16x16x32_bf16 v[164:167], a[4:7], a[72:75], v[164:167]
    v_mfma_f32_16x16x32_bf16 v[168:171], a[8:11], a[72:75], v[168:171]
    ds_read_b64_tr_b16 a[44:45], v10 offset:8192
    v_mfma_f32_16x16x32_bf16 v[172:175], a[12:15], a[72:75], v[172:175]
    v_mfma_f32_16x16x32_bf16 v[176:179], a[16:19], a[72:75], v[176:179]
    ds_read_b64_tr_b16 a[46:47], v10 offset:9216
    v_mfma_f32_16x16x32_bf16 v[180:183], a[20:23], a[72:75], v[180:183]
    v_mfma_f32_16x16x32_bf16 v[184:187], a[24:27], a[72:75], v[184:187]
    ds_read_b128 a[112:115], v6 offset:8192
    v_mfma_f32_16x16x32_bf16 v[188:191], a[28:31], a[72:75], v[188:191]
    ds_read_b64_tr_b16 a[48:49], v7 offset:12288
    v_mfma_f32_16x16x32_bf16 v[192:195], a[0:3], a[76:79], v[192:195]
    v_mfma_f32_16x16x32_bf16 v[196:199], a[4:7], a[76:79], v[196:199]
    ds_read_b64_tr_b16 a[50:51], v7 offset:13312
    v_mfma_f32_16x16x32_bf16 v[200:203], a[8:11], a[76:79], v[200:203]
    v_mfma_f32_16x16x32_bf16 v[204:207], a[12:15], a[76:79], v[204:207]
    ds_read_b128 a[116:119], v6 offset:10240
    v_mfma_f32_16x16x32_bf16 v[208:211], a[16:19], a[76:79], v[208:211]
    v_mfma_f32_16x16x32_bf16 v[212:215], a[20:23], a[76:79], v[212:215]
    ds_read_b64_tr_b16 a[52:53], v8 offset:12288
    v_mfma_f32_16x16x32_bf16 v[216:219], a[24:27], a[76:79], v[216:219]
    v_mfma_f32_16x16x32_bf16 v[220:223], a[28:31], a[76:79], v[220:223]
    ds_read_b64_tr_b16 a[54:55], v8 offset:13312
    v_mfma_f32_16x16x32_bf16 v[224:227], a[0:3], a[80:83], v[224:227]
    v_mfma_f32_16x16x32_bf16 v[228:231], a[4:7], a[80:83], v[228:231]
    ds_read_b128 a[120:123], v6 offset:12288
    v_mfma_f32_16x16x32_bf16 v[232:235], a[8:11], a[80:83], v[232:235]
    ds_read_b64_tr_b16 a[56:57], v9 offset:12288
    v_mfma_f32_16x16x32_bf16 v[236:239], a[12:15], a[80:83], v[236:239]
    v_mfma_f32_16x16x32_bf16 v[240:243], a[16:19], a[80:83], v[240:243]
    ds_read_b64_tr_b16 a[58:59], v9 offset:13312
    v_mfma_f32_16x16x32_bf16 v[244:247], a[20:23], a[80:83], v[244:247]
    v_mfma_f32_16x16x32_bf16 v[248:251], a[24:27], a[80:83], v[248:251]
    ds_read_b128 a[124:127], v6 offset:14336
    v_mfma_f32_16x16x32_bf16 v[252:255], a[28:31], a[80:83], v[252:255]
    v_mfma_f32_16x16x32_bf16 a[128:131], a[0:3], a[84:87], a[128:131]
    ds_read_b64_tr_b16 a[60:61], v10 offset:12288
    v_mfma_f32_16x16x32_bf16 a[132:135], a[4:7], a[84:87], a[132:135]
    v_mfma_f32_16x16x32_bf16 a[136:139], a[8:11], a[84:87], a[136:139]
    ds_read_b64_tr_b16 a[62:63], v10 offset:13312
    v_mfma_f32_16x16x32_bf16 a[140:143], a[12:15], a[84:87], a[140:143]
    v_mfma_f32_16x16x32_bf16 a[144:147], a[16:19], a[84:87], a[144:147]
    v_mfma_f32_16x16x32_bf16 a[148:151], a[20:23], a[84:87], a[148:151]
    v_mfma_f32_16x16x32_bf16 a[152:155], a[24:27], a[84:87], a[152:155]
    v_xor_b32 v7, 0x10000, v7
    v_xor_b32 v8, 0x10000, v8
    v_mfma_f32_16x16x32_bf16 a[156:159], a[28:31], a[84:87], a[156:159]
    v_xor_b32 v9, 0x10000, v9
    v_xor_b32 v10, 0x10000, v10
    v_mfma_f32_16x16x32_bf16 a[160:163], a[0:3], a[88:91], a[160:163]
    v_xor_b32 v6, 0x10000, v6
    v_mfma_f32_16x16x32_bf16 a[164:167], a[4:7], a[88:91], a[164:167]
    v_mfma_f32_16x16x32_bf16 a[168:171], a[8:11], a[88:91], a[168:171]
    v_mfma_f32_16x16x32_bf16 a[172:175], a[12:15], a[88:91], a[172:175]
    s_waitcnt lgkmcnt(0)
    v_mfma_f32_16x16x32_bf16 a[176:179], a[16:19], a[88:91], a[176:179]
    s_waitcnt vmcnt(1)
    v_mfma_f32_16x16x32_bf16 a[180:183], a[20:23], a[88:91], a[180:183]
    v_mfma_f32_16x16x32_bf16 a[184:187], a[24:27], a[88:91], a[184:187]
    s_barrier
    v_mfma_f32_16x16x32_bf16 a[188:191], a[28:31], a[88:91], a[188:191]
    v_mfma_f32_16x16x32_bf16 a[192:195], a[0:3], a[92:95], a[192:195]
    buffer_store_dwordx4 v[56:59], v1, s[8:11], s61 offen offset:2048 sc1
    v_mfma_f32_16x16x32_bf16 a[196:199], a[4:7], a[92:95], a[196:199]
    s_add_u32 s61, s61, 1024
    v_mfma_f32_16x16x32_bf16 a[200:203], a[8:11], a[92:95], a[200:203]
    s_add_u32 m0, s42, 0
    v_mfma_f32_16x16x32_bf16 a[204:207], a[12:15], a[92:95], a[204:207]
    s_add_u32 s44, s40, 0
    buffer_load_dwordx4 v2, s[12:15], s44 offen lds
    v_mfma_f32_16x16x32_bf16 a[208:211], a[16:19], a[92:95], a[208:211]
    s_add_u32 s44, s40, 7168
    v_mfma_f32_16x16x32_bf16 a[212:215], a[20:23], a[92:95], a[212:215]
    v_mfma_f32_16x16x32_bf16 a[216:219], a[24:27], a[92:95], a[216:219]
    buffer_load_dwordx4 v2, s[12:15], s44 offen offset:1024 lds
    v_mfma_f32_16x16x32_bf16 a[220:223], a[28:31], a[92:95], a[220:223]
    s_add_u32 s44, s40, 14336
    v_mfma_f32_16x16x32_bf16 v[96:99], a[32:35], a[96:99], v[96:99]
    ds_read_b128 a[64:67], v5 offset:0
    v_mfma_f32_16x16x32_bf16 v[100:103], a[36:39], a[96:99], v[100:103]
    v_mfma_f32_16x16x32_bf16 v[104:107], a[40:43], a[96:99], v[104:107]
    ds_read_b64_tr_b16 a[0:1], v7 offset:0
    buffer_load_dwordx4 v2, s[12:15], s44 offen offset:2048 lds
    v_mfma_f32_16x16x32_bf16 v[108:111], a[44:47], a[96:99], v[108:111]
    s_add_u32 s44, s40, 21504
    v_mfma_f32_16x16x32_bf16 v[112:115], a[48:51], a[96:99], v[112:115]
    ds_read_b64_tr_b16 a[2:3], v7 offset:1024
    v_mfma_f32_16x16x32_bf16 v[116:119], a[52:55], a[96:99], v[116:119]
    v_mfma_f32_16x16x32_bf16 v[120:123], a[56:59], a[96:99], v[120:123]
    ds_read_b128 a[68:71], v5 offset:2048
    buffer_load_dwordx4 v2, s[12:15], s44 offen offset:3072 lds
    v_mfma_f32_16x16x32_bf16 v[124:127], a[60:63], a[96:99], v[124:127]
    s_add_u32 m0, s42, 4096
    v_mfma_f32_16x16x32_bf16 v[128:131], a[32:35], a[100:103], v[128:131]
    s_add_u32 s44, s40, 524288
    v_mfma_f32_16x16x32_bf16 v[132:135], a[36:39], a[100:103], v[132:135]
    ds_read_b64_tr_b16 a[4:5], v8 offset:0
    v_mfma_f32_16x16x32_bf16 v[136:139], a[40:43], a[100:103], v[136:139]
    buffer_load_dwordx4 v2, s[12:15], s44 offen lds
    v_mfma_f32_16x16x32_bf16 v[140:143], a[44:47], a[100:103], v[140:143]
    s_add_u32 s44, s40, 531456
    ds_read_b64_tr_b16 a[6:7], v8 offset:1024
    v_mfma_f32_16x16x32_bf16 v[144:147], a[48:51], a[100:103], v[144:147]
    v_mfma_f32_16x16x32_bf16 v[148:151], a[52:55], a[100:103], v[148:151]
    ds_read_b128 a[72:75], v5 offset:4096
    v_mfma_f32_16x16x32_bf16 v[152:155], a[56:59], a[100:103], v[152:155]
    buffer_load_dwordx4 v2, s[12:15], s44 offen offset:1024 lds
    v_mfma_f32_16x16x32_bf16 v[156:159], a[60:63], a[100:103], v[156:159]
    s_add_u32 s44, s40, 538624
    ds_read_b64_tr_b16 a[8:9], v9 offset:0
    v_mfma_f32_16x16x32_bf16 v[160:163], a[32:35], a[104:107], v[160:163]
    v_mfma_f32_16x16x32_bf16 v[164:167], a[36:39], a[104:107], v[164:167]
    v_mfma_f32_16x16x32_bf16 v[168:171], a[40:43], a[104:107], v[168:171]
    ds_read_b64_tr_b16 a[10:11], v9 offset:1024
    buffer_load_dwordx4 v2, s[12:15], s44 offen offset:2048 lds
    v_mfma_f32_16x16x32_bf16 v[172:175], a[44:47], a[104:107], v[172:175]
    s_add_u32 s44, s40, 545792
    v_mfma_f32_16x16x32_bf16 v[176:179], a[48:51], a[104:107], v[176:179]
    ds_read_b128 a[76:79], v5 offset:6144
    v_mfma_f32_16x16x32_bf16 v[180:183], a[52:55], a[104:107], v[180:183]
    v_mfma_f32_16x16x32_bf16 v[184:187], a[56:59], a[104:107], v[184:187]
    ds_read_b64_tr_b16 a[12:13], v10 offset:0
    buffer_load_dwordx4 v2, s[12:15], s44 offen offset:3072 lds
    v_mfma_f32_16x16x32_bf16 v[188:191], a[60:63], a[104:107], v[188:191]
    s_add_u32 m0, s43, 0
    v_mfma_f32_16x16x32_bf16 v[192:195], a[32:35], a[108:111], v[192:195]
    s_add_u32 s44, s41, 0
    ds_read_b64_tr_b16 a[14:15], v10 offset:1024
    v_mfma_f32_16x16x32_bf16 v[196:199], a[36:39], a[108:111], v[196:199]
    v_mfma_f32_16x16x32_bf16 v[200:203], a[40:43], a[108:111], v[200:203]
    buffer_load_dwordx4 v3, s[16:19], s44 offen lds
    v_mfma_f32_16x16x32_bf16 v[204:207], a[44:47], a[108:111], v[204:207]
    s_add_u32 s44, s41, 31744
    ds_read_b128 a[80:83], v5 offset:8192
    v_mfma_f32_16x16x32_bf16 v[208:211], a[48:51], a[108:111], v[208:211]
    v_mfma_f32_16x16x32_bf16 v[212:215], a[52:55], a[108:111], v[212:215]
    ds_read_b64_tr_b16 a[16:17], v7 offset:4096
    v_mfma_f32_16x16x32_bf16 v[216:219], a[56:59], a[108:111], v[216:219]
    buffer_load_dwordx4 v3, s[16:19], s44 offen offset:1024 lds
    v_mfma_f32_16x16x32_bf16 v[220:223], a[60:63], a[108:111], v[220:223]
    s_add_u32 s44, s41, 129024
    ds_read_b64_tr_b16 a[18:19], v7 offset:5120
    v_mfma_f32_16x16x32_bf16 v[224:227], a[32:35], a[112:115], v[224:227]
    v_mfma_f32_16x16x32_bf16 v[228:231], a[36:39], a[112:115], v[228:231]
    ds_read_b128 a[84:87], v5 offset:10240
    v_mfma_f32_16x16x32_bf16 v[232:235], a[40:43], a[112:115], v[232:235]
    buffer_load_dwordx4 v3, s[16:19], s44 offen offset:2048 lds
    v_mfma_f32_16x16x32_bf16 v[236:239], a[44:47], a[112:115], v[236:239]
    s_add_u32 s44, s41, 160768
    v_mfma_f32_16x16x32_bf16 v[240:243], a[48:51], a[112:115], v[240:243]
    ds_read_b64_tr_b16 a[20:21], v8 offset:4096
    v_mfma_f32_16x16x32_bf16 v[244:247], a[52:55], a[112:115], v[244:247]
    v_mfma_f32_16x16x32_bf16 v[248:251], a[56:59], a[112:115], v[248:251]
    ds_read_b64_tr_b16 a[22:23], v8 offset:5120
    buffer_load_dwordx4 v3, s[16:19], s44 offen offset:3072 lds
    v_mfma_f32_16x16x32_bf16 v[252:255], a[60:63], a[112:115], v[252:255]
    s_add_u32 m0, s43, 4096
    v_mfma_f32_16x16x32_bf16 a[128:131], a[32:35], a[116:119], a[128:131]
    s_add_u32 s44, s41, 128
    ds_read_b128 a[88:91], v5 offset:12288
    v_mfma_f32_16x16x32_bf16 a[132:135], a[36:39], a[116:119], a[132:135]
    v_mfma_f32_16x16x32_bf16 a[136:139], a[40:43], a[116:119], a[136:139]
    ds_read_b64_tr_b16 a[24:25], v9 offset:4096
    buffer_load_dwordx4 v3, s[16:19], s44 offen lds
    v_mfma_f32_16x16x32_bf16 a[140:143], a[44:47], a[116:119], a[140:143]
    s_add_u32 s44, s41, 31872
    v_mfma_f32_16x16x32_bf16 a[144:147], a[48:51], a[116:119], a[144:147]
    v_mfma_f32_16x16x32_bf16 a[148:151], a[52:55], a[116:119], a[148:151]
    ds_read_b64_tr_b16 a[26:27], v9 offset:5120
    v_mfma_f32_16x16x32_bf16 a[152:155], a[56:59], a[116:119], a[152:155]
    buffer_load_dwordx4 v3, s[16:19], s44 offen offset:1024 lds
    v_mfma_f32_16x16x32_bf16 a[156:159], a[60:63], a[116:119], a[156:159]
    s_add_u32 s44, s41, 129152
    ds_read_b128 a[92:95], v5 offset:14336
    v_mfma_f32_16x16x32_bf16 a[160:163], a[32:35], a[120:123], a[160:163]
    v_mfma_f32_16x16x32_bf16 a[164:167], a[36:39], a[120:123], a[164:167]
    ds_read_b64_tr_b16 a[28:29], v10 offset:4096
    v_mfma_f32_16x16x32_bf16 a[168:171], a[40:43], a[120:123], a[168:171]
    buffer_load_dwordx4 v3, s[16:19], s44 offen offset:2048 lds
    v_mfma_f32_16x16x32_bf16 a[172:175], a[44:47], a[120:123], a[172:175]
    s_add_u32 s44, s41, 160896
    ds_read_b64_tr_b16 a[30:31], v10 offset:5120
    v_mfma_f32_16x16x32_bf16 a[176:179], a[48:51], a[120:123], a[176:179]
    v_mfma_f32_16x16x32_bf16 a[180:183], a[52:55], a[120:123], a[180:183]
    v_mfma_f32_16x16x32_bf16 a[184:187], a[56:59], a[120:123], a[184:187]
    buffer_load_dwordx4 v3, s[16:19], s44 offen offset:3072 lds
    v_mfma_f32_16x16x32_bf16 a[188:191], a[60:63], a[120:123], a[188:191]
    v_mfma_f32_16x16x32_bf16 a[192:195], a[32:35], a[124:127], a[192:195]
    v_mfma_f32_16x16x32_bf16 a[196:199], a[36:39], a[124:127], a[196:199]
    v_mfma_f32_16x16x32_bf16 a[200:203], a[40:43], a[124:127], a[200:203]
    buffer_load_dword v13, v14, s[36:39], s51 offen
    v_mfma_f32_16x16x32_bf16 a[204:207], a[44:47], a[124:127], a[204:207]
    s_add_u32 s51, s51, s52
    s_and_b32 s51, s51, 0xffbffbff
    v_mfma_f32_16x16x32_bf16 a[208:211], a[48:51], a[124:127], a[208:211]
    v_mfma_f32_16x16x32_bf16 a[212:215], a[52:55], a[124:127], a[212:215]
    s_cmp_lg_u32 s45, 0
    v_mfma_f32_16x16x32_bf16 a[216:219], a[56:59], a[124:127], a[216:219]
    s_waitcnt lgkmcnt(0)
    v_mfma_f32_16x16x32_bf16 a[220:223], a[60:63], a[124:127], a[220:223]
    s_cbranch_scc1 A_kvl0
    v_mfma_f32_16x16x32_bf16 v[96:99], a[0:3], a[64:67], v[96:99]
    ds_read_b128 a[96:99], v6 offset:0
    buffer_load_dword v62, v60, s[28:31], 0 offen sc1
    v_mfma_f32_16x16x32_bf16 v[100:103], a[4:7], a[64:67], v[100:103]
    ds_read_b64_tr_b16 a[32:33], v7 offset:8192
    v_mfma_f32_16x16x32_bf16 v[104:107], a[8:11], a[64:67], v[104:107]
    v_lshlrev_b32 v42, 16, v42
    v_mfma_f32_16x16x32_bf16 v[108:111], a[12:15], a[64:67], v[108:111]
    ds_read_b64_tr_b16 a[34:35], v7 offset:9216
    buffer_load_dwordx4 v[24:27], v21, s[32:35], s72 offen
    v_mfma_f32_16x16x32_bf16 v[112:115], a[16:19], a[64:67], v[112:115]
    v_mul_f32 v42, 0x3fb8aa3b, v42
    v_mfma_f32_16x16x32_bf16 v[116:119], a[20:23], a[64:67], v[116:119]
    ds_read_b128 a[100:103], v6 offset:2048
    v_mfma_f32_16x16x32_bf16 v[120:123], a[24:27], a[64:67], v[120:123]
    buffer_load_dwordx4 v[28:31], v1, s[20:23], s73 offen
    v_mfma_f32_16x16x32_bf16 v[124:127], a[28:31], a[64:67], v[124:127]
    ds_read_b64_tr_b16 a[36:37], v8 offset:8192
    v_mfma_f32_16x16x32_bf16 v[128:131], a[0:3], a[68:71], v[128:131]
    v_exp_f32 v42, v42
    v_mfma_f32_16x16x32_bf16 v[132:135], a[4:7], a[68:71], v[132:135]
    ds_read_b64_tr_b16 a[38:39], v8 offset:9216
    v_lshlrev_b32 v40, 16, v40
    v_mfma_f32_16x16x32_bf16 v[136:139], a[8:11], a[68:71], v[136:139]
    v_xor_b32 v5, 0x10000, v5
    buffer_load_dwordx4 v[32:35], v1, s[20:23], s73 offen offset:1024
    v_mfma_f32_16x16x32_bf16 v[140:143], a[12:15], a[68:71], v[140:143]
    s_xor_b32 s42, s42, 0x10000
    ds_read_b128 a[104:107], v6 offset:4096
    v_lshlrev_b32 v41, 16, v41
    v_mfma_f32_16x16x32_bf16 v[144:147], a[16:19], a[68:71], v[144:147]
    s_mov_b32 s32, s78
    ds_read_b64_tr_b16 a[40:41], v9 offset:8192
    v_cvt_pk_bf16_f32 v42, v42, v42
    v_mfma_f32_16x16x32_bf16 v[148:151], a[20:23], a[68:71], v[148:151]
    s_mov_b32 s33, s79
    v_lshlrev_b32 v42, 16, v42
    v_mfma_f32_16x16x32_bf16 v[152:155], a[24:27], a[68:71], v[152:155]
    s_mov_b32 s36, s80
    ds_read_b64_tr_b16 a[42:43], v9 offset:9216
    v_mul_f32 v44, v42, v40
    v_mfma_f32_16x16x32_bf16 v[156:159], a[28:31], a[68:71], v[156:159]
    s_mov_b32 s37, s81
    v_mul_f32 v45, v42, v41
    v_mfma_f32_16x16x32_bf16 v[160:163], a[0:3], a[72:75], v[160:163]
    s_mov_b32 s38, 0x80000
    ds_read_b128 a[108:111], v6 offset:6144
    v_mul_f32 v44, 0x3fb8aa3b, v44
    v_mfma_f32_16x16x32_bf16 v[164:167], a[4:7], a[72:75], v[164:167]
    s_lshl_b32 s6, s4, 14
    v_mul_f32 v45, 0.15915494, v45
    v_mfma_f32_16x16x32_bf16 v[168:171], a[8:11], a[72:75], v[168:171]
    s_lshl_b32 s7, s3, 8
    ds_read_b64_tr_b16 a[44:45], v10 offset:8192
    v_mul_f32 v50, 1.0, v44
    v_mfma_f32_16x16x32_bf16 v[172:175], a[12:15], a[72:75], v[172:175]
    s_add_u32 s6, s6, s7
    v_mul_f32 v51, 1.0, v45
    v_mfma_f32_16x16x32_bf16 v[176:179], a[16:19], a[72:75], v[176:179]
    s_add_u32 m0, s42, 131072
    ds_read_b64_tr_b16 a[46:47], v10 offset:9216
    v_mfma_f32_16x16x32_bf16 v[180:183], a[20:23], a[72:75], v[180:183]
    s_add_u32 s44, s6, 0
    buffer_load_dwordx4 v2, s[32:35], s44 offen lds
    v_mfma_f32_16x16x32_bf16 v[184:187], a[24:27], a[72:75], v[184:187]
    s_add_u32 s44, s6, 7168
    ds_read_b128 a[112:115], v6 offset:8192
    buffer_load_dwordx4 v2, s[32:35], s44 offen offset:1024 lds
    v_mfma_f32_16x16x32_bf16 v[188:191], a[28:31], a[72:75], v[188:191]
    s_add_u32 m0, s42, 133120
    ds_read_b64_tr_b16 a[48:49], v7 offset:12288
    v_mfma_f32_16x16x32_bf16 v[192:195], a[0:3], a[76:79], v[192:195]
    s_add_u32 s44, s6, 0
    buffer_load_dwordx4 v2, s[36:39], s44 offen lds
    v_mfma_f32_16x16x32_bf16 v[196:199], a[4:7], a[76:79], v[196:199]
    s_add_u32 s44, s6, 7168
    ds_read_b64_tr_b16 a[50:51], v7 offset:13312
    buffer_load_dwordx4 v2, s[36:39], s44 offen offset:1024 lds
    v_mfma_f32_16x16x32_bf16 v[200:203], a[8:11], a[76:79], v[200:203]
    s_add_u32 m0, s42, 135168
    v_exp_f32 v50, v50
    v_mfma_f32_16x16x32_bf16 v[204:207], a[12:15], a[76:79], v[204:207]
    s_add_u32 s44, s6, 128
    ds_read_b128 a[116:119], v6 offset:10240
    buffer_load_dwordx4 v2, s[32:35], s44 offen lds
    v_mfma_f32_16x16x32_bf16 v[208:211], a[16:19], a[76:79], v[208:211]
    s_add_u32 s44, s6, 7296
    v_fract_f32 v51, v51
    v_mfma_f32_16x16x32_bf16 v[212:215], a[20:23], a[76:79], v[212:215]
    ds_read_b64_tr_b16 a[52:53], v8 offset:12288
    v_mfma_f32_16x16x32_bf16 v[216:219], a[24:27], a[76:79], v[216:219]
    buffer_load_dwordx4 v2, s[32:35], s44 offen offset:1024 lds
    v_mfma_f32_16x16x32_bf16 v[220:223], a[28:31], a[76:79], v[220:223]
    s_add_u32 m0, s42, 137216
    ds_read_b64_tr_b16 a[54:55], v8 offset:13312
    v_mfma_f32_16x16x32_bf16 v[224:227], a[0:3], a[80:83], v[224:227]
    s_add_u32 s44, s6, 128
    v_cos_f32 v48, v51
    v_mfma_f32_16x16x32_bf16 v[228:231], a[4:7], a[80:83], v[228:231]
    ds_read_b128 a[120:123], v6 offset:12288
    buffer_load_dwordx4 v2, s[36:39], s44 offen lds
    v_mfma_f32_16x16x32_bf16 v[232:235], a[8:11], a[80:83], v[232:235]
    s_add_u32 s44, s6, 7296
    ds_read_b64_tr_b16 a[56:57], v9 offset:12288
    v_mfma_f32_16x16x32_bf16 v[236:239], a[12:15], a[80:83], v[236:239]
    v_sin_f32 v49, v51
    v_mfma_f32_16x16x32_bf16 v[240:243], a[16:19], a[80:83], v[240:243]
    ds_read_b64_tr_b16 a[58:59], v9 offset:13312
    buffer_load_dwordx4 v2, s[36:39], s44 offen offset:1024 lds
    v_mfma_f32_16x16x32_bf16 v[244:247], a[20:23], a[80:83], v[244:247]
    s_mov_b32 s32, s70
    v_mul_f32 v48, v48, v50
    v_mfma_f32_16x16x32_bf16 v[248:251], a[24:27], a[80:83], v[248:251]
    s_mov_b32 s33, s71
    ds_read_b128 a[124:127], v6 offset:14336
    v_mul_f32 v49, v49, v50
    v_mfma_f32_16x16x32_bf16 v[252:255], a[28:31], a[80:83], v[252:255]
    s_mov_b32 s34, 0x400000
    v_accvgpr_write_b32 a240, v48
    v_mfma_f32_16x16x32_bf16 a[128:131], a[0:3], a[84:87], a[128:131]
    s_lshl_b32 s6, s4, 17
    ds_read_b64_tr_b16 a[60:61], v10 offset:12288
    v_accvgpr_write_b32 a241, v49
    v_mfma_f32_16x16x32_bf16 a[132:135], a[4:7], a[84:87], a[132:135]
    s_lshl_b32 s7, s3, 15
    v_add_f32 v48, -1.0, v48
    v_mfma_f32_16x16x32_bf16 a[136:139], a[8:11], a[84:87], a[136:139]
    s_add_u32 s6, s6, s7
    ds_read_b64_tr_b16 a[62:63], v10 offset:13312
    v_mul_f32 v52, v40, v40
    v_mfma_f32_16x16x32_bf16 a[140:143], a[12:15], a[84:87], a[140:143]
    s_lshl_b32 s7, s5, 7
    v_fma_f32 v52, v41, v41, v52
    v_mfma_f32_16x16x32_bf16 a[144:147], a[16:19], a[84:87], a[144:147]
    s_add_u32 s6, s6, s7
    v_rcp_f32 v52, v52
    v_mfma_f32_16x16x32_bf16 a[148:151], a[20:23], a[84:87], a[148:151]
    v_mul_f32 v53, v48, v40
    v_mfma_f32_16x16x32_bf16 a[152:155], a[24:27], a[84:87], a[152:155]
    v_xor_b32 v7, 0x10000, v7
    v_xor_b32 v8, 0x10000, v8
    v_mfma_f32_16x16x32_bf16 a[156:159], a[28:31], a[84:87], a[156:159]
    v_xor_b32 v9, 0x10000, v9
    v_xor_b32 v10, 0x10000, v10
    v_mfma_f32_16x16x32_bf16 a[160:163], a[0:3], a[88:91], a[160:163]
    v_xor_b32 v6, 0x10000, v6
    v_fma_f32 v53, v49, v41, v53
    v_mfma_f32_16x16x32_bf16 a[164:167], a[4:7], a[88:91], a[164:167]
    v_mul_f32 v54, v49, v40
    v_mfma_f32_16x16x32_bf16 a[168:171], a[8:11], a[88:91], a[168:171]
    v_fma_f32 v54, -v48, v41, v54
    v_mfma_f32_16x16x32_bf16 a[172:175], a[12:15], a[88:91], a[172:175]
    s_waitcnt lgkmcnt(0)
    v_mul_f32 v52, -2.0, v52
    v_mfma_f32_16x16x32_bf16 a[176:179], a[16:19], a[88:91], a[176:179]
    s_waitcnt vmcnt(13)
    v_mfma_f32_16x16x32_bf16 a[180:183], a[20:23], a[88:91], a[180:183]
    v_mfma_f32_16x16x32_bf16 a[184:187], a[24:27], a[88:91], a[184:187]
    s_barrier
    v_mfma_f32_16x16x32_bf16 a[188:191], a[28:31], a[88:91], a[188:191]
    s_add_u32 m0, s55, 0
    v_mfma_f32_16x16x32_bf16 a[192:195], a[0:3], a[92:95], a[192:195]
    s_add_u32 s44, s54, 0
    buffer_load_dwordx4 v3, s[24:27], s44 offen lds
    v_mul_f32 v53, v53, v52
    v_mfma_f32_16x16x32_bf16 a[196:199], a[4:7], a[92:95], a[196:199]
    s_add_u32 s44, s54, 31744
    v_mul_f32 v54, v54, v52
    v_mfma_f32_16x16x32_bf16 a[200:203], a[8:11], a[92:95], a[200:203]
    v_accvgpr_write_b32 a246, v53
    v_mfma_f32_16x16x32_bf16 a[204:207], a[12:15], a[92:95], a[204:207]
    buffer_load_dwordx4 v3, s[24:27], s44 offen offset:1024 lds
    v_accvgpr_write_b32 a247, v54
    v_mfma_f32_16x16x32_bf16 a[208:211], a[16:19], a[92:95], a[208:211]
    s_add_u32 s44, s54, 129024
    v_mul_f32 v50, 0x41000000, v44
    v_mfma_f32_16x16x32_bf16 a[212:215], a[20:23], a[92:95], a[212:215]
    v_mul_f32 v51, 0x41000000, v45
    v_mfma_f32_16x16x32_bf16 a[216:219], a[24:27], a[92:95], a[216:219]
    v_exp_f32 v50, v50
    v_mfma_f32_16x16x32_bf16 a[220:223], a[28:31], a[92:95], a[220:223]
    buffer_load_dwordx4 v3, s[24:27], s44 offen offset:2048 lds
    v_fract_f32 v51, v51
    v_mfma_f32_16x16x32_bf16 v[96:99], a[32:35], a[96:99], v[96:99]
    s_add_u32 s44, s54, 160768
    ds_read_b128 a[64:67], v5 offset:0
    v_mfma_f32_16x16x32_bf16 v[100:103], a[36:39], a[96:99], v[100:103]
    v_cos_f32 v48, v51
    v_mfma_f32_16x16x32_bf16 v[104:107], a[40:43], a[96:99], v[104:107]
    ds_read_b64_tr_b16 a[0:1], v7 offset:0
    v_mfma_f32_16x16x32_bf16 v[108:111], a[44:47], a[96:99], v[108:111]
    v_sin_f32 v49, v51
    v_mfma_f32_16x16x32_bf16 v[112:115], a[48:51], a[96:99], v[112:115]
    ds_read_b64_tr_b16 a[2:3], v7 offset:1024
    buffer_load_dwordx4 v3, s[24:27], s44 offen offset:3072 lds
    v_mfma_f32_16x16x32_bf16 v[116:119], a[52:55], a[96:99], v[116:119]
    s_add_u32 m0, s42, 0
    v_mul_f32 v48, v48, v50
    v_mfma_f32_16x16x32_bf16 v[120:123], a[56:59], a[96:99], v[120:123]
    s_add_u32 s44, s53, 0
    ds_read_b128 a[68:71], v5 offset:2048
    v_mul_f32 v49, v49, v50
    v_mfma_f32_16x16x32_bf16 v[124:127], a[60:63], a[96:99], v[124:127]
    v_accvgpr_write_b32 a242, v48
    v_mfma_f32_16x16x32_bf16 v[128:131], a[32:35], a[100:103], v[128:131]
    buffer_load_dwordx4 v4, s[20:23], s44 offen lds
    v_accvgpr_write_b32 a243, v49
    v_mfma_f32_16x16x32_bf16 v[132:135], a[36:39], a[100:103], v[132:135]
    s_add_u32 s44, s53, 15360
    ds_read_b64_tr_b16 a[4:5], v8 offset:0
    v_mul_f32 v50, 0x43000000, v44
    v_mfma_f32_16x16x32_bf16 v[136:139], a[40:43], a[100:103], v[136:139]
    v_mul_f32 v51, 0x43000000, v45
    v_mfma_f32_16x16x32_bf16 v[140:143], a[44:47], a[100:103], v[140:143]
    ds_read_b64_tr_b16 a[6:7], v8 offset:1024
    v_mfma_f32_16x16x32_bf16 v[144:147], a[48:51], a[100:103], v[144:147]
    v_exp_f32 v50, v50
    v_mfma_f32_16x16x32_bf16 v[148:151], a[52:55], a[100:103], v[148:151]
    ds_read_b128 a[72:75], v5 offset:4096
    buffer_load_dwordx4 v4, s[20:23], s44 offen offset:1024 lds
    v_mfma_f32_16x16x32_bf16 v[152:155], a[56:59], a[100:103], v[152:155]
    s_add_u32 s44, s53, 2048
    v_fract_f32 v51, v51
    v_mfma_f32_16x16x32_bf16 v[156:159], a[60:63], a[100:103], v[156:159]
    ds_read_b64_tr_b16 a[8:9], v9 offset:0
    v_mfma_f32_16x16x32_bf16 v[160:163], a[32:35], a[104:107], v[160:163]
    v_cos_f32 v48, v51
    v_mfma_f32_16x16x32_bf16 v[164:167], a[36:39], a[104:107], v[164:167]
    buffer_load_dwordx4 v4, s[20:23], s44 offen offset:2048 lds
    v_mfma_f32_16x16x32_bf16 v[168:171], a[40:43], a[104:107], v[168:171]
    s_add_u32 s44, s53, 17408
    ds_read_b64_tr_b16 a[10:11], v9 offset:1024
    v_mfma_f32_16x16x32_bf16 v[172:175], a[44:47], a[104:107], v[172:175]
    v_sin_f32 v49, v51
    v_mfma_f32_16x16x32_bf16 v[176:179], a[48:51], a[104:107], v[176:179]
    ds_read_b128 a[76:79], v5 offset:6144
    v_mul_f32 v48, v48, v50
    v_mfma_f32_16x16x32_bf16 v[180:183], a[52:55], a[104:107], v[180:183]
    v_mul_f32 v49, v49, v50
    v_mfma_f32_16x16x32_bf16 v[184:187], a[56:59], a[104:107], v[184:187]
    ds_read_b64_tr_b16 a[12:13], v10 offset:0
    buffer_load_dwordx4 v4, s[20:23], s44 offen offset:3072 lds
    v_mfma_f32_16x16x32_bf16 v[188:191], a[60:63], a[104:107], v[188:191]
    s_add_u32 m0, s42, 4096
    v_accvgpr_write_b32 a244, v48
    v_mfma_f32_16x16x32_bf16 v[192:195], a[32:35], a[108:111], v[192:195]
    s_add_u32 s44, s47, 0
    ds_read_b64_tr_b16 a[14:15], v10 offset:1024
    v_accvgpr_write_b32 a245, v49
    v_mfma_f32_16x16x32_bf16 v[196:199], a[36:39], a[108:111], v[196:199]
    v_lshl_add_u32 v52, s3, 2, v20
    v_mfma_f32_16x16x32_bf16 v[200:203], a[40:43], a[108:111], v[200:203]
    buffer_load_dwordx4 v4, s[20:23], s44 offen lds
    v_xor_b32 v53, 12, v52
    v_mfma_f32_16x16x32_bf16 v[204:207], a[44:47], a[108:111], v[204:207]
    s_add_u32 s44, s47, 15360
    ds_read_b128 a[80:83], v5 offset:8192
    v_lshlrev_b32 v52, 3, v52
    v_mfma_f32_16x16x32_bf16 v[208:211], a[48:51], a[108:111], v[208:211]
    v_lshlrev_b32 v53, 3, v53
    v_mfma_f32_16x16x32_bf16 v[212:215], a[52:55], a[108:111], v[212:215]
    ds_read_b64_tr_b16 a[16:17], v7 offset:4096
    v_cvt_f32_u32 v52, v52
    v_mfma_f32_16x16x32_bf16 v[216:219], a[56:59], a[108:111], v[216:219]
    buffer_load_dwordx4 v4, s[20:23], s44 offen offset:1024 lds
    v_cvt_f32_u32 v53, v53
    v_mfma_f32_16x16x32_bf16 v[220:223], a[60:63], a[108:111], v[220:223]
    s_add_u32 s44, s47, 2048
    ds_read_b64_tr_b16 a[18:19], v7 offset:5120
    v_mul_f32 v50, v52, v44
    v_mfma_f32_16x16x32_bf16 v[224:227], a[32:35], a[112:115], v[224:227]
    v_mul_f32 v51, v52, v45
    v_mfma_f32_16x16x32_bf16 v[228:231], a[36:39], a[112:115], v[228:231]
    ds_read_b128 a[84:87], v5 offset:10240
    v_mfma_f32_16x16x32_bf16 v[232:235], a[40:43], a[112:115], v[232:235]
    v_exp_f32 v50, v50
    v_mfma_f32_16x16x32_bf16 v[236:239], a[44:47], a[112:115], v[236:239]
    buffer_load_dwordx4 v4, s[20:23], s44 offen offset:2048 lds
    v_fract_f32 v51, v51
    v_mfma_f32_16x16x32_bf16 v[240:243], a[48:51], a[112:115], v[240:243]
    s_add_u32 s44, s47, 17408
    ds_read_b64_tr_b16 a[20:21], v8 offset:4096
    v_mfma_f32_16x16x32_bf16 v[244:247], a[52:55], a[112:115], v[244:247]
    v_cos_f32 v48, v51
    v_mfma_f32_16x16x32_bf16 v[248:251], a[56:59], a[112:115], v[248:251]
    ds_read_b64_tr_b16 a[22:23], v8 offset:5120
    v_mfma_f32_16x16x32_bf16 v[252:255], a[60:63], a[112:115], v[252:255]
    buffer_load_dwordx4 v4, s[20:23], s44 offen offset:3072 lds
    v_mfma_f32_16x16x32_bf16 a[128:131], a[32:35], a[116:119], a[128:131]
    s_add_u32 m0, s55, 0x4000
    ds_read_b128 a[88:91], v5 offset:12288
    v_mfma_f32_16x16x32_bf16 a[132:135], a[36:39], a[116:119], a[132:135]
    s_add_u32 s44, s6, 0
    v_sin_f32 v49, v51
    v_mfma_f32_16x16x32_bf16 a[136:139], a[40:43], a[116:119], a[136:139]
    ds_read_b64_tr_b16 a[24:25], v9 offset:4096
    v_mul_f32 v48, v48, v50
    v_mfma_f32_16x16x32_bf16 a[140:143], a[44:47], a[116:119], a[140:143]
    v_mul_f32 v49, v49, v50
    v_mfma_f32_16x16x32_bf16 a[144:147], a[48:51], a[116:119], a[144:147]
    buffer_load_dwordx4 v2, s[32:35], s44 offen lds
    v_accvgpr_write_b32 a248, v48
    v_mfma_f32_16x16x32_bf16 a[148:151], a[52:55], a[116:119], a[148:151]
    s_add_u32 s44, s6, 15360
    ds_read_b64_tr_b16 a[26:27], v9 offset:5120
    v_accvgpr_write_b32 a249, v49
    v_mfma_f32_16x16x32_bf16 a[152:155], a[56:59], a[116:119], a[152:155]
    v_mul_f32 v50, v53, v44
    v_mfma_f32_16x16x32_bf16 a[156:159], a[60:63], a[116:119], a[156:159]
    ds_read_b128 a[92:95], v5 offset:14336
    v_mul_f32 v51, v53, v45
    v_mfma_f32_16x16x32_bf16 a[160:163], a[32:35], a[120:123], a[160:163]
    buffer_load_dwordx4 v2, s[32:35], s44 offen offset:1024 lds
    v_mfma_f32_16x16x32_bf16 a[164:167], a[36:39], a[120:123], a[164:167]
    s_add_u32 s44, s6, 6144
    ds_read_b64_tr_b16 a[28:29], v10 offset:4096
    v_mfma_f32_16x16x32_bf16 a[168:171], a[40:43], a[120:123], a[168:171]
    v_exp_f32 v50, v50
    v_mfma_f32_16x16x32_bf16 a[172:175], a[44:47], a[120:123], a[172:175]
    ds_read_b64_tr_b16 a[30:31], v10 offset:5120
    v_fract_f32 v51, v51
    v_mfma_f32_16x16x32_bf16 a[176:179], a[48:51], a[120:123], a[176:179]
    v_cos_f32 v48, v51
    v_mfma_f32_16x16x32_bf16 a[180:183], a[52:55], a[120:123], a[180:183]
    buffer_load_dwordx4 v2, s[32:35], s44 offen offset:2048 lds
    v_mfma_f32_16x16x32_bf16 a[184:187], a[56:59], a[120:123], a[184:187]
    s_add_u32 s44, s6, 21504
    v_sin_f32 v49, v51
    v_mfma_f32_16x16x32_bf16 a[188:191], a[60:63], a[120:123], a[188:191]
    v_mul_f32 v48, v48, v50
    v_mfma_f32_16x16x32_bf16 a[192:195], a[32:35], a[124:127], a[192:195]
    v_mul_f32 v49, v49, v50
    v_mfma_f32_16x16x32_bf16 a[196:199], a[36:39], a[124:127], a[196:199]
    buffer_load_dwordx4 v2, s[32:35], s44 offen offset:3072 lds
    v_accvgpr_write_b32 a250, v48
    v_mfma_f32_16x16x32_bf16 a[200:203], a[40:43], a[124:127], a[200:203]
    v_accvgpr_write_b32 a251, v49
    v_mfma_f32_16x16x32_bf16 a[204:207], a[44:47], a[124:127], a[204:207]
    v_mfma_f32_16x16x32_bf16 a[208:211], a[48:51], a[124:127], a[208:211]
    v_mfma_f32_16x16x32_bf16 a[212:215], a[52:55], a[124:127], a[212:215]
    v_mfma_f32_16x16x32_bf16 a[216:219], a[56:59], a[124:127], a[216:219]
    v_mfma_f32_16x16x32_bf16 a[220:223], a[60:63], a[124:127], a[220:223]
    s_waitcnt lgkmcnt(0)
    v_mfma_f32_16x16x32_bf16 v[96:99], a[0:3], a[64:67], v[96:99]
    s_waitcnt vmcnt(24)
    ds_read_b128 a[96:99], v6 offset:0
    v_mov_b32 v16, 0
    v_mfma_f32_16x16x32_bf16 v[100:103], a[4:7], a[64:67], v[100:103]
    s_and_b32 s6, s2, 7
    ds_read_b64_tr_b16 a[32:33], v7 offset:8192
    v_mov_b32 v17, 0
    v_mfma_f32_16x16x32_bf16 v[104:107], a[8:11], a[64:67], v[104:107]
    s_mul_i32 s6, s6, 160
    v_dot2_f32_bf16 v16, v28, v36, v16
    v_mfma_f32_16x16x32_bf16 v[108:111], a[12:15], a[64:67], v[108:111]
    s_lshr_b32 s7, s2, 6
    ds_read_b64_tr_b16 a[34:35], v7 offset:9216
    v_dot2_f32_bf16 v17, v32, v36, v17
    v_mfma_f32_16x16x32_bf16 v[112:115], a[16:19], a[64:67], v[112:115]
    s_mul_i32 s7, s7, 40
    v_dot2_f32_bf16 v16, v29, v37, v16
    v_mfma_f32_16x16x32_bf16 v[116:119], a[20:23], a[64:67], v[116:119]
    s_add_u32 s6, s6, s7
    ds_read_b128 a[100:103], v6 offset:2048
    v_dot2_f32_bf16 v17, v33, v37, v17
    v_mfma_f32_16x16x32_bf16 v[120:123], a[24:27], a[64:67], v[120:123]
    s_add_u32 s6, s6, s5
    v_dot2_f32_bf16 v16, v30, v38, v16
    v_mfma_f32_16x16x32_bf16 v[124:127], a[28:31], a[64:67], v[124:127]
    s_lshl_b32 s6, s6, 2
    ds_read_b64_tr_b16 a[36:37], v8 offset:8192
    v_dot2_f32_bf16 v17, v34, v38, v17
    v_mfma_f32_16x16x32_bf16 v[128:131], a[0:3], a[68:71], v[128:131]
    s_add_u32 s6, s6, s3
    v_dot2_f32_bf16 v16, v31, v39, v16
    v_mfma_f32_16x16x32_bf16 v[132:135], a[4:7], a[68:71], v[132:135]
    s_lshl_b32 s6, s6, 10
    ds_read_b64_tr_b16 a[38:39], v8 offset:9216
    v_dot2_f32_bf16 v17, v35, v39, v17
    v_mfma_f32_16x16x32_bf16 v[136:139], a[8:11], a[68:71], v[136:139]
    s_add_u32 s6, s6, 55705600
    v_add_u32 v5, s56, v5
    buffer_store_dwordx4 v[24:27], v1, s[8:11], s6 offen sc1
    v_mfma_f32_16x16x32_bf16 v[140:143], a[12:15], a[68:71], v[140:143]
    ds_read_b128 a[104:107], v6 offset:4096
    v_and_b32 v36, 1, v0
    v_mfma_f32_16x16x32_bf16 v[144:147], a[16:19], a[68:71], v[144:147]
    ds_read_b64_tr_b16 a[40:41], v9 offset:8192
    v_cmp_eq_u32 vcc, 0, v36
    v_mfma_f32_16x16x32_bf16 v[148:151], a[20:23], a[68:71], v[148:151]
    v_lshlrev_b32 v36, 2, v36
    v_mfma_f32_16x16x32_bf16 v[152:155], a[24:27], a[68:71], v[152:155]
    ds_read_b64_tr_b16 a[42:43], v9 offset:9216
    v_add_f32_dpp v16, v16, v16 row_ror:8 row_mask:0xf bank_mask:0xf
    v_mfma_f32_16x16x32_bf16 v[156:159], a[28:31], a[68:71], v[156:159]
    v_add_f32_dpp v17, v17, v17 row_ror:8 row_mask:0xf bank_mask:0xf
    v_mfma_f32_16x16x32_bf16 v[160:163], a[0:3], a[72:75], v[160:163]
    ds_read_b128 a[108:111], v6 offset:6144
    v_add_f32_dpp v16, v16, v16 row_ror:4 row_mask:0xf bank_mask:0xf
    v_mfma_f32_16x16x32_bf16 v[164:167], a[4:7], a[72:75], v[164:167]
    v_add_f32_dpp v17, v17, v17 row_ror:4 row_mask:0xf bank_mask:0xf
    v_mfma_f32_16x16x32_bf16 v[168:171], a[8:11], a[72:75], v[168:171]
    ds_read_b64_tr_b16 a[44:45], v10 offset:8192
    v_add_f32_dpp v16, v16, v16 row_ror:2 row_mask:0xf bank_mask:0xf
    v_mfma_f32_16x16x32_bf16 v[172:175], a[12:15], a[72:75], v[172:175]
    v_add_f32_dpp v17, v17, v17 row_ror:2 row_mask:0xf bank_mask:0xf
    v_mfma_f32_16x16x32_bf16 v[176:179], a[16:19], a[72:75], v[176:179]
    ds_read_b64_tr_b16 a[46:47], v10 offset:9216
    v_add_f32_dpp v16, v16, v16 row_ror:1 row_mask:0xf bank_mask:0xf
    v_mfma_f32_16x16x32_bf16 v[180:183], a[20:23], a[72:75], v[180:183]
    v_add_f32_dpp v17, v17, v17 row_ror:1 row_mask:0xf bank_mask:0xf
    v_mfma_f32_16x16x32_bf16 v[184:187], a[24:27], a[72:75], v[184:187]
    ds_read_b128 a[112:115], v6 offset:8192
    v_cndmask_b32 v16, v17, v16, vcc
    v_mfma_f32_16x16x32_bf16 v[188:191], a[28:31], a[72:75], v[188:191]
    ds_read_b64_tr_b16 a[48:49], v7 offset:12288
    v_mov_b32 v28, v16
    v_mfma_f32_16x16x32_bf16 v[192:195], a[0:3], a[76:79], v[192:195]
    v_mfma_f32_16x16x32_bf16 v[196:199], a[4:7], a[76:79], v[196:199]
    ds_read_b64_tr_b16 a[50:51], v7 offset:13312
    v_permlane16_swap_b32 v16, v28
    v_mfma_f32_16x16x32_bf16 v[200:203], a[8:11], a[76:79], v[200:203]
    v_add_f32 v16, v16, v28
    v_mfma_f32_16x16x32_bf16 v[204:207], a[12:15], a[76:79], v[204:207]
    ds_read_b128 a[116:119], v6 offset:10240
    v_mov_b32 v28, v16
    v_mfma_f32_16x16x32_bf16 v[208:211], a[16:19], a[76:79], v[208:211]
    v_mfma_f32_16x16x32_bf16 v[212:215], a[20:23], a[76:79], v[212:215]
    ds_read_b64_tr_b16 a[52:53], v8 offset:12288
    v_permlane32_swap_b32 v16, v28
    v_mfma_f32_16x16x32_bf16 v[216:219], a[24:27], a[76:79], v[216:219]
    v_add_f32 v16, v16, v28
    v_mfma_f32_16x16x32_bf16 v[220:223], a[28:31], a[76:79], v[220:223]
    ds_read_b64_tr_b16 a[54:55], v8 offset:13312
    v_mul_f32 v16, 0xbfb8aa3b, v16
    v_mfma_f32_16x16x32_bf16 v[224:227], a[0:3], a[80:83], v[224:227]
    v_exp_f32 v16, v16
    v_mfma_f32_16x16x32_bf16 v[228:231], a[4:7], a[80:83], v[228:231]
    ds_read_b128 a[120:123], v6 offset:12288
    v_add_f32 v16, 1.0, v16
    v_mfma_f32_16x16x32_bf16 v[232:235], a[8:11], a[80:83], v[232:235]
    ds_read_b64_tr_b16 a[56:57], v9 offset:12288
    v_mfma_f32_16x16x32_bf16 v[236:239], a[12:15], a[80:83], v[236:239]
    v_rcp_f32 v16, v16
    v_mfma_f32_16x16x32_bf16 v[240:243], a[16:19], a[80:83], v[240:243]
    s_lshl_b32 s6, s2, 5
    ds_read_b64_tr_b16 a[58:59], v9 offset:13312
    v_mfma_f32_16x16x32_bf16 v[244:247], a[20:23], a[80:83], v[244:247]
    s_lshl_b32 s7, s3, 3
    v_mfma_f32_16x16x32_bf16 v[248:251], a[24:27], a[80:83], v[248:251]
    s_add_u32 s6, s6, s7
    ds_read_b128 a[124:127], v6 offset:14336
    v_mfma_f32_16x16x32_bf16 v[252:255], a[28:31], a[80:83], v[252:255]
    s_add_u32 s6, s6, 60817408
    buffer_store_dword v16, v36, s[8:11], s6 offen sc1
    v_mfma_f32_16x16x32_bf16 a[128:131], a[0:3], a[84:87], a[128:131]
    s_lshl_b32 s6, s96, 5
    ds_read_b64_tr_b16 a[60:61], v10 offset:12288
    v_mfma_f32_16x16x32_bf16 a[132:135], a[4:7], a[84:87], a[132:135]
    s_add_u32 s6, s6, s4
    v_mfma_f32_16x16x32_bf16 a[136:139], a[8:11], a[84:87], a[136:139]
    s_lshl_b32 s6, s6, 7
    ds_read_b64_tr_b16 a[62:63], v10 offset:13312
    v_mfma_f32_16x16x32_bf16 a[140:143], a[12:15], a[84:87], a[140:143]
    s_add_u32 s43, s6, 61145088
    buffer_store_dword v46, off, s[8:11], s43 sc1
    v_mfma_f32_16x16x32_bf16 a[144:147], a[16:19], a[84:87], a[144:147]
    v_lshlrev_b32 v61, 11, v61
    v_mfma_f32_16x16x32_bf16 a[148:151], a[20:23], a[84:87], a[148:151]
    v_lshlrev_b32 v62, 8, v62
    v_mfma_f32_16x16x32_bf16 a[152:155], a[24:27], a[84:87], a[152:155]
    v_add_u32 v7, s57, v7
    v_add_u32 v8, s57, v8
    v_mfma_f32_16x16x32_bf16 a[156:159], a[28:31], a[84:87], a[156:159]
    v_add_u32 v9, s57, v9
    v_add_u32 v10, s57, v10
    v_mfma_f32_16x16x32_bf16 a[160:163], a[0:3], a[88:91], a[160:163]
    v_add_u32 v6, s56, v6
    v_xor_b32 v62, v62, v61
    v_mfma_f32_16x16x32_bf16 a[164:167], a[4:7], a[88:91], a[164:167]
    v_mfma_f32_16x16x32_bf16 a[168:171], a[8:11], a[88:91], a[168:171]
    v_readfirstlane_b32 s57, v62
    v_mfma_f32_16x16x32_bf16 a[172:175], a[12:15], a[88:91], a[172:175]
    s_waitcnt lgkmcnt(0)
    v_mfma_f32_16x16x32_bf16 a[176:179], a[16:19], a[88:91], a[176:179]
    s_waitcnt vmcnt(7)
    v_mfma_f32_16x16x32_bf16 a[180:183], a[20:23], a[88:91], a[180:183]
    v_mfma_f32_16x16x32_bf16 a[184:187], a[24:27], a[88:91], a[184:187]
    s_barrier
    v_mfma_f32_16x16x32_bf16 a[188:191], a[28:31], a[88:91], a[188:191]
    s_add_u32 m0, s55, 65536
    v_mfma_f32_16x16x32_bf16 a[192:195], a[0:3], a[92:95], a[192:195]
    s_add_u32 s44, s54, 524288
    buffer_load_dwordx4 v3, s[24:27], s44 offen lds
    v_mfma_f32_16x16x32_bf16 a[196:199], a[4:7], a[92:95], a[196:199]
    s_add_u32 s44, s54, 556032
    v_mfma_f32_16x16x32_bf16 a[200:203], a[8:11], a[92:95], a[200:203]
    v_mfma_f32_16x16x32_bf16 a[204:207], a[12:15], a[92:95], a[204:207]
    buffer_load_dwordx4 v3, s[24:27], s44 offen offset:1024 lds
    v_mfma_f32_16x16x32_bf16 a[208:211], a[16:19], a[92:95], a[208:211]
    s_add_u32 s44, s54, 653312
    v_mfma_f32_16x16x32_bf16 a[212:215], a[20:23], a[92:95], a[212:215]
    s_add_u32 s6, s46, 0
    v_mfma_f32_16x16x32_bf16 a[216:219], a[24:27], a[92:95], a[216:219]
    v_mfma_f32_16x16x32_bf16 a[220:223], a[28:31], a[92:95], a[220:223]
    buffer_load_dwordx4 v3, s[24:27], s44 offen offset:2048 lds
    v_mfma_f32_16x16x32_bf16 v[96:99], a[32:35], a[96:99], v[96:99]
    s_add_u32 s44, s54, 685056
    ds_read_b128 a[64:67], v5 offset:0
    v_mfma_f32_16x16x32_bf16 v[100:103], a[36:39], a[96:99], v[100:103]
    v_mfma_f32_16x16x32_bf16 v[104:107], a[40:43], a[96:99], v[104:107]
    ds_read_b128 a[68:71], v5 offset:2048
    v_mfma_f32_16x16x32_bf16 v[108:111], a[44:47], a[96:99], v[108:111]
    buffer_load_dwordx4 v3, s[24:27], s44 offen offset:3072 lds
    v_mfma_f32_16x16x32_bf16 v[112:115], a[48:51], a[96:99], v[112:115]
    s_add_u32 m0, s42, 65536
    ds_read_b128 a[72:75], v5 offset:4096
    v_mfma_f32_16x16x32_bf16 v[116:119], a[52:55], a[96:99], v[116:119]
    s_add_u32 s44, s53, 128
    v_cvt_pk_bf16_f32 v96, v96, v97
    v_cvt_pk_bf16_f32 v97, v98, v99
    v_mfma_f32_16x16x32_bf16 v[120:123], a[56:59], a[96:99], v[120:123]
    v_cvt_pk_bf16_f32 v98, v100, v101
    v_cvt_pk_bf16_f32 v99, v102, v103
    v_mfma_f32_16x16x32_bf16 v[124:127], a[60:63], a[96:99], v[124:127]
    buffer_load_dwordx4 v4, s[20:23], s44 offen lds
    ds_read_b128 a[76:79], v5 offset:6144
    v_mfma_f32_16x16x32_bf16 v[128:131], a[32:35], a[100:103], v[128:131]
    s_add_u32 s44, s53, 15488
    v_cvt_pk_bf16_f32 v104, v104, v105
    v_cvt_pk_bf16_f32 v105, v106, v107
    v_mfma_f32_16x16x32_bf16 v[132:135], a[36:39], a[100:103], v[132:135]
    ds_read_b128 a[80:83], v11 offset:0
    v_cvt_pk_bf16_f32 v106, v108, v109
    v_mfma_f32_16x16x32_bf16 v[136:139], a[40:43], a[100:103], v[136:139]
    v_cvt_pk_bf16_f32 v107, v110, v111
    v_cvt_pk_bf16_f32 v112, v112, v113
    v_mfma_f32_16x16x32_bf16 v[140:143], a[44:47], a[100:103], v[140:143]
    buffer_load_dwordx4 v4, s[20:23], s44 offen offset:1024 lds
    v_cvt_pk_bf16_f32 v113, v114, v115
    v_mfma_f32_16x16x32_bf16 v[144:147], a[48:51], a[100:103], v[144:147]
    s_add_u32 s44, s53, 2176
    ds_read_b128 a[84:87], v11 offset:2048
    v_cvt_pk_bf16_f32 v114, v116, v117
    v_mfma_f32_16x16x32_bf16 v[148:151], a[52:55], a[100:103], v[148:151]
    v_cvt_pk_bf16_f32 v115, v118, v119
    v_cvt_pk_bf16_f32 v120, v120, v121
    v_mfma_f32_16x16x32_bf16 v[152:155], a[56:59], a[100:103], v[152:155]
    ds_read_b64_tr_b16 a[0:1], v7 offset:0
    v_cvt_pk_bf16_f32 v121, v122, v123
    v_mfma_f32_16x16x32_bf16 v[156:159], a[60:63], a[100:103], v[156:159]
    buffer_load_dwordx4 v4, s[20:23], s44 offen offset:2048 lds
    v_cvt_pk_bf16_f32 v122, v124, v125
    v_mfma_f32_16x16x32_bf16 v[160:163], a[32:35], a[104:107], v[160:163]
    s_add_u32 s44, s53, 17536
    v_cvt_pk_bf16_f32 v123, v126, v127
    v_cvt_pk_bf16_f32 v128, v128, v129
    v_mfma_f32_16x16x32_bf16 v[164:167], a[36:39], a[104:107], v[164:167]
    ds_read_b64_tr_b16 a[2:3], v7 offset:1024
    v_cvt_pk_bf16_f32 v129, v130, v131
    v_mfma_f32_16x16x32_bf16 v[168:171], a[40:43], a[104:107], v[168:171]
    v_cvt_pk_bf16_f32 v130, v132, v133
    v_cvt_pk_bf16_f32 v131, v134, v135
    v_mfma_f32_16x16x32_bf16 v[172:175], a[44:47], a[104:107], v[172:175]
    buffer_load_dwordx4 v4, s[20:23], s44 offen offset:3072 lds
    ds_read_b64_tr_b16 a[4:5], v8 offset:0
    v_mfma_f32_16x16x32_bf16 v[176:179], a[48:51], a[104:107], v[176:179]
    s_add_u32 m0, s42, 69632
    v_cvt_pk_bf16_f32 v136, v136, v137
    v_cvt_pk_bf16_f32 v137, v138, v139
    v_mfma_f32_16x16x32_bf16 v[180:183], a[52:55], a[104:107], v[180:183]
    s_add_u32 s44, s47, 128
    v_cvt_pk_bf16_f32 v138, v140, v141
    v_cvt_pk_bf16_f32 v139, v142, v143
    v_mfma_f32_16x16x32_bf16 v[184:187], a[56:59], a[104:107], v[184:187]
    ds_read_b64_tr_b16 a[6:7], v8 offset:1024
    v_cvt_pk_bf16_f32 v144, v144, v145
    v_mfma_f32_16x16x32_bf16 v[188:191], a[60:63], a[104:107], v[188:191]
    buffer_load_dwordx4 v4, s[20:23], s44 offen lds
    v_cvt_pk_bf16_f32 v145, v146, v147
    v_mfma_f32_16x16x32_bf16 v[192:195], a[32:35], a[108:111], v[192:195]
    s_add_u32 s44, s47, 15488
    ds_read_b64_tr_b16 a[8:9], v9 offset:0
    v_cvt_pk_bf16_f32 v146, v148, v149
    v_mfma_f32_16x16x32_bf16 v[196:199], a[36:39], a[108:111], v[196:199]
    v_cvt_pk_bf16_f32 v147, v150, v151
    v_cvt_pk_bf16_f32 v152, v152, v153
    v_mfma_f32_16x16x32_bf16 v[200:203], a[40:43], a[108:111], v[200:203]
    v_cvt_pk_bf16_f32 v153, v154, v155
    v_cvt_pk_bf16_f32 v154, v156, v157
    v_mfma_f32_16x16x32_bf16 v[204:207], a[44:47], a[108:111], v[204:207]
    buffer_load_dwordx4 v4, s[20:23], s44 offen offset:1024 lds
    ds_read_b64_tr_b16 a[10:11], v9 offset:1024
    v_mfma_f32_16x16x32_bf16 v[208:211], a[48:51], a[108:111], v[208:211]
    s_add_u32 s44, s47, 2176
    v_cvt_pk_bf16_f32 v155, v158, v159
    v_cvt_pk_bf16_f32 v160, v160, v161
    v_mfma_f32_16x16x32_bf16 v[212:215], a[52:55], a[108:111], v[212:215]
    ds_read_b64_tr_b16 a[12:13], v10 offset:0
    v_cvt_pk_bf16_f32 v161, v162, v163
    v_mfma_f32_16x16x32_bf16 v[216:219], a[56:59], a[108:111], v[216:219]
    v_cvt_pk_bf16_f32 v162, v164, v165
    v_cvt_pk_bf16_f32 v163, v166, v167
    v_mfma_f32_16x16x32_bf16 v[220:223], a[60:63], a[108:111], v[220:223]
    buffer_load_dwordx4 v4, s[20:23], s44 offen offset:2048 lds
    ds_read_b64_tr_b16 a[14:15], v10 offset:1024
    v_mfma_f32_16x16x32_bf16 v[224:227], a[32:35], a[112:115], v[224:227]
    s_add_u32 s44, s47, 17536
    v_cvt_pk_bf16_f32 v168, v168, v169
    v_cvt_pk_bf16_f32 v169, v170, v171
    v_mfma_f32_16x16x32_bf16 v[228:231], a[36:39], a[112:115], v[228:231]
    v_cvt_pk_bf16_f32 v170, v172, v173
    v_cvt_pk_bf16_f32 v171, v174, v175
    v_mfma_f32_16x16x32_bf16 v[232:235], a[40:43], a[112:115], v[232:235]
    ds_read_b64_tr_b16 a[16:17], v7 offset:4096
    v_cvt_pk_bf16_f32 v176, v176, v177
    v_mfma_f32_16x16x32_bf16 v[236:239], a[44:47], a[112:115], v[236:239]
    buffer_load_dwordx4 v4, s[20:23], s44 offen offset:3072 lds
    v_cvt_pk_bf16_f32 v177, v178, v179
    v_mfma_f32_16x16x32_bf16 v[240:243], a[48:51], a[112:115], v[240:243]
    ds_read_b64_tr_b16 a[18:19], v7 offset:5120
    buffer_store_dwordx4 v[96:99], v1, s[8:11], s6 offen offset:0
    v_mfma_f32_16x16x32_bf16 v[244:247], a[52:55], a[112:115], v[244:247]
    v_cvt_pk_bf16_f32 v178, v180, v181
    v_cvt_pk_bf16_f32 v179, v182, v183
    v_mfma_f32_16x16x32_bf16 v[248:251], a[56:59], a[112:115], v[248:251]
    v_cvt_pk_bf16_f32 v184, v184, v185
    v_cvt_pk_bf16_f32 v185, v186, v187
    v_mfma_f32_16x16x32_bf16 v[252:255], a[60:63], a[112:115], v[252:255]
    ds_read_b64_tr_b16 a[20:21], v8 offset:4096
    v_cvt_pk_bf16_f32 v186, v188, v189
    v_mfma_f32_16x16x32_bf16 a[128:131], a[32:35], a[116:119], a[128:131]
    v_cvt_pk_bf16_f32 v187, v190, v191
    buffer_store_dwordx4 v[104:107], v1, s[8:11], s6 offen offset:1024
    v_mfma_f32_16x16x32_bf16 a[132:135], a[36:39], a[116:119], a[132:135]
    ds_read_b64_tr_b16 a[22:23], v8 offset:5120
    v_cvt_pk_bf16_f32 v192, v192, v193
    v_mfma_f32_16x16x32_bf16 a[136:139], a[40:43], a[116:119], a[136:139]
    v_cvt_pk_bf16_f32 v193, v194, v195
    v_cvt_pk_bf16_f32 v194, v196, v197
    v_mfma_f32_16x16x32_bf16 a[140:143], a[44:47], a[116:119], a[140:143]
    v_cvt_pk_bf16_f32 v195, v198, v199
    v_cvt_pk_bf16_f32 v200, v200, v201
    v_mfma_f32_16x16x32_bf16 a[144:147], a[48:51], a[116:119], a[144:147]
    ds_read_b64_tr_b16 a[24:25], v9 offset:4096
    buffer_store_dwordx4 v[112:115], v1, s[8:11], s6 offen offset:2048
    v_mfma_f32_16x16x32_bf16 a[148:151], a[52:55], a[116:119], a[148:151]
    v_cvt_pk_bf16_f32 v201, v202, v203
    v_cvt_pk_bf16_f32 v202, v204, v205
    v_mfma_f32_16x16x32_bf16 a[152:155], a[56:59], a[116:119], a[152:155]
    ds_read_b64_tr_b16 a[26:27], v9 offset:5120
    v_cvt_pk_bf16_f32 v203, v206, v207
    v_mfma_f32_16x16x32_bf16 a[156:159], a[60:63], a[116:119], a[156:159]
    v_cvt_pk_bf16_f32 v208, v208, v209
    v_cvt_pk_bf16_f32 v209, v210, v211
    v_mfma_f32_16x16x32_bf16 a[160:163], a[32:35], a[120:123], a[160:163]
    v_cvt_pk_bf16_f32 v210, v212, v213
    buffer_store_dwordx4 v[120:123], v1, s[8:11], s6 offen offset:3072
    v_mfma_f32_16x16x32_bf16 a[164:167], a[36:39], a[120:123], a[164:167]
    s_add_u32 s6, s46, 4096
    ds_read_b64_tr_b16 a[28:29], v10 offset:4096
    v_cvt_pk_bf16_f32 v211, v214, v215
    v_mfma_f32_16x16x32_bf16 a[168:171], a[40:43], a[120:123], a[168:171]
    v_cvt_pk_bf16_f32 v216, v216, v217
    v_cvt_pk_bf16_f32 v217, v218, v219
    v_mfma_f32_16x16x32_bf16 a[172:175], a[44:47], a[120:123], a[172:175]
    ds_read_b64_tr_b16 a[30:31], v10 offset:5120
    v_cvt_pk_bf16_f32 v218, v220, v221
    v_mfma_f32_16x16x32_bf16 a[176:179], a[48:51], a[120:123], a[176:179]
    v_cvt_pk_bf16_f32 v219, v222, v223
    buffer_store_dwordx4 v[128:131], v1, s[8:11], s6 offen offset:0
    v_mfma_f32_16x16x32_bf16 a[180:183], a[52:55], a[120:123], a[180:183]
    v_cvt_pk_bf16_f32 v224, v224, v225
    v_cvt_pk_bf16_f32 v225, v226, v227
    v_mfma_f32_16x16x32_bf16 a[184:187], a[56:59], a[120:123], a[184:187]
    v_cvt_pk_bf16_f32 v226, v228, v229
    v_cvt_pk_bf16_f32 v227, v230, v231
    v_mfma_f32_16x16x32_bf16 a[188:191], a[60:63], a[120:123], a[188:191]
    v_cvt_pk_bf16_f32 v232, v232, v233
    v_cvt_pk_bf16_f32 v233, v234, v235
    v_mfma_f32_16x16x32_bf16 a[192:195], a[32:35], a[124:127], a[192:195]
    v_cvt_pk_bf16_f32 v234, v236, v237
    buffer_store_dwordx4 v[136:139], v1, s[8:11], s6 offen offset:1024
    v_mfma_f32_16x16x32_bf16 a[196:199], a[36:39], a[124:127], a[196:199]
    v_cvt_pk_bf16_f32 v235, v238, v239
    v_cvt_pk_bf16_f32 v240, v240, v241
    v_mfma_f32_16x16x32_bf16 a[200:203], a[40:43], a[124:127], a[200:203]
    v_cvt_pk_bf16_f32 v241, v242, v243
    v_cvt_pk_bf16_f32 v242, v244, v245
    v_mfma_f32_16x16x32_bf16 a[204:207], a[44:47], a[124:127], a[204:207]
    v_cvt_pk_bf16_f32 v243, v246, v247
    v_cvt_pk_bf16_f32 v248, v248, v249
    v_mfma_f32_16x16x32_bf16 a[208:211], a[48:51], a[124:127], a[208:211]
    v_cvt_pk_bf16_f32 v249, v250, v251
    v_cvt_pk_bf16_f32 v250, v252, v253
    v_mfma_f32_16x16x32_bf16 a[212:215], a[52:55], a[124:127], a[212:215]
    v_cvt_pk_bf16_f32 v251, v254, v255
    v_mfma_f32_16x16x32_bf16 a[216:219], a[56:59], a[124:127], a[216:219]
    s_waitcnt lgkmcnt(0)
    v_mfma_f32_16x16x32_bf16 a[220:223], a[60:63], a[124:127], a[220:223]
    s_branch A_q
A_kv1:
    v_mfma_f32_16x16x32_bf16 v[96:99], a[64:67], a[0:3], 0
    s_add_u32 m0, s42, 4096
    ds_read_b128 a[96:99], v6 offset:0
    v_mfma_f32_16x16x32_bf16 v[100:103], a[68:71], a[0:3], 0
    s_add_u32 s44, s40, 524288
    ds_read_b64_tr_b16 a[32:33], v7 offset:8192
    buffer_load_dwordx4 v2, s[12:15], s44 offen lds
    v_mfma_f32_16x16x32_bf16 v[104:107], a[64:67], a[4:7], 0
    s_add_u32 s44, s40, 531456
    v_mfma_f32_16x16x32_bf16 v[108:111], a[68:71], a[4:7], 0
    ds_read_b64_tr_b16 a[34:35], v7 offset:9216
    buffer_load_dwordx4 v2, s[12:15], s44 offen offset:1024 lds
    v_mfma_f32_16x16x32_bf16 v[112:115], a[64:67], a[8:11], 0
    s_add_u32 s44, s40, 538624
    v_mfma_f32_16x16x32_bf16 v[116:119], a[68:71], a[8:11], 0
    ds_read_b128 a[100:103], v6 offset:2048
    v_mfma_f32_16x16x32_bf16 v[120:123], a[64:67], a[12:15], 0
    v_mfma_f32_16x16x32_bf16 v[124:127], a[68:71], a[12:15], 0
    ds_read_b64_tr_b16 a[36:37], v8 offset:8192
    buffer_load_dwordx4 v2, s[12:15], s44 offen offset:2048 lds
    v_mfma_f32_16x16x32_bf16 v[128:131], a[64:67], a[16:19], 0
    s_add_u32 s44, s40, 545792
    v_mfma_f32_16x16x32_bf16 v[132:135], a[68:71], a[16:19], 0
    ds_read_b64_tr_b16 a[38:39], v8 offset:9216
    v_mfma_f32_16x16x32_bf16 v[136:139], a[64:67], a[20:23], 0
    v_xor_b32 v5, 0x10000, v5
    v_mfma_f32_16x16x32_bf16 v[140:143], a[68:71], a[20:23], 0
    ds_read_b128 a[104:107], v6 offset:4096
    buffer_load_dwordx4 v2, s[12:15], s44 offen offset:3072 lds
    v_mfma_f32_16x16x32_bf16 v[144:147], a[64:67], a[24:27], 0
    s_add_u32 m0, s43, 0
    ds_read_b64_tr_b16 a[40:41], v9 offset:8192
    v_mfma_f32_16x16x32_bf16 v[148:151], a[68:71], a[24:27], 0
    s_add_u32 s44, s41, 0
    v_mfma_f32_16x16x32_bf16 v[152:155], a[64:67], a[28:31], 0
    ds_read_b64_tr_b16 a[42:43], v9 offset:9216
    v_mfma_f32_16x16x32_bf16 v[156:159], a[68:71], a[28:31], 0
    buffer_load_dwordx4 v3, s[16:19], s44 offen lds
    v_mfma_f32_16x16x32_bf16 v[160:163], a[72:75], a[0:3], 0
    s_add_u32 s44, s41, 31744
    ds_read_b128 a[108:111], v6 offset:6144
    v_mfma_f32_16x16x32_bf16 v[164:167], a[76:79], a[0:3], 0
    v_mfma_f32_16x16x32_bf16 v[168:171], a[72:75], a[4:7], 0
    ds_read_b64_tr_b16 a[44:45], v10 offset:8192
    v_mfma_f32_16x16x32_bf16 v[172:175], a[76:79], a[4:7], 0
    buffer_load_dwordx4 v3, s[16:19], s44 offen offset:1024 lds
    v_mfma_f32_16x16x32_bf16 v[176:179], a[72:75], a[8:11], 0
    s_add_u32 s44, s41, 129024
    ds_read_b64_tr_b16 a[46:47], v10 offset:9216
    v_mfma_f32_16x16x32_bf16 v[180:183], a[76:79], a[8:11], 0
    v_mfma_f32_16x16x32_bf16 v[184:187], a[72:75], a[12:15], 0
    ds_read_b128 a[112:115], v6 offset:8192
    v_mfma_f32_16x16x32_bf16 v[188:191], a[76:79], a[12:15], 0
    ds_read_b64_tr_b16 a[48:49], v7 offset:12288
    buffer_load_dwordx4 v3, s[16:19], s44 offen offset:2048 lds
    v_mfma_f32_16x16x32_bf16 v[192:195], a[72:75], a[16:19], 0
    s_add_u32 s44, s41, 160768
    v_mfma_f32_16x16x32_bf16 v[196:199], a[76:79], a[16:19], 0
    ds_read_b64_tr_b16 a[50:51], v7 offset:13312
    v_mfma_f32_16x16x32_bf16 v[200:203], a[72:75], a[20:23], 0
    buffer_load_dwordx4 v3, s[16:19], s44 offen offset:3072 lds
    v_mfma_f32_16x16x32_bf16 v[204:207], a[76:79], a[20:23], 0
    s_add_u32 m0, s43, 4096
    ds_read_b128 a[116:119], v6 offset:10240
    v_mfma_f32_16x16x32_bf16 v[208:211], a[72:75], a[24:27], 0
    s_add_u32 s44, s41, 128
    v_mfma_f32_16x16x32_bf16 v[212:215], a[76:79], a[24:27], 0
    ds_read_b64_tr_b16 a[52:53], v8 offset:12288
    v_mfma_f32_16x16x32_bf16 v[216:219], a[72:75], a[28:31], 0
    buffer_load_dwordx4 v3, s[16:19], s44 offen lds
    v_mfma_f32_16x16x32_bf16 v[220:223], a[76:79], a[28:31], 0
    s_add_u32 s44, s41, 31872
    ds_read_b64_tr_b16 a[54:55], v8 offset:13312
    v_mfma_f32_16x16x32_bf16 v[224:227], a[80:83], a[0:3], 0
    v_mfma_f32_16x16x32_bf16 v[228:231], a[84:87], a[0:3], 0
    ds_read_b128 a[120:123], v6 offset:12288
    v_mfma_f32_16x16x32_bf16 v[232:235], a[80:83], a[4:7], 0
    ds_read_b64_tr_b16 a[56:57], v9 offset:12288
    buffer_load_dwordx4 v3, s[16:19], s44 offen offset:1024 lds
    v_mfma_f32_16x16x32_bf16 v[236:239], a[84:87], a[4:7], 0
    s_add_u32 s44, s41, 129152
    v_mfma_f32_16x16x32_bf16 v[240:243], a[80:83], a[8:11], 0
    ds_read_b64_tr_b16 a[58:59], v9 offset:13312
    v_mfma_f32_16x16x32_bf16 v[244:247], a[84:87], a[8:11], 0
    v_mfma_f32_16x16x32_bf16 v[248:251], a[80:83], a[12:15], 0
    ds_read_b128 a[124:127], v6 offset:14336
    buffer_load_dwordx4 v3, s[16:19], s44 offen offset:2048 lds
    v_mfma_f32_16x16x32_bf16 v[252:255], a[84:87], a[12:15], 0
    s_add_u32 s44, s41, 160896
    v_mfma_f32_16x16x32_bf16 a[128:131], a[80:83], a[16:19], 0
    ds_read_b64_tr_b16 a[60:61], v10 offset:12288
    v_mfma_f32_16x16x32_bf16 a[132:135], a[84:87], a[16:19], 0
    v_mfma_f32_16x16x32_bf16 a[136:139], a[80:83], a[20:23], 0
    ds_read_b64_tr_b16 a[62:63], v10 offset:13312
    buffer_load_dwordx4 v3, s[16:19], s44 offen offset:3072 lds
    v_mfma_f32_16x16x32_bf16 a[140:143], a[84:87], a[20:23], 0
    s_bitcmp1_b32 s58, 7
    s_cselect_b32 s38, s99, 0
    s_cselect_b32 s52, s59, 0
    v_mfma_f32_16x16x32_bf16 a[144:147], a[80:83], a[24:27], 0
    v_mfma_f32_16x16x32_bf16 a[148:151], a[84:87], a[24:27], 0
    v_mfma_f32_16x16x32_bf16 a[152:155], a[80:83], a[28:31], 0
    v_xor_b32 v7, 0x10000, v7
    v_xor_b32 v8, 0x10000, v8
    v_mfma_f32_16x16x32_bf16 a[156:159], a[84:87], a[28:31], 0
    v_xor_b32 v9, 0x10000, v9
    v_xor_b32 v10, 0x10000, v10
    v_mfma_f32_16x16x32_bf16 a[160:163], a[88:91], a[0:3], 0
    v_xor_b32 v6, 0x10000, v6
    buffer_load_dword v13, v14, s[36:39], s51 offen
    v_mfma_f32_16x16x32_bf16 a[164:167], a[92:95], a[0:3], 0
    s_add_u32 s51, s51, s52
    s_and_b32 s51, s51, 0xffbffbff
    v_mfma_f32_16x16x32_bf16 a[168:171], a[88:91], a[4:7], 0
    v_mfma_f32_16x16x32_bf16 a[172:175], a[92:95], a[4:7], 0
    s_waitcnt lgkmcnt(0)
    v_mfma_f32_16x16x32_bf16 a[176:179], a[88:91], a[8:11], 0
    v_mfma_f32_16x16x32_bf16 a[180:183], a[92:95], a[8:11], 0
    v_mfma_f32_16x16x32_bf16 a[184:187], a[88:91], a[12:15], 0
    s_barrier
    v_mfma_f32_16x16x32_bf16 a[188:191], a[92:95], a[12:15], 0
    s_add_u32 s40, s40, 128
    s_bitset0_b32 s40, 10
    v_mfma_f32_16x16x32_bf16 a[192:195], a[88:91], a[16:19], 0
    s_add_u32 s41, s41, 524288
    s_bitset0_b32 s41, 22
    v_mfma_f32_16x16x32_bf16 a[196:199], a[92:95], a[16:19], 0
    s_xor_b32 s42, s42, 0x10000
    v_mfma_f32_16x16x32_bf16 a[200:203], a[88:91], a[20:23], 0
    s_xor_b32 s43, s43, 0x10000
    buffer_atomic_add v61, v60, s[28:31], 0 offen sc1
    buffer_store_dwordx4 v[56:59], v1, s[8:11], s61 offen offset:2048 sc1
    v_mfma_f32_16x16x32_bf16 a[204:207], a[92:95], a[20:23], 0
    s_add_u32 s61, s61, 1024
    v_mfma_f32_16x16x32_bf16 a[208:211], a[88:91], a[24:27], 0
    s_add_u32 m0, s42, 0
    v_mfma_f32_16x16x32_bf16 a[212:215], a[92:95], a[24:27], 0
    s_add_u32 s44, s40, 0
    v_mfma_f32_16x16x32_bf16 a[216:219], a[88:91], a[28:31], 0
    buffer_load_dwordx4 v2, s[12:15], s44 offen lds
    v_mfma_f32_16x16x32_bf16 a[220:223], a[92:95], a[28:31], 0
    s_add_u32 s44, s40, 7168
    v_mfma_f32_16x16x32_bf16 v[96:99], a[96:99], a[32:35], v[96:99]
    v_mfma_f32_16x16x32_bf16 v[100:103], a[100:103], a[32:35], v[100:103]
    v_mfma_f32_16x16x32_bf16 v[104:107], a[96:99], a[36:39], v[104:107]
    buffer_load_dwordx4 v2, s[12:15], s44 offen offset:1024 lds
    v_mfma_f32_16x16x32_bf16 v[108:111], a[100:103], a[36:39], v[108:111]
    s_add_u32 s44, s40, 14336
    v_mfma_f32_16x16x32_bf16 v[112:115], a[96:99], a[40:43], v[112:115]
    v_mfma_f32_16x16x32_bf16 v[116:119], a[100:103], a[40:43], v[116:119]
    buffer_load_dwordx4 v2, s[12:15], s44 offen offset:2048 lds
    v_mfma_f32_16x16x32_bf16 v[120:123], a[96:99], a[44:47], v[120:123]
    s_add_u32 s44, s40, 21504
    v_mfma_f32_16x16x32_bf16 v[124:127], a[100:103], a[44:47], v[124:127]
    v_mfma_f32_16x16x32_bf16 v[128:131], a[96:99], a[48:51], v[128:131]
    v_mfma_f32_16x16x32_bf16 v[132:135], a[100:103], a[48:51], v[132:135]
    buffer_load_dwordx4 v2, s[12:15], s44 offen offset:3072 lds
    v_mfma_f32_16x16x32_bf16 v[136:139], a[96:99], a[52:55], v[136:139]
    s_add_u32 m0, s42, 4096
    v_mfma_f32_16x16x32_bf16 v[140:143], a[100:103], a[52:55], v[140:143]
    s_add_u32 s44, s40, 524288
    v_mfma_f32_16x16x32_bf16 v[144:147], a[96:99], a[56:59], v[144:147]
    v_mfma_f32_16x16x32_bf16 v[148:151], a[100:103], a[56:59], v[148:151]
    buffer_load_dwordx4 v2, s[12:15], s44 offen lds
    v_mfma_f32_16x16x32_bf16 v[152:155], a[96:99], a[60:63], v[152:155]
    s_add_u32 s44, s40, 531456
    v_mfma_f32_16x16x32_bf16 v[156:159], a[100:103], a[60:63], v[156:159]
    v_mfma_f32_16x16x32_bf16 v[160:163], a[104:107], a[32:35], v[160:163]
    buffer_load_dwordx4 v2, s[12:15], s44 offen offset:1024 lds
    v_mfma_f32_16x16x32_bf16 v[164:167], a[108:111], a[32:35], v[164:167]
    s_add_u32 s44, s40, 538624
    v_mfma_f32_16x16x32_bf16 v[168:171], a[104:107], a[36:39], v[168:171]
    v_mfma_f32_16x16x32_bf16 v[172:175], a[108:111], a[36:39], v[172:175]
    v_mfma_f32_16x16x32_bf16 v[176:179], a[104:107], a[40:43], v[176:179]
    buffer_load_dwordx4 v2, s[12:15], s44 offen offset:2048 lds
    v_mfma_f32_16x16x32_bf16 v[180:183], a[108:111], a[40:43], v[180:183]
    s_add_u32 s44, s40, 545792
    v_mfma_f32_16x16x32_bf16 v[184:187], a[104:107], a[44:47], v[184:187]
    v_mfma_f32_16x16x32_bf16 v[188:191], a[108:111], a[44:47], v[188:191]
    v_mfma_f32_16x16x32_bf16 v[192:195], a[104:107], a[48:51], v[192:195]
    buffer_load_dwordx4 v2, s[12:15], s44 offen offset:3072 lds
    v_mfma_f32_16x16x32_bf16 v[196:199], a[108:111], a[48:51], v[196:199]
    s_add_u32 m0, s43, 0
    v_mfma_f32_16x16x32_bf16 v[200:203], a[104:107], a[52:55], v[200:203]
    s_add_u32 s44, s41, 0
    v_mfma_f32_16x16x32_bf16 v[204:207], a[108:111], a[52:55], v[204:207]
    buffer_load_dwordx4 v3, s[16:19], s44 offen lds
    v_mfma_f32_16x16x32_bf16 v[208:211], a[104:107], a[56:59], v[208:211]
    s_add_u32 s44, s41, 31744
    v_mfma_f32_16x16x32_bf16 v[212:215], a[108:111], a[56:59], v[212:215]
    v_mfma_f32_16x16x32_bf16 v[216:219], a[104:107], a[60:63], v[216:219]
    v_mfma_f32_16x16x32_bf16 v[220:223], a[108:111], a[60:63], v[220:223]
    buffer_load_dwordx4 v3, s[16:19], s44 offen offset:1024 lds
    v_mfma_f32_16x16x32_bf16 v[224:227], a[112:115], a[32:35], v[224:227]
    s_add_u32 s44, s41, 129024
    v_mfma_f32_16x16x32_bf16 v[228:231], a[116:119], a[32:35], v[228:231]
    v_mfma_f32_16x16x32_bf16 v[232:235], a[112:115], a[36:39], v[232:235]
    v_mfma_f32_16x16x32_bf16 v[236:239], a[116:119], a[36:39], v[236:239]
    buffer_load_dwordx4 v3, s[16:19], s44 offen offset:2048 lds
    v_mfma_f32_16x16x32_bf16 v[240:243], a[112:115], a[40:43], v[240:243]
    s_waitcnt vmcnt(14)
    v_mfma_f32_16x16x32_bf16 v[244:247], a[116:119], a[40:43], v[244:247]
    s_barrier
    v_mfma_f32_16x16x32_bf16 v[248:251], a[112:115], a[44:47], v[248:251]
    s_add_u32 s44, s41, 160768
    v_mfma_f32_16x16x32_bf16 v[252:255], a[116:119], a[44:47], v[252:255]
    ds_read_b128 a[64:67], v5 offset:0
    ds_read_b64_tr_b16 a[0:1], v7 offset:0
    v_mfma_f32_16x16x32_bf16 a[128:131], a[112:115], a[48:51], a[128:131]
    ds_read_b64_tr_b16 a[2:3], v7 offset:1024
    buffer_load_dwordx4 v3, s[16:19], s44 offen offset:3072 lds
    v_mfma_f32_16x16x32_bf16 a[132:135], a[116:119], a[48:51], a[132:135]
    s_add_u32 m0, s43, 4096
    ds_read_b128 a[68:71], v5 offset:2048
    v_mfma_f32_16x16x32_bf16 a[136:139], a[112:115], a[52:55], a[136:139]
    s_add_u32 s44, s41, 128
    ds_read_b64_tr_b16 a[4:5], v8 offset:0
    ds_read_b64_tr_b16 a[6:7], v8 offset:1024
    v_mfma_f32_16x16x32_bf16 a[140:143], a[116:119], a[52:55], a[140:143]
    ds_read_b128 a[72:75], v5 offset:4096
    buffer_load_dwordx4 v3, s[16:19], s44 offen lds
    v_mfma_f32_16x16x32_bf16 a[144:147], a[112:115], a[56:59], a[144:147]
    s_add_u32 s44, s41, 31872
    ds_read_b64_tr_b16 a[8:9], v9 offset:0
    v_mfma_f32_16x16x32_bf16 a[148:151], a[116:119], a[56:59], a[148:151]
    ds_read_b64_tr_b16 a[10:11], v9 offset:1024
    v_mfma_f32_16x16x32_bf16 a[152:155], a[112:115], a[60:63], a[152:155]
    ds_read_b128 a[76:79], v5 offset:6144
    ds_read_b64_tr_b16 a[12:13], v10 offset:0
    v_mfma_f32_16x16x32_bf16 a[156:159], a[116:119], a[60:63], a[156:159]
    ds_read_b64_tr_b16 a[14:15], v10 offset:1024
    buffer_load_dwordx4 v3, s[16:19], s44 offen offset:1024 lds
    v_mfma_f32_16x16x32_bf16 a[160:163], a[120:123], a[32:35], a[160:163]
    s_add_u32 s44, s41, 129152
    ds_read_b128 a[80:83], v5 offset:8192
    v_mfma_f32_16x16x32_bf16 a[164:167], a[124:127], a[32:35], a[164:167]
    ds_read_b64_tr_b16 a[16:17], v7 offset:4096
    buffer_load_dwordx4 v3, s[16:19], s44 offen offset:2048 lds
    v_mfma_f32_16x16x32_bf16 a[168:171], a[120:123], a[36:39], a[168:171]
    s_add_u32 s44, s41, 160896
    ds_read_b64_tr_b16 a[18:19], v7 offset:5120
    ds_read_b128 a[84:87], v5 offset:10240
    v_mfma_f32_16x16x32_bf16 a[172:175], a[124:127], a[36:39], a[172:175]
    ds_read_b64_tr_b16 a[20:21], v8 offset:4096
    v_mfma_f32_16x16x32_bf16 a[176:179], a[120:123], a[40:43], a[176:179]
    ds_read_b64_tr_b16 a[22:23], v8 offset:5120
    v_mfma_f32_16x16x32_bf16 a[180:183], a[124:127], a[40:43], a[180:183]
    ds_read_b128 a[88:91], v5 offset:12288
    buffer_load_dwordx4 v3, s[16:19], s44 offen offset:3072 lds
    v_mfma_f32_16x16x32_bf16 a[184:187], a[120:123], a[44:47], a[184:187]
    s_bitcmp1_b32 s58, 6
    s_cselect_b32 s38, s99, 0
    s_cselect_b32 s52, s59, 0
    ds_read_b64_tr_b16 a[24:25], v9 offset:4096
    ds_read_b64_tr_b16 a[26:27], v9 offset:5120
    v_mfma_f32_16x16x32_bf16 a[188:191], a[124:127], a[44:47], a[188:191]
    ds_read_b128 a[92:95], v5 offset:14336
    v_mfma_f32_16x16x32_bf16 a[192:195], a[120:123], a[48:51], a[192:195]
    ds_read_b64_tr_b16 a[28:29], v10 offset:4096
    v_mfma_f32_16x16x32_bf16 a[196:199], a[124:127], a[48:51], a[196:199]
    ds_read_b64_tr_b16 a[30:31], v10 offset:5120
    buffer_load_dword v13, v14, s[36:39], s51 offen
    v_mfma_f32_16x16x32_bf16 a[200:203], a[120:123], a[52:55], a[200:203]
    s_add_u32 s51, s51, s52
    s_and_b32 s51, s51, 0xffbffbff
    v_mfma_f32_16x16x32_bf16 a[204:207], a[124:127], a[52:55], a[204:207]
    v_mfma_f32_16x16x32_bf16 a[208:211], a[120:123], a[56:59], a[208:211]
    v_mfma_f32_16x16x32_bf16 a[212:215], a[124:127], a[56:59], a[212:215]
    v_mfma_f32_16x16x32_bf16 a[216:219], a[120:123], a[60:63], a[216:219]
    v_mfma_f32_16x16x32_bf16 a[220:223], a[124:127], a[60:63], a[220:223]
    s_waitcnt lgkmcnt(0)
    .p2align 3
A_kvl1:
    v_mfma_f32_16x16x32_bf16 v[96:99], a[64:67], a[0:3], v[96:99]
    ds_read_b128 a[96:99], v6 offset:0
    v_mfma_f32_16x16x32_bf16 v[100:103], a[68:71], a[0:3], v[100:103]
    ds_read_b64_tr_b16 a[32:33], v7 offset:8192
    v_mfma_f32_16x16x32_bf16 v[104:107], a[64:67], a[4:7], v[104:107]
    s_bitcmp1_b32 s58, s45
    v_mfma_f32_16x16x32_bf16 v[108:111], a[68:71], a[4:7], v[108:111]
    s_cselect_b32 s38, s99, 0
    ds_read_b64_tr_b16 a[34:35], v7 offset:9216
    v_mfma_f32_16x16x32_bf16 v[112:115], a[64:67], a[8:11], v[112:115]
    s_cselect_b32 s52, s59, 0
    v_mfma_f32_16x16x32_bf16 v[116:119], a[68:71], a[8:11], v[116:119]
    ds_read_b128 a[100:103], v6 offset:2048
    v_mfma_f32_16x16x32_bf16 v[120:123], a[64:67], a[12:15], v[120:123]
    s_sub_u32 s45, s45, 1
    v_mfma_f32_16x16x32_bf16 v[124:127], a[68:71], a[12:15], v[124:127]
    ds_read_b64_tr_b16 a[36:37], v8 offset:8192
    v_mfma_f32_16x16x32_bf16 v[128:131], a[64:67], a[16:19], v[128:131]
    s_add_u32 s40, s40, 128
    s_bitset0_b32 s40, 10
    v_mfma_f32_16x16x32_bf16 v[132:135], a[68:71], a[16:19], v[132:135]
    s_add_u32 s41, s41, 524288
    s_bitset0_b32 s41, 22
    ds_read_b64_tr_b16 a[38:39], v8 offset:9216
    v_mfma_f32_16x16x32_bf16 v[136:139], a[64:67], a[20:23], v[136:139]
    s_xor_b32 s42, s42, 0x10000
    v_xor_b32 v5, 0x10000, v5
    v_mfma_f32_16x16x32_bf16 v[140:143], a[68:71], a[20:23], v[140:143]
    s_xor_b32 s43, s43, 0x10000
    ds_read_b128 a[104:107], v6 offset:4096
    v_mfma_f32_16x16x32_bf16 v[144:147], a[64:67], a[24:27], v[144:147]
    ds_read_b64_tr_b16 a[40:41], v9 offset:8192
    v_mfma_f32_16x16x32_bf16 v[148:151], a[68:71], a[24:27], v[148:151]
    v_mfma_f32_16x16x32_bf16 v[152:155], a[64:67], a[28:31], v[152:155]
    ds_read_b64_tr_b16 a[42:43], v9 offset:9216
    v_mfma_f32_16x16x32_bf16 v[156:159], a[68:71], a[28:31], v[156:159]
    v_mfma_f32_16x16x32_bf16 v[160:163], a[72:75], a[0:3], v[160:163]
    ds_read_b128 a[108:111], v6 offset:6144
    v_mfma_f32_16x16x32_bf16 v[164:167], a[76:79], a[0:3], v[164:167]
    v_mfma_f32_16x16x32_bf16 v[168:171], a[72:75], a[4:7], v[168:171]
    ds_read_b64_tr_b16 a[44:45], v10 offset:8192
    v_mfma_f32_16x16x32_bf16 v[172:175], a[76:79], a[4:7], v[172:175]
    v_mfma_f32_16x16x32_bf16 v[176:179], a[72:75], a[8:11], v[176:179]
    ds_read_b64_tr_b16 a[46:47], v10 offset:9216
    v_mfma_f32_16x16x32_bf16 v[180:183], a[76:79], a[8:11], v[180:183]
    v_mfma_f32_16x16x32_bf16 v[184:187], a[72:75], a[12:15], v[184:187]
    ds_read_b128 a[112:115], v6 offset:8192
    v_mfma_f32_16x16x32_bf16 v[188:191], a[76:79], a[12:15], v[188:191]
    ds_read_b64_tr_b16 a[48:49], v7 offset:12288
    v_mfma_f32_16x16x32_bf16 v[192:195], a[72:75], a[16:19], v[192:195]
    v_mfma_f32_16x16x32_bf16 v[196:199], a[76:79], a[16:19], v[196:199]
    ds_read_b64_tr_b16 a[50:51], v7 offset:13312
    v_mfma_f32_16x16x32_bf16 v[200:203], a[72:75], a[20:23], v[200:203]
    v_mfma_f32_16x16x32_bf16 v[204:207], a[76:79], a[20:23], v[204:207]
    ds_read_b128 a[116:119], v6 offset:10240
    v_mfma_f32_16x16x32_bf16 v[208:211], a[72:75], a[24:27], v[208:211]
    v_mfma_f32_16x16x32_bf16 v[212:215], a[76:79], a[24:27], v[212:215]
    ds_read_b64_tr_b16 a[52:53], v8 offset:12288
    v_mfma_f32_16x16x32_bf16 v[216:219], a[72:75], a[28:31], v[216:219]
    v_mfma_f32_16x16x32_bf16 v[220:223], a[76:79], a[28:31], v[220:223]
    ds_read_b64_tr_b16 a[54:55], v8 offset:13312
    v_mfma_f32_16x16x32_bf16 v[224:227], a[80:83], a[0:3], v[224:227]
    v_mfma_f32_16x16x32_bf16 v[228:231], a[84:87], a[0:3], v[228:231]
    ds_read_b128 a[120:123], v6 offset:12288
    v_mfma_f32_16x16x32_bf16 v[232:235], a[80:83], a[4:7], v[232:235]
    ds_read_b64_tr_b16 a[56:57], v9 offset:12288
    v_mfma_f32_16x16x32_bf16 v[236:239], a[84:87], a[4:7], v[236:239]
    v_mfma_f32_16x16x32_bf16 v[240:243], a[80:83], a[8:11], v[240:243]
    ds_read_b64_tr_b16 a[58:59], v9 offset:13312
    v_mfma_f32_16x16x32_bf16 v[244:247], a[84:87], a[8:11], v[244:247]
    v_mfma_f32_16x16x32_bf16 v[248:251], a[80:83], a[12:15], v[248:251]
    ds_read_b128 a[124:127], v6 offset:14336
    v_mfma_f32_16x16x32_bf16 v[252:255], a[84:87], a[12:15], v[252:255]
    v_mfma_f32_16x16x32_bf16 a[128:131], a[80:83], a[16:19], a[128:131]
    ds_read_b64_tr_b16 a[60:61], v10 offset:12288
    v_mfma_f32_16x16x32_bf16 a[132:135], a[84:87], a[16:19], a[132:135]
    v_mfma_f32_16x16x32_bf16 a[136:139], a[80:83], a[20:23], a[136:139]
    ds_read_b64_tr_b16 a[62:63], v10 offset:13312
    v_mfma_f32_16x16x32_bf16 a[140:143], a[84:87], a[20:23], a[140:143]
    v_mfma_f32_16x16x32_bf16 a[144:147], a[80:83], a[24:27], a[144:147]
    v_mfma_f32_16x16x32_bf16 a[148:151], a[84:87], a[24:27], a[148:151]
    v_mfma_f32_16x16x32_bf16 a[152:155], a[80:83], a[28:31], a[152:155]
    v_xor_b32 v7, 0x10000, v7
    v_xor_b32 v8, 0x10000, v8
    v_mfma_f32_16x16x32_bf16 a[156:159], a[84:87], a[28:31], a[156:159]
    v_xor_b32 v9, 0x10000, v9
    v_xor_b32 v10, 0x10000, v10
    v_mfma_f32_16x16x32_bf16 a[160:163], a[88:91], a[0:3], a[160:163]
    v_xor_b32 v6, 0x10000, v6
    v_mfma_f32_16x16x32_bf16 a[164:167], a[92:95], a[0:3], a[164:167]
    v_mfma_f32_16x16x32_bf16 a[168:171], a[88:91], a[4:7], a[168:171]
    v_mfma_f32_16x16x32_bf16 a[172:175], a[92:95], a[4:7], a[172:175]
    s_waitcnt lgkmcnt(0)
    v_mfma_f32_16x16x32_bf16 a[176:179], a[88:91], a[8:11], a[176:179]
    s_waitcnt vmcnt(1)
    v_mfma_f32_16x16x32_bf16 a[180:183], a[92:95], a[8:11], a[180:183]
    v_mfma_f32_16x16x32_bf16 a[184:187], a[88:91], a[12:15], a[184:187]
    s_barrier
    v_mfma_f32_16x16x32_bf16 a[188:191], a[92:95], a[12:15], a[188:191]
    v_mfma_f32_16x16x32_bf16 a[192:195], a[88:91], a[16:19], a[192:195]
    buffer_store_dwordx4 v[56:59], v1, s[8:11], s61 offen offset:2048 sc1
    v_mfma_f32_16x16x32_bf16 a[196:199], a[92:95], a[16:19], a[196:199]
    s_add_u32 s61, s61, 1024
    v_mfma_f32_16x16x32_bf16 a[200:203], a[88:91], a[20:23], a[200:203]
    s_add_u32 m0, s42, 0
    v_mfma_f32_16x16x32_bf16 a[204:207], a[92:95], a[20:23], a[204:207]
    s_add_u32 s44, s40, 0
    buffer_load_dwordx4 v2, s[12:15], s44 offen lds
    v_mfma_f32_16x16x32_bf16 a[208:211], a[88:91], a[24:27], a[208:211]
    s_add_u32 s44, s40, 7168
    v_mfma_f32_16x16x32_bf16 a[212:215], a[92:95], a[24:27], a[212:215]
    v_mfma_f32_16x16x32_bf16 a[216:219], a[88:91], a[28:31], a[216:219]
    buffer_load_dwordx4 v2, s[12:15], s44 offen offset:1024 lds
    v_mfma_f32_16x16x32_bf16 a[220:223], a[92:95], a[28:31], a[220:223]
    s_add_u32 s44, s40, 14336
    v_mfma_f32_16x16x32_bf16 v[96:99], a[96:99], a[32:35], v[96:99]
    ds_read_b128 a[64:67], v5 offset:0
    v_mfma_f32_16x16x32_bf16 v[100:103], a[100:103], a[32:35], v[100:103]
    v_mfma_f32_16x16x32_bf16 v[104:107], a[96:99], a[36:39], v[104:107]
    ds_read_b64_tr_b16 a[0:1], v7 offset:0
    buffer_load_dwordx4 v2, s[12:15], s44 offen offset:2048 lds
    v_mfma_f32_16x16x32_bf16 v[108:111], a[100:103], a[36:39], v[108:111]
    s_add_u32 s44, s40, 21504
    v_mfma_f32_16x16x32_bf16 v[112:115], a[96:99], a[40:43], v[112:115]
    ds_read_b64_tr_b16 a[2:3], v7 offset:1024
    v_mfma_f32_16x16x32_bf16 v[116:119], a[100:103], a[40:43], v[116:119]
    v_mfma_f32_16x16x32_bf16 v[120:123], a[96:99], a[44:47], v[120:123]
    ds_read_b128 a[68:71], v5 offset:2048
    buffer_load_dwordx4 v2, s[12:15], s44 offen offset:3072 lds
    v_mfma_f32_16x16x32_bf16 v[124:127], a[100:103], a[44:47], v[124:127]
    s_add_u32 m0, s42, 4096
    v_mfma_f32_16x16x32_bf16 v[128:131], a[96:99], a[48:51], v[128:131]
    s_add_u32 s44, s40, 524288
    v_mfma_f32_16x16x32_bf16 v[132:135], a[100:103], a[48:51], v[132:135]
    ds_read_b64_tr_b16 a[4:5], v8 offset:0
    v_mfma_f32_16x16x32_bf16 v[136:139], a[96:99], a[52:55], v[136:139]
    buffer_load_dwordx4 v2, s[12:15], s44 offen lds
    v_mfma_f32_16x16x32_bf16 v[140:143], a[100:103], a[52:55], v[140:143]
    s_add_u32 s44, s40, 531456
    ds_read_b64_tr_b16 a[6:7], v8 offset:1024
    v_mfma_f32_16x16x32_bf16 v[144:147], a[96:99], a[56:59], v[144:147]
    v_mfma_f32_16x16x32_bf16 v[148:151], a[100:103], a[56:59], v[148:151]
    ds_read_b128 a[72:75], v5 offset:4096
    v_mfma_f32_16x16x32_bf16 v[152:155], a[96:99], a[60:63], v[152:155]
    buffer_load_dwordx4 v2, s[12:15], s44 offen offset:1024 lds
    v_mfma_f32_16x16x32_bf16 v[156:159], a[100:103], a[60:63], v[156:159]
    s_add_u32 s44, s40, 538624
    ds_read_b64_tr_b16 a[8:9], v9 offset:0
    v_mfma_f32_16x16x32_bf16 v[160:163], a[104:107], a[32:35], v[160:163]
    v_mfma_f32_16x16x32_bf16 v[164:167], a[108:111], a[32:35], v[164:167]
    v_mfma_f32_16x16x32_bf16 v[168:171], a[104:107], a[36:39], v[168:171]
    ds_read_b64_tr_b16 a[10:11], v9 offset:1024
    buffer_load_dwordx4 v2, s[12:15], s44 offen offset:2048 lds
    v_mfma_f32_16x16x32_bf16 v[172:175], a[108:111], a[36:39], v[172:175]
    s_add_u32 s44, s40, 545792
    v_mfma_f32_16x16x32_bf16 v[176:179], a[104:107], a[40:43], v[176:179]
    ds_read_b128 a[76:79], v5 offset:6144
    v_mfma_f32_16x16x32_bf16 v[180:183], a[108:111], a[40:43], v[180:183]
    v_mfma_f32_16x16x32_bf16 v[184:187], a[104:107], a[44:47], v[184:187]
    ds_read_b64_tr_b16 a[12:13], v10 offset:0
    buffer_load_dwordx4 v2, s[12:15], s44 offen offset:3072 lds
    v_mfma_f32_16x16x32_bf16 v[188:191], a[108:111], a[44:47], v[188:191]
    s_add_u32 m0, s43, 0
    v_mfma_f32_16x16x32_bf16 v[192:195], a[104:107], a[48:51], v[192:195]
    s_add_u32 s44, s41, 0
    ds_read_b64_tr_b16 a[14:15], v10 offset:1024
    v_mfma_f32_16x16x32_bf16 v[196:199], a[108:111], a[48:51], v[196:199]
    v_mfma_f32_16x16x32_bf16 v[200:203], a[104:107], a[52:55], v[200:203]
    buffer_load_dwordx4 v3, s[16:19], s44 offen lds
    v_mfma_f32_16x16x32_bf16 v[204:207], a[108:111], a[52:55], v[204:207]
    s_add_u32 s44, s41, 31744
    ds_read_b128 a[80:83], v5 offset:8192
    v_mfma_f32_16x16x32_bf16 v[208:211], a[104:107], a[56:59], v[208:211]
    v_mfma_f32_16x16x32_bf16 v[212:215], a[108:111], a[56:59], v[212:215]
    ds_read_b64_tr_b16 a[16:17], v7 offset:4096
    v_mfma_f32_16x16x32_bf16 v[216:219], a[104:107], a[60:63], v[216:219]
    buffer_load_dwordx4 v3, s[16:19], s44 offen offset:1024 lds
    v_mfma_f32_16x16x32_bf16 v[220:223], a[108:111], a[60:63], v[220:223]
    s_add_u32 s44, s41, 129024
    ds_read_b64_tr_b16 a[18:19], v7 offset:5120
    v_mfma_f32_16x16x32_bf16 v[224:227], a[112:115], a[32:35], v[224:227]
    v_mfma_f32_16x16x32_bf16 v[228:231], a[116:119], a[32:35], v[228:231]
    ds_read_b128 a[84:87], v5 offset:10240
    v_mfma_f32_16x16x32_bf16 v[232:235], a[112:115], a[36:39], v[232:235]
    buffer_load_dwordx4 v3, s[16:19], s44 offen offset:2048 lds
    v_mfma_f32_16x16x32_bf16 v[236:239], a[116:119], a[36:39], v[236:239]
    s_add_u32 s44, s41, 160768
    v_mfma_f32_16x16x32_bf16 v[240:243], a[112:115], a[40:43], v[240:243]
    ds_read_b64_tr_b16 a[20:21], v8 offset:4096
    v_mfma_f32_16x16x32_bf16 v[244:247], a[116:119], a[40:43], v[244:247]
    v_mfma_f32_16x16x32_bf16 v[248:251], a[112:115], a[44:47], v[248:251]
    ds_read_b64_tr_b16 a[22:23], v8 offset:5120
    buffer_load_dwordx4 v3, s[16:19], s44 offen offset:3072 lds
    v_mfma_f32_16x16x32_bf16 v[252:255], a[116:119], a[44:47], v[252:255]
    s_add_u32 m0, s43, 4096
    v_mfma_f32_16x16x32_bf16 a[128:131], a[112:115], a[48:51], a[128:131]
    s_add_u32 s44, s41, 128
    ds_read_b128 a[88:91], v5 offset:12288
    v_mfma_f32_16x16x32_bf16 a[132:135], a[116:119], a[48:51], a[132:135]
    v_mfma_f32_16x16x32_bf16 a[136:139], a[112:115], a[52:55], a[136:139]
    ds_read_b64_tr_b16 a[24:25], v9 offset:4096
    buffer_load_dwordx4 v3, s[16:19], s44 offen lds
    v_mfma_f32_16x16x32_bf16 a[140:143], a[116:119], a[52:55], a[140:143]
    s_add_u32 s44, s41, 31872
    v_mfma_f32_16x16x32_bf16 a[144:147], a[112:115], a[56:59], a[144:147]
    v_mfma_f32_16x16x32_bf16 a[148:151], a[116:119], a[56:59], a[148:151]
    ds_read_b64_tr_b16 a[26:27], v9 offset:5120
    v_mfma_f32_16x16x32_bf16 a[152:155], a[112:115], a[60:63], a[152:155]
    buffer_load_dwordx4 v3, s[16:19], s44 offen offset:1024 lds
    v_mfma_f32_16x16x32_bf16 a[156:159], a[116:119], a[60:63], a[156:159]
    s_add_u32 s44, s41, 129152
    ds_read_b128 a[92:95], v5 offset:14336
    v_mfma_f32_16x16x32_bf16 a[160:163], a[120:123], a[32:35], a[160:163]
    v_mfma_f32_16x16x32_bf16 a[164:167], a[124:127], a[32:35], a[164:167]
    ds_read_b64_tr_b16 a[28:29], v10 offset:4096
    v_mfma_f32_16x16x32_bf16 a[168:171], a[120:123], a[36:39], a[168:171]
    buffer_load_dwordx4 v3, s[16:19], s44 offen offset:2048 lds
    v_mfma_f32_16x16x32_bf16 a[172:175], a[124:127], a[36:39], a[172:175]
    s_add_u32 s44, s41, 160896
    ds_read_b64_tr_b16 a[30:31], v10 offset:5120
    v_mfma_f32_16x16x32_bf16 a[176:179], a[120:123], a[40:43], a[176:179]
    v_mfma_f32_16x16x32_bf16 a[180:183], a[124:127], a[40:43], a[180:183]
    v_mfma_f32_16x16x32_bf16 a[184:187], a[120:123], a[44:47], a[184:187]
    buffer_load_dwordx4 v3, s[16:19], s44 offen offset:3072 lds
    v_mfma_f32_16x16x32_bf16 a[188:191], a[124:127], a[44:47], a[188:191]
    v_mfma_f32_16x16x32_bf16 a[192:195], a[120:123], a[48:51], a[192:195]
    v_mfma_f32_16x16x32_bf16 a[196:199], a[124:127], a[48:51], a[196:199]
    v_mfma_f32_16x16x32_bf16 a[200:203], a[120:123], a[52:55], a[200:203]
    buffer_load_dword v13, v14, s[36:39], s51 offen
    v_mfma_f32_16x16x32_bf16 a[204:207], a[124:127], a[52:55], a[204:207]
    s_add_u32 s51, s51, s52
    s_and_b32 s51, s51, 0xffbffbff
    v_mfma_f32_16x16x32_bf16 a[208:211], a[120:123], a[56:59], a[208:211]
    v_mfma_f32_16x16x32_bf16 a[212:215], a[124:127], a[56:59], a[212:215]
    s_cmp_lg_u32 s45, 0
    v_mfma_f32_16x16x32_bf16 a[216:219], a[120:123], a[60:63], a[216:219]
    s_waitcnt lgkmcnt(0)
    v_mfma_f32_16x16x32_bf16 a[220:223], a[124:127], a[60:63], a[220:223]
    s_cbranch_scc1 A_kvl1
    v_mfma_f32_16x16x32_bf16 v[96:99], a[64:67], a[0:3], v[96:99]
    ds_read_b128 a[96:99], v6 offset:0
    buffer_load_dword v62, v60, s[28:31], 0 offen sc1
    v_mfma_f32_16x16x32_bf16 v[100:103], a[68:71], a[0:3], v[100:103]
    ds_read_b64_tr_b16 a[32:33], v7 offset:8192
    v_mfma_f32_16x16x32_bf16 v[104:107], a[64:67], a[4:7], v[104:107]
    v_lshlrev_b32 v42, 16, v42
    v_mfma_f32_16x16x32_bf16 v[108:111], a[68:71], a[4:7], v[108:111]
    ds_read_b64_tr_b16 a[34:35], v7 offset:9216
    buffer_load_dwordx4 v[24:27], v21, s[32:35], s72 offen
    v_mfma_f32_16x16x32_bf16 v[112:115], a[64:67], a[8:11], v[112:115]
    v_mul_f32 v42, 0x3fb8aa3b, v42
    v_mfma_f32_16x16x32_bf16 v[116:119], a[68:71], a[8:11], v[116:119]
    ds_read_b128 a[100:103], v6 offset:2048
    v_mfma_f32_16x16x32_bf16 v[120:123], a[64:67], a[12:15], v[120:123]
    buffer_load_dwordx4 v[28:31], v1, s[20:23], s73 offen
    v_mfma_f32_16x16x32_bf16 v[124:127], a[68:71], a[12:15], v[124:127]
    ds_read_b64_tr_b16 a[36:37], v8 offset:8192
    v_mfma_f32_16x16x32_bf16 v[128:131], a[64:67], a[16:19], v[128:131]
    v_exp_f32 v42, v42
    v_mfma_f32_16x16x32_bf16 v[132:135], a[68:71], a[16:19], v[132:135]
    ds_read_b64_tr_b16 a[38:39], v8 offset:9216
    v_lshlrev_b32 v40, 16, v40
    v_mfma_f32_16x16x32_bf16 v[136:139], a[64:67], a[20:23], v[136:139]
    v_xor_b32 v5, 0x10000, v5
    buffer_load_dwordx4 v[32:35], v1, s[20:23], s73 offen offset:1024
    v_mfma_f32_16x16x32_bf16 v[140:143], a[68:71], a[20:23], v[140:143]
    s_xor_b32 s42, s42, 0x10000
    ds_read_b128 a[104:107], v6 offset:4096
    v_lshlrev_b32 v41, 16, v41
    v_mfma_f32_16x16x32_bf16 v[144:147], a[64:67], a[24:27], v[144:147]
    s_mov_b32 s32, s78
    ds_read_b64_tr_b16 a[40:41], v9 offset:8192
    v_cvt_pk_bf16_f32 v42, v42, v42
    v_mfma_f32_16x16x32_bf16 v[148:151], a[68:71], a[24:27], v[148:151]
    s_mov_b32 s33, s79
    v_lshlrev_b32 v42, 16, v42
    v_mfma_f32_16x16x32_bf16 v[152:155], a[64:67], a[28:31], v[152:155]
    s_mov_b32 s36, s80
    ds_read_b64_tr_b16 a[42:43], v9 offset:9216
    v_mul_f32 v44, v42, v40
    v_mfma_f32_16x16x32_bf16 v[156:159], a[68:71], a[28:31], v[156:159]
    s_mov_b32 s37, s81
    v_mul_f32 v45, v42, v41
    v_mfma_f32_16x16x32_bf16 v[160:163], a[72:75], a[0:3], v[160:163]
    s_mov_b32 s38, 0x80000
    ds_read_b128 a[108:111], v6 offset:6144
    v_mul_f32 v44, 0x3fb8aa3b, v44
    v_mfma_f32_16x16x32_bf16 v[164:167], a[76:79], a[0:3], v[164:167]
    s_lshl_b32 s6, s4, 14
    v_mul_f32 v45, 0.15915494, v45
    v_mfma_f32_16x16x32_bf16 v[168:171], a[72:75], a[4:7], v[168:171]
    s_lshl_b32 s7, s3, 8
    ds_read_b64_tr_b16 a[44:45], v10 offset:8192
    v_mul_f32 v50, 1.0, v44
    v_mfma_f32_16x16x32_bf16 v[172:175], a[76:79], a[4:7], v[172:175]
    s_add_u32 s6, s6, s7
    v_mul_f32 v51, 1.0, v45
    v_mfma_f32_16x16x32_bf16 v[176:179], a[72:75], a[8:11], v[176:179]
    s_add_u32 m0, s42, 131072
    ds_read_b64_tr_b16 a[46:47], v10 offset:9216
    v_mfma_f32_16x16x32_bf16 v[180:183], a[76:79], a[8:11], v[180:183]
    s_add_u32 s44, s6, 0
    buffer_load_dwordx4 v2, s[32:35], s44 offen lds
    v_mfma_f32_16x16x32_bf16 v[184:187], a[72:75], a[12:15], v[184:187]
    s_add_u32 s44, s6, 7168
    ds_read_b128 a[112:115], v6 offset:8192
    buffer_load_dwordx4 v2, s[32:35], s44 offen offset:1024 lds
    v_mfma_f32_16x16x32_bf16 v[188:191], a[76:79], a[12:15], v[188:191]
    s_add_u32 m0, s42, 133120
    ds_read_b64_tr_b16 a[48:49], v7 offset:12288
    v_mfma_f32_16x16x32_bf16 v[192:195], a[72:75], a[16:19], v[192:195]
    s_add_u32 s44, s6, 0
    buffer_load_dwordx4 v2, s[36:39], s44 offen lds
    v_mfma_f32_16x16x32_bf16 v[196:199], a[76:79], a[16:19], v[196:199]
    s_add_u32 s44, s6, 7168
    ds_read_b64_tr_b16 a[50:51], v7 offset:13312
    buffer_load_dwordx4 v2, s[36:39], s44 offen offset:1024 lds
    v_mfma_f32_16x16x32_bf16 v[200:203], a[72:75], a[20:23], v[200:203]
    s_add_u32 m0, s42, 135168
    v_exp_f32 v50, v50
    v_mfma_f32_16x16x32_bf16 v[204:207], a[76:79], a[20:23], v[204:207]
    s_add_u32 s44, s6, 128
    ds_read_b128 a[116:119], v6 offset:10240
    buffer_load_dwordx4 v2, s[32:35], s44 offen lds
    v_mfma_f32_16x16x32_bf16 v[208:211], a[72:75], a[24:27], v[208:211]
    s_add_u32 s44, s6, 7296
    v_fract_f32 v51, v51
    v_mfma_f32_16x16x32_bf16 v[212:215], a[76:79], a[24:27], v[212:215]
    ds_read_b64_tr_b16 a[52:53], v8 offset:12288
    v_mfma_f32_16x16x32_bf16 v[216:219], a[72:75], a[28:31], v[216:219]
    buffer_load_dwordx4 v2, s[32:35], s44 offen offset:1024 lds
    v_mfma_f32_16x16x32_bf16 v[220:223], a[76:79], a[28:31], v[220:223]
    s_add_u32 m0, s42, 137216
    ds_read_b64_tr_b16 a[54:55], v8 offset:13312
    v_mfma_f32_16x16x32_bf16 v[224:227], a[80:83], a[0:3], v[224:227]
    s_add_u32 s44, s6, 128
    v_cos_f32 v48, v51
    v_mfma_f32_16x16x32_bf16 v[228:231], a[84:87], a[0:3], v[228:231]
    ds_read_b128 a[120:123], v6 offset:12288
    buffer_load_dwordx4 v2, s[36:39], s44 offen lds
    v_mfma_f32_16x16x32_bf16 v[232:235], a[80:83], a[4:7], v[232:235]
    s_add_u32 s44, s6, 7296
    ds_read_b64_tr_b16 a[56:57], v9 offset:12288
    v_mfma_f32_16x16x32_bf16 v[236:239], a[84:87], a[4:7], v[236:239]
    v_sin_f32 v49, v51
    v_mfma_f32_16x16x32_bf16 v[240:243], a[80:83], a[8:11], v[240:243]
    ds_read_b64_tr_b16 a[58:59], v9 offset:13312
    buffer_load_dwordx4 v2, s[36:39], s44 offen offset:1024 lds
    v_mfma_f32_16x16x32_bf16 v[244:247], a[84:87], a[8:11], v[244:247]
    s_mov_b32 s32, s70
    v_mul_f32 v48, v48, v50
    v_mfma_f32_16x16x32_bf16 v[248:251], a[80:83], a[12:15], v[248:251]
    s_mov_b32 s33, s71
    ds_read_b128 a[124:127], v6 offset:14336
    v_mul_f32 v49, v49, v50
    v_mfma_f32_16x16x32_bf16 v[252:255], a[84:87], a[12:15], v[252:255]
    s_mov_b32 s34, 0x400000
    v_accvgpr_write_b32 a240, v48
    v_mfma_f32_16x16x32_bf16 a[128:131], a[80:83], a[16:19], a[128:131]
    s_lshl_b32 s6, s4, 17
    ds_read_b64_tr_b16 a[60:61], v10 offset:12288
    v_accvgpr_write_b32 a241, v49
    v_mfma_f32_16x16x32_bf16 a[132:135], a[84:87], a[16:19], a[132:135]
    s_lshl_b32 s7, s3, 15
    v_add_f32 v48, -1.0, v48
    v_mfma_f32_16x16x32_bf16 a[136:139], a[80:83], a[20:23], a[136:139]
    s_add_u32 s6, s6, s7
    ds_read_b64_tr_b16 a[62:63], v10 offset:13312
    v_mul_f32 v52, v40, v40
    v_mfma_f32_16x16x32_bf16 a[140:143], a[84:87], a[20:23], a[140:143]
    s_lshl_b32 s7, s5, 7
    v_fma_f32 v52, v41, v41, v52
    v_mfma_f32_16x16x32_bf16 a[144:147], a[80:83], a[24:27], a[144:147]
    s_add_u32 s6, s6, s7
    v_rcp_f32 v52, v52
    v_mfma_f32_16x16x32_bf16 a[148:151], a[84:87], a[24:27], a[148:151]
    v_mul_f32 v53, v48, v40
    v_mfma_f32_16x16x32_bf16 a[152:155], a[80:83], a[28:31], a[152:155]
    v_xor_b32 v7, 0x10000, v7
    v_xor_b32 v8, 0x10000, v8
    v_mfma_f32_16x16x32_bf16 a[156:159], a[84:87], a[28:31], a[156:159]
    v_xor_b32 v9, 0x10000, v9
    v_xor_b32 v10, 0x10000, v10
    v_mfma_f32_16x16x32_bf16 a[160:163], a[88:91], a[0:3], a[160:163]
    v_xor_b32 v6, 0x10000, v6
    v_fma_f32 v53, v49, v41, v53
    v_mfma_f32_16x16x32_bf16 a[164:167], a[92:95], a[0:3], a[164:167]
    v_mul_f32 v54, v49, v40
    v_mfma_f32_16x16x32_bf16 a[168:171], a[88:91], a[4:7], a[168:171]
    v_fma_f32 v54, -v48, v41, v54
    v_mfma_f32_16x16x32_bf16 a[172:175], a[92:95], a[4:7], a[172:175]
    s_waitcnt lgkmcnt(0)
    v_mul_f32 v52, -2.0, v52
    v_mfma_f32_16x16x32_bf16 a[176:179], a[88:91], a[8:11], a[176:179]
    s_waitcnt vmcnt(13)
    v_mfma_f32_16x16x32_bf16 a[180:183], a[92:95], a[8:11], a[180:183]
    v_mfma_f32_16x16x32_bf16 a[184:187], a[88:91], a[12:15], a[184:187]
    s_barrier
    v_mfma_f32_16x16x32_bf16 a[188:191], a[92:95], a[12:15], a[188:191]
    s_add_u32 m0, s55, 0
    v_mfma_f32_16x16x32_bf16 a[192:195], a[88:91], a[16:19], a[192:195]
    s_add_u32 s44, s54, 0
    buffer_load_dwordx4 v3, s[24:27], s44 offen lds
    v_mul_f32 v53, v53, v52
    v_mfma_f32_16x16x32_bf16 a[196:199], a[92:95], a[16:19], a[196:199]
    s_add_u32 s44, s54, 31744
    v_mul_f32 v54, v54, v52
    v_mfma_f32_16x16x32_bf16 a[200:203], a[88:91], a[20:23], a[200:203]
    v_accvgpr_write_b32 a246, v53
    v_mfma_f32_16x16x32_bf16 a[204:207], a[92:95], a[20:23], a[204:207]
    buffer_load_dwordx4 v3, s[24:27], s44 offen offset:1024 lds
    v_accvgpr_write_b32 a247, v54
    v_mfma_f32_16x16x32_bf16 a[208:211], a[88:91], a[24:27], a[208:211]
    s_add_u32 s44, s54, 129024
    v_mul_f32 v50, 0x41000000, v44
    v_mfma_f32_16x16x32_bf16 a[212:215], a[92:95], a[24:27], a[212:215]
    v_mul_f32 v51, 0x41000000, v45
    v_mfma_f32_16x16x32_bf16 a[216:219], a[88:91], a[28:31], a[216:219]
    v_exp_f32 v50, v50
    v_mfma_f32_16x16x32_bf16 a[220:223], a[92:95], a[28:31], a[220:223]
    buffer_load_dwordx4 v3, s[24:27], s44 offen offset:2048 lds
    v_fract_f32 v51, v51
    v_mfma_f32_16x16x32_bf16 v[96:99], a[96:99], a[32:35], v[96:99]
    s_add_u32 s44, s54, 160768
    ds_read_b128 a[64:67], v5 offset:0
    v_mfma_f32_16x16x32_bf16 v[100:103], a[100:103], a[32:35], v[100:103]
    v_cos_f32 v48, v51
    v_mfma_f32_16x16x32_bf16 v[104:107], a[96:99], a[36:39], v[104:107]
    ds_read_b64_tr_b16 a[0:1], v7 offset:0
    v_mfma_f32_16x16x32_bf16 v[108:111], a[100:103], a[36:39], v[108:111]
    v_sin_f32 v49, v51
    v_mfma_f32_16x16x32_bf16 v[112:115], a[96:99], a[40:43], v[112:115]
    ds_read_b64_tr_b16 a[2:3], v7 offset:1024
    buffer_load_dwordx4 v3, s[24:27], s44 offen offset:3072 lds
    v_mfma_f32_16x16x32_bf16 v[116:119], a[100:103], a[40:43], v[116:119]
    s_add_u32 m0, s42, 0
    v_mul_f32 v48, v48, v50
    v_mfma_f32_16x16x32_bf16 v[120:123], a[96:99], a[44:47], v[120:123]
    s_add_u32 s44, s53, 0
    ds_read_b128 a[68:71], v5 offset:2048
    v_mul_f32 v49, v49, v50
    v_mfma_f32_16x16x32_bf16 v[124:127], a[100:103], a[44:47], v[124:127]
    v_accvgpr_write_b32 a242, v48
    v_mfma_f32_16x16x32_bf16 v[128:131], a[96:99], a[48:51], v[128:131]
    buffer_load_dwordx4 v4, s[20:23], s44 offen lds
    v_accvgpr_write_b32 a243, v49
    v_mfma_f32_16x16x32_bf16 v[132:135], a[100:103], a[48:51], v[132:135]
    s_add_u32 s44, s53, 15360
    ds_read_b64_tr_b16 a[4:5], v8 offset:0
    v_mul_f32 v50, 0x43000000, v44
    v_mfma_f32_16x16x32_bf16 v[136:139], a[96:99], a[52:55], v[136:139]
    v_mul_f32 v51, 0x43000000, v45
    v_mfma_f32_16x16x32_bf16 v[140:143], a[100:103], a[52:55], v[140:143]
    ds_read_b64_tr_b16 a[6:7], v8 offset:1024
    v_mfma_f32_16x16x32_bf16 v[144:147], a[96:99], a[56:59], v[144:147]
    v_exp_f32 v50, v50
    v_mfma_f32_16x16x32_bf16 v[148:151], a[100:103], a[56:59], v[148:151]
    ds_read_b128 a[72:75], v5 offset:4096
    buffer_load_dwordx4 v4, s[20:23], s44 offen offset:1024 lds
    v_mfma_f32_16x16x32_bf16 v[152:155], a[96:99], a[60:63], v[152:155]
    s_add_u32 s44, s53, 2048
    v_fract_f32 v51, v51
    v_mfma_f32_16x16x32_bf16 v[156:159], a[100:103], a[60:63], v[156:159]
    ds_read_b64_tr_b16 a[8:9], v9 offset:0
    v_mfma_f32_16x16x32_bf16 v[160:163], a[104:107], a[32:35], v[160:163]
    v_cos_f32 v48, v51
    v_mfma_f32_16x16x32_bf16 v[164:167], a[108:111], a[32:35], v[164:167]
    buffer_load_dwordx4 v4, s[20:23], s44 offen offset:2048 lds
    v_mfma_f32_16x16x32_bf16 v[168:171], a[104:107], a[36:39], v[168:171]
    s_add_u32 s44, s53, 17408
    ds_read_b64_tr_b16 a[10:11], v9 offset:1024
    v_mfma_f32_16x16x32_bf16 v[172:175], a[108:111], a[36:39], v[172:175]
    v_sin_f32 v49, v51
    v_mfma_f32_16x16x32_bf16 v[176:179], a[104:107], a[40:43], v[176:179]
    ds_read_b128 a[76:79], v5 offset:6144
    v_mul_f32 v48, v48, v50
    v_mfma_f32_16x16x32_bf16 v[180:183], a[108:111], a[40:43], v[180:183]
    v_mul_f32 v49, v49, v50
    v_mfma_f32_16x16x32_bf16 v[184:187], a[104:107], a[44:47], v[184:187]
    ds_read_b64_tr_b16 a[12:13], v10 offset:0
    buffer_load_dwordx4 v4, s[20:23], s44 offen offset:3072 lds
    v_mfma_f32_16x16x32_bf16 v[188:191], a[108:111], a[44:47], v[188:191]
    s_add_u32 m0, s42, 4096
    v_accvgpr_write_b32 a244, v48
    v_mfma_f32_16x16x32_bf16 v[192:195], a[104:107], a[48:51], v[192:195]
    s_add_u32 s44, s47, 0
    ds_read_b64_tr_b16 a[14:15], v10 offset:1024
    v_accvgpr_write_b32 a245, v49
    v_mfma_f32_16x16x32_bf16 v[196:199], a[108:111], a[48:51], v[196:199]
    v_lshl_add_u32 v52, s3, 2, v20
    v_mfma_f32_16x16x32_bf16 v[200:203], a[104:107], a[52:55], v[200:203]
    buffer_load_dwordx4 v4, s[20:23], s44 offen lds
    v_xor_b32 v53, 12, v52
    v_mfma_f32_16x16x32_bf16 v[204:207], a[108:111], a[52:55], v[204:207]
    s_add_u32 s44, s47, 15360
    ds_read_b128 a[80:83], v5 offset:8192
    v_lshlrev_b32 v52, 3, v52
    v_mfma_f32_16x16x32_bf16 v[208:211], a[104:107], a[56:59], v[208:211]
    v_lshlrev_b32 v53, 3, v53
    v_mfma_f32_16x16x32_bf16 v[212:215], a[108:111], a[56:59], v[212:215]
    ds_read_b64_tr_b16 a[16:17], v7 offset:4096
    v_cvt_f32_u32 v52, v52
    v_mfma_f32_16x16x32_bf16 v[216:219], a[104:107], a[60:63], v[216:219]
    buffer_load_dwordx4 v4, s[20:23], s44 offen offset:1024 lds
    v_cvt_f32_u32 v53, v53
    v_mfma_f32_16x16x32_bf16 v[220:223], a[108:111], a[60:63], v[220:223]
    s_add_u32 s44, s47, 2048
    ds_read_b64_tr_b16 a[18:19], v7 offset:5120
    v_mul_f32 v50, v52, v44
    v_mfma_f32_16x16x32_bf16 v[224:227], a[112:115], a[32:35], v[224:227]
    v_mul_f32 v51, v52, v45
    v_mfma_f32_16x16x32_bf16 v[228:231], a[116:119], a[32:35], v[228:231]
    ds_read_b128 a[84:87], v5 offset:10240
    v_mfma_f32_16x16x32_bf16 v[232:235], a[112:115], a[36:39], v[232:235]
    v_exp_f32 v50, v50
    v_mfma_f32_16x16x32_bf16 v[236:239], a[116:119], a[36:39], v[236:239]
    buffer_load_dwordx4 v4, s[20:23], s44 offen offset:2048 lds
    v_fract_f32 v51, v51
    v_mfma_f32_16x16x32_bf16 v[240:243], a[112:115], a[40:43], v[240:243]
    s_add_u32 s44, s47, 17408
    ds_read_b64_tr_b16 a[20:21], v8 offset:4096
    v_mfma_f32_16x16x32_bf16 v[244:247], a[116:119], a[40:43], v[244:247]
    v_cos_f32 v48, v51
    v_mfma_f32_16x16x32_bf16 v[248:251], a[112:115], a[44:47], v[248:251]
    ds_read_b64_tr_b16 a[22:23], v8 offset:5120
    v_mfma_f32_16x16x32_bf16 v[252:255], a[116:119], a[44:47], v[252:255]
    buffer_load_dwordx4 v4, s[20:23], s44 offen offset:3072 lds
    v_mfma_f32_16x16x32_bf16 a[128:131], a[112:115], a[48:51], a[128:131]
    s_add_u32 m0, s55, 0x4000
    ds_read_b128 a[88:91], v5 offset:12288
    v_mfma_f32_16x16x32_bf16 a[132:135], a[116:119], a[48:51], a[132:135]
    s_add_u32 s44, s6, 0
    v_sin_f32 v49, v51
    v_mfma_f32_16x16x32_bf16 a[136:139], a[112:115], a[52:55], a[136:139]
    ds_read_b64_tr_b16 a[24:25], v9 offset:4096
    v_mul_f32 v48, v48, v50
    v_mfma_f32_16x16x32_bf16 a[140:143], a[116:119], a[52:55], a[140:143]
    v_mul_f32 v49, v49, v50
    v_mfma_f32_16x16x32_bf16 a[144:147], a[112:115], a[56:59], a[144:147]
    buffer_load_dwordx4 v2, s[32:35], s44 offen lds
    v_accvgpr_write_b32 a248, v48
    v_mfma_f32_16x16x32_bf16 a[148:151], a[116:119], a[56:59], a[148:151]
    s_add_u32 s44, s6, 15360
    ds_read_b64_tr_b16 a[26:27], v9 offset:5120
    v_accvgpr_write_b32 a249, v49
    v_mfma_f32_16x16x32_bf16 a[152:155], a[112:115], a[60:63], a[152:155]
    v_mul_f32 v50, v53, v44
    v_mfma_f32_16x16x32_bf16 a[156:159], a[116:119], a[60:63], a[156:159]
    ds_read_b128 a[92:95], v5 offset:14336
    v_mul_f32 v51, v53, v45
    v_mfma_f32_16x16x32_bf16 a[160:163], a[120:123], a[32:35], a[160:163]
    buffer_load_dwordx4 v2, s[32:35], s44 offen offset:1024 lds
    v_mfma_f32_16x16x32_bf16 a[164:167], a[124:127], a[32:35], a[164:167]
    s_add_u32 s44, s6, 6144
    ds_read_b64_tr_b16 a[28:29], v10 offset:4096
    v_mfma_f32_16x16x32_bf16 a[168:171], a[120:123], a[36:39], a[168:171]
    v_exp_f32 v50, v50
    v_mfma_f32_16x16x32_bf16 a[172:175], a[124:127], a[36:39], a[172:175]
    ds_read_b64_tr_b16 a[30:31], v10 offset:5120
    v_fract_f32 v51, v51
    v_mfma_f32_16x16x32_bf16 a[176:179], a[120:123], a[40:43], a[176:179]
    v_cos_f32 v48, v51
    v_mfma_f32_16x16x32_bf16 a[180:183], a[124:127], a[40:43], a[180:183]
    buffer_load_dwordx4 v2, s[32:35], s44 offen offset:2048 lds
    v_mfma_f32_16x16x32_bf16 a[184:187], a[120:123], a[44:47], a[184:187]
    s_add_u32 s44, s6, 21504
    v_sin_f32 v49, v51
    v_mfma_f32_16x16x32_bf16 a[188:191], a[124:127], a[44:47], a[188:191]
    v_mul_f32 v48, v48, v50
    v_mfma_f32_16x16x32_bf16 a[192:195], a[120:123], a[48:51], a[192:195]
    v_mul_f32 v49, v49, v50
    v_mfma_f32_16x16x32_bf16 a[196:199], a[124:127], a[48:51], a[196:199]
    buffer_load_dwordx4 v2, s[32:35], s44 offen offset:3072 lds
    v_accvgpr_write_b32 a250, v48
    v_mfma_f32_16x16x32_bf16 a[200:203], a[120:123], a[52:55], a[200:203]
    v_accvgpr_write_b32 a251, v49
    v_mfma_f32_16x16x32_bf16 a[204:207], a[124:127], a[52:55], a[204:207]
    v_mfma_f32_16x16x32_bf16 a[208:211], a[120:123], a[56:59], a[208:211]
    v_mfma_f32_16x16x32_bf16 a[212:215], a[124:127], a[56:59], a[212:215]
    v_mfma_f32_16x16x32_bf16 a[216:219], a[120:123], a[60:63], a[216:219]
    v_mfma_f32_16x16x32_bf16 a[220:223], a[124:127], a[60:63], a[220:223]
    s_waitcnt lgkmcnt(0)
    v_mfma_f32_16x16x32_bf16 v[96:99], a[64:67], a[0:3], v[96:99]
    s_waitcnt vmcnt(24)
    ds_read_b128 a[96:99], v6 offset:0
    v_mov_b32 v16, 0
    v_mfma_f32_16x16x32_bf16 v[100:103], a[68:71], a[0:3], v[100:103]
    s_and_b32 s6, s2, 7
    ds_read_b64_tr_b16 a[32:33], v7 offset:8192
    v_mov_b32 v17, 0
    v_mfma_f32_16x16x32_bf16 v[104:107], a[64:67], a[4:7], v[104:107]
    s_mul_i32 s6, s6, 160
    v_dot2_f32_bf16 v16, v28, v36, v16
    v_mfma_f32_16x16x32_bf16 v[108:111], a[68:71], a[4:7], v[108:111]
    s_lshr_b32 s7, s2, 6
    ds_read_b64_tr_b16 a[34:35], v7 offset:9216
    v_dot2_f32_bf16 v17, v32, v36, v17
    v_mfma_f32_16x16x32_bf16 v[112:115], a[64:67], a[8:11], v[112:115]
    s_mul_i32 s7, s7, 40
    v_dot2_f32_bf16 v16, v29, v37, v16
    v_mfma_f32_16x16x32_bf16 v[116:119], a[68:71], a[8:11], v[116:119]
    s_add_u32 s6, s6, s7
    ds_read_b128 a[100:103], v6 offset:2048
    v_dot2_f32_bf16 v17, v33, v37, v17
    v_mfma_f32_16x16x32_bf16 v[120:123], a[64:67], a[12:15], v[120:123]
    s_add_u32 s6, s6, s5
    v_dot2_f32_bf16 v16, v30, v38, v16
    v_mfma_f32_16x16x32_bf16 v[124:127], a[68:71], a[12:15], v[124:127]
    s_lshl_b32 s6, s6, 2
    ds_read_b64_tr_b16 a[36:37], v8 offset:8192
    v_dot2_f32_bf16 v17, v34, v38, v17
    v_mfma_f32_16x16x32_bf16 v[128:131], a[64:67], a[16:19], v[128:131]
    s_add_u32 s6, s6, s3
    v_dot2_f32_bf16 v16, v31, v39, v16
    v_mfma_f32_16x16x32_bf16 v[132:135], a[68:71], a[16:19], v[132:135]
    s_lshl_b32 s6, s6, 10
    ds_read_b64_tr_b16 a[38:39], v8 offset:9216
    v_dot2_f32_bf16 v17, v35, v39, v17
    v_mfma_f32_16x16x32_bf16 v[136:139], a[64:67], a[20:23], v[136:139]
    s_add_u32 s6, s6, 55705600
    v_add_u32 v5, s56, v5
    buffer_store_dwordx4 v[24:27], v1, s[8:11], s6 offen sc1
    v_mfma_f32_16x16x32_bf16 v[140:143], a[68:71], a[20:23], v[140:143]
    ds_read_b128 a[104:107], v6 offset:4096
    v_and_b32 v36, 1, v0
    v_mfma_f32_16x16x32_bf16 v[144:147], a[64:67], a[24:27], v[144:147]
    ds_read_b64_tr_b16 a[40:41], v9 offset:8192
    v_cmp_eq_u32 vcc, 0, v36
    v_mfma_f32_16x16x32_bf16 v[148:151], a[68:71], a[24:27], v[148:151]
    v_lshlrev_b32 v36, 2, v36
    v_mfma_f32_16x16x32_bf16 v[152:155], a[64:67], a[28:31], v[152:155]
    ds_read_b64_tr_b16 a[42:43], v9 offset:9216
    v_add_f32_dpp v16, v16, v16 row_ror:8 row_mask:0xf bank_mask:0xf
    v_mfma_f32_16x16x32_bf16 v[156:159], a[68:71], a[28:31], v[156:159]
    v_add_f32_dpp v17, v17, v17 row_ror:8 row_mask:0xf bank_mask:0xf
    v_mfma_f32_16x16x32_bf16 v[160:163], a[72:75], a[0:3], v[160:163]
    ds_read_b128 a[108:111], v6 offset:6144
    v_add_f32_dpp v16, v16, v16 row_ror:4 row_mask:0xf bank_mask:0xf
    v_mfma_f32_16x16x32_bf16 v[164:167], a[76:79], a[0:3], v[164:167]
    v_add_f32_dpp v17, v17, v17 row_ror:4 row_mask:0xf bank_mask:0xf
    v_mfma_f32_16x16x32_bf16 v[168:171], a[72:75], a[4:7], v[168:171]
    ds_read_b64_tr_b16 a[44:45], v10 offset:8192
    v_add_f32_dpp v16, v16, v16 row_ror:2 row_mask:0xf bank_mask:0xf
    v_mfma_f32_16x16x32_bf16 v[172:175], a[76:79], a[4:7], v[172:175]
    v_add_f32_dpp v17, v17, v17 row_ror:2 row_mask:0xf bank_mask:0xf
    v_mfma_f32_16x16x32_bf16 v[176:179], a[72:75], a[8:11], v[176:179]
    ds_read_b64_tr_b16 a[46:47], v10 offset:9216
    v_add_f32_dpp v16, v16, v16 row_ror:1 row_mask:0xf bank_mask:0xf
    v_mfma_f32_16x16x32_bf16 v[180:183], a[76:79], a[8:11], v[180:183]
    v_add_f32_dpp v17, v17, v17 row_ror:1 row_mask:0xf bank_mask:0xf
    v_mfma_f32_16x16x32_bf16 v[184:187], a[72:75], a[12:15], v[184:187]
    ds_read_b128 a[112:115], v6 offset:8192
    v_cndmask_b32 v16, v17, v16, vcc
    v_mfma_f32_16x16x32_bf16 v[188:191], a[76:79], a[12:15], v[188:191]
    ds_read_b64_tr_b16 a[48:49], v7 offset:12288
    v_mov_b32 v28, v16
    v_mfma_f32_16x16x32_bf16 v[192:195], a[72:75], a[16:19], v[192:195]
    v_mfma_f32_16x16x32_bf16 v[196:199], a[76:79], a[16:19], v[196:199]
    ds_read_b64_tr_b16 a[50:51], v7 offset:13312
    v_permlane16_swap_b32 v16, v28
    v_mfma_f32_16x16x32_bf16 v[200:203], a[72:75], a[20:23], v[200:203]
    v_add_f32 v16, v16, v28
    v_mfma_f32_16x16x32_bf16 v[204:207], a[76:79], a[20:23], v[204:207]
    ds_read_b128 a[116:119], v6 offset:10240
    v_mov_b32 v28, v16
    v_mfma_f32_16x16x32_bf16 v[208:211], a[72:75], a[24:27], v[208:211]
    v_mfma_f32_16x16x32_bf16 v[212:215], a[76:79], a[24:27], v[212:215]
    ds_read_b64_tr_b16 a[52:53], v8 offset:12288
    v_permlane32_swap_b32 v16, v28
    v_mfma_f32_16x16x32_bf16 v[216:219], a[72:75], a[28:31], v[216:219]
    v_add_f32 v16, v16, v28
    v_mfma_f32_16x16x32_bf16 v[220:223], a[76:79], a[28:31], v[220:223]
    ds_read_b64_tr_b16 a[54:55], v8 offset:13312
    v_mul_f32 v16, 0xbfb8aa3b, v16
    v_mfma_f32_16x16x32_bf16 v[224:227], a[80:83], a[0:3], v[224:227]
    v_exp_f32 v16, v16
    v_mfma_f32_16x16x32_bf16 v[228:231], a[84:87], a[0:3], v[228:231]
    ds_read_b128 a[120:123], v6 offset:12288
    v_add_f32 v16, 1.0, v16
    v_mfma_f32_16x16x32_bf16 v[232:235], a[80:83], a[4:7], v[232:235]
    ds_read_b64_tr_b16 a[56:57], v9 offset:12288
    v_mfma_f32_16x16x32_bf16 v[236:239], a[84:87], a[4:7], v[236:239]
    v_rcp_f32 v16, v16
    v_mfma_f32_16x16x32_bf16 v[240:243], a[80:83], a[8:11], v[240:243]
    s_lshl_b32 s6, s2, 5
    ds_read_b64_tr_b16 a[58:59], v9 offset:13312
    v_mfma_f32_16x16x32_bf16 v[244:247], a[84:87], a[8:11], v[244:247]
    s_lshl_b32 s7, s3, 3
    v_mfma_f32_16x16x32_bf16 v[248:251], a[80:83], a[12:15], v[248:251]
    s_add_u32 s6, s6, s7
    ds_read_b128 a[124:127], v6 offset:14336
    v_mfma_f32_16x16x32_bf16 v[252:255], a[84:87], a[12:15], v[252:255]
    s_add_u32 s6, s6, 60817408
    buffer_store_dword v16, v36, s[8:11], s6 offen sc1
    v_mfma_f32_16x16x32_bf16 a[128:131], a[80:83], a[16:19], a[128:131]
    s_lshl_b32 s6, s96, 5
    ds_read_b64_tr_b16 a[60:61], v10 offset:12288
    v_mfma_f32_16x16x32_bf16 a[132:135], a[84:87], a[16:19], a[132:135]
    s_add_u32 s6, s6, s4
    v_mfma_f32_16x16x32_bf16 a[136:139], a[80:83], a[20:23], a[136:139]
    s_lshl_b32 s6, s6, 7
    ds_read_b64_tr_b16 a[62:63], v10 offset:13312
    v_mfma_f32_16x16x32_bf16 a[140:143], a[84:87], a[20:23], a[140:143]
    s_add_u32 s43, s6, 61145088
    buffer_store_dword v46, off, s[8:11], s43 sc1
    v_mfma_f32_16x16x32_bf16 a[144:147], a[80:83], a[24:27], a[144:147]
    v_lshlrev_b32 v61, 11, v61
    v_mfma_f32_16x16x32_bf16 a[148:151], a[84:87], a[24:27], a[148:151]
    v_lshlrev_b32 v62, 8, v62
    v_mfma_f32_16x16x32_bf16 a[152:155], a[80:83], a[28:31], a[152:155]
    v_add_u32 v7, s57, v7
    v_add_u32 v8, s57, v8
    v_mfma_f32_16x16x32_bf16 a[156:159], a[84:87], a[28:31], a[156:159]
    v_add_u32 v9, s57, v9
    v_add_u32 v10, s57, v10
    v_mfma_f32_16x16x32_bf16 a[160:163], a[88:91], a[0:3], a[160:163]
    v_add_u32 v6, s56, v6
    v_xor_b32 v62, v62, v61
    v_mfma_f32_16x16x32_bf16 a[164:167], a[92:95], a[0:3], a[164:167]
    v_mfma_f32_16x16x32_bf16 a[168:171], a[88:91], a[4:7], a[168:171]
    v_readfirstlane_b32 s57, v62
    v_mfma_f32_16x16x32_bf16 a[172:175], a[92:95], a[4:7], a[172:175]
    s_waitcnt lgkmcnt(0)
    v_mfma_f32_16x16x32_bf16 a[176:179], a[88:91], a[8:11], a[176:179]
    s_waitcnt vmcnt(7)
    v_mfma_f32_16x16x32_bf16 a[180:183], a[92:95], a[8:11], a[180:183]
    v_mfma_f32_16x16x32_bf16 a[184:187], a[88:91], a[12:15], a[184:187]
    s_barrier
    v_mfma_f32_16x16x32_bf16 a[188:191], a[92:95], a[12:15], a[188:191]
    s_add_u32 m0, s55, 65536
    v_mfma_f32_16x16x32_bf16 a[192:195], a[88:91], a[16:19], a[192:195]
    s_add_u32 s44, s54, 524288
    buffer_load_dwordx4 v3, s[24:27], s44 offen lds
    v_mfma_f32_16x16x32_bf16 a[196:199], a[92:95], a[16:19], a[196:199]
    s_add_u32 s44, s54, 556032
    v_mfma_f32_16x16x32_bf16 a[200:203], a[88:91], a[20:23], a[200:203]
    v_mfma_f32_16x16x32_bf16 a[204:207], a[92:95], a[20:23], a[204:207]
    buffer_load_dwordx4 v3, s[24:27], s44 offen offset:1024 lds
    v_mfma_f32_16x16x32_bf16 a[208:211], a[88:91], a[24:27], a[208:211]
    s_add_u32 s44, s54, 653312
    v_mfma_f32_16x16x32_bf16 a[212:215], a[92:95], a[24:27], a[212:215]
    s_add_u32 s6, s46, 0
    v_mfma_f32_16x16x32_bf16 a[216:219], a[88:91], a[28:31], a[216:219]
    v_mfma_f32_16x16x32_bf16 a[220:223], a[92:95], a[28:31], a[220:223]
    buffer_load_dwordx4 v3, s[24:27], s44 offen offset:2048 lds
    v_mfma_f32_16x16x32_bf16 v[96:99], a[96:99], a[32:35], v[96:99]
    s_add_u32 s44, s54, 685056
    ds_read_b128 a[64:67], v5 offset:0
    v_mfma_f32_16x16x32_bf16 v[100:103], a[100:103], a[32:35], v[100:103]
    v_mfma_f32_16x16x32_bf16 v[104:107], a[96:99], a[36:39], v[104:107]
    ds_read_b128 a[68:71], v5 offset:2048
    v_mfma_f32_16x16x32_bf16 v[108:111], a[100:103], a[36:39], v[108:111]
    buffer_load_dwordx4 v3, s[24:27], s44 offen offset:3072 lds
    v_mfma_f32_16x16x32_bf16 v[112:115], a[96:99], a[40:43], v[112:115]
    s_add_u32 m0, s42, 65536
    ds_read_b128 a[72:75], v5 offset:4096
    v_mfma_f32_16x16x32_bf16 v[116:119], a[100:103], a[40:43], v[116:119]
    s_add_u32 s44, s53, 128
    v_cvt_pk_bf16_f32 v96, v96, v97
    v_cvt_pk_bf16_f32 v97, v98, v99
    v_mfma_f32_16x16x32_bf16 v[120:123], a[96:99], a[44:47], v[120:123]
    v_cvt_pk_bf16_f32 v98, v100, v101
    v_cvt_pk_bf16_f32 v99, v102, v103
    v_mfma_f32_16x16x32_bf16 v[124:127], a[100:103], a[44:47], v[124:127]
    buffer_load_dwordx4 v4, s[20:23], s44 offen lds
    ds_read_b128 a[76:79], v5 offset:6144
    v_mfma_f32_16x16x32_bf16 v[128:131], a[96:99], a[48:51], v[128:131]
    s_add_u32 s44, s53, 15488
    v_cvt_pk_bf16_f32 v104, v104, v105
    v_cvt_pk_bf16_f32 v105, v106, v107
    v_mfma_f32_16x16x32_bf16 v[132:135], a[100:103], a[48:51], v[132:135]
    ds_read_b128 a[80:83], v11 offset:0
    v_cvt_pk_bf16_f32 v106, v108, v109
    v_mfma_f32_16x16x32_bf16 v[136:139], a[96:99], a[52:55], v[136:139]
    v_cvt_pk_bf16_f32 v107, v110, v111
    v_cvt_pk_bf16_f32 v112, v112, v113
    v_mfma_f32_16x16x32_bf16 v[140:143], a[100:103], a[52:55], v[140:143]
    buffer_load_dwordx4 v4, s[20:23], s44 offen offset:1024 lds
    v_cvt_pk_bf16_f32 v113, v114, v115
    v_mfma_f32_16x16x32_bf16 v[144:147], a[96:99], a[56:59], v[144:147]
    s_add_u32 s44, s53, 2176
    ds_read_b128 a[84:87], v11 offset:2048
    v_cvt_pk_bf16_f32 v114, v116, v117
    v_mfma_f32_16x16x32_bf16 v[148:151], a[100:103], a[56:59], v[148:151]
    v_cvt_pk_bf16_f32 v115, v118, v119
    v_cvt_pk_bf16_f32 v120, v120, v121
    v_mfma_f32_16x16x32_bf16 v[152:155], a[96:99], a[60:63], v[152:155]
    ds_read_b64_tr_b16 a[0:1], v7 offset:0
    v_cvt_pk_bf16_f32 v121, v122, v123
    v_mfma_f32_16x16x32_bf16 v[156:159], a[100:103], a[60:63], v[156:159]
    buffer_load_dwordx4 v4, s[20:23], s44 offen offset:2048 lds
    v_cvt_pk_bf16_f32 v122, v124, v125
    v_mfma_f32_16x16x32_bf16 v[160:163], a[104:107], a[32:35], v[160:163]
    s_add_u32 s44, s53, 17536
    v_cvt_pk_bf16_f32 v123, v126, v127
    v_cvt_pk_bf16_f32 v128, v128, v129
    v_mfma_f32_16x16x32_bf16 v[164:167], a[108:111], a[32:35], v[164:167]
    ds_read_b64_tr_b16 a[2:3], v7 offset:1024
    v_cvt_pk_bf16_f32 v129, v130, v131
    v_mfma_f32_16x16x32_bf16 v[168:171], a[104:107], a[36:39], v[168:171]
    v_cvt_pk_bf16_f32 v130, v132, v133
    v_cvt_pk_bf16_f32 v131, v134, v135
    v_mfma_f32_16x16x32_bf16 v[172:175], a[108:111], a[36:39], v[172:175]
    buffer_load_dwordx4 v4, s[20:23], s44 offen offset:3072 lds
    ds_read_b64_tr_b16 a[4:5], v8 offset:0
    v_mfma_f32_16x16x32_bf16 v[176:179], a[104:107], a[40:43], v[176:179]
    s_add_u32 m0, s42, 69632
    v_cvt_pk_bf16_f32 v136, v136, v137
    v_cvt_pk_bf16_f32 v137, v138, v139
    v_mfma_f32_16x16x32_bf16 v[180:183], a[108:111], a[40:43], v[180:183]
    s_add_u32 s44, s47, 128
    v_cvt_pk_bf16_f32 v138, v140, v141
    v_cvt_pk_bf16_f32 v139, v142, v143
    v_mfma_f32_16x16x32_bf16 v[184:187], a[104:107], a[44:47], v[184:187]
    ds_read_b64_tr_b16 a[6:7], v8 offset:1024
    v_cvt_pk_bf16_f32 v144, v144, v145
    v_mfma_f32_16x16x32_bf16 v[188:191], a[108:111], a[44:47], v[188:191]
    buffer_load_dwordx4 v4, s[20:23], s44 offen lds
    v_cvt_pk_bf16_f32 v145, v146, v147
    v_mfma_f32_16x16x32_bf16 v[192:195], a[104:107], a[48:51], v[192:195]
    s_add_u32 s44, s47, 15488
    ds_read_b64_tr_b16 a[8:9], v9 offset:0
    v_cvt_pk_bf16_f32 v146, v148, v149
    v_mfma_f32_16x16x32_bf16 v[196:199], a[108:111], a[48:51], v[196:199]
    v_cvt_pk_bf16_f32 v147, v150, v151
    v_cvt_pk_bf16_f32 v152, v152, v153
    v_mfma_f32_16x16x32_bf16 v[200:203], a[104:107], a[52:55], v[200:203]
    v_cvt_pk_bf16_f32 v153, v154, v155
    v_cvt_pk_bf16_f32 v154, v156, v157
    v_mfma_f32_16x16x32_bf16 v[204:207], a[108:111], a[52:55], v[204:207]
    buffer_load_dwordx4 v4, s[20:23], s44 offen offset:1024 lds
    ds_read_b64_tr_b16 a[10:11], v9 offset:1024
    v_mfma_f32_16x16x32_bf16 v[208:211], a[104:107], a[56:59], v[208:211]
    s_add_u32 s44, s47, 2176
    v_cvt_pk_bf16_f32 v155, v158, v159
    v_cvt_pk_bf16_f32 v160, v160, v161
    v_mfma_f32_16x16x32_bf16 v[212:215], a[108:111], a[56:59], v[212:215]
    ds_read_b64_tr_b16 a[12:13], v10 offset:0
    v_cvt_pk_bf16_f32 v161, v162, v163
    v_mfma_f32_16x16x32_bf16 v[216:219], a[104:107], a[60:63], v[216:219]
    v_cvt_pk_bf16_f32 v162, v164, v165
    v_cvt_pk_bf16_f32 v163, v166, v167
    v_mfma_f32_16x16x32_bf16 v[220:223], a[108:111], a[60:63], v[220:223]
    buffer_load_dwordx4 v4, s[20:23], s44 offen offset:2048 lds
    ds_read_b64_tr_b16 a[14:15], v10 offset:1024
    v_mfma_f32_16x16x32_bf16 v[224:227], a[112:115], a[32:35], v[224:227]
    s_add_u32 s44, s47, 17536
    v_cvt_pk_bf16_f32 v168, v168, v169
    v_cvt_pk_bf16_f32 v169, v170, v171
    v_mfma_f32_16x16x32_bf16 v[228:231], a[116:119], a[32:35], v[228:231]
    v_cvt_pk_bf16_f32 v170, v172, v173
    v_cvt_pk_bf16_f32 v171, v174, v175
    v_mfma_f32_16x16x32_bf16 v[232:235], a[112:115], a[36:39], v[232:235]
    ds_read_b64_tr_b16 a[16:17], v7 offset:4096
    v_cvt_pk_bf16_f32 v176, v176, v177
    v_mfma_f32_16x16x32_bf16 v[236:239], a[116:119], a[36:39], v[236:239]
    buffer_load_dwordx4 v4, s[20:23], s44 offen offset:3072 lds
    v_cvt_pk_bf16_f32 v177, v178, v179
    v_mfma_f32_16x16x32_bf16 v[240:243], a[112:115], a[40:43], v[240:243]
    ds_read_b64_tr_b16 a[18:19], v7 offset:5120
    buffer_store_dwordx4 v[96:99], v1, s[8:11], s6 offen offset:0
    v_mfma_f32_16x16x32_bf16 v[244:247], a[116:119], a[40:43], v[244:247]
    v_cvt_pk_bf16_f32 v178, v180, v181
    v_cvt_pk_bf16_f32 v179, v182, v183
    v_mfma_f32_16x16x32_bf16 v[248:251], a[112:115], a[44:47], v[248:251]
    v_cvt_pk_bf16_f32 v184, v184, v185
    v_cvt_pk_bf16_f32 v185, v186, v187
    v_mfma_f32_16x16x32_bf16 v[252:255], a[116:119], a[44:47], v[252:255]
    ds_read_b64_tr_b16 a[20:21], v8 offset:4096
    v_cvt_pk_bf16_f32 v186, v188, v189
    v_mfma_f32_16x16x32_bf16 a[128:131], a[112:115], a[48:51], a[128:131]
    v_cvt_pk_bf16_f32 v187, v190, v191
    buffer_store_dwordx4 v[104:107], v1, s[8:11], s6 offen offset:1024
    v_mfma_f32_16x16x32_bf16 a[132:135], a[116:119], a[48:51], a[132:135]
    ds_read_b64_tr_b16 a[22:23], v8 offset:5120
    v_cvt_pk_bf16_f32 v192, v192, v193
    v_mfma_f32_16x16x32_bf16 a[136:139], a[112:115], a[52:55], a[136:139]
    v_cvt_pk_bf16_f32 v193, v194, v195
    v_cvt_pk_bf16_f32 v194, v196, v197
    v_mfma_f32_16x16x32_bf16 a[140:143], a[116:119], a[52:55], a[140:143]
    v_cvt_pk_bf16_f32 v195, v198, v199
    v_cvt_pk_bf16_f32 v200, v200, v201
    v_mfma_f32_16x16x32_bf16 a[144:147], a[112:115], a[56:59], a[144:147]
    ds_read_b64_tr_b16 a[24:25], v9 offset:4096
    buffer_store_dwordx4 v[112:115], v1, s[8:11], s6 offen offset:2048
    v_mfma_f32_16x16x32_bf16 a[148:151], a[116:119], a[56:59], a[148:151]
    v_cvt_pk_bf16_f32 v201, v202, v203
    v_cvt_pk_bf16_f32 v202, v204, v205
    v_mfma_f32_16x16x32_bf16 a[152:155], a[112:115], a[60:63], a[152:155]
    ds_read_b64_tr_b16 a[26:27], v9 offset:5120
    v_cvt_pk_bf16_f32 v203, v206, v207
    v_mfma_f32_16x16x32_bf16 a[156:159], a[116:119], a[60:63], a[156:159]
    v_cvt_pk_bf16_f32 v208, v208, v209
    v_cvt_pk_bf16_f32 v209, v210, v211
    v_mfma_f32_16x16x32_bf16 a[160:163], a[120:123], a[32:35], a[160:163]
    v_cvt_pk_bf16_f32 v210, v212, v213
    buffer_store_dwordx4 v[120:123], v1, s[8:11], s6 offen offset:3072
    v_mfma_f32_16x16x32_bf16 a[164:167], a[124:127], a[32:35], a[164:167]
    s_add_u32 s6, s46, 4096
    ds_read_b64_tr_b16 a[28:29], v10 offset:4096
    v_cvt_pk_bf16_f32 v211, v214, v215
    v_mfma_f32_16x16x32_bf16 a[168:171], a[120:123], a[36:39], a[168:171]
    v_cvt_pk_bf16_f32 v216, v216, v217
    v_cvt_pk_bf16_f32 v217, v218, v219
    v_mfma_f32_16x16x32_bf16 a[172:175], a[124:127], a[36:39], a[172:175]
    ds_read_b64_tr_b16 a[30:31], v10 offset:5120
    v_cvt_pk_bf16_f32 v218, v220, v221
    v_mfma_f32_16x16x32_bf16 a[176:179], a[120:123], a[40:43], a[176:179]
    v_cvt_pk_bf16_f32 v219, v222, v223
    buffer_store_dwordx4 v[128:131], v1, s[8:11], s6 offen offset:0
    v_mfma_f32_16x16x32_bf16 a[180:183], a[124:127], a[40:43], a[180:183]
    v_cvt_pk_bf16_f32 v224, v224, v225
    v_cvt_pk_bf16_f32 v225, v226, v227
    v_mfma_f32_16x16x32_bf16 a[184:187], a[120:123], a[44:47], a[184:187]
    v_cvt_pk_bf16_f32 v226, v228, v229
    v_cvt_pk_bf16_f32 v227, v230, v231
    v_mfma_f32_16x16x32_bf16 a[188:191], a[124:127], a[44:47], a[188:191]
    v_cvt_pk_bf16_f32 v232, v232, v233
    v_cvt_pk_bf16_f32 v233, v234, v235
    v_mfma_f32_16x16x32_bf16 a[192:195], a[120:123], a[48:51], a[192:195]
    v_cvt_pk_bf16_f32 v234, v236, v237
    buffer_store_dwordx4 v[136:139], v1, s[8:11], s6 offen offset:1024
    v_mfma_f32_16x16x32_bf16 a[196:199], a[124:127], a[48:51], a[196:199]
    v_cvt_pk_bf16_f32 v235, v238, v239
    v_cvt_pk_bf16_f32 v240, v240, v241
    v_mfma_f32_16x16x32_bf16 a[200:203], a[120:123], a[52:55], a[200:203]
    v_cvt_pk_bf16_f32 v241, v242, v243
    v_cvt_pk_bf16_f32 v242, v244, v245
    v_mfma_f32_16x16x32_bf16 a[204:207], a[124:127], a[52:55], a[204:207]
    v_cvt_pk_bf16_f32 v243, v246, v247
    v_cvt_pk_bf16_f32 v248, v248, v249
    v_mfma_f32_16x16x32_bf16 a[208:211], a[120:123], a[56:59], a[208:211]
    v_cvt_pk_bf16_f32 v249, v250, v251
    v_cvt_pk_bf16_f32 v250, v252, v253
    v_mfma_f32_16x16x32_bf16 a[212:215], a[124:127], a[56:59], a[212:215]
    v_cvt_pk_bf16_f32 v251, v254, v255
    v_mfma_f32_16x16x32_bf16 a[216:219], a[120:123], a[60:63], a[216:219]
    s_waitcnt lgkmcnt(0)
    v_mfma_f32_16x16x32_bf16 a[220:223], a[124:127], a[60:63], a[220:223]
A_q:
    v_mfma_f32_16x16x32_bf16 v[16:19], a[64:67], a[80:83], 0
    ds_read_b128 a[96:99], v6 offset:0
    v_mfma_f32_16x16x32_bf16 v[20:23], a[68:71], a[80:83], 0
    s_lshl_b32 s52, s4, 3
    ds_read_b128 a[100:103], v6 offset:2048
    v_mfma_f32_16x16x32_bf16 v[24:27], a[72:75], a[80:83], 0
    ds_read_b128 a[104:107], v6 offset:4096
    v_xor_b32 v5, 0x10000, v5
    v_mfma_f32_16x16x32_bf16 v[28:31], a[76:79], a[80:83], 0
    v_mfma_f32_16x16x32_bf16 v[32:35], a[64:67], a[84:87], 0
    s_mov_b32 s64, 0xfff0ffff
    ds_read_b128 a[108:111], v6 offset:6144
    v_mfma_f32_16x16x32_bf16 v[36:39], a[68:71], a[84:87], 0
    s_mov_b32 s65, 0xff00fff0
    ds_read_b128 a[112:115], v12 offset:0
    v_mfma_f32_16x16x32_bf16 v[40:43], a[72:75], a[84:87], 0
    s_mov_b32 s66, 0xfff0fffe
    ds_read_b128 a[116:119], v12 offset:2048
    v_mfma_f32_16x16x32_bf16 v[44:47], a[76:79], a[84:87], 0
    s_mov_b32 s67, 0xff00ffe0
    v_mfma_f32_16x16x32_bf16 v[48:51], a[0:3], a[64:67], 0
    s_mov_b32 s68, 0xfff0fffc
    ds_read_b64_tr_b16 a[32:33], v7 offset:8192
    v_mfma_f32_16x16x32_bf16 v[52:55], a[0:3], a[68:71], 0
    s_mov_b32 s69, 0xff00ffc0
    ds_read_b64_tr_b16 a[34:35], v7 offset:9216
    v_mfma_f32_16x16x32_bf16 v[56:59], a[0:3], a[72:75], 0
    s_mov_b32 s70, 0xfff0fff8
    ds_read_b64_tr_b16 a[36:37], v8 offset:8192
    v_mfma_f32_16x16x32_bf16 v[60:63], a[0:3], a[76:79], 0
    s_mov_b32 s71, 0xff00ff80
    v_mfma_f32_16x16x32_bf16 v[64:67], a[4:7], a[64:67], 0
    s_mov_b32 s72, 0xffffffff
    ds_read_b64_tr_b16 a[38:39], v8 offset:9216
    v_mfma_f32_16x16x32_bf16 v[68:71], a[4:7], a[68:71], 0
    s_mov_b32 s73, 0xfff0fff0
    ds_read_b64_tr_b16 a[40:41], v9 offset:8192
    v_mfma_f32_16x16x32_bf16 v[72:75], a[4:7], a[72:75], 0
    s_mov_b32 s74, 0xfffeffff
    v_mfma_f32_16x16x32_bf16 v[76:79], a[4:7], a[76:79], 0
    s_mov_b32 s75, 0xffe0fff0
    ds_read_b64_tr_b16 a[42:43], v9 offset:9216
    v_mfma_f32_16x16x32_bf16 v[80:83], a[8:11], a[64:67], 0
    s_mov_b32 s76, 0xfffcffff
    ds_read_b64_tr_b16 a[44:45], v10 offset:8192
    v_mfma_f32_16x16x32_bf16 v[84:87], a[8:11], a[68:71], 0
    s_mov_b32 s77, 0xffc0fff0
    ds_read_b64_tr_b16 a[46:47], v10 offset:9216
    v_mfma_f32_16x16x32_bf16 v[88:91], a[8:11], a[72:75], 0
    s_mov_b32 s78, 0xfff8ffff
    v_mfma_f32_16x16x32_bf16 v[92:95], a[8:11], a[76:79], 0
    s_mov_b32 s79, 0xff80fff0
    ds_read_b64_tr_b16 a[48:49], v7 offset:12288
    v_mfma_f32_16x16x32_bf16 v[100:103], a[12:15], a[64:67], 0
    s_mov_b32 s80, 0xf000ff00
    ds_read_b64_tr_b16 a[50:51], v7 offset:13312
    v_mfma_f32_16x16x32_bf16 v[108:111], a[12:15], a[68:71], 0
    s_mov_b32 s81, 0xf000
    ds_read_b64_tr_b16 a[52:53], v8 offset:12288
    v_mfma_f32_16x16x32_bf16 v[116:119], a[12:15], a[72:75], 0
    s_mov_b32 s82, 0xf000fe00
    v_mfma_f32_16x16x32_bf16 v[124:127], a[12:15], a[76:79], 0
    s_mov_b32 s83, 0xe000
    ds_read_b64_tr_b16 a[54:55], v8 offset:13312
    v_mfma_f32_16x16x32_bf16 v[132:135], a[16:19], a[64:67], 0
    s_mov_b32 s84, 0xf000fc00
    ds_read_b64_tr_b16 a[56:57], v9 offset:12288
    v_mfma_f32_16x16x32_bf16 v[140:143], a[16:19], a[68:71], 0
    s_mov_b32 s85, 0xc000
    ds_read_b64_tr_b16 a[58:59], v9 offset:13312
    v_mfma_f32_16x16x32_bf16 v[148:151], a[16:19], a[72:75], 0
    s_mov_b32 s86, 0xf000f800
    v_mfma_f32_16x16x32_bf16 v[156:159], a[16:19], a[76:79], 0
    s_mov_b32 s87, 0x8000
    ds_read_b64_tr_b16 a[60:61], v10 offset:12288
    v_mfma_f32_16x16x32_bf16 v[164:167], a[20:23], a[64:67], 0
    s_mov_b32 s88, 0xff00ff00
    ds_read_b64_tr_b16 a[62:63], v10 offset:13312
    v_mfma_f32_16x16x32_bf16 v[172:175], a[20:23], a[68:71], 0
    s_mov_b32 s89, 0xf000f000
    v_mfma_f32_16x16x32_bf16 v[180:183], a[20:23], a[72:75], 0
    s_mov_b32 s90, 0xfe00ff00
    v_mfma_f32_16x16x32_bf16 v[188:191], a[20:23], a[76:79], 0
    s_mov_b32 s91, 0xe000f000
    v_mfma_f32_16x16x32_bf16 v[196:199], a[24:27], a[64:67], 0
    s_mov_b32 s92, 0xfc00ff00
    v_mfma_f32_16x16x32_bf16 v[204:207], a[24:27], a[68:71], 0
    s_mov_b32 s93, 0xc000f000
    v_mfma_f32_16x16x32_bf16 v[212:215], a[24:27], a[72:75], 0
    s_mov_b32 s94, 0xf800ff00
    v_xor_b32 v7, 0x10000, v7
    v_xor_b32 v8, 0x10000, v8
    v_mfma_f32_16x16x32_bf16 v[220:223], a[24:27], a[76:79], 0
    s_mov_b32 s95, 0x8000f000
    v_xor_b32 v9, 0x10000, v9
    v_xor_b32 v10, 0x10000, v10
    v_mfma_f32_16x16x32_bf16 v[228:231], a[28:31], a[64:67], 0
    s_mov_b32 s58, 0x3e0293ee
    v_xor_b32 v6, 0x10000, v6
    v_mfma_f32_16x16x32_bf16 v[236:239], a[28:31], a[68:71], 0
    s_mov_b32 s59, 0x3e0293ee
    v_mfma_f32_16x16x32_bf16 v[244:247], a[28:31], a[72:75], 0
    s_mov_b32 s99, 0
    v_mfma_f32_16x16x32_bf16 v[252:255], a[28:31], a[76:79], 0
    s_waitcnt lgkmcnt(0)
    v_mfma_f32_16x16x32_bf16 v[16:19], a[96:99], a[112:115], v[16:19]
    s_waitcnt vmcnt(6)
    v_mfma_f32_16x16x32_bf16 v[20:23], a[100:103], a[112:115], v[20:23]
    s_lshr_b32 s17, s4, 3
    v_mfma_f32_16x16x32_bf16 v[24:27], a[104:107], a[112:115], v[24:27]
    s_barrier
    v_mfma_f32_16x16x32_bf16 v[28:31], a[108:111], a[112:115], v[28:31]
    s_add_u32 m0, s55, 0
    v_mfma_f32_16x16x32_bf16 v[32:35], a[96:99], a[116:119], v[32:35]
    s_add_u32 s44, s54, 1048576
    ds_read_b128 a[64:67], v5 offset:0
    buffer_load_dwordx4 v3, s[24:27], s44 offen lds
    v_mfma_f32_16x16x32_bf16 v[36:39], a[100:103], a[116:119], v[36:39]
    s_add_u32 s44, s54, 1080320
    ds_read_b128 a[68:71], v5 offset:2048
    v_mfma_f32_16x16x32_bf16 v[40:43], a[104:107], a[116:119], v[40:43]
    s_bfe_u32 s18, s4, 0x10002
    ds_read_b128 a[72:75], v5 offset:4096
    v_mov_b32 v14, s52
    v_mfma_f32_16x16x32_bf16 v[44:47], a[108:111], a[116:119], v[44:47]
    s_lshl_b32 s16, s5, 1
    ds_read_b128 a[76:79], v5 offset:6144
    buffer_load_dwordx4 v3, s[24:27], s44 offen offset:1024 lds
    v_mfma_f32_16x16x32_bf16 v[48:51], a[32:35], a[96:99], v[48:51]
    s_add_u32 s44, s54, 1177600
    v_mov_b32 v15, 0x1000000
    v_mfma_f32_16x16x32_bf16 v[52:55], a[32:35], a[100:103], v[52:55]
    s_add_u32 s16, s16, s18
    ds_read_b128 a[80:83], v11 offset:4096
    v_mfma_f32_16x16x32_bf16 v[56:59], a[32:35], a[104:107], v[56:59]
    s_lshl_b32 s18, s16, 3
    ds_read_b128 a[84:87], v11 offset:6144
    v_mfma_f32_16x16x32_bf16 v[60:63], a[32:35], a[108:111], v[60:63]
    s_add_u32 s18, s18, s17
    ds_read_b64_tr_b16 a[0:1], v7 offset:0
    buffer_load_dwordx4 v3, s[24:27], s44 offen offset:2048 lds
    v_mfma_f32_16x16x32_bf16 v[64:67], a[36:39], a[96:99], v[64:67]
    s_add_u32 s44, s54, 1209344
    ds_read_b64_tr_b16 a[2:3], v7 offset:1024
    v_mfma_f32_16x16x32_bf16 v[68:71], a[36:39], a[100:103], v[68:71]
    s_lshl_b32 s18, s18, 10
    v_mfma_f32_16x16x32_bf16 v[72:75], a[36:39], a[104:107], v[72:75]
    s_add_u32 s61, s18, 61145088
    ds_read_b64_tr_b16 a[4:5], v8 offset:0
    v_mfma_f32_16x16x32_bf16 v[76:79], a[36:39], a[108:111], v[76:79]
    s_mov_b32 s32, s8
    ds_read_b64_tr_b16 a[6:7], v8 offset:1024
    buffer_load_dwordx4 v3, s[24:27], s44 offen offset:3072 lds
    v_mfma_f32_16x16x32_bf16 v[80:83], a[40:43], a[96:99], v[80:83]
    s_add_u32 m0, s42, 0
    ds_read_b64_tr_b16 a[8:9], v9 offset:0
    v_mfma_f32_16x16x32_bf16 v[84:87], a[40:43], a[100:103], v[84:87]
    s_add_u32 s44, s53, 256
    v_mfma_f32_16x16x32_bf16 v[88:91], a[40:43], a[104:107], v[88:91]
    s_mov_b32 s33, s9
    ds_read_b64_tr_b16 a[10:11], v9 offset:1024
    v_mfma_f32_16x16x32_bf16 v[92:95], a[40:43], a[108:111], v[92:95]
    s_mov_b32 s35, s11
    ds_read_b64_tr_b16 a[12:13], v10 offset:0
    buffer_load_dwordx4 v4, s[20:23], s44 offen lds
    v_mfma_f32_16x16x32_bf16 v[100:103], a[44:47], a[96:99], v[100:103]
    s_add_u32 s44, s53, 15616
    ds_read_b64_tr_b16 a[14:15], v10 offset:1024
    v_mfma_f32_16x16x32_bf16 v[108:111], a[44:47], a[100:103], v[108:111]
    s_mul_i32 s19, s17, 163840
    ds_read_b64_tr_b16 a[16:17], v7 offset:4096
    v_mfma_f32_16x16x32_bf16 v[116:119], a[44:47], a[104:107], v[116:119]
    s_and_b32 s15, s4, 3
    v_mfma_f32_16x16x32_bf16 v[124:127], a[44:47], a[108:111], v[124:127]
    s_lshl_b32 s15, s15, 1
    ds_read_b64_tr_b16 a[18:19], v7 offset:5120
    buffer_load_dwordx4 v4, s[20:23], s44 offen offset:1024 lds
    v_mfma_f32_16x16x32_bf16 v[132:135], a[48:51], a[96:99], v[132:135]
    s_add_u32 s44, s53, 2304
    ds_read_b64_tr_b16 a[20:21], v8 offset:4096
    v_mfma_f32_16x16x32_bf16 v[140:143], a[48:51], a[100:103], v[140:143]
    s_lshr_b32 s14, s3, 1
    ds_read_b64_tr_b16 a[22:23], v8 offset:5120
    v_mfma_f32_16x16x32_bf16 v[148:151], a[48:51], a[104:107], v[148:151]
    s_add_u32 s15, s15, s14
    ds_read_b64_tr_b16 a[24:25], v9 offset:4096
    v_mfma_f32_16x16x32_bf16 v[156:159], a[48:51], a[108:111], v[156:159]
    s_mul_i32 s15, s15, 655360
    buffer_load_dwordx4 v4, s[20:23], s44 offen offset:2048 lds
    v_mfma_f32_16x16x32_bf16 v[164:167], a[52:55], a[96:99], v[164:167]
    s_add_u32 s44, s53, 17664
    ds_read_b64_tr_b16 a[26:27], v9 offset:5120
    v_mfma_f32_16x16x32_bf16 v[172:175], a[52:55], a[100:103], v[172:175]
    s_add_u32 s15, s15, s19
    ds_read_b64_tr_b16 a[28:29], v10 offset:4096
    v_mfma_f32_16x16x32_bf16 v[180:183], a[52:55], a[104:107], v[180:183]
    s_and_b32 s18, s3, 1
    ds_read_b64_tr_b16 a[30:31], v10 offset:5120
    v_mfma_f32_16x16x32_bf16 v[188:191], a[52:55], a[108:111], v[188:191]
    s_lshl_b32 s18, s18, 11
    buffer_load_dwordx4 v4, s[20:23], s44 offen offset:3072 lds
    v_mfma_f32_16x16x32_bf16 v[196:199], a[56:59], a[96:99], v[196:199]
    s_add_u32 m0, s42, 4096
    v_mfma_f32_16x16x32_bf16 v[204:207], a[56:59], a[100:103], v[204:207]
    s_add_u32 s44, s47, 256
    v_mfma_f32_16x16x32_bf16 v[212:215], a[56:59], a[104:107], v[212:215]
    s_add_u32 s15, s15, s18
    v_mfma_f32_16x16x32_bf16 v[220:223], a[56:59], a[108:111], v[220:223]
    s_add_u32 s15, s15, 55574528
    buffer_load_dwordx4 v4, s[20:23], s44 offen lds
    v_mfma_f32_16x16x32_bf16 v[228:231], a[60:63], a[96:99], v[228:231]
    s_add_u32 s44, s47, 15616
    v_mfma_f32_16x16x32_bf16 v[236:239], a[60:63], a[100:103], v[236:239]
    s_lshl_b32 s13, s17, 10
    v_mfma_f32_16x16x32_bf16 v[244:247], a[60:63], a[104:107], v[244:247]
    s_xor_b32 s18, s18, s13
    v_mfma_f32_16x16x32_bf16 v[252:255], a[60:63], a[108:111], v[252:255]
    s_waitcnt lgkmcnt(0)
    buffer_load_dwordx4 v4, s[20:23], s44 offen offset:1024 lds
    v_mfma_f32_16x16x32_bf16 v[16:19], a[64:67], a[80:83], v[16:19]
    s_add_u32 s44, s47, 2304
    ds_read_b128 a[96:99], v6 offset:0
    v_mfma_f32_16x16x32_bf16 v[20:23], a[68:71], a[80:83], v[20:23]
    s_and_b32 s18, s18, 2048
    ds_read_b128 a[100:103], v6 offset:2048
    v_mfma_f32_16x16x32_bf16 v[24:27], a[72:75], a[80:83], v[24:27]
    s_add_u32 s19, s19, s18
    ds_read_b128 a[104:107], v6 offset:4096
    v_xor_b32 v5, 0x10000, v5
    v_mfma_f32_16x16x32_bf16 v[28:31], a[76:79], a[80:83], v[28:31]
    s_lshl_b32 s18, s14, 12
    buffer_load_dwordx4 v4, s[20:23], s44 offen offset:2048 lds
    v_mfma_f32_16x16x32_bf16 v[32:35], a[64:67], a[84:87], v[32:35]
    s_add_u32 s44, s47, 17664
    ds_read_b128 a[108:111], v6 offset:6144
    v_mfma_f32_16x16x32_bf16 v[36:39], a[68:71], a[84:87], v[36:39]
    s_add_u32 s19, s19, s18
    ds_read_b128 a[112:115], v12 offset:4096
    v_mfma_f32_16x16x32_bf16 v[40:43], a[72:75], a[84:87], v[40:43]
    s_add_u32 s19, s19, 34601984
    ds_read_b128 a[116:119], v12 offset:6144
    v_mfma_f32_16x16x32_bf16 v[44:47], a[76:79], a[84:87], v[44:47]
    s_mul_i32 s12, s16, 655360
    buffer_load_dwordx4 v4, s[20:23], s44 offen offset:3072 lds
    v_mfma_f32_16x16x32_bf16 v[48:51], a[0:3], a[64:67], v[48:51]
    s_sub_u32 s13, 20316160, s12
    ds_read_b64_tr_b16 a[32:33], v7 offset:8192
    buffer_store_dwordx4 v[144:147], v1, s[8:11], s6 offen offset:2048
    v_mfma_f32_16x16x32_bf16 v[52:55], a[0:3], a[68:71], v[52:55]
    s_add_u32 s12, s12, s19
    ds_read_b64_tr_b16 a[34:35], v7 offset:9216
    v_mfma_f32_16x16x32_bf16 v[56:59], a[0:3], a[72:75], v[56:59]
    s_add_u32 s13, s13, s19
    ds_read_b64_tr_b16 a[36:37], v8 offset:8192
    v_mfma_f32_16x16x32_bf16 v[60:63], a[0:3], a[76:79], v[60:63]
    s_cmp_eq_u32 s14, 0
    s_cselect_b32 s14, s12, s13
    v_mfma_f32_16x16x32_bf16 v[64:67], a[4:7], a[64:67], v[64:67]
    s_sub_u32 s14, s14, s18
    ds_read_b64_tr_b16 a[38:39], v8 offset:9216
    buffer_store_dwordx4 v[152:155], v1, s[8:11], s6 offen offset:3072
    v_mfma_f32_16x16x32_bf16 v[68:71], a[4:7], a[68:71], v[68:71]
    s_add_u32 s6, s46, 262144
    ds_read_b64_tr_b16 a[40:41], v9 offset:8192
    v_mfma_f32_16x16x32_bf16 v[72:75], a[4:7], a[72:75], v[72:75]
    s_add_u32 s14, s14, 131072
    v_mfma_f32_16x16x32_bf16 v[76:79], a[4:7], a[76:79], v[76:79]
    s_and_b32 s18, s17, 1
    ds_read_b64_tr_b16 a[42:43], v9 offset:9216
    v_mfma_f32_16x16x32_bf16 v[80:83], a[8:11], a[64:67], v[80:83]
    s_lshl_b32 s18, s18, 10
    ds_read_b64_tr_b16 a[44:45], v10 offset:8192
    buffer_store_dwordx4 v[160:163], v1, s[8:11], s6 offen offset:0
    v_mfma_f32_16x16x32_bf16 v[84:87], a[8:11], a[68:71], v[84:87]
    s_add_u32 s19, s18, 1024
    ds_read_b64_tr_b16 a[46:47], v10 offset:9216
    v_mfma_f32_16x16x32_bf16 v[88:91], a[8:11], a[72:75], v[88:91]
    s_xor_b32 s18, s18, 1024
    v_mfma_f32_16x16x32_bf16 v[92:95], a[8:11], a[76:79], v[92:95]
    ds_read_b64_tr_b16 a[48:49], v7 offset:12288
    v_mfma_f32_16x16x32_bf16 v[100:103], a[12:15], a[64:67], v[100:103]
    ds_read_b64_tr_b16 a[50:51], v7 offset:13312
    buffer_store_dwordx4 v[168:171], v1, s[8:11], s6 offen offset:1024
    v_mfma_f32_16x16x32_bf16 v[108:111], a[12:15], a[68:71], v[108:111]
    ds_read_b64_tr_b16 a[52:53], v8 offset:12288
    v_mfma_f32_16x16x32_bf16 v[116:119], a[12:15], a[72:75], v[116:119]
    v_mfma_f32_16x16x32_bf16 v[124:127], a[12:15], a[76:79], v[124:127]
    ds_read_b64_tr_b16 a[54:55], v8 offset:13312
    v_mfma_f32_16x16x32_bf16 v[132:135], a[16:19], a[64:67], v[132:135]
    ds_read_b64_tr_b16 a[56:57], v9 offset:12288
    buffer_store_dwordx4 v[176:179], v1, s[8:11], s6 offen offset:2048
    v_mfma_f32_16x16x32_bf16 v[140:143], a[16:19], a[68:71], v[140:143]
    ds_read_b64_tr_b16 a[58:59], v9 offset:13312
    v_mfma_f32_16x16x32_bf16 v[148:151], a[16:19], a[72:75], v[148:151]
    v_mfma_f32_16x16x32_bf16 v[156:159], a[16:19], a[76:79], v[156:159]
    ds_read_b64_tr_b16 a[60:61], v10 offset:12288
    v_mfma_f32_16x16x32_bf16 v[164:167], a[20:23], a[64:67], v[164:167]
    ds_read_b64_tr_b16 a[62:63], v10 offset:13312
    v_mfma_f32_16x16x32_bf16 v[172:175], a[20:23], a[68:71], v[172:175]
    v_mfma_f32_16x16x32_bf16 v[180:183], a[20:23], a[72:75], v[180:183]
    v_mfma_f32_16x16x32_bf16 v[188:191], a[20:23], a[76:79], v[188:191]
    v_mfma_f32_16x16x32_bf16 v[196:199], a[24:27], a[64:67], v[196:199]
    v_mfma_f32_16x16x32_bf16 v[204:207], a[24:27], a[68:71], v[204:207]
    v_mfma_f32_16x16x32_bf16 v[212:215], a[24:27], a[72:75], v[212:215]
    v_xor_b32 v7, 0x10000, v7
    v_xor_b32 v8, 0x10000, v8
    v_mfma_f32_16x16x32_bf16 v[220:223], a[24:27], a[76:79], v[220:223]
    v_xor_b32 v9, 0x10000, v9
    v_xor_b32 v10, 0x10000, v10
    v_mfma_f32_16x16x32_bf16 v[228:231], a[28:31], a[64:67], v[228:231]
    v_xor_b32 v6, 0x10000, v6
    v_mfma_f32_16x16x32_bf16 v[236:239], a[28:31], a[68:71], v[236:239]
    v_mfma_f32_16x16x32_bf16 v[244:247], a[28:31], a[72:75], v[244:247]
    v_mfma_f32_16x16x32_bf16 v[252:255], a[28:31], a[76:79], v[252:255]
    s_waitcnt lgkmcnt(0)
    v_mfma_f32_16x16x32_bf16 v[16:19], a[96:99], a[112:115], v[16:19]
    s_waitcnt vmcnt(5)
    v_mfma_f32_16x16x32_bf16 v[20:23], a[100:103], a[112:115], v[20:23]
    v_mfma_f32_16x16x32_bf16 v[24:27], a[104:107], a[112:115], v[24:27]
    s_barrier
    v_mfma_f32_16x16x32_bf16 v[28:31], a[108:111], a[112:115], v[28:31]
    s_add_u32 m0, s55, 65536
    v_mfma_f32_16x16x32_bf16 v[32:35], a[96:99], a[116:119], v[32:35]
    s_add_u32 s44, s54, 1572864
    ds_read_b128 a[64:67], v5 offset:0
    buffer_load_dwordx4 v3, s[24:27], s44 offen lds
    v_mfma_f32_16x16x32_bf16 v[36:39], a[100:103], a[116:119], v[36:39]
    s_add_u32 s44, s54, 1604608
    ds_read_b128 a[68:71], v5 offset:2048
    v_mfma_f32_16x16x32_bf16 v[40:43], a[104:107], a[116:119], v[40:43]
    ds_read_b128 a[72:75], v5 offset:4096
    v_mfma_f32_16x16x32_bf16 v[44:47], a[108:111], a[116:119], v[44:47]
    ds_read_b128 a[76:79], v5 offset:6144
    buffer_load_dwordx4 v3, s[24:27], s44 offen offset:1024 lds
    v_mfma_f32_16x16x32_bf16 v[48:51], a[32:35], a[96:99], v[48:51]
    s_add_u32 s44, s54, 1701888
    v_mfma_f32_16x16x32_bf16 v[52:55], a[32:35], a[100:103], v[52:55]
    ds_read_b128 a[80:83], v11 offset:8192
    v_mfma_f32_16x16x32_bf16 v[56:59], a[32:35], a[104:107], v[56:59]
    ds_read_b128 a[84:87], v11 offset:10240
    v_mfma_f32_16x16x32_bf16 v[60:63], a[32:35], a[108:111], v[60:63]
    ds_read_b64_tr_b16 a[0:1], v7 offset:0
    buffer_load_dwordx4 v3, s[24:27], s44 offen offset:2048 lds
    v_mfma_f32_16x16x32_bf16 v[64:67], a[36:39], a[96:99], v[64:67]
    s_add_u32 s44, s54, 1733632
    ds_read_b64_tr_b16 a[2:3], v7 offset:1024
    v_mfma_f32_16x16x32_bf16 v[68:71], a[36:39], a[100:103], v[68:71]
    v_mfma_f32_16x16x32_bf16 v[72:75], a[36:39], a[104:107], v[72:75]
    ds_read_b64_tr_b16 a[4:5], v8 offset:0
    v_mfma_f32_16x16x32_bf16 v[76:79], a[36:39], a[108:111], v[76:79]
    ds_read_b64_tr_b16 a[6:7], v8 offset:1024
    buffer_load_dwordx4 v3, s[24:27], s44 offen offset:3072 lds
    v_mfma_f32_16x16x32_bf16 v[80:83], a[40:43], a[96:99], v[80:83]
    s_add_u32 m0, s42, 65536
    ds_read_b64_tr_b16 a[8:9], v9 offset:0
    v_mfma_f32_16x16x32_bf16 v[84:87], a[40:43], a[100:103], v[84:87]
    s_add_u32 s44, s53, 384
    v_mfma_f32_16x16x32_bf16 v[88:91], a[40:43], a[104:107], v[88:91]
    ds_read_b64_tr_b16 a[10:11], v9 offset:1024
    v_mfma_f32_16x16x32_bf16 v[92:95], a[40:43], a[108:111], v[92:95]
    ds_read_b64_tr_b16 a[12:13], v10 offset:0
    buffer_load_dwordx4 v4, s[20:23], s44 offen lds
    v_mfma_f32_16x16x32_bf16 v[100:103], a[44:47], a[96:99], v[100:103]
    s_add_u32 s44, s53, 15744
    ds_read_b64_tr_b16 a[14:15], v10 offset:1024
    v_mfma_f32_16x16x32_bf16 v[108:111], a[44:47], a[100:103], v[108:111]
    ds_read_b64_tr_b16 a[16:17], v7 offset:4096
    v_mfma_f32_16x16x32_bf16 v[116:119], a[44:47], a[104:107], v[116:119]
    v_mfma_f32_16x16x32_bf16 v[124:127], a[44:47], a[108:111], v[124:127]
    ds_read_b64_tr_b16 a[18:19], v7 offset:5120
    buffer_load_dwordx4 v4, s[20:23], s44 offen offset:1024 lds
    v_mfma_f32_16x16x32_bf16 v[132:135], a[48:51], a[96:99], v[132:135]
    s_add_u32 s44, s53, 2432
    ds_read_b64_tr_b16 a[20:21], v8 offset:4096
    v_mfma_f32_16x16x32_bf16 v[140:143], a[48:51], a[100:103], v[140:143]
    ds_read_b64_tr_b16 a[22:23], v8 offset:5120
    v_mfma_f32_16x16x32_bf16 v[148:151], a[48:51], a[104:107], v[148:151]
    ds_read_b64_tr_b16 a[24:25], v9 offset:4096
    v_mfma_f32_16x16x32_bf16 v[156:159], a[48:51], a[108:111], v[156:159]
    buffer_load_dwordx4 v4, s[20:23], s44 offen offset:2048 lds
    v_mfma_f32_16x16x32_bf16 v[164:167], a[52:55], a[96:99], v[164:167]
    s_add_u32 s44, s53, 17792
    ds_read_b64_tr_b16 a[26:27], v9 offset:5120
    v_mfma_f32_16x16x32_bf16 v[172:175], a[52:55], a[100:103], v[172:175]
    ds_read_b64_tr_b16 a[28:29], v10 offset:4096
    v_mfma_f32_16x16x32_bf16 v[180:183], a[52:55], a[104:107], v[180:183]
    ds_read_b64_tr_b16 a[30:31], v10 offset:5120
    v_mfma_f32_16x16x32_bf16 v[188:191], a[52:55], a[108:111], v[188:191]
    buffer_load_dwordx4 v4, s[20:23], s44 offen offset:3072 lds
    v_mfma_f32_16x16x32_bf16 v[196:199], a[56:59], a[96:99], v[196:199]
    s_add_u32 m0, s42, 69632
    v_mfma_f32_16x16x32_bf16 v[204:207], a[56:59], a[100:103], v[204:207]
    s_add_u32 s44, s47, 384
    v_mfma_f32_16x16x32_bf16 v[212:215], a[56:59], a[104:107], v[212:215]
    s_sub_u32 s7, s55, 0x4000
    v_mfma_f32_16x16x32_bf16 v[220:223], a[56:59], a[108:111], v[220:223]
    buffer_load_dwordx4 v4, s[20:23], s44 offen lds
    v_mfma_f32_16x16x32_bf16 v[228:231], a[60:63], a[96:99], v[228:231]
    s_add_u32 s44, s47, 15744
    v_mfma_f32_16x16x32_bf16 v[236:239], a[60:63], a[100:103], v[236:239]
    v_mfma_f32_16x16x32_bf16 v[244:247], a[60:63], a[104:107], v[244:247]
    v_mfma_f32_16x16x32_bf16 v[252:255], a[60:63], a[108:111], v[252:255]
    s_waitcnt lgkmcnt(0)
    buffer_load_dwordx4 v4, s[20:23], s44 offen offset:1024 lds
    v_mfma_f32_16x16x32_bf16 v[16:19], a[64:67], a[80:83], v[16:19]
    s_add_u32 s44, s47, 2432
    ds_read_b128 a[96:99], v6 offset:0
    v_add_u32 v128, s7, v7
    v_mfma_f32_16x16x32_bf16 v[20:23], a[68:71], a[80:83], v[20:23]
    ds_read_b128 a[100:103], v6 offset:2048
    v_add_u32 v129, s7, v8
    v_mfma_f32_16x16x32_bf16 v[24:27], a[72:75], a[80:83], v[24:27]
    ds_read_b128 a[104:107], v6 offset:4096
    v_xor_b32 v5, 0x10000, v5
    v_mfma_f32_16x16x32_bf16 v[28:31], a[76:79], a[80:83], v[28:31]
    buffer_load_dwordx4 v4, s[20:23], s44 offen offset:2048 lds
    v_add_u32 v130, s7, v9
    v_mfma_f32_16x16x32_bf16 v[32:35], a[64:67], a[84:87], v[32:35]
    s_add_u32 s44, s47, 17792
    ds_read_b128 a[108:111], v6 offset:6144
    v_add_u32 v131, s7, v10
    v_mfma_f32_16x16x32_bf16 v[36:39], a[68:71], a[84:87], v[36:39]
    ds_read_b128 a[112:115], v12 offset:8192
    ds_read_b64_tr_b16 v[96:97], v128 offset:0
    v_mfma_f32_16x16x32_bf16 v[40:43], a[72:75], a[84:87], v[40:43]
    ds_read_b128 a[116:119], v12 offset:10240
    ds_read_b64_tr_b16 v[98:99], v128 offset:1024
    v_mfma_f32_16x16x32_bf16 v[44:47], a[76:79], a[84:87], v[44:47]
    buffer_load_dwordx4 v4, s[20:23], s44 offen offset:3072 lds
    ds_read_b64_tr_b16 v[104:105], v129 offset:0
    v_mfma_f32_16x16x32_bf16 v[48:51], a[0:3], a[64:67], v[48:51]
    ds_read_b64_tr_b16 a[32:33], v7 offset:8192
    buffer_store_dwordx4 v[184:187], v1, s[8:11], s6 offen offset:3072
    v_mfma_f32_16x16x32_bf16 v[52:55], a[0:3], a[68:71], v[52:55]
    s_add_u32 s6, s46, 266240
    ds_read_b64_tr_b16 a[34:35], v7 offset:9216
    ds_read_b64_tr_b16 v[106:107], v129 offset:1024
    v_mfma_f32_16x16x32_bf16 v[56:59], a[0:3], a[72:75], v[56:59]
    ds_read_b64_tr_b16 a[36:37], v8 offset:8192
    ds_read_b64_tr_b16 v[112:113], v130 offset:0
    v_mfma_f32_16x16x32_bf16 v[60:63], a[0:3], a[76:79], v[60:63]
    ds_read_b64_tr_b16 v[114:115], v130 offset:1024
    ds_read_b64_tr_b16 v[120:121], v131 offset:0
    v_mfma_f32_16x16x32_bf16 v[64:67], a[4:7], a[64:67], v[64:67]
    ds_read_b64_tr_b16 a[38:39], v8 offset:9216
    buffer_store_dwordx4 v[192:195], v1, s[8:11], s6 offen offset:0
    v_mfma_f32_16x16x32_bf16 v[68:71], a[4:7], a[68:71], v[68:71]
    ds_read_b64_tr_b16 a[40:41], v9 offset:8192
    ds_read_b64_tr_b16 v[122:123], v131 offset:1024
    v_mfma_f32_16x16x32_bf16 v[72:75], a[4:7], a[72:75], v[72:75]
    s_lshr_b32 s7, s4, 3
    v_mfma_f32_16x16x32_bf16 v[76:79], a[4:7], a[76:79], v[76:79]
    s_mul_i32 s7, s7, 40
    ds_read_b64_tr_b16 a[42:43], v9 offset:9216
    v_mfma_f32_16x16x32_bf16 v[80:83], a[8:11], a[64:67], v[80:83]
    s_and_b32 s98, s4, 7
    ds_read_b64_tr_b16 a[44:45], v10 offset:8192
    buffer_store_dwordx4 v[200:203], v1, s[8:11], s6 offen offset:1024
    v_mfma_f32_16x16x32_bf16 v[84:87], a[8:11], a[68:71], v[84:87]
    s_lshl_b32 s98, s98, 2
    ds_read_b64_tr_b16 a[46:47], v10 offset:9216
    v_mfma_f32_16x16x32_bf16 v[88:91], a[8:11], a[72:75], v[88:91]
    s_add_u32 s98, s98, s7
    v_mfma_f32_16x16x32_bf16 v[92:95], a[8:11], a[76:79], v[92:95]
    s_mul_i32 s7, s5, 160
    ds_read_b64_tr_b16 a[48:49], v7 offset:12288
    v_mfma_f32_16x16x32_bf16 v[100:103], a[12:15], a[64:67], v[100:103]
    s_add_u32 s7, s7, s98
    ds_read_b64_tr_b16 a[50:51], v7 offset:13312
    buffer_store_dwordx4 v[208:211], v1, s[8:11], s6 offen offset:2048
    v_mfma_f32_16x16x32_bf16 v[108:111], a[12:15], a[68:71], v[108:111]
    s_add_u32 s7, s7, s3
    ds_read_b64_tr_b16 a[52:53], v8 offset:12288
    v_mfma_f32_16x16x32_bf16 v[116:119], a[12:15], a[72:75], v[116:119]
    s_lshl_b32 s7, s7, 12
    v_mfma_f32_16x16x32_bf16 v[124:127], a[12:15], a[76:79], v[124:127]
    s_add_u32 s7, s7, 55574528
    ds_read_b64_tr_b16 a[54:55], v8 offset:13312
    v_mfma_f32_16x16x32_bf16 v[132:135], a[16:19], a[64:67], v[132:135]
    ds_read_b64_tr_b16 a[56:57], v9 offset:12288
    buffer_store_dwordx4 v[216:219], v1, s[8:11], s6 offen offset:3072
    v_mfma_f32_16x16x32_bf16 v[140:143], a[16:19], a[68:71], v[140:143]
    s_add_u32 s6, s46, 524288
    ds_read_b64_tr_b16 a[58:59], v9 offset:13312
    v_mfma_f32_16x16x32_bf16 v[148:151], a[16:19], a[72:75], v[148:151]
    v_mfma_f32_16x16x32_bf16 v[156:159], a[16:19], a[76:79], v[156:159]
    ds_read_b64_tr_b16 a[60:61], v10 offset:12288
    v_mfma_f32_16x16x32_bf16 v[164:167], a[20:23], a[64:67], v[164:167]
    ds_read_b64_tr_b16 a[62:63], v10 offset:13312
    v_mfma_f32_16x16x32_bf16 v[172:175], a[20:23], a[68:71], v[172:175]
    v_mfma_f32_16x16x32_bf16 v[180:183], a[20:23], a[72:75], v[180:183]
    v_mfma_f32_16x16x32_bf16 v[188:191], a[20:23], a[76:79], v[188:191]
    v_mfma_f32_16x16x32_bf16 v[196:199], a[24:27], a[64:67], v[196:199]
    v_mfma_f32_16x16x32_bf16 v[204:207], a[24:27], a[68:71], v[204:207]
    v_mfma_f32_16x16x32_bf16 v[212:215], a[24:27], a[72:75], v[212:215]
    v_xor_b32 v7, 0x10000, v7
    v_xor_b32 v8, 0x10000, v8
    v_mfma_f32_16x16x32_bf16 v[220:223], a[24:27], a[76:79], v[220:223]
    v_xor_b32 v9, 0x10000, v9
    v_xor_b32 v10, 0x10000, v10
    v_mfma_f32_16x16x32_bf16 v[228:231], a[28:31], a[64:67], v[228:231]
    v_xor_b32 v6, 0x10000, v6
    v_mfma_f32_16x16x32_bf16 v[236:239], a[28:31], a[68:71], v[236:239]
    v_mfma_f32_16x16x32_bf16 v[244:247], a[28:31], a[72:75], v[244:247]
    v_mfma_f32_16x16x32_bf16 v[252:255], a[28:31], a[76:79], v[252:255]
    s_waitcnt lgkmcnt(0)
    v_mfma_f32_16x16x32_bf16 v[16:19], a[96:99], a[112:115], v[16:19]
    s_waitcnt vmcnt(5)
    v_mfma_f32_16x16x32_bf16 v[20:23], a[100:103], a[112:115], v[20:23]
    v_mfma_f32_16x16x32_bf16 v[24:27], a[104:107], a[112:115], v[24:27]
    s_barrier
    v_mfma_f32_16x16x32_bf16 v[28:31], a[108:111], a[112:115], v[28:31]
    s_add_u32 m0, s55, 0
    v_mfma_f32_16x16x32_bf16 v[32:35], a[96:99], a[116:119], v[32:35]
    s_add_u32 s44, s54, 2097152
    ds_read_b128 a[64:67], v5 offset:0
    buffer_load_dwordx4 v3, s[24:27], s44 offen lds
    v_mfma_f32_16x16x32_bf16 v[36:39], a[100:103], a[116:119], v[36:39]
    s_add_u32 s44, s54, 2128896
    ds_read_b128 a[68:71], v5 offset:2048
    v_mfma_f32_16x16x32_bf16 v[40:43], a[104:107], a[116:119], v[40:43]
    ds_read_b128 a[72:75], v5 offset:4096
    v_mfma_f32_16x16x32_bf16 v[44:47], a[108:111], a[116:119], v[44:47]
    ds_read_b128 a[76:79], v5 offset:6144
    buffer_load_dwordx4 v3, s[24:27], s44 offen offset:1024 lds
    v_mfma_f32_16x16x32_bf16 v[48:51], a[32:35], a[96:99], v[48:51]
    s_add_u32 s44, s54, 2226176
    v_mfma_f32_16x16x32_bf16 v[52:55], a[32:35], a[100:103], v[52:55]
    ds_read_b128 a[80:83], v11 offset:12288
    v_mfma_f32_16x16x32_bf16 v[56:59], a[32:35], a[104:107], v[56:59]
    ds_read_b128 a[84:87], v11 offset:14336
    v_mfma_f32_16x16x32_bf16 v[60:63], a[32:35], a[108:111], v[60:63]
    ds_read_b64_tr_b16 a[0:1], v7 offset:0
    buffer_load_dwordx4 v3, s[24:27], s44 offen offset:2048 lds
    v_mfma_f32_16x16x32_bf16 v[64:67], a[36:39], a[96:99], v[64:67]
    s_add_u32 s44, s54, 2257920
    ds_read_b64_tr_b16 a[2:3], v7 offset:1024
    v_mfma_f32_16x16x32_bf16 v[68:71], a[36:39], a[100:103], v[68:71]
    v_mfma_f32_16x16x32_bf16 v[72:75], a[36:39], a[104:107], v[72:75]
    ds_read_b64_tr_b16 a[4:5], v8 offset:0
    v_mfma_f32_16x16x32_bf16 v[76:79], a[36:39], a[108:111], v[76:79]
    ds_read_b64_tr_b16 a[6:7], v8 offset:1024
    buffer_load_dwordx4 v3, s[24:27], s44 offen offset:3072 lds
    v_mfma_f32_16x16x32_bf16 v[80:83], a[40:43], a[96:99], v[80:83]
    s_add_u32 m0, s42, 0
    ds_read_b64_tr_b16 a[8:9], v9 offset:0
    v_mfma_f32_16x16x32_bf16 v[84:87], a[40:43], a[100:103], v[84:87]
    s_add_u32 s44, s53, 512
    v_mfma_f32_16x16x32_bf16 v[88:91], a[40:43], a[104:107], v[88:91]
    ds_read_b64_tr_b16 a[10:11], v9 offset:1024
    v_mfma_f32_16x16x32_bf16 v[92:95], a[40:43], a[108:111], v[92:95]
    ds_read_b64_tr_b16 a[12:13], v10 offset:0
    buffer_load_dwordx4 v4, s[20:23], s44 offen lds
    v_mfma_f32_16x16x32_bf16 v[100:103], a[44:47], a[96:99], v[100:103]
    s_add_u32 s44, s53, 15872
    ds_read_b64_tr_b16 a[14:15], v10 offset:1024
    v_mfma_f32_16x16x32_bf16 v[108:111], a[44:47], a[100:103], v[108:111]
    ds_read_b64_tr_b16 a[16:17], v7 offset:4096
    v_mfma_f32_16x16x32_bf16 v[116:119], a[44:47], a[104:107], v[116:119]
    v_mfma_f32_16x16x32_bf16 v[124:127], a[44:47], a[108:111], v[124:127]
    ds_read_b64_tr_b16 a[18:19], v7 offset:5120
    buffer_load_dwordx4 v4, s[20:23], s44 offen offset:1024 lds
    v_mfma_f32_16x16x32_bf16 v[132:135], a[48:51], a[96:99], v[132:135]
    s_add_u32 s44, s53, 2560
    ds_read_b64_tr_b16 a[20:21], v8 offset:4096
    v_mfma_f32_16x16x32_bf16 v[140:143], a[48:51], a[100:103], v[140:143]
    ds_read_b64_tr_b16 a[22:23], v8 offset:5120
    v_mfma_f32_16x16x32_bf16 v[148:151], a[48:51], a[104:107], v[148:151]
    ds_read_b64_tr_b16 a[24:25], v9 offset:4096
    v_mfma_f32_16x16x32_bf16 v[156:159], a[48:51], a[108:111], v[156:159]
    buffer_load_dwordx4 v4, s[20:23], s44 offen offset:2048 lds
    v_mfma_f32_16x16x32_bf16 v[164:167], a[52:55], a[96:99], v[164:167]
    s_add_u32 s44, s53, 17920
    ds_read_b64_tr_b16 a[26:27], v9 offset:5120
    v_mfma_f32_16x16x32_bf16 v[172:175], a[52:55], a[100:103], v[172:175]
    ds_read_b64_tr_b16 a[28:29], v10 offset:4096
    v_mfma_f32_16x16x32_bf16 v[180:183], a[52:55], a[104:107], v[180:183]
    ds_read_b64_tr_b16 a[30:31], v10 offset:5120
    v_mfma_f32_16x16x32_bf16 v[188:191], a[52:55], a[108:111], v[188:191]
    buffer_load_dwordx4 v4, s[20:23], s44 offen offset:3072 lds
    v_mfma_f32_16x16x32_bf16 v[196:199], a[56:59], a[96:99], v[196:199]
    s_add_u32 m0, s42, 4096
    v_mfma_f32_16x16x32_bf16 v[204:207], a[56:59], a[100:103], v[204:207]
    s_add_u32 s44, s47, 512
    v_mfma_f32_16x16x32_bf16 v[212:215], a[56:59], a[104:107], v[212:215]
    v_mfma_f32_16x16x32_bf16 v[220:223], a[56:59], a[108:111], v[220:223]
    buffer_load_dwordx4 v4, s[20:23], s44 offen lds
    v_mfma_f32_16x16x32_bf16 v[228:231], a[60:63], a[96:99], v[228:231]
    s_add_u32 s44, s47, 15872
    v_mfma_f32_16x16x32_bf16 v[236:239], a[60:63], a[100:103], v[236:239]
    v_mfma_f32_16x16x32_bf16 v[244:247], a[60:63], a[104:107], v[244:247]
    v_mfma_f32_16x16x32_bf16 v[252:255], a[60:63], a[108:111], v[252:255]
    s_waitcnt lgkmcnt(0)
    buffer_load_dwordx4 v4, s[20:23], s44 offen offset:1024 lds
    v_mfma_f32_16x16x32_bf16 v[16:19], a[64:67], a[80:83], v[16:19]
    s_add_u32 s44, s47, 2560
    ds_read_b128 a[96:99], v6 offset:0
    v_mfma_f32_16x16x32_bf16 v[20:23], a[68:71], a[80:83], v[20:23]
    ds_read_b128 a[100:103], v6 offset:2048
    v_mfma_f32_16x16x32_bf16 v[24:27], a[72:75], a[80:83], v[24:27]
    ds_read_b128 a[104:107], v6 offset:4096
    v_xor_b32 v5, 0x10000, v5
    v_mfma_f32_16x16x32_bf16 v[28:31], a[76:79], a[80:83], v[28:31]
    buffer_load_dwordx4 v4, s[20:23], s44 offen offset:2048 lds
    v_mfma_f32_16x16x32_bf16 v[32:35], a[64:67], a[84:87], v[32:35]
    s_add_u32 s44, s47, 17920
    ds_read_b128 a[108:111], v6 offset:6144
    v_mfma_f32_16x16x32_bf16 v[36:39], a[68:71], a[84:87], v[36:39]
    ds_read_b128 a[112:115], v12 offset:12288
    v_mfma_f32_16x16x32_bf16 v[40:43], a[72:75], a[84:87], v[40:43]
    ds_read_b128 a[116:119], v12 offset:14336
    v_mfma_f32_16x16x32_bf16 v[44:47], a[76:79], a[84:87], v[44:47]
    buffer_load_dwordx4 v4, s[20:23], s44 offen offset:3072 lds
    v_mfma_f32_16x16x32_bf16 v[48:51], a[0:3], a[64:67], v[48:51]
    ds_read_b64_tr_b16 a[32:33], v7 offset:8192
    buffer_store_dwordx4 v[224:227], v1, s[8:11], s6 offen offset:0
    v_mfma_f32_16x16x32_bf16 v[52:55], a[0:3], a[68:71], v[52:55]
    ds_read_b64_tr_b16 a[34:35], v7 offset:9216
    v_mfma_f32_16x16x32_bf16 v[56:59], a[0:3], a[72:75], v[56:59]
    ds_read_b64_tr_b16 a[36:37], v8 offset:8192
    v_mfma_f32_16x16x32_bf16 v[60:63], a[0:3], a[76:79], v[60:63]
    v_mfma_f32_16x16x32_bf16 v[64:67], a[4:7], a[64:67], v[64:67]
    ds_read_b64_tr_b16 a[38:39], v8 offset:9216
    buffer_store_dwordx4 v[232:235], v1, s[8:11], s6 offen offset:1024
    v_mfma_f32_16x16x32_bf16 v[68:71], a[4:7], a[68:71], v[68:71]
    ds_read_b64_tr_b16 a[40:41], v9 offset:8192
    v_mfma_f32_16x16x32_bf16 v[72:75], a[4:7], a[72:75], v[72:75]
    v_mfma_f32_16x16x32_bf16 v[76:79], a[4:7], a[76:79], v[76:79]
    ds_read_b64_tr_b16 a[42:43], v9 offset:9216
    v_mfma_f32_16x16x32_bf16 v[80:83], a[8:11], a[64:67], v[80:83]
    ds_read_b64_tr_b16 a[44:45], v10 offset:8192
    buffer_store_dwordx4 v[240:243], v1, s[8:11], s6 offen offset:2048
    v_mfma_f32_16x16x32_bf16 v[84:87], a[8:11], a[68:71], v[84:87]
    ds_read_b64_tr_b16 a[46:47], v10 offset:9216
    v_mfma_f32_16x16x32_bf16 v[88:91], a[8:11], a[72:75], v[88:91]
    v_mfma_f32_16x16x32_bf16 v[92:95], a[8:11], a[76:79], v[92:95]
    ds_read_b64_tr_b16 a[48:49], v7 offset:12288
    v_mfma_f32_16x16x32_bf16 v[100:103], a[12:15], a[64:67], v[100:103]
    ds_read_b64_tr_b16 a[50:51], v7 offset:13312
    buffer_store_dwordx4 v[248:251], v1, s[8:11], s6 offen offset:3072
    v_mfma_f32_16x16x32_bf16 v[108:111], a[12:15], a[68:71], v[108:111]
    s_add_u32 s6, s46, 528384
    ds_read_b64_tr_b16 a[52:53], v8 offset:12288
    v_mfma_f32_16x16x32_bf16 v[116:119], a[12:15], a[72:75], v[116:119]
    v_mfma_f32_16x16x32_bf16 v[124:127], a[12:15], a[76:79], v[124:127]
    ds_read_b64_tr_b16 a[54:55], v8 offset:13312
    v_mfma_f32_16x16x32_bf16 v[132:135], a[16:19], a[64:67], v[132:135]
    ds_read_b64_tr_b16 a[56:57], v9 offset:12288
    buffer_store_dwordx4 v[96:99], v1, s[8:11], s7 offen offset:0 sc1
    v_mfma_f32_16x16x32_bf16 v[140:143], a[16:19], a[68:71], v[140:143]
    ds_read_b64_tr_b16 a[58:59], v9 offset:13312
    v_mfma_f32_16x16x32_bf16 v[148:151], a[16:19], a[72:75], v[148:151]
    v_mfma_f32_16x16x32_bf16 v[156:159], a[16:19], a[76:79], v[156:159]
    ds_read_b64_tr_b16 a[60:61], v10 offset:12288
    v_mfma_f32_16x16x32_bf16 v[164:167], a[20:23], a[64:67], v[164:167]
    ds_read_b64_tr_b16 a[62:63], v10 offset:13312
    v_mfma_f32_16x16x32_bf16 v[172:175], a[20:23], a[68:71], v[172:175]
    v_mfma_f32_16x16x32_bf16 v[180:183], a[20:23], a[72:75], v[180:183]
    v_mfma_f32_16x16x32_bf16 v[188:191], a[20:23], a[76:79], v[188:191]
    v_mfma_f32_16x16x32_bf16 v[196:199], a[24:27], a[64:67], v[196:199]
    v_mfma_f32_16x16x32_bf16 v[204:207], a[24:27], a[68:71], v[204:207]
    v_mfma_f32_16x16x32_bf16 v[212:215], a[24:27], a[72:75], v[212:215]
    v_xor_b32 v7, 0x10000, v7
    v_xor_b32 v8, 0x10000, v8
    v_mfma_f32_16x16x32_bf16 v[220:223], a[24:27], a[76:79], v[220:223]
    v_xor_b32 v9, 0x10000, v9
    v_xor_b32 v10, 0x10000, v10
    v_mfma_f32_16x16x32_bf16 v[228:231], a[28:31], a[64:67], v[228:231]
    v_xor_b32 v6, 0x10000, v6
    v_mfma_f32_16x16x32_bf16 v[236:239], a[28:31], a[68:71], v[236:239]
    v_mfma_f32_16x16x32_bf16 v[244:247], a[28:31], a[72:75], v[244:247]
    v_mfma_f32_16x16x32_bf16 v[252:255], a[28:31], a[76:79], v[252:255]
    s_waitcnt lgkmcnt(0)
    v_mfma_f32_16x16x32_bf16 v[16:19], a[96:99], a[112:115], v[16:19]
    s_waitcnt vmcnt(5)
    v_mfma_f32_16x16x32_bf16 v[20:23], a[100:103], a[112:115], v[20:23]
    v_mfma_f32_16x16x32_bf16 v[24:27], a[104:107], a[112:115], v[24:27]
    s_barrier
    v_mfma_f32_16x16x32_bf16 v[28:31], a[108:111], a[112:115], v[28:31]
    s_add_u32 m0, s55, 65536
    v_mfma_f32_16x16x32_bf16 v[32:35], a[96:99], a[116:119], v[32:35]
    s_add_u32 s44, s54, 2621440
    ds_read_b128 a[64:67], v5 offset:0
    buffer_load_dwordx4 v3, s[24:27], s44 offen lds
    v_mfma_f32_16x16x32_bf16 v[36:39], a[100:103], a[116:119], v[36:39]
    s_add_u32 s44, s54, 2653184
    ds_read_b128 a[68:71], v5 offset:2048
    v_accvgpr_read_b32 v136, a128
    v_mfma_f32_16x16x32_bf16 v[40:43], a[104:107], a[116:119], v[40:43]
    ds_read_b128 a[72:75], v5 offset:4096
    v_accvgpr_read_b32 v137, a129
    v_mfma_f32_16x16x32_bf16 v[44:47], a[108:111], a[116:119], v[44:47]
    ds_read_b128 a[76:79], v5 offset:6144
    buffer_load_dwordx4 v3, s[24:27], s44 offen offset:1024 lds
    v_mfma_f32_16x16x32_bf16 v[48:51], a[32:35], a[96:99], v[48:51]
    s_add_u32 s44, s54, 2750464
    v_accvgpr_read_b32 v138, a130
    v_accvgpr_read_b32 v139, a131
    v_mfma_f32_16x16x32_bf16 v[52:55], a[32:35], a[100:103], v[52:55]
    ds_read_b128 a[80:83], v11 offset:16384
    v_accvgpr_read_b32 v144, a132
    v_mfma_f32_16x16x32_bf16 v[56:59], a[32:35], a[104:107], v[56:59]
    ds_read_b128 a[84:87], v11 offset:18432
    v_accvgpr_read_b32 v145, a133
    v_mfma_f32_16x16x32_bf16 v[60:63], a[32:35], a[108:111], v[60:63]
    ds_read_b64_tr_b16 a[0:1], v7 offset:0
    buffer_load_dwordx4 v3, s[24:27], s44 offen offset:2048 lds
    v_mfma_f32_16x16x32_bf16 v[64:67], a[36:39], a[96:99], v[64:67]
    s_add_u32 s44, s54, 2782208
    ds_read_b64_tr_b16 a[2:3], v7 offset:1024
    v_accvgpr_read_b32 v146, a134
    v_mfma_f32_16x16x32_bf16 v[68:71], a[36:39], a[100:103], v[68:71]
    v_accvgpr_read_b32 v147, a135
    v_cvt_pk_bf16_f32 v136, v136, v137
    v_mfma_f32_16x16x32_bf16 v[72:75], a[36:39], a[104:107], v[72:75]
    ds_read_b64_tr_b16 a[4:5], v8 offset:0
    v_cvt_pk_bf16_f32 v137, v138, v139
    v_mfma_f32_16x16x32_bf16 v[76:79], a[36:39], a[108:111], v[76:79]
    ds_read_b64_tr_b16 a[6:7], v8 offset:1024
    buffer_load_dwordx4 v3, s[24:27], s44 offen offset:3072 lds
    v_mfma_f32_16x16x32_bf16 v[80:83], a[40:43], a[96:99], v[80:83]
    s_add_u32 m0, s42, 65536
    ds_read_b64_tr_b16 a[8:9], v9 offset:0
    v_cvt_pk_bf16_f32 v138, v144, v145
    v_mfma_f32_16x16x32_bf16 v[84:87], a[40:43], a[100:103], v[84:87]
    s_add_u32 s44, s53, 640
    v_cvt_pk_bf16_f32 v139, v146, v147
    v_accvgpr_read_b32 v152, a136
    v_mfma_f32_16x16x32_bf16 v[88:91], a[40:43], a[104:107], v[88:91]
    ds_read_b64_tr_b16 a[10:11], v9 offset:1024
    v_accvgpr_read_b32 v153, a137
    v_mfma_f32_16x16x32_bf16 v[92:95], a[40:43], a[108:111], v[92:95]
    ds_read_b64_tr_b16 a[12:13], v10 offset:0
    buffer_load_dwordx4 v4, s[20:23], s44 offen lds
    v_mfma_f32_16x16x32_bf16 v[100:103], a[44:47], a[96:99], v[100:103]
    s_add_u32 s44, s53, 16000
    ds_read_b64_tr_b16 a[14:15], v10 offset:1024
    v_accvgpr_read_b32 v154, a138
    v_mfma_f32_16x16x32_bf16 v[108:111], a[44:47], a[100:103], v[108:111]
    ds_read_b64_tr_b16 a[16:17], v7 offset:4096
    v_accvgpr_read_b32 v155, a139
    v_mfma_f32_16x16x32_bf16 v[116:119], a[44:47], a[104:107], v[116:119]
    v_accvgpr_read_b32 v160, a140
    v_accvgpr_read_b32 v161, a141
    v_mfma_f32_16x16x32_bf16 v[124:127], a[44:47], a[108:111], v[124:127]
    ds_read_b64_tr_b16 a[18:19], v7 offset:5120
    buffer_load_dwordx4 v4, s[20:23], s44 offen offset:1024 lds
    v_mfma_f32_16x16x32_bf16 v[132:135], a[48:51], a[96:99], v[132:135]
    s_add_u32 s44, s53, 2688
    ds_read_b64_tr_b16 a[20:21], v8 offset:4096
    v_accvgpr_read_b32 v162, a142
    v_mfma_f32_16x16x32_bf16 v[140:143], a[48:51], a[100:103], v[140:143]
    ds_read_b64_tr_b16 a[22:23], v8 offset:5120
    v_accvgpr_read_b32 v163, a143
    v_mfma_f32_16x16x32_bf16 v[148:151], a[48:51], a[104:107], v[148:151]
    ds_read_b64_tr_b16 a[24:25], v9 offset:4096
    v_cvt_pk_bf16_f32 v152, v152, v153
    v_mfma_f32_16x16x32_bf16 v[156:159], a[48:51], a[108:111], v[156:159]
    buffer_load_dwordx4 v4, s[20:23], s44 offen offset:2048 lds
    v_cvt_pk_bf16_f32 v153, v154, v155
    v_mfma_f32_16x16x32_bf16 v[164:167], a[52:55], a[96:99], v[164:167]
    s_add_u32 s44, s53, 18048
    ds_read_b64_tr_b16 a[26:27], v9 offset:5120
    v_cvt_pk_bf16_f32 v154, v160, v161
    v_mfma_f32_16x16x32_bf16 v[172:175], a[52:55], a[100:103], v[172:175]
    ds_read_b64_tr_b16 a[28:29], v10 offset:4096
    v_cvt_pk_bf16_f32 v155, v162, v163
    v_mfma_f32_16x16x32_bf16 v[180:183], a[52:55], a[104:107], v[180:183]
    ds_read_b64_tr_b16 a[30:31], v10 offset:5120
    v_accvgpr_read_b32 v168, a144
    v_mfma_f32_16x16x32_bf16 v[188:191], a[52:55], a[108:111], v[188:191]
    buffer_load_dwordx4 v4, s[20:23], s44 offen offset:3072 lds
    v_accvgpr_read_b32 v169, a145
    v_mfma_f32_16x16x32_bf16 v[196:199], a[56:59], a[96:99], v[196:199]
    s_add_u32 m0, s42, 69632
    v_accvgpr_read_b32 v170, a146
    v_accvgpr_read_b32 v171, a147
    v_mfma_f32_16x16x32_bf16 v[204:207], a[56:59], a[100:103], v[204:207]
    s_add_u32 s44, s47, 640
    v_accvgpr_read_b32 v176, a148
    v_accvgpr_read_b32 v177, a149
    v_mfma_f32_16x16x32_bf16 v[212:215], a[56:59], a[104:107], v[212:215]
    v_accvgpr_read_b32 v178, a150
    v_accvgpr_read_b32 v179, a151
    v_mfma_f32_16x16x32_bf16 v[220:223], a[56:59], a[108:111], v[220:223]
    buffer_load_dwordx4 v4, s[20:23], s44 offen lds
    v_cvt_pk_bf16_f32 v168, v168, v169
    v_mfma_f32_16x16x32_bf16 v[228:231], a[60:63], a[96:99], v[228:231]
    s_add_u32 s44, s47, 16000
    v_cvt_pk_bf16_f32 v169, v170, v171
    v_cvt_pk_bf16_f32 v170, v176, v177
    v_mfma_f32_16x16x32_bf16 v[236:239], a[60:63], a[100:103], v[236:239]
    v_cvt_pk_bf16_f32 v171, v178, v179
    v_accvgpr_read_b32 v184, a152
    v_mfma_f32_16x16x32_bf16 v[244:247], a[60:63], a[104:107], v[244:247]
    v_accvgpr_read_b32 v185, a153
    v_accvgpr_read_b32 v186, a154
    v_mfma_f32_16x16x32_bf16 v[252:255], a[60:63], a[108:111], v[252:255]
    s_waitcnt lgkmcnt(0)
    buffer_load_dwordx4 v4, s[20:23], s44 offen offset:1024 lds
    v_accvgpr_read_b32 v187, a155
    v_mfma_f32_16x16x32_bf16 v[16:19], a[64:67], a[80:83], v[16:19]
    s_add_u32 s44, s47, 2688
    ds_read_b128 a[96:99], v6 offset:0
    v_accvgpr_read_b32 v192, a156
    v_mfma_f32_16x16x32_bf16 v[20:23], a[68:71], a[80:83], v[20:23]
    ds_read_b128 a[100:103], v6 offset:2048
    v_accvgpr_read_b32 v193, a157
    v_mfma_f32_16x16x32_bf16 v[24:27], a[72:75], a[80:83], v[24:27]
    ds_read_b128 a[104:107], v6 offset:4096
    v_xor_b32 v5, 0x10000, v5
    v_mfma_f32_16x16x32_bf16 v[28:31], a[76:79], a[80:83], v[28:31]
    buffer_load_dwordx4 v4, s[20:23], s44 offen offset:2048 lds
    v_accvgpr_read_b32 v194, a158
    v_mfma_f32_16x16x32_bf16 v[32:35], a[64:67], a[84:87], v[32:35]
    s_add_u32 s44, s47, 18048
    ds_read_b128 a[108:111], v6 offset:6144
    v_accvgpr_read_b32 v195, a159
    v_mfma_f32_16x16x32_bf16 v[36:39], a[68:71], a[84:87], v[36:39]
    ds_read_b128 a[112:115], v12 offset:16384
    v_cvt_pk_bf16_f32 v184, v184, v185
    v_mfma_f32_16x16x32_bf16 v[40:43], a[72:75], a[84:87], v[40:43]
    ds_read_b128 a[116:119], v12 offset:18432
    v_cvt_pk_bf16_f32 v185, v186, v187
    v_mfma_f32_16x16x32_bf16 v[44:47], a[76:79], a[84:87], v[44:47]
    buffer_load_dwordx4 v4, s[20:23], s44 offen offset:3072 lds
    v_cvt_pk_bf16_f32 v186, v192, v193
    v_mfma_f32_16x16x32_bf16 v[48:51], a[0:3], a[64:67], v[48:51]
    s_cmp_eq_u32 s50, 1
    s_cbranch_scc1 A_pub1
    buffer_load_dword v13, v1, s[20:23], 0 offen
A_ret0:
    ds_read_b64_tr_b16 a[32:33], v7 offset:8192
    v_mfma_f32_16x16x32_bf16 v[52:55], a[0:3], a[68:71], v[52:55]
    ds_read_b64_tr_b16 a[34:35], v7 offset:9216
    buffer_store_dwordx4 v[136:139], v1, s[8:11], s6 offen offset:0
    v_mfma_f32_16x16x32_bf16 v[56:59], a[0:3], a[72:75], v[56:59]
    ds_read_b64_tr_b16 a[36:37], v8 offset:8192
    v_cvt_pk_bf16_f32 v187, v194, v195
    v_mfma_f32_16x16x32_bf16 v[60:63], a[0:3], a[76:79], v[60:63]
    v_mfma_f32_16x16x32_bf16 v[64:67], a[4:7], a[64:67], v[64:67]
    ds_read_b64_tr_b16 a[38:39], v8 offset:9216
    v_mfma_f32_16x16x32_bf16 v[68:71], a[4:7], a[68:71], v[68:71]
    ds_read_b64_tr_b16 a[40:41], v9 offset:8192
    buffer_store_dwordx4 v[152:155], v1, s[8:11], s6 offen offset:1024
    v_mfma_f32_16x16x32_bf16 v[72:75], a[4:7], a[72:75], v[72:75]
    v_mfma_f32_16x16x32_bf16 v[76:79], a[4:7], a[76:79], v[76:79]
    ds_read_b64_tr_b16 a[42:43], v9 offset:9216
    v_mfma_f32_16x16x32_bf16 v[80:83], a[8:11], a[64:67], v[80:83]
    ds_read_b64_tr_b16 a[44:45], v10 offset:8192
    v_mfma_f32_16x16x32_bf16 v[84:87], a[8:11], a[68:71], v[84:87]
    ds_read_b64_tr_b16 a[46:47], v10 offset:9216
    buffer_store_dwordx4 v[168:171], v1, s[8:11], s6 offen offset:2048
    v_mfma_f32_16x16x32_bf16 v[88:91], a[8:11], a[72:75], v[88:91]
    v_mfma_f32_16x16x32_bf16 v[92:95], a[8:11], a[76:79], v[92:95]
    ds_read_b64_tr_b16 a[48:49], v7 offset:12288
    v_mfma_f32_16x16x32_bf16 v[100:103], a[12:15], a[64:67], v[100:103]
    ds_read_b64_tr_b16 a[50:51], v7 offset:13312
    v_mfma_f32_16x16x32_bf16 v[108:111], a[12:15], a[68:71], v[108:111]
    ds_read_b64_tr_b16 a[52:53], v8 offset:12288
    buffer_store_dwordx4 v[184:187], v1, s[8:11], s6 offen offset:3072
    v_mfma_f32_16x16x32_bf16 v[116:119], a[12:15], a[72:75], v[116:119]
    s_add_u32 s6, s46, 786432
    v_mfma_f32_16x16x32_bf16 v[124:127], a[12:15], a[76:79], v[124:127]
    ds_read_b64_tr_b16 a[54:55], v8 offset:13312
    v_mfma_f32_16x16x32_bf16 v[132:135], a[16:19], a[64:67], v[132:135]
    ds_read_b64_tr_b16 a[56:57], v9 offset:12288
    v_mfma_f32_16x16x32_bf16 v[140:143], a[16:19], a[68:71], v[140:143]
    ds_read_b64_tr_b16 a[58:59], v9 offset:13312
    buffer_store_dwordx4 v[104:107], v1, s[8:11], s7 offen offset:1024 sc1
    v_mfma_f32_16x16x32_bf16 v[148:151], a[16:19], a[72:75], v[148:151]
    v_mfma_f32_16x16x32_bf16 v[156:159], a[16:19], a[76:79], v[156:159]
    ds_read_b64_tr_b16 a[60:61], v10 offset:12288
    v_mfma_f32_16x16x32_bf16 v[164:167], a[20:23], a[64:67], v[164:167]
    ds_read_b64_tr_b16 a[62:63], v10 offset:13312
    v_mfma_f32_16x16x32_bf16 v[172:175], a[20:23], a[68:71], v[172:175]
    v_mfma_f32_16x16x32_bf16 v[180:183], a[20:23], a[72:75], v[180:183]
    v_mfma_f32_16x16x32_bf16 v[188:191], a[20:23], a[76:79], v[188:191]
    v_mfma_f32_16x16x32_bf16 v[196:199], a[24:27], a[64:67], v[196:199]
    v_mfma_f32_16x16x32_bf16 v[204:207], a[24:27], a[68:71], v[204:207]
    v_mfma_f32_16x16x32_bf16 v[212:215], a[24:27], a[72:75], v[212:215]
    v_xor_b32 v7, 0x10000, v7
    v_xor_b32 v8, 0x10000, v8
    v_mfma_f32_16x16x32_bf16 v[220:223], a[24:27], a[76:79], v[220:223]
    v_xor_b32 v9, 0x10000, v9
    v_xor_b32 v10, 0x10000, v10
    v_mfma_f32_16x16x32_bf16 v[228:231], a[28:31], a[64:67], v[228:231]
    v_xor_b32 v6, 0x10000, v6
    v_mfma_f32_16x16x32_bf16 v[236:239], a[28:31], a[68:71], v[236:239]
    v_mfma_f32_16x16x32_bf16 v[244:247], a[28:31], a[72:75], v[244:247]
    v_mfma_f32_16x16x32_bf16 v[252:255], a[28:31], a[76:79], v[252:255]
    s_waitcnt lgkmcnt(0)
    v_mfma_f32_16x16x32_bf16 v[16:19], a[96:99], a[112:115], v[16:19]
    s_waitcnt vmcnt(6)
    v_mfma_f32_16x16x32_bf16 v[20:23], a[100:103], a[112:115], v[20:23]
    v_mfma_f32_16x16x32_bf16 v[24:27], a[104:107], a[112:115], v[24:27]
    s_barrier
    v_mfma_f32_16x16x32_bf16 v[28:31], a[108:111], a[112:115], v[28:31]
    s_add_u32 m0, s55, 0
    v_mfma_f32_16x16x32_bf16 v[32:35], a[96:99], a[116:119], v[32:35]
    s_add_u32 s44, s54, 3145728
    ds_read_b128 a[64:67], v5 offset:0
    buffer_load_dwordx4 v3, s[24:27], s44 offen lds
    v_mfma_f32_16x16x32_bf16 v[36:39], a[100:103], a[116:119], v[36:39]
    s_add_u32 s44, s54, 3177472
    ds_read_b128 a[68:71], v5 offset:2048
    v_accvgpr_read_b32 v200, a160
    v_mfma_f32_16x16x32_bf16 v[40:43], a[104:107], a[116:119], v[40:43]
    ds_read_b128 a[72:75], v5 offset:4096
    v_accvgpr_read_b32 v201, a161
    v_mfma_f32_16x16x32_bf16 v[44:47], a[108:111], a[116:119], v[44:47]
    ds_read_b128 a[76:79], v5 offset:6144
    buffer_load_dwordx4 v3, s[24:27], s44 offen offset:1024 lds
    v_mfma_f32_16x16x32_bf16 v[48:51], a[32:35], a[96:99], v[48:51]
    s_add_u32 s44, s54, 3274752
    v_accvgpr_read_b32 v202, a162
    v_accvgpr_read_b32 v203, a163
    v_mfma_f32_16x16x32_bf16 v[52:55], a[32:35], a[100:103], v[52:55]
    ds_read_b128 a[80:83], v11 offset:20480
    v_accvgpr_read_b32 v208, a164
    v_mfma_f32_16x16x32_bf16 v[56:59], a[32:35], a[104:107], v[56:59]
    ds_read_b128 a[84:87], v11 offset:22528
    v_accvgpr_read_b32 v209, a165
    v_mfma_f32_16x16x32_bf16 v[60:63], a[32:35], a[108:111], v[60:63]
    ds_read_b64_tr_b16 a[0:1], v7 offset:0
    buffer_load_dwordx4 v3, s[24:27], s44 offen offset:2048 lds
    v_mfma_f32_16x16x32_bf16 v[64:67], a[36:39], a[96:99], v[64:67]
    s_add_u32 s44, s54, 3306496
    ds_read_b64_tr_b16 a[2:3], v7 offset:1024
    v_accvgpr_read_b32 v210, a166
    v_mfma_f32_16x16x32_bf16 v[68:71], a[36:39], a[100:103], v[68:71]
    v_accvgpr_read_b32 v211, a167
    v_cvt_pk_bf16_f32 v200, v200, v201
    v_mfma_f32_16x16x32_bf16 v[72:75], a[36:39], a[104:107], v[72:75]
    ds_read_b64_tr_b16 a[4:5], v8 offset:0
    v_cvt_pk_bf16_f32 v201, v202, v203
    v_mfma_f32_16x16x32_bf16 v[76:79], a[36:39], a[108:111], v[76:79]
    ds_read_b64_tr_b16 a[6:7], v8 offset:1024
    buffer_load_dwordx4 v3, s[24:27], s44 offen offset:3072 lds
    v_mfma_f32_16x16x32_bf16 v[80:83], a[40:43], a[96:99], v[80:83]
    s_add_u32 m0, s42, 0
    ds_read_b64_tr_b16 a[8:9], v9 offset:0
    v_cvt_pk_bf16_f32 v202, v208, v209
    v_mfma_f32_16x16x32_bf16 v[84:87], a[40:43], a[100:103], v[84:87]
    s_add_u32 s44, s53, 768
    v_cvt_pk_bf16_f32 v203, v210, v211
    v_accvgpr_read_b32 v216, a168
    v_mfma_f32_16x16x32_bf16 v[88:91], a[40:43], a[104:107], v[88:91]
    ds_read_b64_tr_b16 a[10:11], v9 offset:1024
    v_accvgpr_read_b32 v217, a169
    v_mfma_f32_16x16x32_bf16 v[92:95], a[40:43], a[108:111], v[92:95]
    ds_read_b64_tr_b16 a[12:13], v10 offset:0
    buffer_load_dwordx4 v4, s[20:23], s44 offen lds
    v_mfma_f32_16x16x32_bf16 v[100:103], a[44:47], a[96:99], v[100:103]
    s_add_u32 s44, s53, 16128
    ds_read_b64_tr_b16 a[14:15], v10 offset:1024
    v_accvgpr_read_b32 v218, a170
    v_mfma_f32_16x16x32_bf16 v[108:111], a[44:47], a[100:103], v[108:111]
    ds_read_b64_tr_b16 a[16:17], v7 offset:4096
    v_accvgpr_read_b32 v219, a171
    v_mfma_f32_16x16x32_bf16 v[116:119], a[44:47], a[104:107], v[116:119]
    v_accvgpr_read_b32 v128, a172
    v_accvgpr_read_b32 v129, a173
    v_mfma_f32_16x16x32_bf16 v[124:127], a[44:47], a[108:111], v[124:127]
    ds_read_b64_tr_b16 a[18:19], v7 offset:5120
    buffer_load_dwordx4 v4, s[20:23], s44 offen offset:1024 lds
    v_mfma_f32_16x16x32_bf16 v[132:135], a[48:51], a[96:99], v[132:135]
    s_add_u32 s44, s53, 2816
    ds_read_b64_tr_b16 a[20:21], v8 offset:4096
    v_accvgpr_read_b32 v130, a174
    v_mfma_f32_16x16x32_bf16 v[140:143], a[48:51], a[100:103], v[140:143]
    ds_read_b64_tr_b16 a[22:23], v8 offset:5120
    v_accvgpr_read_b32 v131, a175
    v_mfma_f32_16x16x32_bf16 v[148:151], a[48:51], a[104:107], v[148:151]
    ds_read_b64_tr_b16 a[24:25], v9 offset:4096
    v_cvt_pk_bf16_f32 v216, v216, v217
    v_mfma_f32_16x16x32_bf16 v[156:159], a[48:51], a[108:111], v[156:159]
    buffer_load_dwordx4 v4, s[20:23], s44 offen offset:2048 lds
    v_cvt_pk_bf16_f32 v217, v218, v219
    v_mfma_f32_16x16x32_bf16 v[164:167], a[52:55], a[96:99], v[164:167]
    s_add_u32 s44, s53, 18176
    ds_read_b64_tr_b16 a[26:27], v9 offset:5120
    v_cvt_pk_bf16_f32 v218, v128, v129
    v_mfma_f32_16x16x32_bf16 v[172:175], a[52:55], a[100:103], v[172:175]
    ds_read_b64_tr_b16 a[28:29], v10 offset:4096
    v_cvt_pk_bf16_f32 v219, v130, v131
    v_mfma_f32_16x16x32_bf16 v[180:183], a[52:55], a[104:107], v[180:183]
    ds_read_b64_tr_b16 a[30:31], v10 offset:5120
    v_accvgpr_read_b32 v224, a176
    v_mfma_f32_16x16x32_bf16 v[188:191], a[52:55], a[108:111], v[188:191]
    buffer_load_dwordx4 v4, s[20:23], s44 offen offset:3072 lds
    v_accvgpr_read_b32 v225, a177
    v_mfma_f32_16x16x32_bf16 v[196:199], a[56:59], a[96:99], v[196:199]
    s_add_u32 m0, s42, 4096
    v_accvgpr_read_b32 v226, a178
    v_accvgpr_read_b32 v227, a179
    v_mfma_f32_16x16x32_bf16 v[204:207], a[56:59], a[100:103], v[204:207]
    s_add_u32 s44, s47, 768
    v_accvgpr_read_b32 v232, a180
    v_accvgpr_read_b32 v233, a181
    v_mfma_f32_16x16x32_bf16 v[212:215], a[56:59], a[104:107], v[212:215]
    v_accvgpr_read_b32 v234, a182
    v_accvgpr_read_b32 v235, a183
    v_mfma_f32_16x16x32_bf16 v[220:223], a[56:59], a[108:111], v[220:223]
    buffer_load_dwordx4 v4, s[20:23], s44 offen lds
    v_cvt_pk_bf16_f32 v224, v224, v225
    v_mfma_f32_16x16x32_bf16 v[228:231], a[60:63], a[96:99], v[228:231]
    s_add_u32 s44, s47, 16128
    v_cvt_pk_bf16_f32 v225, v226, v227
    v_cvt_pk_bf16_f32 v226, v232, v233
    v_mfma_f32_16x16x32_bf16 v[236:239], a[60:63], a[100:103], v[236:239]
    v_cvt_pk_bf16_f32 v227, v234, v235
    v_accvgpr_read_b32 v240, a184
    v_mfma_f32_16x16x32_bf16 v[244:247], a[60:63], a[104:107], v[244:247]
    v_accvgpr_read_b32 v241, a185
    v_accvgpr_read_b32 v242, a186
    v_mfma_f32_16x16x32_bf16 v[252:255], a[60:63], a[108:111], v[252:255]
    s_waitcnt lgkmcnt(0)
    buffer_load_dwordx4 v4, s[20:23], s44 offen offset:1024 lds
    v_accvgpr_read_b32 v243, a187
    v_mfma_f32_16x16x32_bf16 v[16:19], a[64:67], a[80:83], v[16:19]
    s_add_u32 s44, s47, 2816
    ds_read_b128 a[96:99], v6 offset:0
    v_accvgpr_read_b32 v248, a188
    v_mfma_f32_16x16x32_bf16 v[20:23], a[68:71], a[80:83], v[20:23]
    ds_read_b128 a[100:103], v6 offset:2048
    v_accvgpr_read_b32 v249, a189
    v_mfma_f32_16x16x32_bf16 v[24:27], a[72:75], a[80:83], v[24:27]
    ds_read_b128 a[104:107], v6 offset:4096
    v_xor_b32 v5, 0x10000, v5
    v_mfma_f32_16x16x32_bf16 v[28:31], a[76:79], a[80:83], v[28:31]
    buffer_load_dwordx4 v4, s[20:23], s44 offen offset:2048 lds
    v_accvgpr_read_b32 v250, a190
    v_mfma_f32_16x16x32_bf16 v[32:35], a[64:67], a[84:87], v[32:35]
    s_add_u32 s44, s47, 18176
    ds_read_b128 a[108:111], v6 offset:6144
    v_accvgpr_read_b32 v251, a191
    v_mfma_f32_16x16x32_bf16 v[36:39], a[68:71], a[84:87], v[36:39]
    ds_read_b128 a[112:115], v12 offset:20480
    v_cvt_pk_bf16_f32 v240, v240, v241
    v_mfma_f32_16x16x32_bf16 v[40:43], a[72:75], a[84:87], v[40:43]
    ds_read_b128 a[116:119], v12 offset:22528
    v_cvt_pk_bf16_f32 v241, v242, v243
    v_mfma_f32_16x16x32_bf16 v[44:47], a[76:79], a[84:87], v[44:47]
    buffer_load_dwordx4 v4, s[20:23], s44 offen offset:3072 lds
    v_cvt_pk_bf16_f32 v242, v248, v249
    v_mfma_f32_16x16x32_bf16 v[48:51], a[0:3], a[64:67], v[48:51]
    ds_read_b64_tr_b16 a[32:33], v7 offset:8192
    buffer_store_dwordx4 v[200:203], v1, s[8:11], s6 offen offset:0
    v_mfma_f32_16x16x32_bf16 v[52:55], a[0:3], a[68:71], v[52:55]
    ds_read_b64_tr_b16 a[34:35], v7 offset:9216
    v_cvt_pk_bf16_f32 v243, v250, v251
    v_mfma_f32_16x16x32_bf16 v[56:59], a[0:3], a[72:75], v[56:59]
    ds_read_b64_tr_b16 a[36:37], v8 offset:8192
    v_mfma_f32_16x16x32_bf16 v[60:63], a[0:3], a[76:79], v[60:63]
    v_mfma_f32_16x16x32_bf16 v[64:67], a[4:7], a[64:67], v[64:67]
    ds_read_b64_tr_b16 a[38:39], v8 offset:9216
    buffer_store_dwordx4 v[216:219], v1, s[8:11], s6 offen offset:1024
    v_mfma_f32_16x16x32_bf16 v[68:71], a[4:7], a[68:71], v[68:71]
    ds_read_b64_tr_b16 a[40:41], v9 offset:8192
    v_mfma_f32_16x16x32_bf16 v[72:75], a[4:7], a[72:75], v[72:75]
    v_mfma_f32_16x16x32_bf16 v[76:79], a[4:7], a[76:79], v[76:79]
    ds_read_b64_tr_b16 a[42:43], v9 offset:9216
    v_mfma_f32_16x16x32_bf16 v[80:83], a[8:11], a[64:67], v[80:83]
    ds_read_b64_tr_b16 a[44:45], v10 offset:8192
    buffer_store_dwordx4 v[224:227], v1, s[8:11], s6 offen offset:2048
    v_mfma_f32_16x16x32_bf16 v[84:87], a[8:11], a[68:71], v[84:87]
    ds_read_b64_tr_b16 a[46:47], v10 offset:9216
    v_mfma_f32_16x16x32_bf16 v[88:91], a[8:11], a[72:75], v[88:91]
    v_mfma_f32_16x16x32_bf16 v[92:95], a[8:11], a[76:79], v[92:95]
    ds_read_b64_tr_b16 a[48:49], v7 offset:12288
    v_mfma_f32_16x16x32_bf16 v[100:103], a[12:15], a[64:67], v[100:103]
    ds_read_b64_tr_b16 a[50:51], v7 offset:13312
    buffer_store_dwordx4 v[240:243], v1, s[8:11], s6 offen offset:3072
    v_mfma_f32_16x16x32_bf16 v[108:111], a[12:15], a[68:71], v[108:111]
    s_add_u32 s6, s46, 790528
    ds_read_b64_tr_b16 a[52:53], v8 offset:12288
    v_mfma_f32_16x16x32_bf16 v[116:119], a[12:15], a[72:75], v[116:119]
    v_mfma_f32_16x16x32_bf16 v[124:127], a[12:15], a[76:79], v[124:127]
    ds_read_b64_tr_b16 a[54:55], v8 offset:13312
    v_mfma_f32_16x16x32_bf16 v[132:135], a[16:19], a[64:67], v[132:135]
    ds_read_b64_tr_b16 a[56:57], v9 offset:12288
    buffer_store_dwordx4 v[112:115], v1, s[8:11], s7 offen offset:2048 sc1
    v_mfma_f32_16x16x32_bf16 v[140:143], a[16:19], a[68:71], v[140:143]
    ds_read_b64_tr_b16 a[58:59], v9 offset:13312
    v_mfma_f32_16x16x32_bf16 v[148:151], a[16:19], a[72:75], v[148:151]
    v_mfma_f32_16x16x32_bf16 v[156:159], a[16:19], a[76:79], v[156:159]
    ds_read_b64_tr_b16 a[60:61], v10 offset:12288
    v_mfma_f32_16x16x32_bf16 v[164:167], a[20:23], a[64:67], v[164:167]
    ds_read_b64_tr_b16 a[62:63], v10 offset:13312
    v_mfma_f32_16x16x32_bf16 v[172:175], a[20:23], a[68:71], v[172:175]
    v_mfma_f32_16x16x32_bf16 v[180:183], a[20:23], a[72:75], v[180:183]
    v_mfma_f32_16x16x32_bf16 v[188:191], a[20:23], a[76:79], v[188:191]
    v_mfma_f32_16x16x32_bf16 v[196:199], a[24:27], a[64:67], v[196:199]
    v_mfma_f32_16x16x32_bf16 v[204:207], a[24:27], a[68:71], v[204:207]
    v_mfma_f32_16x16x32_bf16 v[212:215], a[24:27], a[72:75], v[212:215]
    v_xor_b32 v7, 0x10000, v7
    v_xor_b32 v8, 0x10000, v8
    v_mfma_f32_16x16x32_bf16 v[220:223], a[24:27], a[76:79], v[220:223]
    v_xor_b32 v9, 0x10000, v9
    v_xor_b32 v10, 0x10000, v10
    v_mfma_f32_16x16x32_bf16 v[228:231], a[28:31], a[64:67], v[228:231]
    v_xor_b32 v6, 0x10000, v6
    v_mfma_f32_16x16x32_bf16 v[236:239], a[28:31], a[68:71], v[236:239]
    v_mfma_f32_16x16x32_bf16 v[244:247], a[28:31], a[72:75], v[244:247]
    v_mfma_f32_16x16x32_bf16 v[252:255], a[28:31], a[76:79], v[252:255]
    s_waitcnt lgkmcnt(0)
    v_mfma_f32_16x16x32_bf16 v[16:19], a[96:99], a[112:115], v[16:19]
    s_waitcnt vmcnt(5)
    v_mfma_f32_16x16x32_bf16 v[20:23], a[100:103], a[112:115], v[20:23]
    v_mfma_f32_16x16x32_bf16 v[24:27], a[104:107], a[112:115], v[24:27]
    s_barrier
    v_mfma_f32_16x16x32_bf16 v[28:31], a[108:111], a[112:115], v[28:31]
    s_add_u32 m0, s55, 65536
    v_mfma_f32_16x16x32_bf16 v[32:35], a[96:99], a[116:119], v[32:35]
    s_add_u32 s44, s54, 3670016
    ds_read_b128 a[64:67], v5 offset:0
    buffer_load_dwordx4 v3, s[24:27], s44 offen lds
    v_mfma_f32_16x16x32_bf16 v[36:39], a[100:103], a[116:119], v[36:39]
    s_add_u32 s44, s54, 3701760
    ds_read_b128 a[68:71], v5 offset:2048
    v_accvgpr_read_b32 v96, a192
    v_mfma_f32_16x16x32_bf16 v[40:43], a[104:107], a[116:119], v[40:43]
    ds_read_b128 a[72:75], v5 offset:4096
    buffer_load_dwordx4 v3, s[24:27], s44 offen offset:1024 lds
    v_mfma_f32_16x16x32_bf16 v[44:47], a[108:111], a[116:119], v[44:47]
    s_add_u32 s44, s54, 3799040
    ds_read_b128 a[76:79], v5 offset:6144
    v_accvgpr_read_b32 v97, a193
    v_mfma_f32_16x16x32_bf16 v[48:51], a[32:35], a[96:99], v[48:51]
    v_accvgpr_read_b32 v98, a194
    v_accvgpr_read_b32 v99, a195
    v_mfma_f32_16x16x32_bf16 v[52:55], a[32:35], a[100:103], v[52:55]
    ds_read_b128 a[80:83], v11 offset:24576
    v_accvgpr_read_b32 v144, a196
    v_mfma_f32_16x16x32_bf16 v[56:59], a[32:35], a[104:107], v[56:59]
    ds_read_b128 a[84:87], v11 offset:26624
    buffer_load_dwordx4 v3, s[24:27], s44 offen offset:2048 lds
    v_mfma_f32_16x16x32_bf16 v[60:63], a[32:35], a[108:111], v[60:63]
    s_add_u32 s44, s54, 3830784
    ds_read_b64_tr_b16 a[0:1], v7 offset:0
    v_accvgpr_read_b32 v145, a197
    v_mfma_f32_16x16x32_bf16 v[64:67], a[36:39], a[96:99], v[64:67]
    ds_read_b64_tr_b16 a[2:3], v7 offset:1024
    v_accvgpr_read_b32 v146, a198
    v_mfma_f32_16x16x32_bf16 v[68:71], a[36:39], a[100:103], v[68:71]
    v_accvgpr_read_b32 v147, a199
    v_cvt_pk_bf16_f32 v96, v96, v97
    v_mfma_f32_16x16x32_bf16 v[72:75], a[36:39], a[104:107], v[72:75]
    ds_read_b64_tr_b16 a[4:5], v8 offset:0
    buffer_load_dwordx4 v3, s[24:27], s44 offen offset:3072 lds
    v_mfma_f32_16x16x32_bf16 v[76:79], a[36:39], a[108:111], v[76:79]
    s_add_u32 m0, s42, 65536
    ds_read_b64_tr_b16 a[6:7], v8 offset:1024
    v_cvt_pk_bf16_f32 v97, v98, v99
    v_mfma_f32_16x16x32_bf16 v[80:83], a[40:43], a[96:99], v[80:83]
    s_add_u32 s44, s53, 896
    ds_read_b64_tr_b16 a[8:9], v9 offset:0
    v_cvt_pk_bf16_f32 v98, v144, v145
    v_mfma_f32_16x16x32_bf16 v[84:87], a[40:43], a[100:103], v[84:87]
    v_cvt_pk_bf16_f32 v99, v146, v147
    v_accvgpr_read_b32 v136, a200
    v_mfma_f32_16x16x32_bf16 v[88:91], a[40:43], a[104:107], v[88:91]
    ds_read_b64_tr_b16 a[10:11], v9 offset:1024
    buffer_load_dwordx4 v4, s[20:23], s44 offen lds
    v_mfma_f32_16x16x32_bf16 v[92:95], a[40:43], a[108:111], v[92:95]
    ds_read_b64_tr_b16 a[12:13], v10 offset:0
    v_accvgpr_read_b32 v137, a201
    v_mfma_f32_16x16x32_bf16 v[100:103], a[44:47], a[96:99], v[100:103]
    ds_read_b64_tr_b16 a[14:15], v10 offset:1024
    v_accvgpr_read_b32 v138, a202
    v_mfma_f32_16x16x32_bf16 v[108:111], a[44:47], a[100:103], v[108:111]
    ds_read_b64_tr_b16 a[16:17], v7 offset:4096
    buffer_load_dword v13, v14, s[28:31], 0 offen sc1
    v_mfma_f32_16x16x32_bf16 v[116:119], a[44:47], a[104:107], v[116:119]
    s_add_u32 s44, s53, 16256
    v_accvgpr_read_b32 v139, a203
    v_accvgpr_read_b32 v160, a204
    v_mfma_f32_16x16x32_bf16 v[124:127], a[44:47], a[108:111], v[124:127]
    ds_read_b64_tr_b16 a[18:19], v7 offset:5120
    v_accvgpr_read_b32 v161, a205
    v_mfma_f32_16x16x32_bf16 v[132:135], a[48:51], a[96:99], v[132:135]
    ds_read_b64_tr_b16 a[20:21], v8 offset:4096
    v_accvgpr_read_b32 v162, a206
    v_mfma_f32_16x16x32_bf16 v[140:143], a[48:51], a[100:103], v[140:143]
    ds_read_b64_tr_b16 a[22:23], v8 offset:5120
    buffer_load_dwordx4 v4, s[20:23], s44 offen offset:1024 lds
    v_mfma_f32_16x16x32_bf16 v[148:151], a[48:51], a[104:107], v[148:151]
    s_add_u32 s44, s53, 2944
    ds_read_b64_tr_b16 a[24:25], v9 offset:4096
    v_accvgpr_read_b32 v163, a207
    v_mfma_f32_16x16x32_bf16 v[156:159], a[48:51], a[108:111], v[156:159]
    v_cvt_pk_bf16_f32 v136, v136, v137
    v_cvt_pk_bf16_f32 v137, v138, v139
    v_mfma_f32_16x16x32_bf16 v[164:167], a[52:55], a[96:99], v[164:167]
    ds_read_b64_tr_b16 a[26:27], v9 offset:5120
    v_cvt_pk_bf16_f32 v138, v160, v161
    v_mfma_f32_16x16x32_bf16 v[172:175], a[52:55], a[100:103], v[172:175]
    ds_read_b64_tr_b16 a[28:29], v10 offset:4096
    buffer_load_dwordx4 v4, s[20:23], s44 offen offset:2048 lds
    v_mfma_f32_16x16x32_bf16 v[180:183], a[52:55], a[104:107], v[180:183]
    s_add_u32 s44, s53, 18304
    ds_read_b64_tr_b16 a[30:31], v10 offset:5120
    v_cvt_pk_bf16_f32 v139, v162, v163
    v_mfma_f32_16x16x32_bf16 v[188:191], a[52:55], a[108:111], v[188:191]
    v_accvgpr_read_b32 v152, a208
    v_accvgpr_read_b32 v153, a209
    v_mfma_f32_16x16x32_bf16 v[196:199], a[56:59], a[96:99], v[196:199]
    v_accvgpr_read_b32 v154, a210
    v_accvgpr_read_b32 v155, a211
    v_mfma_f32_16x16x32_bf16 v[204:207], a[56:59], a[100:103], v[204:207]
    buffer_load_dwordx4 v4, s[20:23], s44 offen offset:3072 lds
    v_accvgpr_read_b32 v176, a212
    v_mfma_f32_16x16x32_bf16 v[212:215], a[56:59], a[104:107], v[212:215]
    s_add_u32 m0, s42, 69632
    v_accvgpr_read_b32 v177, a213
    v_accvgpr_read_b32 v178, a214
    v_mfma_f32_16x16x32_bf16 v[220:223], a[56:59], a[108:111], v[220:223]
    s_add_u32 s44, s47, 896
    v_accvgpr_read_b32 v179, a215
    v_cvt_pk_bf16_f32 v152, v152, v153
    v_mfma_f32_16x16x32_bf16 v[228:231], a[60:63], a[96:99], v[228:231]
    buffer_load_dwordx4 v4, s[20:23], s44 offen lds
    v_cvt_pk_bf16_f32 v153, v154, v155
    v_mfma_f32_16x16x32_bf16 v[236:239], a[60:63], a[100:103], v[236:239]
    s_add_u32 s44, s47, 16256
    v_cvt_pk_bf16_f32 v154, v176, v177
    v_cvt_pk_bf16_f32 v155, v178, v179
    v_mfma_f32_16x16x32_bf16 v[244:247], a[60:63], a[104:107], v[244:247]
    v_accvgpr_read_b32 v168, a216
    v_accvgpr_read_b32 v169, a217
    v_mfma_f32_16x16x32_bf16 v[252:255], a[60:63], a[108:111], v[252:255]
    s_waitcnt lgkmcnt(0)
    v_accvgpr_read_b32 v170, a218
    v_accvgpr_read_b32 v171, a219
    v_mfma_f32_16x16x32_bf16 v[16:19], a[64:67], a[80:83], v[16:19]
    buffer_load_dwordx4 v4, s[20:23], s44 offen offset:1024 lds
    ds_read_b128 a[96:99], v6 offset:0
    v_mfma_f32_16x16x32_bf16 v[20:23], a[68:71], a[80:83], v[20:23]
    s_add_u32 s44, s47, 2944
    ds_read_b128 a[100:103], v6 offset:2048
    v_accvgpr_read_b32 v192, a220
    v_mfma_f32_16x16x32_bf16 v[24:27], a[72:75], a[80:83], v[24:27]
    ds_read_b128 a[104:107], v6 offset:4096
    v_xor_b32 v5, 0x10000, v5
    v_mfma_f32_16x16x32_bf16 v[28:31], a[76:79], a[80:83], v[28:31]
    v_accvgpr_read_b32 v193, a221
    v_accvgpr_read_b32 v194, a222
    v_mfma_f32_16x16x32_bf16 v[32:35], a[64:67], a[84:87], v[32:35]
    buffer_load_dwordx4 v4, s[20:23], s44 offen offset:2048 lds
    ds_read_b128 a[108:111], v6 offset:6144
    v_mfma_f32_16x16x32_bf16 v[36:39], a[68:71], a[84:87], v[36:39]
    s_add_u32 s44, s47, 18304
    ds_read_b128 a[112:115], v12 offset:24576
    v_accvgpr_read_b32 v195, a223
    v_mfma_f32_16x16x32_bf16 v[40:43], a[72:75], a[84:87], v[40:43]
    ds_read_b128 a[116:119], v12 offset:26624
    v_cvt_pk_bf16_f32 v168, v168, v169
    v_mfma_f32_16x16x32_bf16 v[44:47], a[76:79], a[84:87], v[44:47]
    v_cvt_pk_bf16_f32 v169, v170, v171
    v_cvt_pk_bf16_f32 v170, v192, v193
    v_mfma_f32_16x16x32_bf16 v[48:51], a[0:3], a[64:67], v[48:51]
    buffer_load_dwordx4 v4, s[20:23], s44 offen offset:3072 lds
    ds_read_b64_tr_b16 a[32:33], v7 offset:8192
    v_mfma_f32_16x16x32_bf16 v[52:55], a[0:3], a[68:71], v[52:55]
    ds_read_b64_tr_b16 a[34:35], v7 offset:9216
    buffer_store_dwordx4 v[96:99], v1, s[8:11], s6 offen offset:0
    v_mfma_f32_16x16x32_bf16 v[56:59], a[0:3], a[72:75], v[56:59]
    ds_read_b64_tr_b16 a[36:37], v8 offset:8192
    v_cvt_pk_bf16_f32 v171, v194, v195
    v_mfma_f32_16x16x32_bf16 v[60:63], a[0:3], a[76:79], v[60:63]
    v_mfma_f32_16x16x32_bf16 v[64:67], a[4:7], a[64:67], v[64:67]
    ds_read_b64_tr_b16 a[38:39], v8 offset:9216
    v_mfma_f32_16x16x32_bf16 v[68:71], a[4:7], a[68:71], v[68:71]
    ds_read_b64_tr_b16 a[40:41], v9 offset:8192
    buffer_store_dwordx4 v[136:139], v1, s[8:11], s6 offen offset:1024
    v_mfma_f32_16x16x32_bf16 v[72:75], a[4:7], a[72:75], v[72:75]
    v_mfma_f32_16x16x32_bf16 v[76:79], a[4:7], a[76:79], v[76:79]
    ds_read_b64_tr_b16 a[42:43], v9 offset:9216
    v_mfma_f32_16x16x32_bf16 v[80:83], a[8:11], a[64:67], v[80:83]
    ds_read_b64_tr_b16 a[44:45], v10 offset:8192
    v_mfma_f32_16x16x32_bf16 v[84:87], a[8:11], a[68:71], v[84:87]
    ds_read_b64_tr_b16 a[46:47], v10 offset:9216
    buffer_store_dwordx4 v[152:155], v1, s[8:11], s6 offen offset:2048
    v_mfma_f32_16x16x32_bf16 v[88:91], a[8:11], a[72:75], v[88:91]
    v_mfma_f32_16x16x32_bf16 v[92:95], a[8:11], a[76:79], v[92:95]
    ds_read_b64_tr_b16 a[48:49], v7 offset:12288
    v_mfma_f32_16x16x32_bf16 v[100:103], a[12:15], a[64:67], v[100:103]
    ds_read_b64_tr_b16 a[50:51], v7 offset:13312
    v_mfma_f32_16x16x32_bf16 v[108:111], a[12:15], a[68:71], v[108:111]
    ds_read_b64_tr_b16 a[52:53], v8 offset:12288
    buffer_store_dwordx4 v[168:171], v1, s[8:11], s6 offen offset:3072
    v_mfma_f32_16x16x32_bf16 v[116:119], a[12:15], a[72:75], v[116:119]
    v_mfma_f32_16x16x32_bf16 v[124:127], a[12:15], a[76:79], v[124:127]
    ds_read_b64_tr_b16 a[54:55], v8 offset:13312
    v_mfma_f32_16x16x32_bf16 v[132:135], a[16:19], a[64:67], v[132:135]
    ds_read_b64_tr_b16 a[56:57], v9 offset:12288
    v_mfma_f32_16x16x32_bf16 v[140:143], a[16:19], a[68:71], v[140:143]
    ds_read_b64_tr_b16 a[58:59], v9 offset:13312
    buffer_store_dwordx4 v[120:123], v1, s[8:11], s7 offen offset:3072 sc1
    v_mfma_f32_16x16x32_bf16 v[148:151], a[16:19], a[72:75], v[148:151]
    v_mfma_f32_16x16x32_bf16 v[156:159], a[16:19], a[76:79], v[156:159]
    ds_read_b64_tr_b16 a[60:61], v10 offset:12288
    v_mfma_f32_16x16x32_bf16 v[164:167], a[20:23], a[64:67], v[164:167]
    ds_read_b64_tr_b16 a[62:63], v10 offset:13312
    v_mfma_f32_16x16x32_bf16 v[172:175], a[20:23], a[68:71], v[172:175]
    v_mfma_f32_16x16x32_bf16 v[180:183], a[20:23], a[72:75], v[180:183]
    v_mfma_f32_16x16x32_bf16 v[188:191], a[20:23], a[76:79], v[188:191]
    v_mfma_f32_16x16x32_bf16 v[196:199], a[24:27], a[64:67], v[196:199]
    v_mfma_f32_16x16x32_bf16 v[204:207], a[24:27], a[68:71], v[204:207]
    v_mfma_f32_16x16x32_bf16 v[212:215], a[24:27], a[72:75], v[212:215]
    v_xor_b32 v7, 0x10000, v7
    v_xor_b32 v8, 0x10000, v8
    v_mfma_f32_16x16x32_bf16 v[220:223], a[24:27], a[76:79], v[220:223]
    v_xor_b32 v9, 0x10000, v9
    v_xor_b32 v10, 0x10000, v10
    v_mfma_f32_16x16x32_bf16 v[228:231], a[28:31], a[64:67], v[228:231]
    s_waitcnt vmcnt(12)
    v_xor_b32 v6, 0x10000, v6
    v_readfirstlane_b32 s52, v13
    v_mfma_f32_16x16x32_bf16 v[236:239], a[28:31], a[68:71], v[236:239]
    s_lshr_b32 s52, s52, 27
    v_mfma_f32_16x16x32_bf16 v[244:247], a[28:31], a[72:75], v[244:247]
    s_cmp_ge_u32 s52, s50
    s_cbranch_scc0 A_spin1
A_ret1:
    v_mfma_f32_16x16x32_bf16 v[252:255], a[28:31], a[76:79], v[252:255]
    s_waitcnt lgkmcnt(0)
    v_mfma_f32_16x16x32_bf16 v[16:19], a[96:99], a[112:115], v[16:19]
    s_waitcnt vmcnt(5)
    v_mfma_f32_16x16x32_bf16 v[20:23], a[100:103], a[112:115], v[20:23]
    v_mfma_f32_16x16x32_bf16 v[24:27], a[104:107], a[112:115], v[24:27]
    s_barrier
    v_mfma_f32_16x16x32_bf16 v[28:31], a[108:111], a[112:115], v[28:31]
    s_add_u32 m0, s49, 0
    v_mfma_f32_16x16x32_bf16 v[32:35], a[96:99], a[116:119], v[32:35]
    s_add_u32 s44, s48, 0
    ds_read_b128 a[64:67], v5 offset:0
    buffer_load_dwordx4 v1, s[8:11], s44 offen sc1 lds
    v_mfma_f32_16x16x32_bf16 v[36:39], a[100:103], a[116:119], v[36:39]
    ds_read_b128 a[68:71], v5 offset:2048
    v_mfma_f32_16x16x32_bf16 v[40:43], a[104:107], a[116:119], v[40:43]
    ds_read_b128 a[72:75], v5 offset:4096
    v_mfma_f32_16x16x32_bf16 v[44:47], a[108:111], a[116:119], v[44:47]
    ds_read_b128 a[76:79], v5 offset:6144
    buffer_load_dwordx4 v1, s[8:11], s44 offen offset:1024 sc1 lds
    v_mfma_f32_16x16x32_bf16 v[48:51], a[32:35], a[96:99], v[48:51]
    v_mfma_f32_16x16x32_bf16 v[52:55], a[32:35], a[100:103], v[52:55]
    ds_read_b128 a[80:83], v11 offset:28672
    v_mfma_f32_16x16x32_bf16 v[56:59], a[32:35], a[104:107], v[56:59]
    ds_read_b128 a[84:87], v11 offset:30720
    v_mfma_f32_16x16x32_bf16 v[60:63], a[32:35], a[108:111], v[60:63]
    ds_read_b64_tr_b16 a[0:1], v7 offset:0
    buffer_load_dwordx4 v1, s[8:11], s44 offen offset:2048 sc1 lds
    v_mfma_f32_16x16x32_bf16 v[64:67], a[36:39], a[96:99], v[64:67]
    ds_read_b64_tr_b16 a[2:3], v7 offset:1024
    v_mfma_f32_16x16x32_bf16 v[68:71], a[36:39], a[100:103], v[68:71]
    v_mfma_f32_16x16x32_bf16 v[72:75], a[36:39], a[104:107], v[72:75]
    ds_read_b64_tr_b16 a[4:5], v8 offset:0
    v_mfma_f32_16x16x32_bf16 v[76:79], a[36:39], a[108:111], v[76:79]
    ds_read_b64_tr_b16 a[6:7], v8 offset:1024
    buffer_load_dwordx4 v1, s[8:11], s44 offen offset:3072 sc1 lds
    v_mfma_f32_16x16x32_bf16 v[80:83], a[40:43], a[96:99], v[80:83]
    s_add_u32 m0, s49, 4096
    ds_read_b64_tr_b16 a[8:9], v9 offset:0
    v_mfma_f32_16x16x32_bf16 v[84:87], a[40:43], a[100:103], v[84:87]
    s_add_u32 s44, s48, 4096
    v_mfma_f32_16x16x32_bf16 v[88:91], a[40:43], a[104:107], v[88:91]
    ds_read_b64_tr_b16 a[10:11], v9 offset:1024
    v_mfma_f32_16x16x32_bf16 v[92:95], a[40:43], a[108:111], v[92:95]
    ds_read_b64_tr_b16 a[12:13], v10 offset:0
    buffer_load_dwordx4 v1, s[8:11], s44 offen sc1 lds
    v_mfma_f32_16x16x32_bf16 v[100:103], a[44:47], a[96:99], v[100:103]
    ds_read_b64_tr_b16 a[14:15], v10 offset:1024
    v_mfma_f32_16x16x32_bf16 v[108:111], a[44:47], a[100:103], v[108:111]
    ds_read_b64_tr_b16 a[16:17], v7 offset:4096
    v_mfma_f32_16x16x32_bf16 v[116:119], a[44:47], a[104:107], v[116:119]
    v_mfma_f32_16x16x32_bf16 v[124:127], a[44:47], a[108:111], v[124:127]
    ds_read_b64_tr_b16 a[18:19], v7 offset:5120
    buffer_load_dwordx4 v1, s[8:11], s44 offen offset:1024 sc1 lds
    v_mfma_f32_16x16x32_bf16 v[132:135], a[48:51], a[96:99], v[132:135]
    ds_read_b64_tr_b16 a[20:21], v8 offset:4096
    v_mfma_f32_16x16x32_bf16 v[140:143], a[48:51], a[100:103], v[140:143]
    ds_read_b64_tr_b16 a[22:23], v8 offset:5120
    v_mfma_f32_16x16x32_bf16 v[148:151], a[48:51], a[104:107], v[148:151]
    ds_read_b64_tr_b16 a[24:25], v9 offset:4096
    v_mfma_f32_16x16x32_bf16 v[156:159], a[48:51], a[108:111], v[156:159]
    v_mfma_f32_16x16x32_bf16 v[164:167], a[52:55], a[96:99], v[164:167]
    ds_read_b64_tr_b16 a[26:27], v9 offset:5120
    buffer_load_dwordx4 v1, s[8:11], s44 offen offset:2048 sc1 lds
    v_mfma_f32_16x16x32_bf16 v[172:175], a[52:55], a[100:103], v[172:175]
    ds_read_b64_tr_b16 a[28:29], v10 offset:4096
    v_mfma_f32_16x16x32_bf16 v[180:183], a[52:55], a[104:107], v[180:183]
    ds_read_b64_tr_b16 a[30:31], v10 offset:5120
    v_mfma_f32_16x16x32_bf16 v[188:191], a[52:55], a[108:111], v[188:191]
    v_mfma_f32_16x16x32_bf16 v[196:199], a[56:59], a[96:99], v[196:199]
    buffer_load_dwordx4 v1, s[8:11], s44 offen offset:3072 sc1 lds
    v_mfma_f32_16x16x32_bf16 v[204:207], a[56:59], a[100:103], v[204:207]
    s_add_u32 m0, s49, 8192
    v_mfma_f32_16x16x32_bf16 v[212:215], a[56:59], a[104:107], v[212:215]
    s_add_u32 s44, s48, 8192
    v_mfma_f32_16x16x32_bf16 v[220:223], a[56:59], a[108:111], v[220:223]
    v_mfma_f32_16x16x32_bf16 v[228:231], a[60:63], a[96:99], v[228:231]
    buffer_load_dwordx4 v1, s[8:11], s44 offen sc1 lds
    v_mfma_f32_16x16x32_bf16 v[236:239], a[60:63], a[100:103], v[236:239]
    v_mfma_f32_16x16x32_bf16 v[244:247], a[60:63], a[104:107], v[244:247]
    v_mfma_f32_16x16x32_bf16 v[252:255], a[60:63], a[108:111], v[252:255]
    s_waitcnt lgkmcnt(0)
    v_mfma_f32_16x16x32_bf16 v[16:19], a[64:67], a[80:83], v[16:19]
    buffer_load_dwordx4 v1, s[8:11], s44 offen offset:1024 sc1 lds
    ds_read_b128 a[96:99], v6 offset:0
    v_mfma_f32_16x16x32_bf16 v[20:23], a[68:71], a[80:83], v[20:23]
    ds_read_b128 a[100:103], v6 offset:2048
    v_mfma_f32_16x16x32_bf16 v[24:27], a[72:75], a[80:83], v[24:27]
    ds_read_b128 a[104:107], v6 offset:4096
    v_mfma_f32_16x16x32_bf16 v[28:31], a[76:79], a[80:83], v[28:31]
    v_mfma_f32_16x16x32_bf16 v[32:35], a[64:67], a[84:87], v[32:35]
    buffer_load_dwordx4 v1, s[8:11], s44 offen offset:2048 sc1 lds
    ds_read_b128 a[108:111], v6 offset:6144
    v_mfma_f32_16x16x32_bf16 v[36:39], a[68:71], a[84:87], v[36:39]
    ds_read_b128 a[112:115], v12 offset:28672
    v_mfma_f32_16x16x32_bf16 v[40:43], a[72:75], a[84:87], v[40:43]
    ds_read_b128 a[116:119], v12 offset:30720
    v_mfma_f32_16x16x32_bf16 v[44:47], a[76:79], a[84:87], v[44:47]
    v_mfma_f32_16x16x32_bf16 v[48:51], a[0:3], a[64:67], v[48:51]
    ds_read_b64_tr_b16 a[32:33], v7 offset:8192
    v_mfma_f32_16x16x32_bf16 v[52:55], a[0:3], a[68:71], v[52:55]
    buffer_load_dwordx4 v1, s[8:11], s44 offen offset:3072 sc1 lds
    ds_read_b64_tr_b16 a[34:35], v7 offset:9216
    v_mfma_f32_16x16x32_bf16 v[56:59], a[0:3], a[72:75], v[56:59]
    s_add_u32 m0, s49, 12288
    ds_read_b64_tr_b16 a[36:37], v8 offset:8192
    v_mfma_f32_16x16x32_bf16 v[60:63], a[0:3], a[76:79], v[60:63]
    s_add_u32 s44, s48, 12288
    v_mfma_f32_16x16x32_bf16 v[64:67], a[4:7], a[64:67], v[64:67]
    ds_read_b64_tr_b16 a[38:39], v8 offset:9216
    v_mfma_f32_16x16x32_bf16 v[68:71], a[4:7], a[68:71], v[68:71]
    buffer_load_dwordx4 v1, s[8:11], s44 offen sc1 lds
    ds_read_b64_tr_b16 a[40:41], v9 offset:8192
    v_mfma_f32_16x16x32_bf16 v[72:75], a[4:7], a[72:75], v[72:75]
    s_add_u32 s48, s48, 0x10000
    v_mfma_f32_16x16x32_bf16 v[76:79], a[4:7], a[76:79], v[76:79]
    s_xor_b32 s49, s49, 0x10000
    ds_read_b64_tr_b16 a[42:43], v9 offset:9216
    v_mfma_f32_16x16x32_bf16 v[80:83], a[8:11], a[64:67], v[80:83]
    ds_read_b64_tr_b16 a[44:45], v10 offset:8192
    v_mfma_f32_16x16x32_bf16 v[84:87], a[8:11], a[68:71], v[84:87]
    buffer_load_dwordx4 v1, s[8:11], s44 offen offset:1024 sc1 lds
    ds_read_b64_tr_b16 a[46:47], v10 offset:9216
    v_mfma_f32_16x16x32_bf16 v[88:91], a[8:11], a[72:75], v[88:91]
    v_mfma_f32_16x16x32_bf16 v[92:95], a[8:11], a[76:79], v[92:95]
    ds_read_b64_tr_b16 a[48:49], v7 offset:12288
    v_mfma_f32_16x16x32_bf16 v[100:103], a[12:15], a[64:67], v[100:103]
    ds_read_b64_tr_b16 a[50:51], v7 offset:13312
    v_mfma_f32_16x16x32_bf16 v[108:111], a[12:15], a[68:71], v[108:111]
    buffer_load_dwordx4 v1, s[8:11], s44 offen offset:2048 sc1 lds
    ds_read_b64_tr_b16 a[52:53], v8 offset:12288
    v_mfma_f32_16x16x32_bf16 v[116:119], a[12:15], a[72:75], v[116:119]
    v_mfma_f32_16x16x32_bf16 v[124:127], a[12:15], a[76:79], v[124:127]
    ds_read_b64_tr_b16 a[54:55], v8 offset:13312
    v_mfma_f32_16x16x32_bf16 v[132:135], a[16:19], a[64:67], v[132:135]
    ds_read_b64_tr_b16 a[56:57], v9 offset:12288
    v_mfma_f32_16x16x32_bf16 v[140:143], a[16:19], a[68:71], v[140:143]
    buffer_load_dwordx4 v1, s[8:11], s44 offen offset:3072 sc1 lds
    ds_read_b64_tr_b16 a[58:59], v9 offset:13312
    v_mfma_f32_16x16x32_bf16 v[148:151], a[16:19], a[72:75], v[148:151]
    v_mfma_f32_16x16x32_bf16 v[156:159], a[16:19], a[76:79], v[156:159]
    ds_read_b64_tr_b16 a[60:61], v10 offset:12288
    v_mfma_f32_16x16x32_bf16 v[164:167], a[20:23], a[64:67], v[164:167]
    ds_read_b64_tr_b16 a[62:63], v10 offset:13312
    v_mfma_f32_16x16x32_bf16 v[172:175], a[20:23], a[68:71], v[172:175]
    v_mfma_f32_16x16x32_bf16 v[180:183], a[20:23], a[72:75], v[180:183]
    v_mfma_f32_16x16x32_bf16 v[188:191], a[20:23], a[76:79], v[188:191]
    v_mfma_f32_16x16x32_bf16 v[196:199], a[24:27], a[64:67], v[196:199]
    s_lshl_b32 s53, s3, 5
    v_mfma_f32_16x16x32_bf16 v[204:207], a[24:27], a[68:71], v[204:207]
    s_sub_u32 s54, 133472, s53
    v_mfma_f32_16x16x32_bf16 v[212:215], a[24:27], a[72:75], v[212:215]
    s_add_u32 s53, s53, 131072
    v_mfma_f32_16x16x32_bf16 v[220:223], a[24:27], a[76:79], v[220:223]
    v_mfma_f32_16x16x32_bf16 v[228:231], a[28:31], a[64:67], v[228:231]
    v_mfma_f32_16x16x32_bf16 v[236:239], a[28:31], a[68:71], v[236:239]
    v_mfma_f32_16x16x32_bf16 v[244:247], a[28:31], a[72:75], v[244:247]
    v_mfma_f32_16x16x32_bf16 v[252:255], a[28:31], a[76:79], v[252:255]
    s_waitcnt lgkmcnt(0)
    v_mfma_f32_16x16x32_bf16 v[16:19], a[96:99], a[112:115], v[16:19]
    v_accvgpr_read_b32 v208, a240
    v_accvgpr_read_b32 v209, a241
    v_mfma_f32_16x16x32_bf16 v[20:23], a[100:103], a[112:115], v[20:23]
    v_and_b32 v210, 15, v0
    v_mul_u32_u24 v210, 144, v210
    v_mfma_f32_16x16x32_bf16 v[24:27], a[104:107], a[112:115], v[24:27]
    v_lshrrev_b32 v211, 4, v0
    v_lshl_add_u32 v210, v211, 3, v210
    v_mfma_f32_16x16x32_bf16 v[28:31], a[108:111], a[112:115], v[28:31]
    v_add_u32 v11, s53, v210
    v_add_u32 v12, s54, v210
    v_mfma_f32_16x16x32_bf16 v[32:35], a[96:99], a[116:119], v[32:35]
    v_mfma_f32_16x16x32_bf16 v[36:39], a[100:103], a[116:119], v[36:39]
    v_mfma_f32_16x16x32_bf16 v[40:43], a[104:107], a[116:119], v[40:43]
    v_mfma_f32_16x16x32_bf16 v[44:47], a[108:111], a[116:119], v[44:47]
    v_mfma_f32_16x16x32_bf16 v[48:51], a[32:35], a[96:99], v[48:51]
    v_mfma_f32_16x16x32_bf16 v[52:55], a[32:35], a[100:103], v[52:55]
    v_mfma_f32_16x16x32_bf16 v[56:59], a[32:35], a[104:107], v[56:59]
    v_mfma_f32_16x16x32_bf16 v[60:63], a[32:35], a[108:111], v[60:63]
    v_fma_f32 v186, v208, v16, v17
    v_fma_f32 v187, v208, v32, v33
    v_mfma_f32_16x16x32_bf16 v[64:67], a[36:39], a[96:99], v[64:67]
    v_fma_f32 v106, v208, v24, v25
    v_fma_f32 v107, v208, v40, v41
    v_mfma_f32_16x16x32_bf16 v[68:71], a[36:39], a[100:103], v[68:71]
    v_fma_f32 v186, -v209, v32, v186
    v_fma_f32 v187, v209, v16, v187
    v_mfma_f32_16x16x32_bf16 v[72:75], a[36:39], a[104:107], v[72:75]
    v_fma_f32 v106, -v209, v40, v106
    v_fma_f32 v107, v209, v24, v107
    v_mfma_f32_16x16x32_bf16 v[76:79], a[36:39], a[108:111], v[76:79]
    v_fma_f32 v184, v208, v186, v18
    v_fma_f32 v185, v208, v187, v34
    v_mfma_f32_16x16x32_bf16 v[80:83], a[40:43], a[96:99], v[80:83]
    v_fma_f32 v104, v208, v106, v26
    v_fma_f32 v105, v208, v107, v42
    v_mfma_f32_16x16x32_bf16 v[84:87], a[40:43], a[100:103], v[84:87]
    v_fma_f32 v184, -v209, v187, v184
    v_fma_f32 v185, v209, v186, v185
    v_mfma_f32_16x16x32_bf16 v[88:91], a[40:43], a[104:107], v[88:91]
    v_fma_f32 v104, -v209, v107, v104
    v_fma_f32 v105, v209, v106, v105
    v_mfma_f32_16x16x32_bf16 v[92:95], a[40:43], a[108:111], v[92:95]
    v_fma_f32 v186, v208, v184, v19
    v_fma_f32 v187, v208, v185, v35
    v_mfma_f32_16x16x32_bf16 v[100:103], a[44:47], a[96:99], v[100:103]
    v_fma_f32 v106, v208, v104, v27
    v_fma_f32 v107, v208, v105, v43
    v_mfma_f32_16x16x32_bf16 v[108:111], a[44:47], a[100:103], v[108:111]
    v_fma_f32 v186, -v209, v185, v186
    v_fma_f32 v187, v209, v184, v187
    v_mfma_f32_16x16x32_bf16 v[116:119], a[44:47], a[104:107], v[116:119]
    v_fma_f32 v106, -v209, v105, v106
    v_fma_f32 v107, v209, v104, v107
    v_mfma_f32_16x16x32_bf16 v[124:127], a[44:47], a[108:111], v[124:127]
    v_fma_f32 v184, v208, v186, v20
    v_fma_f32 v185, v208, v187, v36
    v_mfma_f32_16x16x32_bf16 v[132:135], a[48:51], a[96:99], v[132:135]
    v_fma_f32 v104, v208, v106, v28
    v_fma_f32 v105, v208, v107, v44
    v_mfma_f32_16x16x32_bf16 v[140:143], a[48:51], a[100:103], v[140:143]
    v_fma_f32 v184, -v209, v187, v184
    v_fma_f32 v185, v209, v186, v185
    v_mfma_f32_16x16x32_bf16 v[148:151], a[48:51], a[104:107], v[148:151]
    v_fma_f32 v104, -v209, v107, v104
    v_fma_f32 v105, v209, v106, v105
    v_mfma_f32_16x16x32_bf16 v[156:159], a[48:51], a[108:111], v[156:159]
    v_fma_f32 v186, v208, v184, v21
    v_fma_f32 v187, v208, v185, v37
    v_mfma_f32_16x16x32_bf16 v[164:167], a[52:55], a[96:99], v[164:167]
    v_fma_f32 v106, v208, v104, v29
    v_fma_f32 v107, v208, v105, v45
    v_mfma_f32_16x16x32_bf16 v[172:175], a[52:55], a[100:103], v[172:175]
    v_fma_f32 v186, -v209, v185, v186
    v_fma_f32 v187, v209, v184, v187
    v_mfma_f32_16x16x32_bf16 v[180:183], a[52:55], a[104:107], v[180:183]
    v_fma_f32 v106, -v209, v105, v106
    v_fma_f32 v107, v209, v104, v107
    v_mfma_f32_16x16x32_bf16 v[188:191], a[52:55], a[108:111], v[188:191]
    v_fma_f32 v184, v208, v186, v22
    v_fma_f32 v185, v208, v187, v38
    v_mfma_f32_16x16x32_bf16 v[196:199], a[56:59], a[96:99], v[196:199]
    v_fma_f32 v104, v208, v106, v30
    v_fma_f32 v105, v208, v107, v46
    v_mfma_f32_16x16x32_bf16 v[204:207], a[56:59], a[100:103], v[204:207]
    v_fma_f32 v184, -v209, v187, v184
    v_fma_f32 v185, v209, v186, v185
    v_mfma_f32_16x16x32_bf16 v[212:215], a[56:59], a[104:107], v[212:215]
    v_fma_f32 v104, -v209, v107, v104
    v_fma_f32 v105, v209, v106, v105
    v_mfma_f32_16x16x32_bf16 v[220:223], a[56:59], a[108:111], v[220:223]
    v_fma_f32 v186, v208, v184, v23
    v_fma_f32 v187, v208, v185, v39
    v_mfma_f32_16x16x32_bf16 v[228:231], a[60:63], a[96:99], v[228:231]
    v_fma_f32 v106, v208, v104, v31
    v_fma_f32 v107, v208, v105, v47
    v_mfma_f32_16x16x32_bf16 v[236:239], a[60:63], a[100:103], v[236:239]
    v_fma_f32 v186, -v209, v185, v186
    v_fma_f32 v187, v209, v184, v187
    v_mfma_f32_16x16x32_bf16 v[244:247], a[60:63], a[104:107], v[244:247]
    v_fma_f32 v106, -v209, v105, v106
    v_fma_f32 v107, v209, v104, v107
    v_mfma_f32_16x16x32_bf16 v[252:255], a[60:63], a[108:111], v[252:255]
    ds_write_b64 v11, v[186:187]
    ds_write_b64 v12, v[106:107]
    v_mov_b32 v128, 0
    v_mov_b32 v129, 0
    v_mov_b32 v130, 0
    v_mov_b32 v131, 0
    v_pk_mul_f32 v[48:49], v[48:49], s[58:59]
    v_pk_mul_f32 v[50:51], v[50:51], s[58:59]
    v_pk_mul_f32 v[64:65], v[64:65], s[58:59]
    v_pk_mul_f32 v[66:67], v[66:67], s[58:59]
    v_mfma_f32_32x32x16_bf16 a[0:15], v[128:131], v[128:131], 0
    v_cvt_pk_bf16_f32 v48, v48, v49
    v_cvt_pk_bf16_f32 v49, v50, v51
    v_cvt_pk_bf16_f32 v50, v64, v65
    v_cvt_pk_bf16_f32 v51, v66, v67
    v_pk_mul_f32 v[52:53], v[52:53], s[58:59]
    v_pk_mul_f32 v[54:55], v[54:55], s[58:59]
    v_pk_mul_f32 v[68:69], v[68:69], s[58:59]
    v_pk_mul_f32 v[70:71], v[70:71], s[58:59]
    v_cvt_pk_bf16_f32 v52, v52, v53
    v_cvt_pk_bf16_f32 v53, v54, v55
    v_cvt_pk_bf16_f32 v54, v68, v69
    v_cvt_pk_bf16_f32 v55, v70, v71
    v_mfma_f32_32x32x16_bf16 a[16:31], v[128:131], v[128:131], 0
    v_pk_mul_f32 v[56:57], v[56:57], s[58:59]
    v_pk_mul_f32 v[58:59], v[58:59], s[58:59]
    v_pk_mul_f32 v[72:73], v[72:73], s[58:59]
    v_pk_mul_f32 v[74:75], v[74:75], s[58:59]
    v_cvt_pk_bf16_f32 v56, v56, v57
    v_cvt_pk_bf16_f32 v57, v58, v59
    v_cvt_pk_bf16_f32 v58, v72, v73
    v_cvt_pk_bf16_f32 v59, v74, v75
    v_pk_mul_f32 v[60:61], v[60:61], s[58:59]
    v_pk_mul_f32 v[62:63], v[62:63], s[58:59]
    v_pk_mul_f32 v[76:77], v[76:77], s[58:59]
    v_pk_mul_f32 v[78:79], v[78:79], s[58:59]
    v_mfma_f32_32x32x16_bf16 a[32:47], v[128:131], v[128:131], 0
    v_cvt_pk_bf16_f32 v60, v60, v61
    v_cvt_pk_bf16_f32 v61, v62, v63
    v_cvt_pk_bf16_f32 v62, v76, v77
    v_cvt_pk_bf16_f32 v63, v78, v79
    v_pk_mul_f32 v[80:81], v[80:81], s[58:59]
    v_pk_mul_f32 v[82:83], v[82:83], s[58:59]
    v_pk_mul_f32 v[100:101], v[100:101], s[58:59]
    v_pk_mul_f32 v[102:103], v[102:103], s[58:59]
    v_cvt_pk_bf16_f32 v80, v80, v81
    v_cvt_pk_bf16_f32 v81, v82, v83
    v_cvt_pk_bf16_f32 v82, v100, v101
    v_cvt_pk_bf16_f32 v83, v102, v103
    v_mfma_f32_32x32x16_bf16 a[48:63], v[128:131], v[128:131], 0
    v_pk_mul_f32 v[84:85], v[84:85], s[58:59]
    v_pk_mul_f32 v[86:87], v[86:87], s[58:59]
    v_pk_mul_f32 v[108:109], v[108:109], s[58:59]
    v_pk_mul_f32 v[110:111], v[110:111], s[58:59]
    v_cvt_pk_bf16_f32 v84, v84, v85
    v_cvt_pk_bf16_f32 v85, v86, v87
    v_cvt_pk_bf16_f32 v86, v108, v109
    v_cvt_pk_bf16_f32 v87, v110, v111
    v_pk_mul_f32 v[88:89], v[88:89], s[58:59]
    v_pk_mul_f32 v[90:91], v[90:91], s[58:59]
    v_pk_mul_f32 v[116:117], v[116:117], s[58:59]
    v_pk_mul_f32 v[118:119], v[118:119], s[58:59]
    v_mfma_f32_32x32x16_bf16 a[64:79], v[128:131], v[128:131], 0
    v_cvt_pk_bf16_f32 v88, v88, v89
    v_cvt_pk_bf16_f32 v89, v90, v91
    v_cvt_pk_bf16_f32 v90, v116, v117
    v_cvt_pk_bf16_f32 v91, v118, v119
    v_pk_mul_f32 v[92:93], v[92:93], s[58:59]
    v_pk_mul_f32 v[94:95], v[94:95], s[58:59]
    v_pk_mul_f32 v[124:125], v[124:125], s[58:59]
    v_pk_mul_f32 v[126:127], v[126:127], s[58:59]
    v_cvt_pk_bf16_f32 v92, v92, v93
    v_cvt_pk_bf16_f32 v93, v94, v95
    v_cvt_pk_bf16_f32 v94, v124, v125
    v_cvt_pk_bf16_f32 v95, v126, v127
    v_mfma_f32_32x32x16_bf16 a[80:95], v[128:131], v[128:131], 0
    v_pk_mul_f32 v[132:133], v[132:133], s[58:59]
    v_pk_mul_f32 v[134:135], v[134:135], s[58:59]
    v_pk_mul_f32 v[164:165], v[164:165], s[58:59]
    v_pk_mul_f32 v[166:167], v[166:167], s[58:59]
    v_cvt_pk_bf16_f32 v132, v132, v133
    v_cvt_pk_bf16_f32 v133, v134, v135
    v_cvt_pk_bf16_f32 v134, v164, v165
    v_cvt_pk_bf16_f32 v135, v166, v167
    v_pk_mul_f32 v[140:141], v[140:141], s[58:59]
    v_pk_mul_f32 v[142:143], v[142:143], s[58:59]
    v_pk_mul_f32 v[172:173], v[172:173], s[58:59]
    v_pk_mul_f32 v[174:175], v[174:175], s[58:59]
    v_mfma_f32_32x32x16_bf16 a[96:111], v[128:131], v[128:131], 0
    v_cvt_pk_bf16_f32 v140, v140, v141
    v_cvt_pk_bf16_f32 v141, v142, v143
    v_cvt_pk_bf16_f32 v142, v172, v173
    v_cvt_pk_bf16_f32 v143, v174, v175
    v_pk_mul_f32 v[148:149], v[148:149], s[58:59]
    v_pk_mul_f32 v[150:151], v[150:151], s[58:59]
    v_pk_mul_f32 v[180:181], v[180:181], s[58:59]
    v_pk_mul_f32 v[182:183], v[182:183], s[58:59]
    v_cvt_pk_bf16_f32 v148, v148, v149
    v_cvt_pk_bf16_f32 v149, v150, v151
    v_cvt_pk_bf16_f32 v150, v180, v181
    v_cvt_pk_bf16_f32 v151, v182, v183
    v_mfma_f32_32x32x16_bf16 a[112:127], v[128:131], v[128:131], 0
    v_pk_mul_f32 v[156:157], v[156:157], s[58:59]
    v_pk_mul_f32 v[158:159], v[158:159], s[58:59]
    v_pk_mul_f32 v[188:189], v[188:189], s[58:59]
    v_pk_mul_f32 v[190:191], v[190:191], s[58:59]
    v_cvt_pk_bf16_f32 v156, v156, v157
    v_cvt_pk_bf16_f32 v157, v158, v159
    v_cvt_pk_bf16_f32 v158, v188, v189
    v_cvt_pk_bf16_f32 v159, v190, v191
    v_pk_mul_f32 v[196:197], v[196:197], s[58:59]
    v_pk_mul_f32 v[198:199], v[198:199], s[58:59]
    v_pk_mul_f32 v[228:229], v[228:229], s[58:59]
    v_pk_mul_f32 v[230:231], v[230:231], s[58:59]
    v_mfma_f32_32x32x16_bf16 a[128:143], v[128:131], v[128:131], 0
    v_cvt_pk_bf16_f32 v196, v196, v197
    v_cvt_pk_bf16_f32 v197, v198, v199
    v_cvt_pk_bf16_f32 v198, v228, v229
    v_cvt_pk_bf16_f32 v199, v230, v231
    v_pk_mul_f32 v[204:205], v[204:205], s[58:59]
    v_pk_mul_f32 v[206:207], v[206:207], s[58:59]
    v_pk_mul_f32 v[236:237], v[236:237], s[58:59]
    v_pk_mul_f32 v[238:239], v[238:239], s[58:59]
    v_cvt_pk_bf16_f32 v204, v204, v205
    v_cvt_pk_bf16_f32 v205, v206, v207
    v_cvt_pk_bf16_f32 v206, v236, v237
    v_cvt_pk_bf16_f32 v207, v238, v239
    v_pk_mul_f32 v[212:213], v[212:213], s[58:59]
    v_pk_mul_f32 v[214:215], v[214:215], s[58:59]
    v_pk_mul_f32 v[244:245], v[244:245], s[58:59]
    v_pk_mul_f32 v[246:247], v[246:247], s[58:59]
    v_cvt_pk_bf16_f32 v212, v212, v213
    v_cvt_pk_bf16_f32 v213, v214, v215
    v_cvt_pk_bf16_f32 v214, v244, v245
    v_cvt_pk_bf16_f32 v215, v246, v247
    v_pk_mul_f32 v[220:221], v[220:221], s[58:59]
    v_pk_mul_f32 v[222:223], v[222:223], s[58:59]
    v_pk_mul_f32 v[252:253], v[252:253], s[58:59]
    v_pk_mul_f32 v[254:255], v[254:255], s[58:59]
    v_cvt_pk_bf16_f32 v220, v220, v221
    v_cvt_pk_bf16_f32 v221, v222, v223
    v_cvt_pk_bf16_f32 v222, v252, v253
    v_cvt_pk_bf16_f32 v223, v254, v255
    v_and_b32 v15, 3, v0
    v_cmp_eq_u32 vcc, 0, v15
    v_mov_b32 v15, 0x3f803f80
    v_mov_b32 v5, v1
    v_cndmask_b32 v15, 0, v15, vcc
    s_lshl_b32 s51, s5, 2
    s_add_u32 s51, s51, s3
    s_mov_b32 s45, s5
    s_cmp_eq_u32 s3, 0
    s_cselect_b32 s47, 1, 7
    s_lshl_b32 s47, s47, 16
    s_add_u32 s47, s47, s48
    v_accvgpr_write_b32 a176, v15
    v_accvgpr_write_b32 a177, v15
    v_accvgpr_write_b32 a178, v15
    v_accvgpr_write_b32 a179, v15
    s_cmp_gt_u32 s51, 0
    s_cselect_b32 s6, 0, 0xff800000
    s_cmp_ge_u32 s51, 0
    s_cselect_b32 s7, 0, 0xff800000
    v_mov_b32 v7, s6
    v_mov_b32 v8, s7
    v_cndmask_b32 v232, v7, v8, s[64:65]
    v_cndmask_b32 v233, v7, v8, s[66:67]
    v_cndmask_b32 v234, v7, v8, s[68:69]
    v_cndmask_b32 v235, v7, v8, s[70:71]
    v_cndmask_b32 v248, v7, v8, s[72:73]
    v_cndmask_b32 v249, v7, v8, s[74:75]
    v_cndmask_b32 v250, v7, v8, s[76:77]
    v_cndmask_b32 v251, v7, v8, s[78:79]
    v_mov_b32 v15, 1
    v_add_u32 v14, s4, v0
    v_and_b32 v14, 31, v14
    v_lshl_add_u32 v14, v14, 3, 4
    v_and_b32 v9, 15, v0
    v_lshlrev_b32 v9, 7, v9
    s_lshr_b32 s6, s96, 1
    s_mul_i32 s6, s6, 160
    s_add_u32 s6, s6, s98
    s_lshl_b32 s6, s6, 1
    s_and_b32 s7, s96, 1
    s_add_u32 s6, s6, s7
    s_lshl_b32 s6, s6, 11
    s_add_u32 s40, s6, 34603008
    s_lshr_b32 s6, s97, 1
    s_mul_i32 s6, s6, 160
    s_add_u32 s6, s6, s98
    s_lshl_b32 s6, s6, 1
    s_and_b32 s7, s97, 1
    s_add_u32 s6, s6, s7
    s_lshl_b32 s6, s6, 11
    s_add_u32 s41, s6, 34603008
    s_waitcnt vmcnt(0) lgkmcnt(0)
    s_barrier
    s_cmp_eq_u32 s3, 0
    s_cbranch_scc1 A_chain
A_ret2:
    ds_read_b128 a[144:147], v5 offset:0
    ds_read_b128 a[148:151], v5 offset:1024
    ds_read_b128 a[152:155], v5 offset:2048
    ds_read_b128 a[156:159], v5 offset:3072
    ds_read_b128 a[160:163], v5 offset:4096
    ds_read_b128 a[164:167], v5 offset:5120
    s_waitcnt lgkmcnt(4)
    v_mfma_f32_16x16x32_bf16 v[224:227], a[144:147], v[48:51], v[232:235]
    s_add_u32 m0, s49, 0
    ds_read_b128 a[168:171], v5 offset:6144
    v_cndmask_b32 v200, v7, v8, s[80:81]
    v_mfma_f32_16x16x32_bf16 v[240:243], a[144:147], v[52:55], v[248:251]
    s_add_u32 s44, s48, 0
    v_cndmask_b32 v201, v7, v8, s[82:83]
    buffer_load_dwordx4 v1, s[8:11], s44 offen sc1 lds
    v_mfma_f32_16x16x32_bf16 v[160:163], a[144:147], v[56:59], 0
    v_mfma_f32_16x16x32_bf16 v[176:179], a[144:147], v[60:63], 0
    v_cndmask_b32 v202, v7, v8, s[84:85]
    v_mfma_f32_16x16x32_bf16 v[224:227], a[148:151], v[80:83], v[224:227]
    ds_read_b128 a[172:175], v5 offset:7168
    ds_read_b128 a[144:147], v5 offset:16384
    v_mfma_f32_16x16x32_bf16 v[240:243], a[148:151], v[84:87], v[240:243]
    v_cndmask_b32 v203, v7, v8, s[86:87]
    buffer_load_dwordx4 v1, s[8:11], s44 offen offset:1024 sc1 lds
    v_mfma_f32_16x16x32_bf16 v[160:163], a[148:151], v[88:91], v[160:163]
    v_cndmask_b32 v216, v7, v8, s[88:89]
    v_mfma_f32_16x16x32_bf16 v[176:179], a[148:151], v[92:95], v[176:179]
    s_waitcnt lgkmcnt(5)
    v_mfma_f32_16x16x32_bf16 v[224:227], a[152:155], v[132:135], v[224:227]
    ds_read_b128 a[148:151], v5 offset:17408
    v_cndmask_b32 v217, v7, v8, s[90:91]
    v_mfma_f32_16x16x32_bf16 v[240:243], a[152:155], v[140:143], v[240:243]
    v_cndmask_b32 v218, v7, v8, s[92:93]
    v_mfma_f32_16x16x32_bf16 v[160:163], a[152:155], v[148:151], v[160:163]
    buffer_load_dwordx4 v1, s[8:11], s44 offen offset:2048 sc1 lds
    v_mfma_f32_16x16x32_bf16 v[176:179], a[152:155], v[156:159], v[176:179]
    v_cndmask_b32 v219, v7, v8, s[94:95]
    v_mfma_f32_16x16x32_bf16 v[224:227], a[156:159], v[196:199], v[224:227]
    ds_read_b128 a[152:155], v5 offset:18432
    v_mfma_f32_16x16x32_bf16 v[240:243], a[156:159], v[204:207], v[240:243]
    v_mfma_f32_16x16x32_bf16 v[160:163], a[156:159], v[212:215], v[160:163]
    v_mfma_f32_16x16x32_bf16 v[176:179], a[156:159], v[220:223], v[176:179]
    s_waitcnt lgkmcnt(5)
    buffer_load_dwordx4 v1, s[8:11], s44 offen offset:3072 sc1 lds
    v_mfma_f32_16x16x32_bf16 v[112:115], a[160:163], v[48:51], v[200:203]
    s_add_u32 m0, s49, 4096
    ds_read_b128 a[156:159], v5 offset:19456
    v_mfma_f32_16x16x32_bf16 v[144:147], a[160:163], v[52:55], v[216:219]
    s_add_u32 s44, s48, 4096
    v_mfma_f32_16x16x32_bf16 v[192:195], a[160:163], v[56:59], 0
    v_mfma_f32_16x16x32_bf16 v[96:99], a[160:163], v[60:63], 0
    v_exp_f32 v224, v224
    v_mfma_f32_16x16x32_bf16 v[112:115], a[164:167], v[80:83], v[112:115]
    ds_read_b128 a[160:163], v5 offset:20480
    buffer_load_dwordx4 v1, s[8:11], s44 offen sc1 lds
    v_mfma_f32_16x16x32_bf16 v[144:147], a[164:167], v[84:87], v[144:147]
    v_exp_f32 v160, v160
    v_mfma_f32_16x16x32_bf16 v[192:195], a[164:167], v[88:91], v[192:195]
    v_mfma_f32_16x16x32_bf16 v[96:99], a[164:167], v[92:95], v[96:99]
    s_waitcnt lgkmcnt(5)
    v_exp_f32 v225, v225
    v_mfma_f32_16x16x32_bf16 v[112:115], a[168:171], v[132:135], v[112:115]
    ds_read_b128 a[164:167], v5 offset:21504
    v_mfma_f32_16x16x32_bf16 v[144:147], a[168:171], v[140:143], v[144:147]
    v_exp_f32 v161, v161
    v_mfma_f32_16x16x32_bf16 v[192:195], a[168:171], v[148:151], v[192:195]
    v_mfma_f32_16x16x32_bf16 v[96:99], a[168:171], v[156:159], v[96:99]
    v_exp_f32 v226, v226
    v_mfma_f32_16x16x32_bf16 v[112:115], a[172:175], v[196:199], v[112:115]
    v_mfma_f32_16x16x32_bf16 v[144:147], a[172:175], v[204:207], v[144:147]
    v_exp_f32 v162, v162
    v_mfma_f32_16x16x32_bf16 v[192:195], a[172:175], v[212:215], v[192:195]
    v_mfma_f32_16x16x32_bf16 v[96:99], a[172:175], v[220:223], v[96:99]
    s_waitcnt lgkmcnt(3)
    v_exp_f32 v227, v227
    v_exp_f32 v163, v163
    v_exp_f32 v240, v240
    v_exp_f32 v176, v176
    v_exp_f32 v241, v241
    v_exp_f32 v177, v177
    v_exp_f32 v242, v242
    v_exp_f32 v178, v178
    v_exp_f32 v243, v243
    v_exp_f32 v179, v179
    v_exp_f32 v112, v112
    v_exp_f32 v192, v192
    v_exp_f32 v113, v113
    v_exp_f32 v193, v193
    v_exp_f32 v114, v114
    v_exp_f32 v194, v194
    v_exp_f32 v115, v115
    v_exp_f32 v195, v195
    v_cvt_pk_bf16_f32 v136, v224, v225
    v_cvt_pk_bf16_f32 v64, v160, v161
    v_cvt_pk_bf16_f32 v137, v226, v227
    v_cvt_pk_bf16_f32 v65, v162, v163
    v_cvt_pk_bf16_f32 v152, v240, v241
    v_cvt_pk_bf16_f32 v68, v176, v177
    v_cvt_pk_bf16_f32 v153, v242, v243
    v_cvt_pk_bf16_f32 v69, v178, v179
    v_cvt_pk_bf16_f32 v138, v112, v113
    v_cvt_pk_bf16_f32 v66, v192, v193
    v_cvt_pk_bf16_f32 v139, v114, v115
    v_cvt_pk_bf16_f32 v67, v194, v195
    s_cmp_gt_u32 s51, 1
    s_cselect_b32 s6, 0, 0xff800000
    s_cmp_ge_u32 s51, 1
    s_cselect_b32 s7, 0, 0xff800000
    v_mov_b32 v7, s6
    v_mov_b32 v8, s7
    v_cndmask_b32 v232, v7, v8, s[64:65]
    v_cndmask_b32 v233, v7, v8, s[66:67]
    v_cndmask_b32 v234, v7, v8, s[68:69]
    v_cndmask_b32 v235, v7, v8, s[70:71]
    v_cndmask_b32 v248, v7, v8, s[72:73]
    v_cndmask_b32 v249, v7, v8, s[74:75]
    v_cndmask_b32 v250, v7, v8, s[76:77]
    v_cndmask_b32 v251, v7, v8, s[78:79]
    s_cmp_eq_u32 s5, 0
    s_cbranch_scc1 A_SD1
    s_branch A_D1
    .p2align 3
A_D0:
    v_mfma_f32_16x16x32_bf16 v[224:227], a[144:147], v[48:51], 0
    s_add_u32 m0, s49, 0
    v_exp_f32 v144, v144
    v_mfma_f32_16x16x32_bf16 v[240:243], a[144:147], v[52:55], 0
    s_add_u32 s44, s48, 0
    ds_read_b128 a[168:171], v5 offset:6144
    ds_read_b128 a[172:175], v5 offset:7168
    v_mfma_f32_16x16x32_bf16 v[160:163], a[144:147], v[56:59], 0
    v_exp_f32 v96, v96
    v_mfma_f32_16x16x32_bf16 v[176:179], a[144:147], v[60:63], 0
    buffer_load_dwordx4 v1, s[8:11], s44 offen sc1 lds
    v_mfma_f32_16x16x32_bf16 v[224:227], a[148:151], v[80:83], v[224:227]
    v_exp_f32 v145, v145
    v_mfma_f32_16x16x32_bf16 v[240:243], a[148:151], v[84:87], v[240:243]
    ds_read_b128 a[144:147], v5 offset:8192
    v_cvt_pk_bf16_f32 v122, v144, v145
    v_mfma_f32_16x16x32_bf16 v[160:163], a[148:151], v[88:91], v[160:163]
    v_exp_f32 v97, v97
    v_mfma_f32_16x16x32_bf16 v[176:179], a[148:151], v[92:95], v[176:179]
    s_waitcnt lgkmcnt(5)
    v_cvt_pk_bf16_f32 v78, v96, v97
    v_mfma_f32_16x16x32_bf16 v[224:227], a[152:155], v[132:135], v[224:227]
    v_exp_f32 v146, v146
    v_mfma_f32_16x16x32_bf16 v[240:243], a[152:155], v[140:143], v[240:243]
    ds_read_b128 a[148:151], v5 offset:9216
    v_mfma_f32_16x16x32_bf16 v[160:163], a[152:155], v[148:151], v[160:163]
    v_exp_f32 v98, v98
    v_mfma_f32_16x16x32_bf16 v[176:179], a[152:155], v[156:159], v[176:179]
    v_mfma_f32_16x16x32_bf16 v[224:227], a[156:159], v[196:199], v[224:227]
    v_exp_f32 v147, v147
    v_mfma_f32_16x16x32_bf16 v[240:243], a[156:159], v[204:207], v[240:243]
    v_exp_f32 v99, v99
    v_mfma_f32_16x16x32_bf16 v[160:163], a[156:159], v[212:215], v[160:163]
    ds_read_b128 a[152:155], v5 offset:10240
    v_cvt_pk_bf16_f32 v123, v146, v147
    v_mfma_f32_16x16x32_bf16 v[176:179], a[156:159], v[220:223], v[176:179]
    s_waitcnt lgkmcnt(5)
    v_cvt_pk_bf16_f32 v79, v98, v99
    buffer_load_dwordx4 v1, s[8:11], s44 offen offset:1024 sc1 lds
    v_mfma_f32_16x16x32_bf16 v[112:115], a[160:163], v[48:51], 0
    ds_read_b128 a[156:159], v5 offset:11264
    v_mfma_f32_16x16x32_bf16 v[144:147], a[160:163], v[52:55], 0
    v_mfma_f32_16x16x32_bf16 v[192:195], a[160:163], v[56:59], 0
    v_mfma_f32_16x16x32_bf16 v[96:99], a[160:163], v[60:63], 0
    v_exp_f32 v224, v224
    v_mfma_f32_16x16x32_bf16 v[112:115], a[164:167], v[80:83], v[112:115]
    v_exp_f32 v160, v160
    v_mfma_f32_16x16x32_bf16 v[144:147], a[164:167], v[84:87], v[144:147]
    ds_read_b128 a[160:163], v5 offset:12288
    v_mfma_f32_16x16x32_bf16 v[192:195], a[164:167], v[88:91], v[192:195]
    v_exp_f32 v225, v225
    v_mfma_f32_16x16x32_bf16 v[96:99], a[164:167], v[92:95], v[96:99]
    s_waitcnt lgkmcnt(5)
    v_cvt_pk_bf16_f32 v136, v224, v225
    v_mfma_f32_16x16x32_bf16 v[112:115], a[168:171], v[132:135], v[112:115]
    v_exp_f32 v161, v161
    v_mfma_f32_16x16x32_bf16 v[144:147], a[168:171], v[140:143], v[144:147]
    ds_read_b128 a[164:167], v5 offset:13312
    v_cvt_pk_bf16_f32 v64, v160, v161
    v_mfma_f32_16x16x32_bf16 v[192:195], a[168:171], v[148:151], v[192:195]
    v_exp_f32 v226, v226
    v_mfma_f32_16x16x32_bf16 v[96:99], a[168:171], v[156:159], v[96:99]
    buffer_load_dwordx4 v1, s[8:11], s44 offen offset:2048 sc1 lds
    v_mfma_f32_16x16x32_bf16 v[112:115], a[172:175], v[196:199], v[112:115]
    v_exp_f32 v162, v162
    v_mfma_f32_16x16x32_bf16 v[144:147], a[172:175], v[204:207], v[144:147]
    ds_read_b128 a[168:171], v5 offset:14336
    v_mfma_f32_16x16x32_bf16 v[192:195], a[172:175], v[212:215], v[192:195]
    v_exp_f32 v227, v227
    v_mfma_f32_16x16x32_bf16 v[96:99], a[172:175], v[220:223], v[96:99]
    s_waitcnt lgkmcnt(5)
    v_cvt_pk_bf16_f32 v137, v226, v227
    v_mfma_f32_16x16x32_bf16 a[0:3], a[144:147], v[168:171], a[0:3]
    v_exp_f32 v163, v163
    v_mfma_f32_16x16x32_bf16 a[4:7], a[144:147], v[120:123], a[4:7]
    ds_read_b128 a[172:175], v5 offset:15360
    v_cvt_pk_bf16_f32 v65, v162, v163
    v_mfma_f32_16x16x32_bf16 a[64:67], a[144:147], v[72:75], a[64:67]
    v_exp_f32 v240, v240
    v_mfma_f32_16x16x32_bf16 a[68:71], a[144:147], v[76:79], a[68:71]
    v_mfma_f32_16x16x32_bf16 a[8:11], a[148:151], v[168:171], a[8:11]
    v_exp_f32 v176, v176
    v_mfma_f32_16x16x32_bf16 a[12:15], a[148:151], v[120:123], a[12:15]
    ds_read_b128 a[144:147], v5 offset:16384
    buffer_load_dwordx4 v1, s[8:11], s44 offen offset:3072 sc1 lds
    v_mfma_f32_16x16x32_bf16 a[72:75], a[148:151], v[72:75], a[72:75]
    s_add_u32 m0, s49, 4096
    v_exp_f32 v241, v241
    v_mfma_f32_16x16x32_bf16 a[76:79], a[148:151], v[76:79], a[76:79]
    s_waitcnt lgkmcnt(5)
    v_cvt_pk_bf16_f32 v152, v240, v241
    v_mfma_f32_16x16x32_bf16 a[16:19], a[152:155], v[168:171], a[16:19]
    s_add_u32 s44, s48, 4096
    v_exp_f32 v177, v177
    v_mfma_f32_16x16x32_bf16 a[20:23], a[152:155], v[120:123], a[20:23]
    ds_read_b128 a[148:151], v5 offset:17408
    v_cvt_pk_bf16_f32 v68, v176, v177
    v_mfma_f32_16x16x32_bf16 a[80:83], a[152:155], v[72:75], a[80:83]
    v_exp_f32 v242, v242
    v_mfma_f32_16x16x32_bf16 a[84:87], a[152:155], v[76:79], a[84:87]
    v_mfma_f32_16x16x32_bf16 a[24:27], a[156:159], v[168:171], a[24:27]
    v_exp_f32 v178, v178
    v_mfma_f32_16x16x32_bf16 a[28:31], a[156:159], v[120:123], a[28:31]
    ds_read_b128 a[152:155], v5 offset:18432
    v_mfma_f32_16x16x32_bf16 a[88:91], a[156:159], v[72:75], a[88:91]
    v_exp_f32 v243, v243
    v_mfma_f32_16x16x32_bf16 a[92:95], a[156:159], v[76:79], a[92:95]
    s_waitcnt lgkmcnt(5)
    v_cvt_pk_bf16_f32 v153, v242, v243
    v_mfma_f32_16x16x32_bf16 a[32:35], a[160:163], v[168:171], a[32:35]
    v_exp_f32 v179, v179
    v_mfma_f32_16x16x32_bf16 a[36:39], a[160:163], v[120:123], a[36:39]
    ds_read_b128 a[156:159], v5 offset:19456
    v_cvt_pk_bf16_f32 v69, v178, v179
    v_mfma_f32_16x16x32_bf16 a[96:99], a[160:163], v[72:75], a[96:99]
    v_exp_f32 v112, v112
    v_mfma_f32_16x16x32_bf16 a[100:103], a[160:163], v[76:79], a[100:103]
    buffer_load_dwordx4 v1, s[8:11], s44 offen sc1 lds
    v_mfma_f32_16x16x32_bf16 a[40:43], a[164:167], v[168:171], a[40:43]
    v_exp_f32 v192, v192
    v_mfma_f32_16x16x32_bf16 a[44:47], a[164:167], v[120:123], a[44:47]
    ds_read_b128 a[160:163], v5 offset:20480
    v_mfma_f32_16x16x32_bf16 a[104:107], a[164:167], v[72:75], a[104:107]
    v_exp_f32 v113, v113
    v_mfma_f32_16x16x32_bf16 a[108:111], a[164:167], v[76:79], a[108:111]
    s_waitcnt lgkmcnt(5)
    v_cvt_pk_bf16_f32 v138, v112, v113
    v_mfma_f32_16x16x32_bf16 a[48:51], a[168:171], v[168:171], a[48:51]
    v_exp_f32 v193, v193
    v_mfma_f32_16x16x32_bf16 a[52:55], a[168:171], v[120:123], a[52:55]
    ds_read_b128 a[164:167], v5 offset:21504
    v_cvt_pk_bf16_f32 v66, v192, v193
    v_mfma_f32_16x16x32_bf16 a[112:115], a[168:171], v[72:75], a[112:115]
    v_exp_f32 v114, v114
    v_mfma_f32_16x16x32_bf16 a[116:119], a[168:171], v[76:79], a[116:119]
    v_mfma_f32_16x16x32_bf16 a[56:59], a[172:175], v[168:171], a[56:59]
    v_exp_f32 v194, v194
    v_mfma_f32_16x16x32_bf16 a[60:63], a[172:175], v[120:123], a[60:63]
    v_mfma_f32_16x16x32_bf16 a[120:123], a[172:175], v[72:75], a[120:123]
    v_exp_f32 v115, v115
    v_mfma_f32_16x16x32_bf16 a[124:127], a[172:175], v[76:79], a[124:127]
    v_cvt_pk_bf16_f32 v139, v114, v115
    v_mfma_f32_16x16x32_bf16 a[128:131], a[176:179], v[168:171], a[128:131]
    v_exp_f32 v195, v195
    v_mfma_f32_16x16x32_bf16 a[132:135], a[176:179], v[120:123], a[132:135]
    v_cvt_pk_bf16_f32 v67, v194, v195
    v_mfma_f32_16x16x32_bf16 a[136:139], a[176:179], v[72:75], a[136:139]
    v_mfma_f32_16x16x32_bf16 a[140:143], a[176:179], v[76:79], a[140:143]
    s_waitcnt lgkmcnt(3)
A_D1:
    v_mfma_f32_16x16x32_bf16 v[224:227], a[144:147], v[48:51], 0
    v_exp_f32 v144, v144
    v_mfma_f32_16x16x32_bf16 v[240:243], a[144:147], v[52:55], 0
    ds_read_b128 a[168:171], v5 offset:22528
    ds_read_b128 a[172:175], v5 offset:23552
    v_mfma_f32_16x16x32_bf16 v[160:163], a[144:147], v[56:59], 0
    v_exp_f32 v96, v96
    v_mfma_f32_16x16x32_bf16 v[176:179], a[144:147], v[60:63], 0
    buffer_load_dwordx4 v1, s[8:11], s44 offen offset:1024 sc1 lds
    v_mfma_f32_16x16x32_bf16 v[224:227], a[148:151], v[80:83], v[224:227]
    v_exp_f32 v145, v145
    v_mfma_f32_16x16x32_bf16 v[240:243], a[148:151], v[84:87], v[240:243]
    ds_read_b128 a[144:147], v5 offset:24576
    v_cvt_pk_bf16_f32 v154, v144, v145
    v_mfma_f32_16x16x32_bf16 v[160:163], a[148:151], v[88:91], v[160:163]
    v_exp_f32 v97, v97
    v_mfma_f32_16x16x32_bf16 v[176:179], a[148:151], v[92:95], v[176:179]
    s_waitcnt lgkmcnt(5)
    v_cvt_pk_bf16_f32 v70, v96, v97
    v_mfma_f32_16x16x32_bf16 v[224:227], a[152:155], v[132:135], v[224:227]
    v_exp_f32 v146, v146
    v_mfma_f32_16x16x32_bf16 v[240:243], a[152:155], v[140:143], v[240:243]
    ds_read_b128 a[148:151], v5 offset:25600
    v_mfma_f32_16x16x32_bf16 v[160:163], a[152:155], v[148:151], v[160:163]
    v_exp_f32 v98, v98
    v_mfma_f32_16x16x32_bf16 v[176:179], a[152:155], v[156:159], v[176:179]
    buffer_load_dwordx4 v1, s[8:11], s44 offen offset:2048 sc1 lds
    v_mfma_f32_16x16x32_bf16 v[224:227], a[156:159], v[196:199], v[224:227]
    v_exp_f32 v147, v147
    v_mfma_f32_16x16x32_bf16 v[240:243], a[156:159], v[204:207], v[240:243]
    v_exp_f32 v99, v99
    v_mfma_f32_16x16x32_bf16 v[160:163], a[156:159], v[212:215], v[160:163]
    ds_read_b128 a[152:155], v5 offset:26624
    v_cvt_pk_bf16_f32 v155, v146, v147
    v_mfma_f32_16x16x32_bf16 v[176:179], a[156:159], v[220:223], v[176:179]
    s_waitcnt lgkmcnt(5)
    v_cvt_pk_bf16_f32 v71, v98, v99
    v_mfma_f32_16x16x32_bf16 v[112:115], a[160:163], v[48:51], 0
    ds_read_b128 a[156:159], v5 offset:27648
    v_mfma_f32_16x16x32_bf16 v[144:147], a[160:163], v[52:55], 0
    v_mfma_f32_16x16x32_bf16 v[192:195], a[160:163], v[56:59], 0
    v_mfma_f32_16x16x32_bf16 v[96:99], a[160:163], v[60:63], 0
    v_exp_f32 v224, v224
    v_mfma_f32_16x16x32_bf16 v[112:115], a[164:167], v[80:83], v[112:115]
    v_exp_f32 v160, v160
    v_mfma_f32_16x16x32_bf16 v[144:147], a[164:167], v[84:87], v[144:147]
    ds_read_b128 a[160:163], v5 offset:28672
    buffer_load_dwordx4 v1, s[8:11], s44 offen offset:3072 sc1 lds
    v_mfma_f32_16x16x32_bf16 v[192:195], a[164:167], v[88:91], v[192:195]
    s_add_u32 m0, s49, 8192
    v_exp_f32 v225, v225
    v_mfma_f32_16x16x32_bf16 v[96:99], a[164:167], v[92:95], v[96:99]
    s_waitcnt lgkmcnt(5)
    v_cvt_pk_bf16_f32 v168, v224, v225
    v_mfma_f32_16x16x32_bf16 v[112:115], a[168:171], v[132:135], v[112:115]
    s_add_u32 s44, s48, 8192
    v_exp_f32 v161, v161
    v_mfma_f32_16x16x32_bf16 v[144:147], a[168:171], v[140:143], v[144:147]
    ds_read_b128 a[164:167], v5 offset:29696
    v_cvt_pk_bf16_f32 v72, v160, v161
    v_mfma_f32_16x16x32_bf16 v[192:195], a[168:171], v[148:151], v[192:195]
    v_exp_f32 v226, v226
    v_mfma_f32_16x16x32_bf16 v[96:99], a[168:171], v[156:159], v[96:99]
    v_mfma_f32_16x16x32_bf16 v[112:115], a[172:175], v[196:199], v[112:115]
    v_exp_f32 v162, v162
    v_mfma_f32_16x16x32_bf16 v[144:147], a[172:175], v[204:207], v[144:147]
    ds_read_b128 a[168:171], v5 offset:30720
    v_mfma_f32_16x16x32_bf16 v[192:195], a[172:175], v[212:215], v[192:195]
    v_exp_f32 v227, v227
    v_mfma_f32_16x16x32_bf16 v[96:99], a[172:175], v[220:223], v[96:99]
    s_waitcnt lgkmcnt(5)
    v_cvt_pk_bf16_f32 v169, v226, v227
    buffer_load_dwordx4 v1, s[8:11], s44 offen sc1 lds
    v_mfma_f32_16x16x32_bf16 a[0:3], a[144:147], v[136:139], a[0:3]
    v_exp_f32 v163, v163
    v_mfma_f32_16x16x32_bf16 a[4:7], a[144:147], v[152:155], a[4:7]
    ds_read_b128 a[172:175], v5 offset:31744
    v_cvt_pk_bf16_f32 v73, v162, v163
    v_mfma_f32_16x16x32_bf16 a[64:67], a[144:147], v[64:67], a[64:67]
    v_exp_f32 v240, v240
    v_mfma_f32_16x16x32_bf16 a[68:71], a[144:147], v[68:71], a[68:71]
    v_mfma_f32_16x16x32_bf16 a[8:11], a[148:151], v[136:139], a[8:11]
    v_exp_f32 v176, v176
    v_mfma_f32_16x16x32_bf16 a[12:15], a[148:151], v[152:155], a[12:15]
    ds_read_b128 a[144:147], v5 offset:32768
    v_mfma_f32_16x16x32_bf16 a[72:75], a[148:151], v[64:67], a[72:75]
    v_exp_f32 v241, v241
    v_mfma_f32_16x16x32_bf16 a[76:79], a[148:151], v[68:71], a[76:79]
    s_waitcnt lgkmcnt(5)
    v_cvt_pk_bf16_f32 v120, v240, v241
    v_mfma_f32_16x16x32_bf16 a[16:19], a[152:155], v[136:139], a[16:19]
    v_exp_f32 v177, v177
    v_mfma_f32_16x16x32_bf16 a[20:23], a[152:155], v[152:155], a[20:23]
    ds_read_b128 a[148:151], v5 offset:33792
    v_cvt_pk_bf16_f32 v76, v176, v177
    v_mfma_f32_16x16x32_bf16 a[80:83], a[152:155], v[64:67], a[80:83]
    v_exp_f32 v242, v242
    v_mfma_f32_16x16x32_bf16 a[84:87], a[152:155], v[68:71], a[84:87]
    buffer_load_dwordx4 v1, s[8:11], s44 offen offset:1024 sc1 lds
    v_mfma_f32_16x16x32_bf16 a[24:27], a[156:159], v[136:139], a[24:27]
    v_exp_f32 v178, v178
    v_mfma_f32_16x16x32_bf16 a[28:31], a[156:159], v[152:155], a[28:31]
    ds_read_b128 a[152:155], v5 offset:34816
    v_mfma_f32_16x16x32_bf16 a[88:91], a[156:159], v[64:67], a[88:91]
    v_exp_f32 v243, v243
    v_mfma_f32_16x16x32_bf16 a[92:95], a[156:159], v[68:71], a[92:95]
    s_waitcnt lgkmcnt(5)
    v_cvt_pk_bf16_f32 v121, v242, v243
    v_mfma_f32_16x16x32_bf16 a[32:35], a[160:163], v[136:139], a[32:35]
    v_exp_f32 v179, v179
    v_mfma_f32_16x16x32_bf16 a[36:39], a[160:163], v[152:155], a[36:39]
    ds_read_b128 a[156:159], v5 offset:35840
    v_cvt_pk_bf16_f32 v77, v178, v179
    v_mfma_f32_16x16x32_bf16 a[96:99], a[160:163], v[64:67], a[96:99]
    v_exp_f32 v112, v112
    v_mfma_f32_16x16x32_bf16 a[100:103], a[160:163], v[68:71], a[100:103]
    buffer_load_dwordx4 v1, s[8:11], s44 offen offset:2048 sc1 lds
    v_mfma_f32_16x16x32_bf16 a[40:43], a[164:167], v[136:139], a[40:43]
    v_exp_f32 v192, v192
    v_mfma_f32_16x16x32_bf16 a[44:47], a[164:167], v[152:155], a[44:47]
    ds_read_b128 a[160:163], v5 offset:36864
    v_mfma_f32_16x16x32_bf16 a[104:107], a[164:167], v[64:67], a[104:107]
    v_exp_f32 v113, v113
    v_mfma_f32_16x16x32_bf16 a[108:111], a[164:167], v[68:71], a[108:111]
    s_waitcnt lgkmcnt(5)
    v_cvt_pk_bf16_f32 v170, v112, v113
    v_mfma_f32_16x16x32_bf16 a[48:51], a[168:171], v[136:139], a[48:51]
    v_exp_f32 v193, v193
    v_mfma_f32_16x16x32_bf16 a[52:55], a[168:171], v[152:155], a[52:55]
    ds_read_b128 a[164:167], v5 offset:37888
    v_cvt_pk_bf16_f32 v74, v192, v193
    v_mfma_f32_16x16x32_bf16 a[112:115], a[168:171], v[64:67], a[112:115]
    v_exp_f32 v114, v114
    v_mfma_f32_16x16x32_bf16 a[116:119], a[168:171], v[68:71], a[116:119]
    v_mfma_f32_16x16x32_bf16 a[56:59], a[172:175], v[136:139], a[56:59]
    v_exp_f32 v194, v194
    v_mfma_f32_16x16x32_bf16 a[60:63], a[172:175], v[152:155], a[60:63]
    v_mfma_f32_16x16x32_bf16 a[120:123], a[172:175], v[64:67], a[120:123]
    v_exp_f32 v115, v115
    v_mfma_f32_16x16x32_bf16 a[124:127], a[172:175], v[68:71], a[124:127]
    v_cvt_pk_bf16_f32 v171, v114, v115
    v_mfma_f32_16x16x32_bf16 a[128:131], a[176:179], v[136:139], a[128:131]
    v_exp_f32 v195, v195
    v_mfma_f32_16x16x32_bf16 a[132:135], a[176:179], v[152:155], a[132:135]
    v_cvt_pk_bf16_f32 v75, v194, v195
    v_mfma_f32_16x16x32_bf16 a[136:139], a[176:179], v[64:67], a[136:139]
    v_mfma_f32_16x16x32_bf16 a[140:143], a[176:179], v[68:71], a[140:143]
    s_waitcnt lgkmcnt(3)
    v_mfma_f32_16x16x32_bf16 v[224:227], a[144:147], v[48:51], 0
    v_exp_f32 v144, v144
    v_mfma_f32_16x16x32_bf16 v[240:243], a[144:147], v[52:55], 0
    ds_read_b128 a[168:171], v5 offset:38912
    ds_read_b128 a[172:175], v5 offset:39936
    v_mfma_f32_16x16x32_bf16 v[160:163], a[144:147], v[56:59], 0
    v_exp_f32 v96, v96
    v_mfma_f32_16x16x32_bf16 v[176:179], a[144:147], v[60:63], 0
    buffer_load_dwordx4 v1, s[8:11], s44 offen offset:3072 sc1 lds
    v_mfma_f32_16x16x32_bf16 v[224:227], a[148:151], v[80:83], v[224:227]
    s_add_u32 m0, s49, 12288
    v_exp_f32 v145, v145
    v_mfma_f32_16x16x32_bf16 v[240:243], a[148:151], v[84:87], v[240:243]
    s_add_u32 s44, s48, 12288
    ds_read_b128 a[144:147], v5 offset:40960
    v_cvt_pk_bf16_f32 v122, v144, v145
    v_mfma_f32_16x16x32_bf16 v[160:163], a[148:151], v[88:91], v[160:163]
    v_exp_f32 v97, v97
    v_mfma_f32_16x16x32_bf16 v[176:179], a[148:151], v[92:95], v[176:179]
    s_waitcnt lgkmcnt(5)
    v_cvt_pk_bf16_f32 v78, v96, v97
    v_mfma_f32_16x16x32_bf16 v[224:227], a[152:155], v[132:135], v[224:227]
    v_exp_f32 v146, v146
    v_mfma_f32_16x16x32_bf16 v[240:243], a[152:155], v[140:143], v[240:243]
    ds_read_b128 a[148:151], v5 offset:41984
    v_mfma_f32_16x16x32_bf16 v[160:163], a[152:155], v[148:151], v[160:163]
    v_exp_f32 v98, v98
    v_mfma_f32_16x16x32_bf16 v[176:179], a[152:155], v[156:159], v[176:179]
    v_mfma_f32_16x16x32_bf16 v[224:227], a[156:159], v[196:199], v[224:227]
    v_exp_f32 v147, v147
    v_mfma_f32_16x16x32_bf16 v[240:243], a[156:159], v[204:207], v[240:243]
    v_exp_f32 v99, v99
    v_mfma_f32_16x16x32_bf16 v[160:163], a[156:159], v[212:215], v[160:163]
    ds_read_b128 a[152:155], v5 offset:43008
    v_cvt_pk_bf16_f32 v123, v146, v147
    v_mfma_f32_16x16x32_bf16 v[176:179], a[156:159], v[220:223], v[176:179]
    s_waitcnt lgkmcnt(5)
    v_cvt_pk_bf16_f32 v79, v98, v99
    buffer_load_dwordx4 v1, s[8:11], s44 offen sc1 lds
    v_mfma_f32_16x16x32_bf16 v[112:115], a[160:163], v[48:51], 0
    s_add_u32 s48, s48, 0x10000
    ds_read_b128 a[156:159], v5 offset:44032
    v_mfma_f32_16x16x32_bf16 v[144:147], a[160:163], v[52:55], 0
    s_xor_b32 s49, s49, 0x10000
    v_mfma_f32_16x16x32_bf16 v[192:195], a[160:163], v[56:59], 0
    v_mfma_f32_16x16x32_bf16 v[96:99], a[160:163], v[60:63], 0
    v_exp_f32 v224, v224
    v_mfma_f32_16x16x32_bf16 v[112:115], a[164:167], v[80:83], v[112:115]
    v_exp_f32 v160, v160
    v_mfma_f32_16x16x32_bf16 v[144:147], a[164:167], v[84:87], v[144:147]
    ds_read_b128 a[160:163], v5 offset:45056
    v_mfma_f32_16x16x32_bf16 v[192:195], a[164:167], v[88:91], v[192:195]
    v_exp_f32 v225, v225
    v_mfma_f32_16x16x32_bf16 v[96:99], a[164:167], v[92:95], v[96:99]
    s_waitcnt lgkmcnt(5)
    v_cvt_pk_bf16_f32 v136, v224, v225
    v_mfma_f32_16x16x32_bf16 v[112:115], a[168:171], v[132:135], v[112:115]
    v_exp_f32 v161, v161
    v_mfma_f32_16x16x32_bf16 v[144:147], a[168:171], v[140:143], v[144:147]
    ds_read_b128 a[164:167], v5 offset:46080
    v_cvt_pk_bf16_f32 v64, v160, v161
    v_mfma_f32_16x16x32_bf16 v[192:195], a[168:171], v[148:151], v[192:195]
    v_exp_f32 v226, v226
    v_mfma_f32_16x16x32_bf16 v[96:99], a[168:171], v[156:159], v[96:99]
    buffer_load_dwordx4 v1, s[8:11], s44 offen offset:1024 sc1 lds
    v_mfma_f32_16x16x32_bf16 v[112:115], a[172:175], v[196:199], v[112:115]
    v_exp_f32 v162, v162
    v_mfma_f32_16x16x32_bf16 v[144:147], a[172:175], v[204:207], v[144:147]
    ds_read_b128 a[168:171], v5 offset:47104
    v_mfma_f32_16x16x32_bf16 v[192:195], a[172:175], v[212:215], v[192:195]
    v_exp_f32 v227, v227
    v_mfma_f32_16x16x32_bf16 v[96:99], a[172:175], v[220:223], v[96:99]
    s_waitcnt lgkmcnt(5)
    v_cvt_pk_bf16_f32 v137, v226, v227
    v_mfma_f32_16x16x32_bf16 a[0:3], a[144:147], v[168:171], a[0:3]
    v_exp_f32 v163, v163
    v_mfma_f32_16x16x32_bf16 a[4:7], a[144:147], v[120:123], a[4:7]
    ds_read_b128 a[172:175], v5 offset:48128
    v_cvt_pk_bf16_f32 v65, v162, v163
    v_mfma_f32_16x16x32_bf16 a[64:67], a[144:147], v[72:75], a[64:67]
    v_exp_f32 v240, v240
    v_mfma_f32_16x16x32_bf16 a[68:71], a[144:147], v[76:79], a[68:71]
    v_mfma_f32_16x16x32_bf16 a[8:11], a[148:151], v[168:171], a[8:11]
    v_exp_f32 v176, v176
    v_mfma_f32_16x16x32_bf16 a[12:15], a[148:151], v[120:123], a[12:15]
    ds_read_b128 a[144:147], v5 offset:49152
    buffer_load_dwordx4 v1, s[8:11], s44 offen offset:2048 sc1 lds
    v_mfma_f32_16x16x32_bf16 a[72:75], a[148:151], v[72:75], a[72:75]
    v_exp_f32 v241, v241
    v_mfma_f32_16x16x32_bf16 a[76:79], a[148:151], v[76:79], a[76:79]
    s_waitcnt lgkmcnt(5)
    v_cvt_pk_bf16_f32 v152, v240, v241
    v_mfma_f32_16x16x32_bf16 a[16:19], a[152:155], v[168:171], a[16:19]
    v_exp_f32 v177, v177
    v_mfma_f32_16x16x32_bf16 a[20:23], a[152:155], v[120:123], a[20:23]
    ds_read_b128 a[148:151], v5 offset:50176
    v_cvt_pk_bf16_f32 v68, v176, v177
    v_mfma_f32_16x16x32_bf16 a[80:83], a[152:155], v[72:75], a[80:83]
    v_exp_f32 v242, v242
    v_mfma_f32_16x16x32_bf16 a[84:87], a[152:155], v[76:79], a[84:87]
    v_mfma_f32_16x16x32_bf16 a[24:27], a[156:159], v[168:171], a[24:27]
    v_exp_f32 v178, v178
    v_mfma_f32_16x16x32_bf16 a[28:31], a[156:159], v[120:123], a[28:31]
    ds_read_b128 a[152:155], v5 offset:51200
    v_mfma_f32_16x16x32_bf16 a[88:91], a[156:159], v[72:75], a[88:91]
    v_exp_f32 v243, v243
    v_mfma_f32_16x16x32_bf16 a[92:95], a[156:159], v[76:79], a[92:95]
    s_waitcnt lgkmcnt(5)
    v_cvt_pk_bf16_f32 v153, v242, v243
    v_mfma_f32_16x16x32_bf16 a[32:35], a[160:163], v[168:171], a[32:35]
    v_exp_f32 v179, v179
    v_mfma_f32_16x16x32_bf16 a[36:39], a[160:163], v[120:123], a[36:39]
    ds_read_b128 a[156:159], v5 offset:52224
    v_cvt_pk_bf16_f32 v69, v178, v179
    v_mfma_f32_16x16x32_bf16 a[96:99], a[160:163], v[72:75], a[96:99]
    v_exp_f32 v112, v112
    v_mfma_f32_16x16x32_bf16 a[100:103], a[160:163], v[76:79], a[100:103]
    buffer_load_dwordx4 v1, s[8:11], s44 offen offset:3072 sc1 lds
    v_mfma_f32_16x16x32_bf16 a[40:43], a[164:167], v[168:171], a[40:43]
    v_exp_f32 v192, v192
    v_mfma_f32_16x16x32_bf16 a[44:47], a[164:167], v[120:123], a[44:47]
    ds_read_b128 a[160:163], v5 offset:53248
    v_mfma_f32_16x16x32_bf16 a[104:107], a[164:167], v[72:75], a[104:107]
    v_exp_f32 v113, v113
    v_mfma_f32_16x16x32_bf16 a[108:111], a[164:167], v[76:79], a[108:111]
    s_waitcnt lgkmcnt(5)
    v_cvt_pk_bf16_f32 v138, v112, v113
    v_mfma_f32_16x16x32_bf16 a[48:51], a[168:171], v[168:171], a[48:51]
    v_exp_f32 v193, v193
    v_mfma_f32_16x16x32_bf16 a[52:55], a[168:171], v[120:123], a[52:55]
    ds_read_b128 a[164:167], v5 offset:54272
    v_cvt_pk_bf16_f32 v66, v192, v193
    v_mfma_f32_16x16x32_bf16 a[112:115], a[168:171], v[72:75], a[112:115]
    v_exp_f32 v114, v114
    v_mfma_f32_16x16x32_bf16 a[116:119], a[168:171], v[76:79], a[116:119]
    v_mfma_f32_16x16x32_bf16 a[56:59], a[172:175], v[168:171], a[56:59]
    v_exp_f32 v194, v194
    v_mfma_f32_16x16x32_bf16 a[60:63], a[172:175], v[120:123], a[60:63]
    v_mfma_f32_16x16x32_bf16 a[120:123], a[172:175], v[72:75], a[120:123]
    v_exp_f32 v115, v115
    v_mfma_f32_16x16x32_bf16 a[124:127], a[172:175], v[76:79], a[124:127]
    v_cvt_pk_bf16_f32 v139, v114, v115
    v_mfma_f32_16x16x32_bf16 a[128:131], a[176:179], v[168:171], a[128:131]
    v_exp_f32 v195, v195
    v_mfma_f32_16x16x32_bf16 a[132:135], a[176:179], v[120:123], a[132:135]
    v_cvt_pk_bf16_f32 v67, v194, v195
    v_mfma_f32_16x16x32_bf16 a[136:139], a[176:179], v[72:75], a[136:139]
    v_mfma_f32_16x16x32_bf16 a[140:143], a[176:179], v[76:79], a[140:143]
    s_waitcnt lgkmcnt(3)
    v_mfma_f32_16x16x32_bf16 v[224:227], a[144:147], v[48:51], 0
    v_exp_f32 v144, v144
    v_mfma_f32_16x16x32_bf16 v[240:243], a[144:147], v[52:55], 0
    ds_read_b128 a[168:171], v5 offset:55296
    ds_read_b128 a[172:175], v5 offset:56320
    v_mfma_f32_16x16x32_bf16 v[160:163], a[144:147], v[56:59], 0
    v_exp_f32 v96, v96
    v_mfma_f32_16x16x32_bf16 v[176:179], a[144:147], v[60:63], 0
    v_mfma_f32_16x16x32_bf16 v[224:227], a[148:151], v[80:83], v[224:227]
    v_exp_f32 v145, v145
    v_mfma_f32_16x16x32_bf16 v[240:243], a[148:151], v[84:87], v[240:243]
    ds_read_b128 a[144:147], v5 offset:57344
    v_cvt_pk_bf16_f32 v154, v144, v145
    v_mfma_f32_16x16x32_bf16 v[160:163], a[148:151], v[88:91], v[160:163]
    v_exp_f32 v97, v97
    v_mfma_f32_16x16x32_bf16 v[176:179], a[148:151], v[92:95], v[176:179]
    s_waitcnt lgkmcnt(5)
    v_cvt_pk_bf16_f32 v70, v96, v97
    v_mfma_f32_16x16x32_bf16 v[224:227], a[152:155], v[132:135], v[224:227]
    v_exp_f32 v146, v146
    v_mfma_f32_16x16x32_bf16 v[240:243], a[152:155], v[140:143], v[240:243]
    ds_read_b128 a[148:151], v5 offset:58368
    v_mfma_f32_16x16x32_bf16 v[160:163], a[152:155], v[148:151], v[160:163]
    v_exp_f32 v98, v98
    v_mfma_f32_16x16x32_bf16 v[176:179], a[152:155], v[156:159], v[176:179]
    v_mfma_f32_16x16x32_bf16 v[224:227], a[156:159], v[196:199], v[224:227]
    v_exp_f32 v147, v147
    v_mfma_f32_16x16x32_bf16 v[240:243], a[156:159], v[204:207], v[240:243]
    v_exp_f32 v99, v99
    v_mfma_f32_16x16x32_bf16 v[160:163], a[156:159], v[212:215], v[160:163]
    ds_read_b128 a[152:155], v5 offset:59392
    v_cvt_pk_bf16_f32 v155, v146, v147
    v_mfma_f32_16x16x32_bf16 v[176:179], a[156:159], v[220:223], v[176:179]
    s_waitcnt lgkmcnt(5)
    v_cvt_pk_bf16_f32 v71, v98, v99
    v_mfma_f32_16x16x32_bf16 v[112:115], a[160:163], v[48:51], 0
    ds_read_b128 a[156:159], v5 offset:60416
    v_mfma_f32_16x16x32_bf16 v[144:147], a[160:163], v[52:55], 0
    v_mfma_f32_16x16x32_bf16 v[192:195], a[160:163], v[56:59], 0
    v_mfma_f32_16x16x32_bf16 v[96:99], a[160:163], v[60:63], 0
    v_exp_f32 v224, v224
    v_mfma_f32_16x16x32_bf16 v[112:115], a[164:167], v[80:83], v[112:115]
    v_exp_f32 v160, v160
    v_mfma_f32_16x16x32_bf16 v[144:147], a[164:167], v[84:87], v[144:147]
    ds_read_b128 a[160:163], v5 offset:61440
    v_mfma_f32_16x16x32_bf16 v[192:195], a[164:167], v[88:91], v[192:195]
    v_exp_f32 v225, v225
    v_mfma_f32_16x16x32_bf16 v[96:99], a[164:167], v[92:95], v[96:99]
    s_waitcnt lgkmcnt(5)
    v_cvt_pk_bf16_f32 v168, v224, v225
    v_mfma_f32_16x16x32_bf16 v[112:115], a[168:171], v[132:135], v[112:115]
    v_exp_f32 v161, v161
    v_mfma_f32_16x16x32_bf16 v[144:147], a[168:171], v[140:143], v[144:147]
    ds_read_b128 a[164:167], v5 offset:62464
    v_cvt_pk_bf16_f32 v72, v160, v161
    v_mfma_f32_16x16x32_bf16 v[192:195], a[168:171], v[148:151], v[192:195]
    v_exp_f32 v226, v226
    v_mfma_f32_16x16x32_bf16 v[96:99], a[168:171], v[156:159], v[96:99]
    v_mfma_f32_16x16x32_bf16 v[112:115], a[172:175], v[196:199], v[112:115]
    v_exp_f32 v162, v162
    v_mfma_f32_16x16x32_bf16 v[144:147], a[172:175], v[204:207], v[144:147]
    ds_read_b128 a[168:171], v5 offset:63488
    v_mfma_f32_16x16x32_bf16 v[192:195], a[172:175], v[212:215], v[192:195]
    v_exp_f32 v227, v227
    v_mfma_f32_16x16x32_bf16 v[96:99], a[172:175], v[220:223], v[96:99]
    s_waitcnt lgkmcnt(5)
    v_cvt_pk_bf16_f32 v169, v226, v227
    v_mfma_f32_16x16x32_bf16 a[0:3], a[144:147], v[136:139], a[0:3]
    v_exp_f32 v163, v163
    v_mfma_f32_16x16x32_bf16 a[4:7], a[144:147], v[152:155], a[4:7]
    ds_read_b128 a[172:175], v5 offset:64512
    v_cvt_pk_bf16_f32 v73, v162, v163
    v_mfma_f32_16x16x32_bf16 a[64:67], a[144:147], v[64:67], a[64:67]
    v_exp_f32 v240, v240
    v_mfma_f32_16x16x32_bf16 a[68:71], a[144:147], v[68:71], a[68:71]
    v_xor_b32 v5, 0x10000, v5
    v_mfma_f32_16x16x32_bf16 a[8:11], a[148:151], v[136:139], a[8:11]
    v_exp_f32 v176, v176
    v_mfma_f32_16x16x32_bf16 a[12:15], a[148:151], v[152:155], a[12:15]
    v_mfma_f32_16x16x32_bf16 a[72:75], a[148:151], v[64:67], a[72:75]
    v_exp_f32 v241, v241
    v_mfma_f32_16x16x32_bf16 a[76:79], a[148:151], v[68:71], a[76:79]
    s_waitcnt vmcnt(0) lgkmcnt(0)
    v_cvt_pk_bf16_f32 v120, v240, v241
    v_mfma_f32_16x16x32_bf16 a[16:19], a[152:155], v[136:139], a[16:19]
    s_barrier
    v_mfma_f32_16x16x32_bf16 a[20:23], a[152:155], v[152:155], a[20:23]
    v_mfma_f32_16x16x32_bf16 a[80:83], a[152:155], v[64:67], a[80:83]
    s_cmp_eq_u32 s47, s48
    s_cbranch_scc1 A_eva
A_evra:
    v_exp_f32 v177, v177
    ds_read_b128 a[144:147], v5 offset:0
    v_mfma_f32_16x16x32_bf16 a[84:87], a[152:155], v[68:71], a[84:87]
    v_exp_f32 v242, v242
    v_cvt_pk_bf16_f32 v76, v176, v177
    v_mfma_f32_16x16x32_bf16 a[24:27], a[156:159], v[136:139], a[24:27]
    v_exp_f32 v178, v178
    v_mfma_f32_16x16x32_bf16 a[28:31], a[156:159], v[152:155], a[28:31]
    v_exp_f32 v243, v243
    v_mfma_f32_16x16x32_bf16 a[88:91], a[156:159], v[64:67], a[88:91]
    ds_read_b128 a[148:151], v5 offset:1024
    ds_read_b128 a[152:155], v5 offset:2048
    v_mfma_f32_16x16x32_bf16 a[92:95], a[156:159], v[68:71], a[92:95]
    v_exp_f32 v179, v179
    v_mfma_f32_16x16x32_bf16 a[32:35], a[160:163], v[136:139], a[32:35]
    ds_read_b128 a[156:159], v5 offset:3072
    v_cvt_pk_bf16_f32 v121, v242, v243
    v_mfma_f32_16x16x32_bf16 a[36:39], a[160:163], v[152:155], a[36:39]
    v_exp_f32 v112, v112
    v_mfma_f32_16x16x32_bf16 a[96:99], a[160:163], v[64:67], a[96:99]
    v_cvt_pk_bf16_f32 v77, v178, v179
    v_mfma_f32_16x16x32_bf16 a[100:103], a[160:163], v[68:71], a[100:103]
    v_exp_f32 v192, v192
    v_mfma_f32_16x16x32_bf16 a[40:43], a[164:167], v[136:139], a[40:43]
    ds_read_b128 a[160:163], v5 offset:4096
    v_mfma_f32_16x16x32_bf16 a[44:47], a[164:167], v[152:155], a[44:47]
    v_exp_f32 v113, v113
    v_mfma_f32_16x16x32_bf16 a[104:107], a[164:167], v[64:67], a[104:107]
    v_cvt_pk_bf16_f32 v170, v112, v113
    v_mfma_f32_16x16x32_bf16 a[108:111], a[164:167], v[68:71], a[108:111]
    v_exp_f32 v193, v193
    v_mfma_f32_16x16x32_bf16 a[48:51], a[168:171], v[136:139], a[48:51]
    ds_read_b128 a[164:167], v5 offset:5120
    v_cvt_pk_bf16_f32 v74, v192, v193
    v_mfma_f32_16x16x32_bf16 a[52:55], a[168:171], v[152:155], a[52:55]
    v_exp_f32 v114, v114
    v_mfma_f32_16x16x32_bf16 a[112:115], a[168:171], v[64:67], a[112:115]
    v_mfma_f32_16x16x32_bf16 a[116:119], a[168:171], v[68:71], a[116:119]
    v_exp_f32 v194, v194
    v_mfma_f32_16x16x32_bf16 a[56:59], a[172:175], v[136:139], a[56:59]
    v_mfma_f32_16x16x32_bf16 a[60:63], a[172:175], v[152:155], a[60:63]
    v_exp_f32 v115, v115
    v_mfma_f32_16x16x32_bf16 a[120:123], a[172:175], v[64:67], a[120:123]
    v_cvt_pk_bf16_f32 v171, v114, v115
    v_mfma_f32_16x16x32_bf16 a[124:127], a[172:175], v[68:71], a[124:127]
    v_exp_f32 v195, v195
    v_mfma_f32_16x16x32_bf16 a[128:131], a[176:179], v[136:139], a[128:131]
    s_sub_u32 s45, s45, 1
    v_cvt_pk_bf16_f32 v75, v194, v195
    v_mfma_f32_16x16x32_bf16 a[132:135], a[176:179], v[152:155], a[132:135]
    s_cmp_lg_u32 s45, 0
    v_mfma_f32_16x16x32_bf16 a[136:139], a[176:179], v[64:67], a[136:139]
    s_waitcnt lgkmcnt(3)
    v_mfma_f32_16x16x32_bf16 a[140:143], a[176:179], v[68:71], a[140:143]
    s_cbranch_scc1 A_D0
    s_mov_b32 s51, s3
    s_cmp_gt_u32 s51, 0
    s_cselect_b32 s6, 0, 0xff800000
    s_cmp_ge_u32 s51, 0
    s_cselect_b32 s7, 0, 0xff800000
    v_mov_b32 v7, s6
    v_mov_b32 v8, s7
    v_cndmask_b32 v232, v7, v8, s[64:65]
    v_cndmask_b32 v233, v7, v8, s[66:67]
    v_cndmask_b32 v234, v7, v8, s[68:69]
    v_cndmask_b32 v235, v7, v8, s[70:71]
    v_cndmask_b32 v248, v7, v8, s[72:73]
    v_cndmask_b32 v249, v7, v8, s[74:75]
    v_cndmask_b32 v250, v7, v8, s[76:77]
    v_cndmask_b32 v251, v7, v8, s[78:79]
    v_mfma_f32_16x16x32_bf16 v[224:227], a[144:147], v[48:51], v[232:235]
    s_add_u32 m0, s49, 0
    v_exp_f32 v144, v144
    v_cndmask_b32 v200, v7, v8, s[80:81]
    v_mfma_f32_16x16x32_bf16 v[240:243], a[144:147], v[52:55], v[248:251]
    s_add_u32 s44, s48, 0
    ds_read_b128 a[168:171], v5 offset:6144
    ds_read_b128 a[172:175], v5 offset:7168
    buffer_load_dwordx4 v1, s[8:11], s44 offen sc1 lds
    v_mfma_f32_16x16x32_bf16 v[160:163], a[144:147], v[56:59], 0
    v_exp_f32 v96, v96
    v_mfma_f32_16x16x32_bf16 v[176:179], a[144:147], v[60:63], 0
    v_cndmask_b32 v201, v7, v8, s[82:83]
    v_cndmask_b32 v202, v7, v8, s[84:85]
    v_mfma_f32_16x16x32_bf16 v[224:227], a[148:151], v[80:83], v[224:227]
    v_exp_f32 v145, v145
    v_cndmask_b32 v203, v7, v8, s[86:87]
    v_mfma_f32_16x16x32_bf16 v[240:243], a[148:151], v[84:87], v[240:243]
    ds_read_b128 a[144:147], v5 offset:8192
    v_cvt_pk_bf16_f32 v122, v144, v145
    v_mfma_f32_16x16x32_bf16 v[160:163], a[148:151], v[88:91], v[160:163]
    v_exp_f32 v97, v97
    v_mfma_f32_16x16x32_bf16 v[176:179], a[148:151], v[92:95], v[176:179]
    s_waitcnt lgkmcnt(5)
    v_cvt_pk_bf16_f32 v78, v96, v97
    v_cndmask_b32 v216, v7, v8, s[88:89]
    v_mfma_f32_16x16x32_bf16 v[224:227], a[152:155], v[132:135], v[224:227]
    v_exp_f32 v146, v146
    v_mfma_f32_16x16x32_bf16 v[240:243], a[152:155], v[140:143], v[240:243]
    ds_read_b128 a[148:151], v5 offset:9216
    v_cndmask_b32 v217, v7, v8, s[90:91]
    v_mfma_f32_16x16x32_bf16 v[160:163], a[152:155], v[148:151], v[160:163]
    v_exp_f32 v98, v98
    v_mfma_f32_16x16x32_bf16 v[176:179], a[152:155], v[156:159], v[176:179]
    v_cndmask_b32 v218, v7, v8, s[92:93]
    v_cndmask_b32 v219, v7, v8, s[94:95]
    v_mfma_f32_16x16x32_bf16 v[224:227], a[156:159], v[196:199], v[224:227]
    v_exp_f32 v147, v147
    v_mfma_f32_16x16x32_bf16 v[240:243], a[156:159], v[204:207], v[240:243]
    v_exp_f32 v99, v99
    v_mfma_f32_16x16x32_bf16 v[160:163], a[156:159], v[212:215], v[160:163]
    ds_read_b128 a[152:155], v5 offset:10240
    v_cvt_pk_bf16_f32 v123, v146, v147
    v_mfma_f32_16x16x32_bf16 v[176:179], a[156:159], v[220:223], v[176:179]
    s_waitcnt lgkmcnt(5)
    v_cvt_pk_bf16_f32 v79, v98, v99
    buffer_load_dwordx4 v1, s[8:11], s44 offen offset:1024 sc1 lds
    v_mfma_f32_16x16x32_bf16 v[112:115], a[160:163], v[48:51], v[200:203]
    s_cmp_gt_u32 s51, 1
    s_cselect_b32 s6, 0, 0xff800000
    ds_read_b128 a[156:159], v5 offset:11264
    v_mfma_f32_16x16x32_bf16 v[144:147], a[160:163], v[52:55], v[216:219]
    s_cmp_ge_u32 s51, 1
    s_cselect_b32 s7, 0, 0xff800000
    v_mov_b32 v7, s6
    v_mfma_f32_16x16x32_bf16 v[192:195], a[160:163], v[56:59], 0
    v_mov_b32 v8, s7
    v_mfma_f32_16x16x32_bf16 v[96:99], a[160:163], v[60:63], 0
    v_exp_f32 v224, v224
    v_mfma_f32_16x16x32_bf16 v[112:115], a[164:167], v[80:83], v[112:115]
    v_exp_f32 v160, v160
    v_mfma_f32_16x16x32_bf16 v[144:147], a[164:167], v[84:87], v[144:147]
    ds_read_b128 a[160:163], v5 offset:12288
    v_cndmask_b32 v232, v7, v8, s[64:65]
    v_mfma_f32_16x16x32_bf16 v[192:195], a[164:167], v[88:91], v[192:195]
    v_exp_f32 v225, v225
    v_mfma_f32_16x16x32_bf16 v[96:99], a[164:167], v[92:95], v[96:99]
    s_waitcnt lgkmcnt(5)
    v_cvt_pk_bf16_f32 v136, v224, v225
    v_cndmask_b32 v233, v7, v8, s[66:67]
    v_mfma_f32_16x16x32_bf16 v[112:115], a[168:171], v[132:135], v[112:115]
    v_exp_f32 v161, v161
    v_mfma_f32_16x16x32_bf16 v[144:147], a[168:171], v[140:143], v[144:147]
    ds_read_b128 a[164:167], v5 offset:13312
    v_cvt_pk_bf16_f32 v64, v160, v161
    v_mfma_f32_16x16x32_bf16 v[192:195], a[168:171], v[148:151], v[192:195]
    v_exp_f32 v226, v226
    v_mfma_f32_16x16x32_bf16 v[96:99], a[168:171], v[156:159], v[96:99]
    buffer_load_dwordx4 v1, s[8:11], s44 offen offset:2048 sc1 lds
    v_cndmask_b32 v234, v7, v8, s[68:69]
    v_mfma_f32_16x16x32_bf16 v[112:115], a[172:175], v[196:199], v[112:115]
    v_exp_f32 v162, v162
    v_mfma_f32_16x16x32_bf16 v[144:147], a[172:175], v[204:207], v[144:147]
    ds_read_b128 a[168:171], v5 offset:14336
    v_cndmask_b32 v235, v7, v8, s[70:71]
    v_mfma_f32_16x16x32_bf16 v[192:195], a[172:175], v[212:215], v[192:195]
    v_exp_f32 v227, v227
    v_mfma_f32_16x16x32_bf16 v[96:99], a[172:175], v[220:223], v[96:99]
    s_waitcnt lgkmcnt(5)
    v_cvt_pk_bf16_f32 v137, v226, v227
    v_cndmask_b32 v248, v7, v8, s[72:73]
    v_mfma_f32_16x16x32_bf16 a[0:3], a[144:147], v[168:171], a[0:3]
    v_exp_f32 v163, v163
    v_mfma_f32_16x16x32_bf16 a[4:7], a[144:147], v[120:123], a[4:7]
    ds_read_b128 a[172:175], v5 offset:15360
    v_cvt_pk_bf16_f32 v65, v162, v163
    v_mfma_f32_16x16x32_bf16 a[64:67], a[144:147], v[72:75], a[64:67]
    v_exp_f32 v240, v240
    v_mfma_f32_16x16x32_bf16 a[68:71], a[144:147], v[76:79], a[68:71]
    v_cndmask_b32 v249, v7, v8, s[74:75]
    v_cndmask_b32 v250, v7, v8, s[76:77]
    v_mfma_f32_16x16x32_bf16 a[8:11], a[148:151], v[168:171], a[8:11]
    v_exp_f32 v176, v176
    v_mfma_f32_16x16x32_bf16 a[12:15], a[148:151], v[120:123], a[12:15]
    ds_read_b128 a[144:147], v5 offset:16384
    buffer_load_dwordx4 v1, s[8:11], s44 offen offset:3072 sc1 lds
    v_mfma_f32_16x16x32_bf16 a[72:75], a[148:151], v[72:75], a[72:75]
    s_add_u32 m0, s49, 4096
    v_exp_f32 v241, v241
    v_mfma_f32_16x16x32_bf16 a[76:79], a[148:151], v[76:79], a[76:79]
    s_waitcnt lgkmcnt(5)
    v_cvt_pk_bf16_f32 v152, v240, v241
    v_cndmask_b32 v251, v7, v8, s[78:79]
    v_mfma_f32_16x16x32_bf16 a[16:19], a[152:155], v[168:171], a[16:19]
    s_add_u32 s44, s48, 4096
    v_exp_f32 v177, v177
    v_mfma_f32_16x16x32_bf16 a[20:23], a[152:155], v[120:123], a[20:23]
    ds_read_b128 a[148:151], v5 offset:17408
    v_cvt_pk_bf16_f32 v68, v176, v177
    v_mfma_f32_16x16x32_bf16 a[80:83], a[152:155], v[72:75], a[80:83]
    v_exp_f32 v242, v242
    v_mfma_f32_16x16x32_bf16 a[84:87], a[152:155], v[76:79], a[84:87]
    v_mfma_f32_16x16x32_bf16 a[24:27], a[156:159], v[168:171], a[24:27]
    v_exp_f32 v178, v178
    v_mfma_f32_16x16x32_bf16 a[28:31], a[156:159], v[120:123], a[28:31]
    ds_read_b128 a[152:155], v5 offset:18432
    v_mfma_f32_16x16x32_bf16 a[88:91], a[156:159], v[72:75], a[88:91]
    v_exp_f32 v243, v243
    v_mfma_f32_16x16x32_bf16 a[92:95], a[156:159], v[76:79], a[92:95]
    s_waitcnt lgkmcnt(5)
    v_cvt_pk_bf16_f32 v153, v242, v243
    v_mfma_f32_16x16x32_bf16 a[32:35], a[160:163], v[168:171], a[32:35]
    v_exp_f32 v179, v179
    v_mfma_f32_16x16x32_bf16 a[36:39], a[160:163], v[120:123], a[36:39]
    ds_read_b128 a[156:159], v5 offset:19456
    v_cvt_pk_bf16_f32 v69, v178, v179
    v_mfma_f32_16x16x32_bf16 a[96:99], a[160:163], v[72:75], a[96:99]
    v_exp_f32 v112, v112
    v_mfma_f32_16x16x32_bf16 a[100:103], a[160:163], v[76:79], a[100:103]
    buffer_load_dwordx4 v1, s[8:11], s44 offen sc1 lds
    v_mfma_f32_16x16x32_bf16 a[40:43], a[164:167], v[168:171], a[40:43]
    v_exp_f32 v192, v192
    v_mfma_f32_16x16x32_bf16 a[44:47], a[164:167], v[120:123], a[44:47]
    ds_read_b128 a[160:163], v5 offset:20480
    v_mfma_f32_16x16x32_bf16 a[104:107], a[164:167], v[72:75], a[104:107]
    v_exp_f32 v113, v113
    v_mfma_f32_16x16x32_bf16 a[108:111], a[164:167], v[76:79], a[108:111]
    s_waitcnt lgkmcnt(5)
    v_cvt_pk_bf16_f32 v138, v112, v113
    v_mfma_f32_16x16x32_bf16 a[48:51], a[168:171], v[168:171], a[48:51]
    v_exp_f32 v193, v193
    v_mfma_f32_16x16x32_bf16 a[52:55], a[168:171], v[120:123], a[52:55]
    ds_read_b128 a[164:167], v5 offset:21504
    v_cvt_pk_bf16_f32 v66, v192, v193
    v_mfma_f32_16x16x32_bf16 a[112:115], a[168:171], v[72:75], a[112:115]
    v_exp_f32 v114, v114
    v_mfma_f32_16x16x32_bf16 a[116:119], a[168:171], v[76:79], a[116:119]
    v_mfma_f32_16x16x32_bf16 a[56:59], a[172:175], v[168:171], a[56:59]
    v_exp_f32 v194, v194
    v_mfma_f32_16x16x32_bf16 a[60:63], a[172:175], v[120:123], a[60:63]
    v_mfma_f32_16x16x32_bf16 a[120:123], a[172:175], v[72:75], a[120:123]
    v_exp_f32 v115, v115
    v_mfma_f32_16x16x32_bf16 a[124:127], a[172:175], v[76:79], a[124:127]
    v_cvt_pk_bf16_f32 v139, v114, v115
    v_mfma_f32_16x16x32_bf16 a[128:131], a[176:179], v[168:171], a[128:131]
    v_exp_f32 v195, v195
    v_mfma_f32_16x16x32_bf16 a[132:135], a[176:179], v[120:123], a[132:135]
    v_cvt_pk_bf16_f32 v67, v194, v195
    v_mfma_f32_16x16x32_bf16 a[136:139], a[176:179], v[72:75], a[136:139]
    v_mfma_f32_16x16x32_bf16 a[140:143], a[176:179], v[76:79], a[140:143]
    s_waitcnt lgkmcnt(3)
A_SD1:
    v_mfma_f32_16x16x32_bf16 v[224:227], a[144:147], v[48:51], v[232:235]
    v_exp_f32 v144, v144
    v_cndmask_b32 v200, v7, v8, s[80:81]
    v_mfma_f32_16x16x32_bf16 v[240:243], a[144:147], v[52:55], v[248:251]
    ds_read_b128 a[168:171], v5 offset:22528
    ds_read_b128 a[172:175], v5 offset:23552
    buffer_load_dwordx4 v1, s[8:11], s44 offen offset:1024 sc1 lds
    v_mfma_f32_16x16x32_bf16 v[160:163], a[144:147], v[56:59], 0
    v_exp_f32 v96, v96
    v_mfma_f32_16x16x32_bf16 v[176:179], a[144:147], v[60:63], 0
    v_cndmask_b32 v201, v7, v8, s[82:83]
    v_cndmask_b32 v202, v7, v8, s[84:85]
    v_mfma_f32_16x16x32_bf16 v[224:227], a[148:151], v[80:83], v[224:227]
    v_exp_f32 v145, v145
    v_cndmask_b32 v203, v7, v8, s[86:87]
    v_mfma_f32_16x16x32_bf16 v[240:243], a[148:151], v[84:87], v[240:243]
    ds_read_b128 a[144:147], v5 offset:24576
    v_cvt_pk_bf16_f32 v154, v144, v145
    v_mfma_f32_16x16x32_bf16 v[160:163], a[148:151], v[88:91], v[160:163]
    v_exp_f32 v97, v97
    v_mfma_f32_16x16x32_bf16 v[176:179], a[148:151], v[92:95], v[176:179]
    s_waitcnt lgkmcnt(5)
    v_cvt_pk_bf16_f32 v70, v96, v97
    v_cndmask_b32 v216, v7, v8, s[88:89]
    v_mfma_f32_16x16x32_bf16 v[224:227], a[152:155], v[132:135], v[224:227]
    v_exp_f32 v146, v146
    v_mfma_f32_16x16x32_bf16 v[240:243], a[152:155], v[140:143], v[240:243]
    ds_read_b128 a[148:151], v5 offset:25600
    v_cndmask_b32 v217, v7, v8, s[90:91]
    v_mfma_f32_16x16x32_bf16 v[160:163], a[152:155], v[148:151], v[160:163]
    v_exp_f32 v98, v98
    buffer_load_dwordx4 v1, s[8:11], s44 offen offset:2048 sc1 lds
    v_mfma_f32_16x16x32_bf16 v[176:179], a[152:155], v[156:159], v[176:179]
    v_cndmask_b32 v218, v7, v8, s[92:93]
    v_cndmask_b32 v219, v7, v8, s[94:95]
    v_mfma_f32_16x16x32_bf16 v[224:227], a[156:159], v[196:199], v[224:227]
    v_exp_f32 v147, v147
    v_mfma_f32_16x16x32_bf16 v[240:243], a[156:159], v[204:207], v[240:243]
    v_exp_f32 v99, v99
    v_mfma_f32_16x16x32_bf16 v[160:163], a[156:159], v[212:215], v[160:163]
    ds_read_b128 a[152:155], v5 offset:26624
    v_cvt_pk_bf16_f32 v155, v146, v147
    v_mfma_f32_16x16x32_bf16 v[176:179], a[156:159], v[220:223], v[176:179]
    s_waitcnt lgkmcnt(5)
    v_cvt_pk_bf16_f32 v71, v98, v99
    v_mfma_f32_16x16x32_bf16 v[112:115], a[160:163], v[48:51], v[200:203]
    s_cmp_gt_u32 s51, 2
    s_cselect_b32 s6, 0, 0xff800000
    ds_read_b128 a[156:159], v5 offset:27648
    v_mfma_f32_16x16x32_bf16 v[144:147], a[160:163], v[52:55], v[216:219]
    s_cmp_ge_u32 s51, 2
    s_cselect_b32 s7, 0, 0xff800000
    v_mov_b32 v7, s6
    v_mfma_f32_16x16x32_bf16 v[192:195], a[160:163], v[56:59], 0
    v_mov_b32 v8, s7
    v_mfma_f32_16x16x32_bf16 v[96:99], a[160:163], v[60:63], 0
    v_exp_f32 v224, v224
    v_mfma_f32_16x16x32_bf16 v[112:115], a[164:167], v[80:83], v[112:115]
    v_exp_f32 v160, v160
    v_mfma_f32_16x16x32_bf16 v[144:147], a[164:167], v[84:87], v[144:147]
    ds_read_b128 a[160:163], v5 offset:28672
    buffer_load_dwordx4 v1, s[8:11], s44 offen offset:3072 sc1 lds
    v_mfma_f32_16x16x32_bf16 v[192:195], a[164:167], v[88:91], v[192:195]
    s_add_u32 m0, s49, 8192
    v_exp_f32 v225, v225
    v_mfma_f32_16x16x32_bf16 v[96:99], a[164:167], v[92:95], v[96:99]
    s_waitcnt lgkmcnt(5)
    v_cvt_pk_bf16_f32 v168, v224, v225
    v_cndmask_b32 v232, v7, v8, s[64:65]
    v_mfma_f32_16x16x32_bf16 v[112:115], a[168:171], v[132:135], v[112:115]
    s_add_u32 s44, s48, 8192
    v_exp_f32 v161, v161
    v_mfma_f32_16x16x32_bf16 v[144:147], a[168:171], v[140:143], v[144:147]
    ds_read_b128 a[164:167], v5 offset:29696
    v_cvt_pk_bf16_f32 v72, v160, v161
    v_mfma_f32_16x16x32_bf16 v[192:195], a[168:171], v[148:151], v[192:195]
    v_exp_f32 v226, v226
    v_mfma_f32_16x16x32_bf16 v[96:99], a[168:171], v[156:159], v[96:99]
    v_cndmask_b32 v233, v7, v8, s[66:67]
    v_cndmask_b32 v234, v7, v8, s[68:69]
    v_mfma_f32_16x16x32_bf16 v[112:115], a[172:175], v[196:199], v[112:115]
    v_exp_f32 v162, v162
    v_mfma_f32_16x16x32_bf16 v[144:147], a[172:175], v[204:207], v[144:147]
    ds_read_b128 a[168:171], v5 offset:30720
    v_cndmask_b32 v235, v7, v8, s[70:71]
    v_mfma_f32_16x16x32_bf16 v[192:195], a[172:175], v[212:215], v[192:195]
    v_exp_f32 v227, v227
    v_mfma_f32_16x16x32_bf16 v[96:99], a[172:175], v[220:223], v[96:99]
    s_waitcnt lgkmcnt(5)
    v_cvt_pk_bf16_f32 v169, v226, v227
    buffer_load_dwordx4 v1, s[8:11], s44 offen sc1 lds
    v_mfma_f32_16x16x32_bf16 a[0:3], a[144:147], v[136:139], a[0:3]
    v_exp_f32 v163, v163
    v_mfma_f32_16x16x32_bf16 a[4:7], a[144:147], v[152:155], a[4:7]
    ds_read_b128 a[172:175], v5 offset:31744
    v_cvt_pk_bf16_f32 v73, v162, v163
    v_mfma_f32_16x16x32_bf16 a[64:67], a[144:147], v[64:67], a[64:67]
    v_exp_f32 v240, v240
    v_mfma_f32_16x16x32_bf16 a[68:71], a[144:147], v[68:71], a[68:71]
    v_cndmask_b32 v248, v7, v8, s[72:73]
    v_cndmask_b32 v249, v7, v8, s[74:75]
    v_mfma_f32_16x16x32_bf16 a[8:11], a[148:151], v[136:139], a[8:11]
    v_exp_f32 v176, v176
    v_mfma_f32_16x16x32_bf16 a[12:15], a[148:151], v[152:155], a[12:15]
    ds_read_b128 a[144:147], v5 offset:32768
    v_cndmask_b32 v250, v7, v8, s[76:77]
    v_mfma_f32_16x16x32_bf16 a[72:75], a[148:151], v[64:67], a[72:75]
    v_exp_f32 v241, v241
    v_mfma_f32_16x16x32_bf16 a[76:79], a[148:151], v[68:71], a[76:79]
    s_waitcnt lgkmcnt(5)
    v_cvt_pk_bf16_f32 v120, v240, v241
    v_cndmask_b32 v251, v7, v8, s[78:79]
    v_mfma_f32_16x16x32_bf16 a[16:19], a[152:155], v[136:139], a[16:19]
    v_exp_f32 v177, v177
    v_mfma_f32_16x16x32_bf16 a[20:23], a[152:155], v[152:155], a[20:23]
    ds_read_b128 a[148:151], v5 offset:33792
    v_cvt_pk_bf16_f32 v76, v176, v177
    v_mfma_f32_16x16x32_bf16 a[80:83], a[152:155], v[64:67], a[80:83]
    v_exp_f32 v242, v242
    v_mfma_f32_16x16x32_bf16 a[84:87], a[152:155], v[68:71], a[84:87]
    buffer_load_dwordx4 v1, s[8:11], s44 offen offset:1024 sc1 lds
    v_cndmask_b32 v200, v7, v8, s[80:81]
    v_mfma_f32_16x16x32_bf16 a[24:27], a[156:159], v[136:139], a[24:27]
    v_exp_f32 v178, v178
    v_mfma_f32_16x16x32_bf16 a[28:31], a[156:159], v[152:155], a[28:31]
    ds_read_b128 a[152:155], v5 offset:34816
    v_cndmask_b32 v201, v7, v8, s[82:83]
    v_mfma_f32_16x16x32_bf16 a[88:91], a[156:159], v[64:67], a[88:91]
    v_exp_f32 v243, v243
    v_mfma_f32_16x16x32_bf16 a[92:95], a[156:159], v[68:71], a[92:95]
    s_waitcnt lgkmcnt(5)
    v_cvt_pk_bf16_f32 v121, v242, v243
    v_cndmask_b32 v202, v7, v8, s[84:85]
    v_mfma_f32_16x16x32_bf16 a[32:35], a[160:163], v[136:139], a[32:35]
    v_exp_f32 v179, v179
    v_mfma_f32_16x16x32_bf16 a[36:39], a[160:163], v[152:155], a[36:39]
    ds_read_b128 a[156:159], v5 offset:35840
    v_cvt_pk_bf16_f32 v77, v178, v179
    v_mfma_f32_16x16x32_bf16 a[96:99], a[160:163], v[64:67], a[96:99]
    v_exp_f32 v112, v112
    v_mfma_f32_16x16x32_bf16 a[100:103], a[160:163], v[68:71], a[100:103]
    buffer_load_dwordx4 v1, s[8:11], s44 offen offset:2048 sc1 lds
    v_cndmask_b32 v203, v7, v8, s[86:87]
    v_mfma_f32_16x16x32_bf16 a[40:43], a[164:167], v[136:139], a[40:43]
    v_exp_f32 v192, v192
    v_mfma_f32_16x16x32_bf16 a[44:47], a[164:167], v[152:155], a[44:47]
    ds_read_b128 a[160:163], v5 offset:36864
    v_cndmask_b32 v216, v7, v8, s[88:89]
    v_mfma_f32_16x16x32_bf16 a[104:107], a[164:167], v[64:67], a[104:107]
    v_exp_f32 v113, v113
    v_mfma_f32_16x16x32_bf16 a[108:111], a[164:167], v[68:71], a[108:111]
    s_waitcnt lgkmcnt(5)
    v_cvt_pk_bf16_f32 v170, v112, v113
    v_cndmask_b32 v217, v7, v8, s[90:91]
    v_mfma_f32_16x16x32_bf16 a[48:51], a[168:171], v[136:139], a[48:51]
    v_exp_f32 v193, v193
    v_mfma_f32_16x16x32_bf16 a[52:55], a[168:171], v[152:155], a[52:55]
    ds_read_b128 a[164:167], v5 offset:37888
    v_cvt_pk_bf16_f32 v74, v192, v193
    v_mfma_f32_16x16x32_bf16 a[112:115], a[168:171], v[64:67], a[112:115]
    v_exp_f32 v114, v114
    v_mfma_f32_16x16x32_bf16 a[116:119], a[168:171], v[68:71], a[116:119]
    v_cndmask_b32 v218, v7, v8, s[92:93]
    v_cndmask_b32 v219, v7, v8, s[94:95]
    v_mfma_f32_16x16x32_bf16 a[56:59], a[172:175], v[136:139], a[56:59]
    v_exp_f32 v194, v194
    v_mfma_f32_16x16x32_bf16 a[60:63], a[172:175], v[152:155], a[60:63]
    v_mfma_f32_16x16x32_bf16 a[120:123], a[172:175], v[64:67], a[120:123]
    v_exp_f32 v115, v115
    v_mfma_f32_16x16x32_bf16 a[124:127], a[172:175], v[68:71], a[124:127]
    v_cvt_pk_bf16_f32 v171, v114, v115
    v_mfma_f32_16x16x32_bf16 a[128:131], a[176:179], v[136:139], a[128:131]
    v_exp_f32 v195, v195
    v_mfma_f32_16x16x32_bf16 a[132:135], a[176:179], v[152:155], a[132:135]
    v_cvt_pk_bf16_f32 v75, v194, v195
    v_mfma_f32_16x16x32_bf16 a[136:139], a[176:179], v[64:67], a[136:139]
    v_mfma_f32_16x16x32_bf16 a[140:143], a[176:179], v[68:71], a[140:143]
    s_waitcnt lgkmcnt(3)
    v_mfma_f32_16x16x32_bf16 v[224:227], a[144:147], v[48:51], v[232:235]
    v_exp_f32 v144, v144
    v_mfma_f32_16x16x32_bf16 v[240:243], a[144:147], v[52:55], v[248:251]
    ds_read_b128 a[168:171], v5 offset:38912
    ds_read_b128 a[172:175], v5 offset:39936
    v_mfma_f32_16x16x32_bf16 v[160:163], a[144:147], v[56:59], 0
    v_exp_f32 v96, v96
    v_mfma_f32_16x16x32_bf16 v[176:179], a[144:147], v[60:63], 0
    buffer_load_dwordx4 v1, s[8:11], s44 offen offset:3072 sc1 lds
    v_mfma_f32_16x16x32_bf16 v[224:227], a[148:151], v[80:83], v[224:227]
    s_add_u32 m0, s49, 12288
    v_exp_f32 v145, v145
    v_mfma_f32_16x16x32_bf16 v[240:243], a[148:151], v[84:87], v[240:243]
    s_add_u32 s44, s48, 12288
    ds_read_b128 a[144:147], v5 offset:40960
    v_cvt_pk_bf16_f32 v122, v144, v145
    v_mfma_f32_16x16x32_bf16 v[160:163], a[148:151], v[88:91], v[160:163]
    v_exp_f32 v97, v97
    v_mfma_f32_16x16x32_bf16 v[176:179], a[148:151], v[92:95], v[176:179]
    s_waitcnt lgkmcnt(5)
    v_cvt_pk_bf16_f32 v78, v96, v97
    v_mfma_f32_16x16x32_bf16 v[224:227], a[152:155], v[132:135], v[224:227]
    v_exp_f32 v146, v146
    v_mfma_f32_16x16x32_bf16 v[240:243], a[152:155], v[140:143], v[240:243]
    ds_read_b128 a[148:151], v5 offset:41984
    v_mfma_f32_16x16x32_bf16 v[160:163], a[152:155], v[148:151], v[160:163]
    v_exp_f32 v98, v98
    v_mfma_f32_16x16x32_bf16 v[176:179], a[152:155], v[156:159], v[176:179]
    v_mfma_f32_16x16x32_bf16 v[224:227], a[156:159], v[196:199], v[224:227]
    v_exp_f32 v147, v147
    v_mfma_f32_16x16x32_bf16 v[240:243], a[156:159], v[204:207], v[240:243]
    v_exp_f32 v99, v99
    v_mfma_f32_16x16x32_bf16 v[160:163], a[156:159], v[212:215], v[160:163]
    ds_read_b128 a[152:155], v5 offset:43008
    v_cvt_pk_bf16_f32 v123, v146, v147
    v_mfma_f32_16x16x32_bf16 v[176:179], a[156:159], v[220:223], v[176:179]
    s_waitcnt lgkmcnt(5)
    v_cvt_pk_bf16_f32 v79, v98, v99
    buffer_load_dwordx4 v1, s[8:11], s44 offen sc1 lds
    v_mfma_f32_16x16x32_bf16 v[112:115], a[160:163], v[48:51], v[200:203]
    s_cmp_gt_u32 s51, 3
    s_cselect_b32 s6, 0, 0xff800000
    ds_read_b128 a[156:159], v5 offset:44032
    v_mfma_f32_16x16x32_bf16 v[144:147], a[160:163], v[52:55], v[216:219]
    s_cmp_ge_u32 s51, 3
    s_cselect_b32 s7, 0, 0xff800000
    v_mov_b32 v7, s6
    v_mfma_f32_16x16x32_bf16 v[192:195], a[160:163], v[56:59], 0
    s_add_u32 s48, s48, 0x10000
    v_mov_b32 v8, s7
    v_mfma_f32_16x16x32_bf16 v[96:99], a[160:163], v[60:63], 0
    s_xor_b32 s49, s49, 0x10000
    v_exp_f32 v224, v224
    v_mfma_f32_16x16x32_bf16 v[112:115], a[164:167], v[80:83], v[112:115]
    v_exp_f32 v160, v160
    v_mfma_f32_16x16x32_bf16 v[144:147], a[164:167], v[84:87], v[144:147]
    ds_read_b128 a[160:163], v5 offset:45056
    v_cndmask_b32 v232, v7, v8, s[64:65]
    v_mfma_f32_16x16x32_bf16 v[192:195], a[164:167], v[88:91], v[192:195]
    v_exp_f32 v225, v225
    v_mfma_f32_16x16x32_bf16 v[96:99], a[164:167], v[92:95], v[96:99]
    s_waitcnt lgkmcnt(5)
    v_cvt_pk_bf16_f32 v136, v224, v225
    v_cndmask_b32 v233, v7, v8, s[66:67]
    v_mfma_f32_16x16x32_bf16 v[112:115], a[168:171], v[132:135], v[112:115]
    v_exp_f32 v161, v161
    v_mfma_f32_16x16x32_bf16 v[144:147], a[168:171], v[140:143], v[144:147]
    ds_read_b128 a[164:167], v5 offset:46080
    v_cvt_pk_bf16_f32 v64, v160, v161
    v_mfma_f32_16x16x32_bf16 v[192:195], a[168:171], v[148:151], v[192:195]
    v_exp_f32 v226, v226
    v_mfma_f32_16x16x32_bf16 v[96:99], a[168:171], v[156:159], v[96:99]
    buffer_load_dwordx4 v1, s[8:11], s44 offen offset:1024 sc1 lds
    v_cndmask_b32 v234, v7, v8, s[68:69]
    v_mfma_f32_16x16x32_bf16 v[112:115], a[172:175], v[196:199], v[112:115]
    v_exp_f32 v162, v162
    v_mfma_f32_16x16x32_bf16 v[144:147], a[172:175], v[204:207], v[144:147]
    ds_read_b128 a[168:171], v5 offset:47104
    v_cndmask_b32 v235, v7, v8, s[70:71]
    v_mfma_f32_16x16x32_bf16 v[192:195], a[172:175], v[212:215], v[192:195]
    v_exp_f32 v227, v227
    v_mfma_f32_16x16x32_bf16 v[96:99], a[172:175], v[220:223], v[96:99]
    s_waitcnt lgkmcnt(5)
    v_cvt_pk_bf16_f32 v137, v226, v227
    v_cndmask_b32 v248, v7, v8, s[72:73]
    v_mfma_f32_16x16x32_bf16 a[0:3], a[144:147], v[168:171], a[0:3]
    v_exp_f32 v163, v163
    v_mfma_f32_16x16x32_bf16 a[4:7], a[144:147], v[120:123], a[4:7]
    ds_read_b128 a[172:175], v5 offset:48128
    v_cvt_pk_bf16_f32 v65, v162, v163
    v_mfma_f32_16x16x32_bf16 a[64:67], a[144:147], v[72:75], a[64:67]
    v_exp_f32 v240, v240
    v_mfma_f32_16x16x32_bf16 a[68:71], a[144:147], v[76:79], a[68:71]
    v_cndmask_b32 v249, v7, v8, s[74:75]
    v_cndmask_b32 v250, v7, v8, s[76:77]
    v_mfma_f32_16x16x32_bf16 a[8:11], a[148:151], v[168:171], a[8:11]
    v_exp_f32 v176, v176
    v_mfma_f32_16x16x32_bf16 a[12:15], a[148:151], v[120:123], a[12:15]
    ds_read_b128 a[144:147], v5 offset:49152
    buffer_load_dwordx4 v1, s[8:11], s44 offen offset:2048 sc1 lds
    v_mfma_f32_16x16x32_bf16 a[72:75], a[148:151], v[72:75], a[72:75]
    v_exp_f32 v241, v241
    v_mfma_f32_16x16x32_bf16 a[76:79], a[148:151], v[76:79], a[76:79]
    s_waitcnt lgkmcnt(5)
    v_cvt_pk_bf16_f32 v152, v240, v241
    v_cndmask_b32 v251, v7, v8, s[78:79]
    v_mfma_f32_16x16x32_bf16 a[16:19], a[152:155], v[168:171], a[16:19]
    v_exp_f32 v177, v177
    v_mfma_f32_16x16x32_bf16 a[20:23], a[152:155], v[120:123], a[20:23]
    ds_read_b128 a[148:151], v5 offset:50176
    v_cvt_pk_bf16_f32 v68, v176, v177
    v_mfma_f32_16x16x32_bf16 a[80:83], a[152:155], v[72:75], a[80:83]
    v_exp_f32 v242, v242
    v_mfma_f32_16x16x32_bf16 a[84:87], a[152:155], v[76:79], a[84:87]
    v_cndmask_b32 v200, v7, v8, s[80:81]
    v_cndmask_b32 v201, v7, v8, s[82:83]
    v_mfma_f32_16x16x32_bf16 a[24:27], a[156:159], v[168:171], a[24:27]
    v_exp_f32 v178, v178
    v_mfma_f32_16x16x32_bf16 a[28:31], a[156:159], v[120:123], a[28:31]
    ds_read_b128 a[152:155], v5 offset:51200
    v_cndmask_b32 v202, v7, v8, s[84:85]
    v_mfma_f32_16x16x32_bf16 a[88:91], a[156:159], v[72:75], a[88:91]
    v_exp_f32 v243, v243
    v_mfma_f32_16x16x32_bf16 a[92:95], a[156:159], v[76:79], a[92:95]
    s_waitcnt lgkmcnt(5)
    v_cvt_pk_bf16_f32 v153, v242, v243
    v_cndmask_b32 v203, v7, v8, s[86:87]
    v_mfma_f32_16x16x32_bf16 a[32:35], a[160:163], v[168:171], a[32:35]
    v_exp_f32 v179, v179
    v_mfma_f32_16x16x32_bf16 a[36:39], a[160:163], v[120:123], a[36:39]
    ds_read_b128 a[156:159], v5 offset:52224
    v_cvt_pk_bf16_f32 v69, v178, v179
    v_mfma_f32_16x16x32_bf16 a[96:99], a[160:163], v[72:75], a[96:99]
    v_exp_f32 v112, v112
    v_mfma_f32_16x16x32_bf16 a[100:103], a[160:163], v[76:79], a[100:103]
    buffer_load_dwordx4 v1, s[8:11], s44 offen offset:3072 sc1 lds
    v_cndmask_b32 v216, v7, v8, s[88:89]
    v_mfma_f32_16x16x32_bf16 a[40:43], a[164:167], v[168:171], a[40:43]
    v_exp_f32 v192, v192
    v_mfma_f32_16x16x32_bf16 a[44:47], a[164:167], v[120:123], a[44:47]
    ds_read_b128 a[160:163], v5 offset:53248
    v_cndmask_b32 v217, v7, v8, s[90:91]
    v_mfma_f32_16x16x32_bf16 a[104:107], a[164:167], v[72:75], a[104:107]
    v_exp_f32 v113, v113
    v_mfma_f32_16x16x32_bf16 a[108:111], a[164:167], v[76:79], a[108:111]
    s_waitcnt lgkmcnt(5)
    v_cvt_pk_bf16_f32 v138, v112, v113
    v_cndmask_b32 v218, v7, v8, s[92:93]
    v_mfma_f32_16x16x32_bf16 a[48:51], a[168:171], v[168:171], a[48:51]
    v_exp_f32 v193, v193
    v_mfma_f32_16x16x32_bf16 a[52:55], a[168:171], v[120:123], a[52:55]
    ds_read_b128 a[164:167], v5 offset:54272
    v_cvt_pk_bf16_f32 v66, v192, v193
    v_mfma_f32_16x16x32_bf16 a[112:115], a[168:171], v[72:75], a[112:115]
    v_exp_f32 v114, v114
    v_mfma_f32_16x16x32_bf16 a[116:119], a[168:171], v[76:79], a[116:119]
    v_cndmask_b32 v219, v7, v8, s[94:95]
    v_mfma_f32_16x16x32_bf16 a[56:59], a[172:175], v[168:171], a[56:59]
    v_exp_f32 v194, v194
    v_mfma_f32_16x16x32_bf16 a[60:63], a[172:175], v[120:123], a[60:63]
    v_mfma_f32_16x16x32_bf16 a[120:123], a[172:175], v[72:75], a[120:123]
    v_exp_f32 v115, v115
    v_mfma_f32_16x16x32_bf16 a[124:127], a[172:175], v[76:79], a[124:127]
    v_cvt_pk_bf16_f32 v139, v114, v115
    v_mfma_f32_16x16x32_bf16 a[128:131], a[176:179], v[168:171], a[128:131]
    v_exp_f32 v195, v195
    v_mfma_f32_16x16x32_bf16 a[132:135], a[176:179], v[120:123], a[132:135]
    v_cvt_pk_bf16_f32 v67, v194, v195
    v_mfma_f32_16x16x32_bf16 a[136:139], a[176:179], v[72:75], a[136:139]
    v_mfma_f32_16x16x32_bf16 a[140:143], a[176:179], v[76:79], a[140:143]
    s_waitcnt lgkmcnt(3)
    v_mfma_f32_16x16x32_bf16 v[224:227], a[144:147], v[48:51], v[232:235]
    v_exp_f32 v144, v144
    v_mfma_f32_16x16x32_bf16 v[240:243], a[144:147], v[52:55], v[248:251]
    ds_read_b128 a[168:171], v5 offset:55296
    ds_read_b128 a[172:175], v5 offset:56320
    v_mfma_f32_16x16x32_bf16 v[160:163], a[144:147], v[56:59], 0
    v_exp_f32 v96, v96
    v_mfma_f32_16x16x32_bf16 v[176:179], a[144:147], v[60:63], 0
    v_mfma_f32_16x16x32_bf16 v[224:227], a[148:151], v[80:83], v[224:227]
    v_exp_f32 v145, v145
    v_mfma_f32_16x16x32_bf16 v[240:243], a[148:151], v[84:87], v[240:243]
    ds_read_b128 a[144:147], v5 offset:57344
    v_cvt_pk_bf16_f32 v154, v144, v145
    v_mfma_f32_16x16x32_bf16 v[160:163], a[148:151], v[88:91], v[160:163]
    v_exp_f32 v97, v97
    v_mfma_f32_16x16x32_bf16 v[176:179], a[148:151], v[92:95], v[176:179]
    s_waitcnt lgkmcnt(5)
    v_cvt_pk_bf16_f32 v70, v96, v97
    v_mfma_f32_16x16x32_bf16 v[224:227], a[152:155], v[132:135], v[224:227]
    v_exp_f32 v146, v146
    v_mfma_f32_16x16x32_bf16 v[240:243], a[152:155], v[140:143], v[240:243]
    ds_read_b128 a[148:151], v5 offset:58368
    v_mfma_f32_16x16x32_bf16 v[160:163], a[152:155], v[148:151], v[160:163]
    v_exp_f32 v98, v98
    v_mfma_f32_16x16x32_bf16 v[176:179], a[152:155], v[156:159], v[176:179]
    v_mfma_f32_16x16x32_bf16 v[224:227], a[156:159], v[196:199], v[224:227]
    v_exp_f32 v147, v147
    v_mfma_f32_16x16x32_bf16 v[240:243], a[156:159], v[204:207], v[240:243]
    v_exp_f32 v99, v99
    v_mfma_f32_16x16x32_bf16 v[160:163], a[156:159], v[212:215], v[160:163]
    ds_read_b128 a[152:155], v5 offset:59392
    v_cvt_pk_bf16_f32 v155, v146, v147
    v_mfma_f32_16x16x32_bf16 v[176:179], a[156:159], v[220:223], v[176:179]
    s_waitcnt lgkmcnt(5)
    v_cvt_pk_bf16_f32 v71, v98, v99
    v_mfma_f32_16x16x32_bf16 v[112:115], a[160:163], v[48:51], v[200:203]
    ds_read_b128 a[156:159], v5 offset:60416
    v_mfma_f32_16x16x32_bf16 v[144:147], a[160:163], v[52:55], v[216:219]
    v_mfma_f32_16x16x32_bf16 v[192:195], a[160:163], v[56:59], 0
    v_mfma_f32_16x16x32_bf16 v[96:99], a[160:163], v[60:63], 0
    v_exp_f32 v224, v224
    v_mfma_f32_16x16x32_bf16 v[112:115], a[164:167], v[80:83], v[112:115]
    v_exp_f32 v160, v160
    v_mfma_f32_16x16x32_bf16 v[144:147], a[164:167], v[84:87], v[144:147]
    ds_read_b128 a[160:163], v5 offset:61440
    v_mfma_f32_16x16x32_bf16 v[192:195], a[164:167], v[88:91], v[192:195]
    v_exp_f32 v225, v225
    v_mfma_f32_16x16x32_bf16 v[96:99], a[164:167], v[92:95], v[96:99]
    s_waitcnt lgkmcnt(5)
    v_cvt_pk_bf16_f32 v168, v224, v225
    v_mfma_f32_16x16x32_bf16 v[112:115], a[168:171], v[132:135], v[112:115]
    v_exp_f32 v161, v161
    v_mfma_f32_16x16x32_bf16 v[144:147], a[168:171], v[140:143], v[144:147]
    v_exp_f32 v226, v226
    v_mfma_f32_16x16x32_bf16 v[192:195], a[168:171], v[148:151], v[192:195]
    ds_read_b128 a[164:167], v5 offset:62464
    v_cvt_pk_bf16_f32 v72, v160, v161
    v_mfma_f32_16x16x32_bf16 v[96:99], a[168:171], v[156:159], v[96:99]
    v_exp_f32 v162, v162
    v_mfma_f32_16x16x32_bf16 v[112:115], a[172:175], v[196:199], v[112:115]
    ds_read_b128 a[168:171], v5 offset:63488
    v_mfma_f32_16x16x32_bf16 v[144:147], a[172:175], v[204:207], v[144:147]
    v_exp_f32 v227, v227
    v_mfma_f32_16x16x32_bf16 v[192:195], a[172:175], v[212:215], v[192:195]
    v_exp_f32 v163, v163
    v_mfma_f32_16x16x32_bf16 v[96:99], a[172:175], v[220:223], v[96:99]
    s_waitcnt lgkmcnt(5)
    v_cvt_pk_bf16_f32 v169, v226, v227
    v_cvt_pk_bf16_f32 v73, v162, v163
    v_mfma_f32_16x16x32_bf16 a[0:3], a[144:147], v[136:139], a[0:3]
    v_exp_f32 v240, v240
    v_mfma_f32_16x16x32_bf16 a[4:7], a[144:147], v[152:155], a[4:7]
    ds_read_b128 a[172:175], v5 offset:64512
    v_mfma_f32_16x16x32_bf16 a[64:67], a[144:147], v[64:67], a[64:67]
    v_exp_f32 v176, v176
    v_mfma_f32_16x16x32_bf16 a[68:71], a[144:147], v[68:71], a[68:71]
    v_exp_f32 v241, v241
    v_mfma_f32_16x16x32_bf16 a[8:11], a[148:151], v[136:139], a[8:11]
    v_xor_b32 v5, 0x10000, v5
    v_cvt_pk_bf16_f32 v120, v240, v241
    v_mfma_f32_16x16x32_bf16 a[12:15], a[148:151], v[152:155], a[12:15]
    v_exp_f32 v177, v177
    v_mfma_f32_16x16x32_bf16 a[72:75], a[148:151], v[64:67], a[72:75]
    v_cvt_pk_bf16_f32 v76, v176, v177
    v_mfma_f32_16x16x32_bf16 a[76:79], a[148:151], v[68:71], a[76:79]
    s_waitcnt vmcnt(0) lgkmcnt(0)
    v_exp_f32 v242, v242
    v_mfma_f32_16x16x32_bf16 a[16:19], a[152:155], v[136:139], a[16:19]
    s_barrier
    v_mfma_f32_16x16x32_bf16 a[20:23], a[152:155], v[152:155], a[20:23]
    v_mfma_f32_16x16x32_bf16 a[80:83], a[152:155], v[64:67], a[80:83]
    s_cmp_eq_u32 s47, s48
    s_cbranch_scc1 A_evb
A_evrb:
    v_exp_f32 v178, v178
    ds_read_b128 a[144:147], v5 offset:0
    v_mfma_f32_16x16x32_bf16 a[84:87], a[152:155], v[68:71], a[84:87]
    v_exp_f32 v243, v243
    v_mfma_f32_16x16x32_bf16 a[24:27], a[156:159], v[136:139], a[24:27]
    v_exp_f32 v179, v179
    v_cvt_pk_bf16_f32 v121, v242, v243
    v_mfma_f32_16x16x32_bf16 a[28:31], a[156:159], v[152:155], a[28:31]
    v_exp_f32 v112, v112
    v_mfma_f32_16x16x32_bf16 a[88:91], a[156:159], v[64:67], a[88:91]
    ds_read_b128 a[148:151], v5 offset:1024
    ds_read_b128 a[152:155], v5 offset:2048
    v_mfma_f32_16x16x32_bf16 a[92:95], a[156:159], v[68:71], a[92:95]
    v_exp_f32 v192, v192
    v_mfma_f32_16x16x32_bf16 a[32:35], a[160:163], v[136:139], a[32:35]
    ds_read_b128 a[156:159], v5 offset:3072
    v_cvt_pk_bf16_f32 v77, v178, v179
    v_mfma_f32_16x16x32_bf16 a[36:39], a[160:163], v[152:155], a[36:39]
    v_exp_f32 v113, v113
    v_mfma_f32_16x16x32_bf16 a[96:99], a[160:163], v[64:67], a[96:99]
    v_exp_f32 v193, v193
    v_mfma_f32_16x16x32_bf16 a[100:103], a[160:163], v[68:71], a[100:103]
    v_cvt_pk_bf16_f32 v170, v112, v113
    v_cvt_pk_bf16_f32 v74, v192, v193
    v_mfma_f32_16x16x32_bf16 a[40:43], a[164:167], v[136:139], a[40:43]
    v_exp_f32 v114, v114
    v_mfma_f32_16x16x32_bf16 a[44:47], a[164:167], v[152:155], a[44:47]
    ds_read_b128 a[160:163], v5 offset:4096
    v_mfma_f32_16x16x32_bf16 a[104:107], a[164:167], v[64:67], a[104:107]
    v_exp_f32 v194, v194
    v_mfma_f32_16x16x32_bf16 a[108:111], a[164:167], v[68:71], a[108:111]
    v_exp_f32 v115, v115
    v_mfma_f32_16x16x32_bf16 a[48:51], a[168:171], v[136:139], a[48:51]
    ds_read_b128 a[164:167], v5 offset:5120
    ds_read_b128 a[180:183], v5 offset:8192
    v_cvt_pk_bf16_f32 v171, v114, v115
    v_mfma_f32_16x16x32_bf16 a[52:55], a[168:171], v[152:155], a[52:55]
    v_exp_f32 v195, v195
    v_mfma_f32_16x16x32_bf16 a[112:115], a[168:171], v[64:67], a[112:115]
    ds_read_b128 a[184:187], v5 offset:9216
    ds_read_b128 a[188:191], v5 offset:10240
    v_cvt_pk_bf16_f32 v75, v194, v195
    v_mfma_f32_16x16x32_bf16 a[116:119], a[168:171], v[68:71], a[116:119]
    v_exp_f32 v144, v144
    v_mfma_f32_16x16x32_bf16 a[56:59], a[172:175], v[136:139], a[56:59]
    v_exp_f32 v145, v145
    v_mfma_f32_16x16x32_bf16 a[60:63], a[172:175], v[152:155], a[60:63]
    ds_read_b128 a[192:195], v5 offset:11264
    ds_read_b128 a[196:199], v5 offset:12288
    v_cvt_pk_bf16_f32 v122, v144, v145
    v_mfma_f32_16x16x32_bf16 a[120:123], a[172:175], v[64:67], a[120:123]
    v_exp_f32 v146, v146
    v_mfma_f32_16x16x32_bf16 a[124:127], a[172:175], v[68:71], a[124:127]
    ds_read_b128 a[200:203], v5 offset:13312
    ds_read_b128 a[204:207], v5 offset:14336
    v_mfma_f32_16x16x32_bf16 a[128:131], a[176:179], v[136:139], a[128:131]
    v_exp_f32 v147, v147
    v_mfma_f32_16x16x32_bf16 a[132:135], a[176:179], v[152:155], a[132:135]
    ds_read_b128 a[208:211], v5 offset:15360
    v_cvt_pk_bf16_f32 v123, v146, v147
    v_mfma_f32_16x16x32_bf16 a[136:139], a[176:179], v[64:67], a[136:139]
    v_mfma_f32_16x16x32_bf16 a[140:143], a[176:179], v[68:71], a[140:143]
    s_waitcnt lgkmcnt(11)
    s_waitcnt lgkmcnt(6)
    v_mfma_f32_16x16x32_bf16 a[0:3], a[180:183], v[168:171], a[0:3]
    v_mfma_f32_16x16x32_bf16 a[4:7], a[180:183], v[120:123], a[4:7]
    v_mfma_f32_16x16x32_bf16 a[8:11], a[184:187], v[168:171], a[8:11]
    v_mfma_f32_16x16x32_bf16 a[12:15], a[184:187], v[120:123], a[12:15]
    s_waitcnt lgkmcnt(4)
    v_mfma_f32_16x16x32_bf16 a[16:19], a[188:191], v[168:171], a[16:19]
    v_mfma_f32_16x16x32_bf16 a[20:23], a[188:191], v[120:123], a[20:23]
    v_mfma_f32_16x16x32_bf16 a[24:27], a[192:195], v[168:171], a[24:27]
    v_mfma_f32_16x16x32_bf16 a[28:31], a[192:195], v[120:123], a[28:31]
    s_waitcnt lgkmcnt(2)
    v_mfma_f32_16x16x32_bf16 a[32:35], a[196:199], v[168:171], a[32:35]
    v_mfma_f32_16x16x32_bf16 a[36:39], a[196:199], v[120:123], a[36:39]
    v_mfma_f32_16x16x32_bf16 a[40:43], a[200:203], v[168:171], a[40:43]
    v_mfma_f32_16x16x32_bf16 a[44:47], a[200:203], v[120:123], a[44:47]
    s_waitcnt lgkmcnt(0)
    v_mfma_f32_16x16x32_bf16 a[48:51], a[204:207], v[168:171], a[48:51]
    v_mfma_f32_16x16x32_bf16 a[52:55], a[204:207], v[120:123], a[52:55]
    v_mfma_f32_16x16x32_bf16 a[56:59], a[208:211], v[168:171], a[56:59]
    v_mfma_f32_16x16x32_bf16 a[60:63], a[208:211], v[120:123], a[60:63]
    v_mfma_f32_16x16x32_bf16 a[128:131], a[176:179], v[168:171], a[128:131]
    v_mfma_f32_16x16x32_bf16 a[132:135], a[176:179], v[120:123], a[132:135]
    s_nop 6
    v_accvgpr_read_b32 v100, a128
    v_accvgpr_read_b32 v101, a132
    v_min_f32 v102, v100, v101
    v_add_f32 v103, v100, v101
    v_cmp_nle_f32 vcc, 0x2b800000, v102
    s_mov_b64 s[6:7], vcc
    v_cmp_nge_f32 vcc, 0x53800000, v103
    s_or_b64 s[6:7], vcc, s[6:7]
    s_cmp_lg_u64 s[6:7], 0
    s_cselect_b32 s56, 0, 1
    s_cbranch_scc1 A_nos
    v_rcp_f32 v108, v100
    v_rcp_f32 v110, v101
    s_add_u32 s44, s40, 0
    v_accvgpr_read_b32 v224, a0
    v_accvgpr_read_b32 v240, a8
    v_accvgpr_read_b32 v225, a1
    v_accvgpr_read_b32 v241, a9
    v_accvgpr_read_b32 v226, a2
    v_accvgpr_read_b32 v242, a10
    v_accvgpr_read_b32 v227, a3
    v_accvgpr_read_b32 v243, a11
    v_pk_mul_f32 v[224:225], v[224:225], v[108:109] op_sel_hi:[1,0]
    v_pk_mul_f32 v[226:227], v[226:227], v[108:109] op_sel_hi:[1,0]
    v_pk_mul_f32 v[240:241], v[240:241], v[108:109] op_sel_hi:[1,0]
    v_pk_mul_f32 v[242:243], v[242:243], v[108:109] op_sel_hi:[1,0]
    v_cvt_pk_bf16_f32 v224, v224, v225
    v_cvt_pk_bf16_f32 v225, v226, v227
    v_cvt_pk_bf16_f32 v226, v240, v241
    v_cvt_pk_bf16_f32 v227, v242, v243
    buffer_store_dwordx4 v[224:227], v1, s[8:11], s44 offen offset:0 sc1
    v_accvgpr_read_b32 v112, a4
    v_accvgpr_read_b32 v144, a12
    v_accvgpr_read_b32 v113, a5
    v_accvgpr_read_b32 v145, a13
    v_accvgpr_read_b32 v114, a6
    v_accvgpr_read_b32 v146, a14
    v_accvgpr_read_b32 v115, a7
    v_accvgpr_read_b32 v147, a15
    v_pk_mul_f32 v[112:113], v[112:113], v[110:111] op_sel_hi:[1,0]
    v_pk_mul_f32 v[114:115], v[114:115], v[110:111] op_sel_hi:[1,0]
    v_pk_mul_f32 v[144:145], v[144:145], v[110:111] op_sel_hi:[1,0]
    v_pk_mul_f32 v[146:147], v[146:147], v[110:111] op_sel_hi:[1,0]
    v_cvt_pk_bf16_f32 v112, v112, v113
    v_cvt_pk_bf16_f32 v113, v114, v115
    v_cvt_pk_bf16_f32 v114, v144, v145
    v_cvt_pk_bf16_f32 v115, v146, v147
    buffer_store_dwordx4 v[112:115], v1, s[8:11], s44 offen offset:1024 sc1
    s_add_u32 s44, s40, 4096
    v_accvgpr_read_b32 v136, a16
    v_accvgpr_read_b32 v152, a24
    v_accvgpr_read_b32 v137, a17
    v_accvgpr_read_b32 v153, a25
    v_accvgpr_read_b32 v138, a18
    v_accvgpr_read_b32 v154, a26
    v_accvgpr_read_b32 v139, a19
    v_accvgpr_read_b32 v155, a27
    v_pk_mul_f32 v[136:137], v[136:137], v[108:109] op_sel_hi:[1,0]
    v_pk_mul_f32 v[138:139], v[138:139], v[108:109] op_sel_hi:[1,0]
    v_pk_mul_f32 v[152:153], v[152:153], v[108:109] op_sel_hi:[1,0]
    v_pk_mul_f32 v[154:155], v[154:155], v[108:109] op_sel_hi:[1,0]
    v_cvt_pk_bf16_f32 v136, v136, v137
    v_cvt_pk_bf16_f32 v137, v138, v139
    v_cvt_pk_bf16_f32 v138, v152, v153
    v_cvt_pk_bf16_f32 v139, v154, v155
    buffer_store_dwordx4 v[136:139], v1, s[8:11], s44 offen offset:0 sc1
    v_accvgpr_read_b32 v168, a20
    v_accvgpr_read_b32 v120, a28
    v_accvgpr_read_b32 v169, a21
    v_accvgpr_read_b32 v121, a29
    v_accvgpr_read_b32 v170, a22
    v_accvgpr_read_b32 v122, a30
    v_accvgpr_read_b32 v171, a23
    v_accvgpr_read_b32 v123, a31
    v_pk_mul_f32 v[168:169], v[168:169], v[110:111] op_sel_hi:[1,0]
    v_pk_mul_f32 v[170:171], v[170:171], v[110:111] op_sel_hi:[1,0]
    v_pk_mul_f32 v[120:121], v[120:121], v[110:111] op_sel_hi:[1,0]
    v_pk_mul_f32 v[122:123], v[122:123], v[110:111] op_sel_hi:[1,0]
    v_cvt_pk_bf16_f32 v168, v168, v169
    v_cvt_pk_bf16_f32 v169, v170, v171
    v_cvt_pk_bf16_f32 v170, v120, v121
    v_cvt_pk_bf16_f32 v171, v122, v123
    buffer_store_dwordx4 v[168:171], v1, s[8:11], s44 offen offset:1024 sc1
    s_add_u32 s44, s40, 8192
    v_accvgpr_read_b32 v224, a32
    v_accvgpr_read_b32 v240, a40
    v_accvgpr_read_b32 v225, a33
    v_accvgpr_read_b32 v241, a41
    v_accvgpr_read_b32 v226, a34
    v_accvgpr_read_b32 v242, a42
    v_accvgpr_read_b32 v227, a35
    v_accvgpr_read_b32 v243, a43
    v_pk_mul_f32 v[224:225], v[224:225], v[108:109] op_sel_hi:[1,0]
    v_pk_mul_f32 v[226:227], v[226:227], v[108:109] op_sel_hi:[1,0]
    v_pk_mul_f32 v[240:241], v[240:241], v[108:109] op_sel_hi:[1,0]
    v_pk_mul_f32 v[242:243], v[242:243], v[108:109] op_sel_hi:[1,0]
    v_cvt_pk_bf16_f32 v224, v224, v225
    v_cvt_pk_bf16_f32 v225, v226, v227
    v_cvt_pk_bf16_f32 v226, v240, v241
    v_cvt_pk_bf16_f32 v227, v242, v243
    buffer_store_dwordx4 v[224:227], v1, s[8:11], s44 offen offset:0 sc1
    v_accvgpr_read_b32 v112, a36
    v_accvgpr_read_b32 v144, a44
    v_accvgpr_read_b32 v113, a37
    v_accvgpr_read_b32 v145, a45
    v_accvgpr_read_b32 v114, a38
    v_accvgpr_read_b32 v146, a46
    v_accvgpr_read_b32 v115, a39
    v_accvgpr_read_b32 v147, a47
    v_pk_mul_f32 v[112:113], v[112:113], v[110:111] op_sel_hi:[1,0]
    v_pk_mul_f32 v[114:115], v[114:115], v[110:111] op_sel_hi:[1,0]
    v_pk_mul_f32 v[144:145], v[144:145], v[110:111] op_sel_hi:[1,0]
    v_pk_mul_f32 v[146:147], v[146:147], v[110:111] op_sel_hi:[1,0]
    v_cvt_pk_bf16_f32 v112, v112, v113
    v_cvt_pk_bf16_f32 v113, v114, v115
    v_cvt_pk_bf16_f32 v114, v144, v145
    v_cvt_pk_bf16_f32 v115, v146, v147
    buffer_store_dwordx4 v[112:115], v1, s[8:11], s44 offen offset:1024 sc1
    s_add_u32 s44, s40, 12288
    v_accvgpr_read_b32 v136, a48
    v_accvgpr_read_b32 v152, a56
    v_accvgpr_read_b32 v137, a49
    v_accvgpr_read_b32 v153, a57
    v_accvgpr_read_b32 v138, a50
    v_accvgpr_read_b32 v154, a58
    v_accvgpr_read_b32 v139, a51
    v_accvgpr_read_b32 v155, a59
    v_pk_mul_f32 v[136:137], v[136:137], v[108:109] op_sel_hi:[1,0]
    v_pk_mul_f32 v[138:139], v[138:139], v[108:109] op_sel_hi:[1,0]
    v_pk_mul_f32 v[152:153], v[152:153], v[108:109] op_sel_hi:[1,0]
    v_pk_mul_f32 v[154:155], v[154:155], v[108:109] op_sel_hi:[1,0]
    v_cvt_pk_bf16_f32 v136, v136, v137
    v_cvt_pk_bf16_f32 v137, v138, v139
    v_cvt_pk_bf16_f32 v138, v152, v153
    v_cvt_pk_bf16_f32 v139, v154, v155
    buffer_store_dwordx4 v[136:139], v1, s[8:11], s44 offen offset:0 sc1
    v_accvgpr_read_b32 v168, a52
    v_accvgpr_read_b32 v120, a60
    v_accvgpr_read_b32 v169, a53
    v_accvgpr_read_b32 v121, a61
    v_accvgpr_read_b32 v170, a54
    v_accvgpr_read_b32 v122, a62
    v_accvgpr_read_b32 v171, a55
    v_accvgpr_read_b32 v123, a63
    v_pk_mul_f32 v[168:169], v[168:169], v[110:111] op_sel_hi:[1,0]
    v_pk_mul_f32 v[170:171], v[170:171], v[110:111] op_sel_hi:[1,0]
    v_pk_mul_f32 v[120:121], v[120:121], v[110:111] op_sel_hi:[1,0]
    v_pk_mul_f32 v[122:123], v[122:123], v[110:111] op_sel_hi:[1,0]
    v_cvt_pk_bf16_f32 v168, v168, v169
    v_cvt_pk_bf16_f32 v169, v170, v171
    v_cvt_pk_bf16_f32 v170, v120, v121
    v_cvt_pk_bf16_f32 v171, v122, v123
    buffer_store_dwordx4 v[168:171], v1, s[8:11], s44 offen offset:1024 sc1
A_nos:
    v_mov_b32 v15, s56
    s_mov_b32 s51, 0
    s_sub_u32 s45, 7, s5
    s_cmp_eq_u32 s45, 0
    s_cbranch_scc1 A_fix
    .p2align 3
A_G0:
    v_mfma_f32_16x16x32_bf16 v[160:163], a[144:147], v[56:59], 0
    s_add_u32 m0, s49, 0
    v_exp_f32 v96, v96
    v_mfma_f32_16x16x32_bf16 v[176:179], a[144:147], v[60:63], 0
    s_add_u32 s44, s48, 0
    ds_read_b128 a[168:171], v5 offset:6144
    ds_read_b128 a[172:175], v5 offset:7168
    v_mfma_f32_16x16x32_bf16 v[160:163], a[148:151], v[88:91], v[160:163]
    v_exp_f32 v97, v97
    v_mfma_f32_16x16x32_bf16 v[176:179], a[148:151], v[92:95], v[176:179]
    s_waitcnt lgkmcnt(4)
    ds_read_b128 a[144:147], v5 offset:8192
    v_cvt_pk_bf16_f32 v78, v96, v97
    v_mfma_f32_16x16x32_bf16 v[160:163], a[152:155], v[148:151], v[160:163]
    v_exp_f32 v98, v98
    v_mfma_f32_16x16x32_bf16 v[176:179], a[152:155], v[156:159], v[176:179]
    v_exp_f32 v99, v99
    v_mfma_f32_16x16x32_bf16 v[160:163], a[156:159], v[212:215], v[160:163]
    ds_read_b128 a[148:151], v5 offset:9216
    buffer_load_dwordx4 v1, s[8:11], s44 offen sc1 lds
    v_mfma_f32_16x16x32_bf16 v[176:179], a[156:159], v[220:223], v[176:179]
    s_waitcnt lgkmcnt(4)
    ds_read_b128 a[152:155], v5 offset:10240
    v_cvt_pk_bf16_f32 v79, v98, v99
    v_mfma_f32_16x16x32_bf16 v[192:195], a[160:163], v[56:59], 0
    ds_read_b128 a[156:159], v5 offset:11264
    v_mfma_f32_16x16x32_bf16 v[96:99], a[160:163], v[60:63], 0
    v_mfma_f32_16x16x32_bf16 v[192:195], a[164:167], v[88:91], v[192:195]
    ds_read_b128 a[160:163], v5 offset:12288
    buffer_load_dwordx4 v1, s[8:11], s44 offen offset:1024 sc1 lds
    v_mfma_f32_16x16x32_bf16 v[96:99], a[164:167], v[92:95], v[96:99]
    s_waitcnt lgkmcnt(5)
    v_exp_f32 v160, v160
    v_mfma_f32_16x16x32_bf16 v[192:195], a[168:171], v[148:151], v[192:195]
    v_exp_f32 v161, v161
    v_mfma_f32_16x16x32_bf16 v[96:99], a[168:171], v[156:159], v[96:99]
    ds_read_b128 a[164:167], v5 offset:13312
    v_cvt_pk_bf16_f32 v64, v160, v161
    v_mfma_f32_16x16x32_bf16 v[192:195], a[172:175], v[212:215], v[192:195]
    v_exp_f32 v162, v162
    v_mfma_f32_16x16x32_bf16 v[96:99], a[172:175], v[220:223], v[96:99]
    s_waitcnt lgkmcnt(4)
    ds_read_b128 a[168:171], v5 offset:14336
    buffer_load_dwordx4 v1, s[8:11], s44 offen offset:2048 sc1 lds
    v_mfma_f32_16x16x32_bf16 a[64:67], a[144:147], v[72:75], a[64:67]
    v_exp_f32 v163, v163
    v_mfma_f32_16x16x32_bf16 a[68:71], a[144:147], v[76:79], a[68:71]
    ds_read_b128 a[172:175], v5 offset:15360
    v_cvt_pk_bf16_f32 v65, v162, v163
    v_mfma_f32_16x16x32_bf16 a[72:75], a[148:151], v[72:75], a[72:75]
    v_exp_f32 v176, v176
    v_mfma_f32_16x16x32_bf16 a[76:79], a[148:151], v[76:79], a[76:79]
    s_waitcnt lgkmcnt(4)
    v_exp_f32 v177, v177
    v_mfma_f32_16x16x32_bf16 a[80:83], a[152:155], v[72:75], a[80:83]
    ds_read_b128 a[144:147], v5 offset:16384
    ds_read_b128 a[148:151], v5 offset:17408
    v_mfma_f32_16x16x32_bf16 a[84:87], a[152:155], v[76:79], a[84:87]
    v_cvt_pk_bf16_f32 v68, v176, v177
    buffer_load_dwordx4 v1, s[8:11], s44 offen offset:3072 sc1 lds
    v_mfma_f32_16x16x32_bf16 a[88:91], a[156:159], v[72:75], a[88:91]
    s_add_u32 m0, s49, 4096
    v_exp_f32 v178, v178
    v_mfma_f32_16x16x32_bf16 a[92:95], a[156:159], v[76:79], a[92:95]
    s_waitcnt lgkmcnt(4)
    v_exp_f32 v179, v179
    v_mfma_f32_16x16x32_bf16 a[96:99], a[160:163], v[72:75], a[96:99]
    s_add_u32 s44, s48, 4096
    ds_read_b128 a[152:155], v5 offset:18432
    ds_read_b128 a[156:159], v5 offset:19456
    v_mfma_f32_16x16x32_bf16 a[100:103], a[160:163], v[76:79], a[100:103]
    v_cvt_pk_bf16_f32 v69, v178, v179
    buffer_load_dwordx4 v1, s[8:11], s44 offen sc1 lds
    v_mfma_f32_16x16x32_bf16 a[104:107], a[164:167], v[72:75], a[104:107]
    v_exp_f32 v192, v192
    v_mfma_f32_16x16x32_bf16 a[108:111], a[164:167], v[76:79], a[108:111]
    s_waitcnt lgkmcnt(4)
    v_exp_f32 v193, v193
    v_mfma_f32_16x16x32_bf16 a[112:115], a[168:171], v[72:75], a[112:115]
    v_exp_f32 v194, v194
    v_mfma_f32_16x16x32_bf16 a[116:119], a[168:171], v[76:79], a[116:119]
    ds_read_b128 a[160:163], v5 offset:20480
    buffer_load_dwordx4 v1, s[8:11], s44 offen offset:1024 sc1 lds
    v_mfma_f32_16x16x32_bf16 a[120:123], a[172:175], v[72:75], a[120:123]
    v_exp_f32 v195, v195
    v_mfma_f32_16x16x32_bf16 a[124:127], a[172:175], v[76:79], a[124:127]
    ds_read_b128 a[164:167], v5 offset:21504
    v_cvt_pk_bf16_f32 v66, v192, v193
    v_mfma_f32_16x16x32_bf16 a[136:139], a[176:179], v[72:75], a[136:139]
    v_cvt_pk_bf16_f32 v67, v194, v195
    v_mfma_f32_16x16x32_bf16 a[140:143], a[176:179], v[76:79], a[140:143]
    s_waitcnt lgkmcnt(3)
    buffer_load_dwordx4 v1, s[8:11], s44 offen offset:2048 sc1 lds
    v_mfma_f32_16x16x32_bf16 v[160:163], a[144:147], v[56:59], 0
    v_exp_f32 v96, v96
    v_mfma_f32_16x16x32_bf16 v[176:179], a[144:147], v[60:63], 0
    ds_read_b128 a[168:171], v5 offset:22528
    ds_read_b128 a[172:175], v5 offset:23552
    v_mfma_f32_16x16x32_bf16 v[160:163], a[148:151], v[88:91], v[160:163]
    v_exp_f32 v97, v97
    v_mfma_f32_16x16x32_bf16 v[176:179], a[148:151], v[92:95], v[176:179]
    s_waitcnt lgkmcnt(4)
    ds_read_b128 a[144:147], v5 offset:24576
    v_cvt_pk_bf16_f32 v70, v96, v97
    v_mfma_f32_16x16x32_bf16 v[160:163], a[152:155], v[148:151], v[160:163]
    v_exp_f32 v98, v98
    v_mfma_f32_16x16x32_bf16 v[176:179], a[152:155], v[156:159], v[176:179]
    v_exp_f32 v99, v99
    v_mfma_f32_16x16x32_bf16 v[160:163], a[156:159], v[212:215], v[160:163]
    ds_read_b128 a[148:151], v5 offset:25600
    buffer_load_dwordx4 v1, s[8:11], s44 offen offset:3072 sc1 lds
    v_mfma_f32_16x16x32_bf16 v[176:179], a[156:159], v[220:223], v[176:179]
    s_waitcnt lgkmcnt(4)
    ds_read_b128 a[152:155], v5 offset:26624
    v_cvt_pk_bf16_f32 v71, v98, v99
    v_mfma_f32_16x16x32_bf16 v[192:195], a[160:163], v[56:59], 0
    s_add_u32 m0, s49, 8192
    ds_read_b128 a[156:159], v5 offset:27648
    v_mfma_f32_16x16x32_bf16 v[96:99], a[160:163], v[60:63], 0
    s_add_u32 s44, s48, 8192
    v_mfma_f32_16x16x32_bf16 v[192:195], a[164:167], v[88:91], v[192:195]
    ds_read_b128 a[160:163], v5 offset:28672
    buffer_load_dwordx4 v1, s[8:11], s44 offen sc1 lds
    v_mfma_f32_16x16x32_bf16 v[96:99], a[164:167], v[92:95], v[96:99]
    s_waitcnt lgkmcnt(5)
    v_exp_f32 v160, v160
    v_mfma_f32_16x16x32_bf16 v[192:195], a[168:171], v[148:151], v[192:195]
    v_exp_f32 v161, v161
    v_mfma_f32_16x16x32_bf16 v[96:99], a[168:171], v[156:159], v[96:99]
    ds_read_b128 a[164:167], v5 offset:29696
    v_cvt_pk_bf16_f32 v72, v160, v161
    v_mfma_f32_16x16x32_bf16 v[192:195], a[172:175], v[212:215], v[192:195]
    v_exp_f32 v162, v162
    v_mfma_f32_16x16x32_bf16 v[96:99], a[172:175], v[220:223], v[96:99]
    s_waitcnt lgkmcnt(4)
    ds_read_b128 a[168:171], v5 offset:30720
    buffer_load_dwordx4 v1, s[8:11], s44 offen offset:1024 sc1 lds
    v_mfma_f32_16x16x32_bf16 a[64:67], a[144:147], v[64:67], a[64:67]
    v_exp_f32 v163, v163
    v_mfma_f32_16x16x32_bf16 a[68:71], a[144:147], v[68:71], a[68:71]
    ds_read_b128 a[172:175], v5 offset:31744
    v_cvt_pk_bf16_f32 v73, v162, v163
    v_mfma_f32_16x16x32_bf16 a[72:75], a[148:151], v[64:67], a[72:75]
    v_exp_f32 v176, v176
    v_mfma_f32_16x16x32_bf16 a[76:79], a[148:151], v[68:71], a[76:79]
    s_waitcnt lgkmcnt(4)
    v_exp_f32 v177, v177
    v_mfma_f32_16x16x32_bf16 a[80:83], a[152:155], v[64:67], a[80:83]
    ds_read_b128 a[144:147], v5 offset:32768
    ds_read_b128 a[148:151], v5 offset:33792
    v_mfma_f32_16x16x32_bf16 a[84:87], a[152:155], v[68:71], a[84:87]
    v_cvt_pk_bf16_f32 v76, v176, v177
    buffer_load_dwordx4 v1, s[8:11], s44 offen offset:2048 sc1 lds
    v_mfma_f32_16x16x32_bf16 a[88:91], a[156:159], v[64:67], a[88:91]
    v_exp_f32 v178, v178
    v_mfma_f32_16x16x32_bf16 a[92:95], a[156:159], v[68:71], a[92:95]
    s_waitcnt lgkmcnt(4)
    v_exp_f32 v179, v179
    v_mfma_f32_16x16x32_bf16 a[96:99], a[160:163], v[64:67], a[96:99]
    ds_read_b128 a[152:155], v5 offset:34816
    ds_read_b128 a[156:159], v5 offset:35840
    v_mfma_f32_16x16x32_bf16 a[100:103], a[160:163], v[68:71], a[100:103]
    v_cvt_pk_bf16_f32 v77, v178, v179
    buffer_load_dwordx4 v1, s[8:11], s44 offen offset:3072 sc1 lds
    v_mfma_f32_16x16x32_bf16 a[104:107], a[164:167], v[64:67], a[104:107]
    s_add_u32 m0, s49, 12288
    v_exp_f32 v192, v192
    v_mfma_f32_16x16x32_bf16 a[108:111], a[164:167], v[68:71], a[108:111]
    s_waitcnt lgkmcnt(4)
    v_exp_f32 v193, v193
    v_mfma_f32_16x16x32_bf16 a[112:115], a[168:171], v[64:67], a[112:115]
    s_add_u32 s44, s48, 12288
    v_exp_f32 v194, v194
    v_mfma_f32_16x16x32_bf16 a[116:119], a[168:171], v[68:71], a[116:119]
    ds_read_b128 a[160:163], v5 offset:36864
    buffer_load_dwordx4 v1, s[8:11], s44 offen sc1 lds
    v_mfma_f32_16x16x32_bf16 a[120:123], a[172:175], v[64:67], a[120:123]
    s_add_u32 s48, s48, 0x10000
    v_exp_f32 v195, v195
    v_mfma_f32_16x16x32_bf16 a[124:127], a[172:175], v[68:71], a[124:127]
    s_xor_b32 s49, s49, 0x10000
    ds_read_b128 a[164:167], v5 offset:37888
    v_cvt_pk_bf16_f32 v74, v192, v193
    v_mfma_f32_16x16x32_bf16 a[136:139], a[176:179], v[64:67], a[136:139]
    v_cvt_pk_bf16_f32 v75, v194, v195
    v_mfma_f32_16x16x32_bf16 a[140:143], a[176:179], v[68:71], a[140:143]
    s_waitcnt lgkmcnt(3)
    buffer_load_dwordx4 v1, s[8:11], s44 offen offset:1024 sc1 lds
    v_mfma_f32_16x16x32_bf16 v[160:163], a[144:147], v[56:59], 0
    v_exp_f32 v96, v96
    v_mfma_f32_16x16x32_bf16 v[176:179], a[144:147], v[60:63], 0
    ds_read_b128 a[168:171], v5 offset:38912
    ds_read_b128 a[172:175], v5 offset:39936
    v_mfma_f32_16x16x32_bf16 v[160:163], a[148:151], v[88:91], v[160:163]
    v_exp_f32 v97, v97
    v_mfma_f32_16x16x32_bf16 v[176:179], a[148:151], v[92:95], v[176:179]
    s_waitcnt lgkmcnt(4)
    ds_read_b128 a[144:147], v5 offset:40960
    v_cvt_pk_bf16_f32 v78, v96, v97
    v_mfma_f32_16x16x32_bf16 v[160:163], a[152:155], v[148:151], v[160:163]
    v_exp_f32 v98, v98
    v_mfma_f32_16x16x32_bf16 v[176:179], a[152:155], v[156:159], v[176:179]
    v_exp_f32 v99, v99
    v_mfma_f32_16x16x32_bf16 v[160:163], a[156:159], v[212:215], v[160:163]
    ds_read_b128 a[148:151], v5 offset:41984
    buffer_load_dwordx4 v1, s[8:11], s44 offen offset:2048 sc1 lds
    v_mfma_f32_16x16x32_bf16 v[176:179], a[156:159], v[220:223], v[176:179]
    s_waitcnt lgkmcnt(4)
    ds_read_b128 a[152:155], v5 offset:43008
    v_cvt_pk_bf16_f32 v79, v98, v99
    v_mfma_f32_16x16x32_bf16 v[192:195], a[160:163], v[56:59], 0
    ds_read_b128 a[156:159], v5 offset:44032
    v_mfma_f32_16x16x32_bf16 v[96:99], a[160:163], v[60:63], 0
    v_mfma_f32_16x16x32_bf16 v[192:195], a[164:167], v[88:91], v[192:195]
    ds_read_b128 a[160:163], v5 offset:45056
    buffer_load_dwordx4 v1, s[8:11], s44 offen offset:3072 sc1 lds
    v_mfma_f32_16x16x32_bf16 v[96:99], a[164:167], v[92:95], v[96:99]
    s_waitcnt lgkmcnt(5)
    v_exp_f32 v160, v160
    v_mfma_f32_16x16x32_bf16 v[192:195], a[168:171], v[148:151], v[192:195]
    v_exp_f32 v161, v161
    v_mfma_f32_16x16x32_bf16 v[96:99], a[168:171], v[156:159], v[96:99]
    ds_read_b128 a[164:167], v5 offset:46080
    v_cvt_pk_bf16_f32 v64, v160, v161
    v_mfma_f32_16x16x32_bf16 v[192:195], a[172:175], v[212:215], v[192:195]
    v_exp_f32 v162, v162
    v_mfma_f32_16x16x32_bf16 v[96:99], a[172:175], v[220:223], v[96:99]
    s_waitcnt lgkmcnt(4)
    ds_read_b128 a[168:171], v5 offset:47104
    v_mfma_f32_16x16x32_bf16 a[64:67], a[144:147], v[72:75], a[64:67]
    v_exp_f32 v163, v163
    v_mfma_f32_16x16x32_bf16 a[68:71], a[144:147], v[76:79], a[68:71]
    ds_read_b128 a[172:175], v5 offset:48128
    v_cvt_pk_bf16_f32 v65, v162, v163
    v_mfma_f32_16x16x32_bf16 a[72:75], a[148:151], v[72:75], a[72:75]
    v_exp_f32 v176, v176
    v_mfma_f32_16x16x32_bf16 a[76:79], a[148:151], v[76:79], a[76:79]
    s_waitcnt lgkmcnt(4)
    v_exp_f32 v177, v177
    v_mfma_f32_16x16x32_bf16 a[80:83], a[152:155], v[72:75], a[80:83]
    ds_read_b128 a[144:147], v5 offset:49152
    ds_read_b128 a[148:151], v5 offset:50176
    v_mfma_f32_16x16x32_bf16 a[84:87], a[152:155], v[76:79], a[84:87]
    v_exp_f32 v178, v178
    v_mfma_f32_16x16x32_bf16 a[88:91], a[156:159], v[72:75], a[88:91]
    ds_read_b128 a[152:155], v5 offset:51200
    v_cvt_pk_bf16_f32 v68, v176, v177
    v_mfma_f32_16x16x32_bf16 a[92:95], a[156:159], v[76:79], a[92:95]
    s_waitcnt lgkmcnt(5)
    v_exp_f32 v179, v179
    v_mfma_f32_16x16x32_bf16 a[96:99], a[160:163], v[72:75], a[96:99]
    ds_read_b128 a[156:159], v5 offset:52224
    v_cvt_pk_bf16_f32 v69, v178, v179
    v_mfma_f32_16x16x32_bf16 a[100:103], a[160:163], v[76:79], a[100:103]
    v_exp_f32 v192, v192
    v_mfma_f32_16x16x32_bf16 a[104:107], a[164:167], v[72:75], a[104:107]
    v_exp_f32 v193, v193
    v_mfma_f32_16x16x32_bf16 a[108:111], a[164:167], v[76:79], a[108:111]
    s_waitcnt lgkmcnt(4)
    ds_read_b128 a[160:163], v5 offset:53248
    v_cvt_pk_bf16_f32 v66, v192, v193
    v_mfma_f32_16x16x32_bf16 a[112:115], a[168:171], v[72:75], a[112:115]
    v_exp_f32 v194, v194
    v_mfma_f32_16x16x32_bf16 a[116:119], a[168:171], v[76:79], a[116:119]
    ds_read_b128 a[164:167], v5 offset:54272
    v_mfma_f32_16x16x32_bf16 a[120:123], a[172:175], v[72:75], a[120:123]
    v_exp_f32 v195, v195
    v_mfma_f32_16x16x32_bf16 a[124:127], a[172:175], v[76:79], a[124:127]
    v_cvt_pk_bf16_f32 v67, v194, v195
    v_mfma_f32_16x16x32_bf16 a[136:139], a[176:179], v[72:75], a[136:139]
    v_mfma_f32_16x16x32_bf16 a[140:143], a[176:179], v[76:79], a[140:143]
    s_waitcnt lgkmcnt(3)
    v_mfma_f32_16x16x32_bf16 v[160:163], a[144:147], v[56:59], 0
    v_exp_f32 v96, v96
    v_mfma_f32_16x16x32_bf16 v[176:179], a[144:147], v[60:63], 0
    ds_read_b128 a[168:171], v5 offset:55296
    ds_read_b128 a[172:175], v5 offset:56320
    v_mfma_f32_16x16x32_bf16 v[160:163], a[148:151], v[88:91], v[160:163]
    v_exp_f32 v97, v97
    v_mfma_f32_16x16x32_bf16 v[176:179], a[148:151], v[92:95], v[176:179]
    s_waitcnt lgkmcnt(4)
    ds_read_b128 a[144:147], v5 offset:57344
    v_cvt_pk_bf16_f32 v70, v96, v97
    v_mfma_f32_16x16x32_bf16 v[160:163], a[152:155], v[148:151], v[160:163]
    v_exp_f32 v98, v98
    v_mfma_f32_16x16x32_bf16 v[176:179], a[152:155], v[156:159], v[176:179]
    v_exp_f32 v99, v99
    v_mfma_f32_16x16x32_bf16 v[160:163], a[156:159], v[212:215], v[160:163]
    ds_read_b128 a[148:151], v5 offset:58368
    ds_read_b128 a[152:155], v5 offset:59392
    v_mfma_f32_16x16x32_bf16 v[176:179], a[156:159], v[220:223], v[176:179]
    s_waitcnt lgkmcnt(5)
    v_cvt_pk_bf16_f32 v71, v98, v99
    v_mfma_f32_16x16x32_bf16 v[192:195], a[160:163], v[56:59], 0
    ds_read_b128 a[156:159], v5 offset:60416
    v_mfma_f32_16x16x32_bf16 v[96:99], a[160:163], v[60:63], 0
    v_mfma_f32_16x16x32_bf16 v[192:195], a[164:167], v[88:91], v[192:195]
    ds_read_b128 a[160:163], v5 offset:61440
    v_mfma_f32_16x16x32_bf16 v[96:99], a[164:167], v[92:95], v[96:99]
    s_waitcnt lgkmcnt(5)
    v_exp_f32 v160, v160
    v_mfma_f32_16x16x32_bf16 v[192:195], a[168:171], v[148:151], v[192:195]
    v_exp_f32 v161, v161
    v_mfma_f32_16x16x32_bf16 v[96:99], a[168:171], v[156:159], v[96:99]
    ds_read_b128 a[164:167], v5 offset:62464
    v_cvt_pk_bf16_f32 v72, v160, v161
    v_mfma_f32_16x16x32_bf16 v[192:195], a[172:175], v[212:215], v[192:195]
    v_exp_f32 v162, v162
    v_mfma_f32_16x16x32_bf16 v[96:99], a[172:175], v[220:223], v[96:99]
    s_waitcnt lgkmcnt(4)
    ds_read_b128 a[168:171], v5 offset:63488
    ds_read_b128 a[172:175], v5 offset:64512
    v_mfma_f32_16x16x32_bf16 a[64:67], a[144:147], v[64:67], a[64:67]
    v_exp_f32 v163, v163
    v_mfma_f32_16x16x32_bf16 a[68:71], a[144:147], v[68:71], a[68:71]
    v_exp_f32 v176, v176
    v_mfma_f32_16x16x32_bf16 a[72:75], a[148:151], v[64:67], a[72:75]
    v_xor_b32 v5, 0x10000, v5
    v_cvt_pk_bf16_f32 v73, v162, v163
    v_mfma_f32_16x16x32_bf16 a[76:79], a[148:151], v[68:71], a[76:79]
    s_waitcnt vmcnt(0) lgkmcnt(0)
    v_exp_f32 v177, v177
    v_mfma_f32_16x16x32_bf16 a[80:83], a[152:155], v[64:67], a[80:83]
    s_barrier
    v_cvt_pk_bf16_f32 v76, v176, v177
    v_mfma_f32_16x16x32_bf16 a[84:87], a[152:155], v[68:71], a[84:87]
    v_exp_f32 v178, v178
    v_mfma_f32_16x16x32_bf16 a[88:91], a[156:159], v[64:67], a[88:91]
    s_cmp_eq_u32 s47, s48
    s_cbranch_scc1 A_evc
A_evrc:
    v_exp_f32 v179, v179
    ds_read_b128 a[144:147], v5 offset:0
    v_mfma_f32_16x16x32_bf16 a[92:95], a[156:159], v[68:71], a[92:95]
    ds_read_b128 a[148:151], v5 offset:1024
    ds_read_b128 a[152:155], v5 offset:2048
    v_mfma_f32_16x16x32_bf16 a[96:99], a[160:163], v[64:67], a[96:99]
    v_exp_f32 v192, v192
    v_mfma_f32_16x16x32_bf16 a[100:103], a[160:163], v[68:71], a[100:103]
    ds_read_b128 a[156:159], v5 offset:3072
    v_cvt_pk_bf16_f32 v77, v178, v179
    v_mfma_f32_16x16x32_bf16 a[104:107], a[164:167], v[64:67], a[104:107]
    v_exp_f32 v193, v193
    v_mfma_f32_16x16x32_bf16 a[108:111], a[164:167], v[68:71], a[108:111]
    v_exp_f32 v194, v194
    v_mfma_f32_16x16x32_bf16 a[112:115], a[168:171], v[64:67], a[112:115]
    ds_read_b128 a[160:163], v5 offset:4096
    ds_read_b128 a[164:167], v5 offset:5120
    v_mfma_f32_16x16x32_bf16 a[116:119], a[168:171], v[68:71], a[116:119]
    v_exp_f32 v195, v195
    v_mfma_f32_16x16x32_bf16 a[120:123], a[172:175], v[64:67], a[120:123]
    s_sub_u32 s45, s45, 1
    v_cvt_pk_bf16_f32 v74, v192, v193
    v_cvt_pk_bf16_f32 v75, v194, v195
    v_mfma_f32_16x16x32_bf16 a[124:127], a[172:175], v[68:71], a[124:127]
    s_cmp_lg_u32 s45, 0
    v_mfma_f32_16x16x32_bf16 a[136:139], a[176:179], v[64:67], a[136:139]
    s_waitcnt lgkmcnt(3)
    v_mfma_f32_16x16x32_bf16 a[140:143], a[176:179], v[68:71], a[140:143]
    s_cbranch_scc1 A_G0
    s_cmp_eq_u32 s51, 0
    s_cbranch_scc0 A_LD
A_fix:
    v_and_b32 v14, 8, v0
    v_and_b32 v2, 7, v0
    v_lshl_add_u32 v14, v14, 2, v2
    v_lshlrev_b32 v14, 7, v14
    v_add_u32 v2, s19, v1
    v_add_u32 v3, s18, v1
    v_mov_b32 v13, 0
    s_add_u32 s62, s15, 131072
    buffer_load_dwordx4 v[224:227], v1, s[8:11], s62 offen offset:0 sc1
    v_accvgpr_read_b32 v100, a240
    v_accvgpr_read_b32 v101, a241
    v_accvgpr_read_b32 v102, a244
    v_accvgpr_read_b32 v103, a245
    v_accvgpr_read_b32 v108, a248
    v_accvgpr_read_b32 v109, a249
    v_accvgpr_read_b32 v110, a250
    v_accvgpr_read_b32 v111, a251
    v_accvgpr_read_b32 v116, a246
    buffer_load_dwordx4 v[240:243], v1, s[8:11], s62 offen offset:1024 sc1
    v_accvgpr_read_b32 v117, a247
    ds_read_b64 v[124:125], v11
    ds_read_b64 v[126:127], v12
    v_mov_b32 v164, 0
    v_mov_b32 v165, 0
    v_mov_b32 v166, 0
    v_mov_b32 v167, 0
    s_cmp_eq_u32 s5, 1
    s_cselect_b64 s[6:7], -1, 0
    v_cndmask_b32 v164, v164, v188, s[6:7]
    v_cndmask_b32 v165, v165, v189, s[6:7]
    v_fma_f32 v190, v102, v188, v190
    s_add_u32 s62, s15, 135168
    buffer_load_dwordx4 v[112:115], v1, s[8:11], s62 offen offset:0 sc1
    v_fma_f32 v191, v102, v189, v191
    v_fma_f32 v190, -v103, v189, v190
    v_fma_f32 v191, v103, v188, v191
    s_cmp_eq_u32 s5, 2
    s_cselect_b64 s[6:7], -1, 0
    v_cndmask_b32 v164, v164, v190, s[6:7]
    v_cndmask_b32 v165, v165, v191, s[6:7]
    v_fma_f32 v228, v102, v190, v228
    v_fma_f32 v229, v102, v191, v229
    v_fma_f32 v228, -v103, v191, v228
    buffer_load_dwordx4 v[144:147], v1, s[8:11], s62 offen offset:1024 sc1
    v_fma_f32 v229, v103, v190, v229
    s_cmp_eq_u32 s5, 3
    s_cselect_b64 s[6:7], -1, 0
    v_cndmask_b32 v164, v164, v228, s[6:7]
    v_cndmask_b32 v165, v165, v229, s[6:7]
    v_fma_f32 v230, v102, v228, v230
    v_fma_f32 v231, v102, v229, v231
    v_fma_f32 v230, -v103, v229, v230
    v_fma_f32 v231, v103, v228, v231
    s_cmp_eq_u32 s5, 4
    s_cselect_b64 s[6:7], -1, 0
    v_cndmask_b32 v164, v164, v230, s[6:7]
    v_cndmask_b32 v165, v165, v231, s[6:7]
    s_add_u32 s62, s15, 139264
    buffer_load_dwordx4 v[136:139], v1, s[8:11], s62 offen offset:0 sc1
    v_fma_f32 v236, v102, v230, v236
    v_fma_f32 v237, v102, v231, v237
    v_fma_f32 v236, -v103, v231, v236
    v_fma_f32 v237, v103, v230, v237
    s_cmp_eq_u32 s5, 5
    s_cselect_b64 s[6:7], -1, 0
    v_cndmask_b32 v164, v164, v236, s[6:7]
    v_cndmask_b32 v165, v165, v237, s[6:7]
    v_fma_f32 v238, v102, v236, v238
    v_fma_f32 v239, v102, v237, v239
    buffer_load_dwordx4 v[152:155], v1, s[8:11], s62 offen offset:1024 sc1
    v_fma_f32 v238, -v103, v237, v238
    v_fma_f32 v239, v103, v236, v239
    s_cmp_eq_u32 s5, 6
    s_cselect_b64 s[6:7], -1, 0
    v_cndmask_b32 v164, v164, v238, s[6:7]
    v_cndmask_b32 v165, v165, v239, s[6:7]
    v_fma_f32 v244, v102, v238, v244
    v_fma_f32 v245, v102, v239, v245
    v_fma_f32 v244, -v103, v239, v244
    v_fma_f32 v245, v103, v238, v245
    s_cmp_eq_u32 s5, 7
    s_cselect_b64 s[6:7], -1, 0
    s_add_u32 s62, s15, 143360
    buffer_load_dwordx4 v[168:171], v1, s[8:11], s62 offen offset:0 sc1
    v_cndmask_b32 v164, v164, v244, s[6:7]
    v_cndmask_b32 v165, v165, v245, s[6:7]
    v_fma_f32 v246, v102, v244, v246
    v_fma_f32 v247, v102, v245, v247
    v_fma_f32 v246, -v103, v245, v246
    v_fma_f32 v247, v103, v244, v247
    s_cmp_eq_u32 s5, 7
    s_cselect_b64 s[6:7], -1, 0
    v_cndmask_b32 v166, v166, v246, s[6:7]
    v_cndmask_b32 v167, v167, v247, s[6:7]
    buffer_load_dwordx4 v[120:123], v1, s[8:11], s62 offen offset:1024 sc1
    v_fma_f32 v252, v102, v246, v252
    v_fma_f32 v253, v102, v247, v253
    v_fma_f32 v252, -v103, v247, v252
    v_fma_f32 v253, v103, v246, v253
    s_cmp_eq_u32 s5, 6
    s_cselect_b64 s[6:7], -1, 0
    v_cndmask_b32 v166, v166, v252, s[6:7]
    v_cndmask_b32 v167, v167, v253, s[6:7]
    v_fma_f32 v254, v102, v252, v254
    v_fma_f32 v255, v102, v253, v255
    v_fma_f32 v254, -v103, v253, v254
    s_add_u32 s62, s15, 147456
    buffer_load_dwordx4 v[128:131], v1, s[8:11], s62 offen offset:0 sc1
    v_fma_f32 v255, v103, v252, v255
    s_cmp_eq_u32 s5, 5
    s_cselect_b64 s[6:7], -1, 0
    v_cndmask_b32 v166, v166, v254, s[6:7]
    v_cndmask_b32 v167, v167, v255, s[6:7]
    v_fma_f32 v184, v102, v254, v184
    v_fma_f32 v185, v102, v255, v185
    v_fma_f32 v184, -v103, v255, v184
    v_fma_f32 v185, v103, v254, v185
    s_cmp_eq_u32 s5, 4
    s_cselect_b64 s[6:7], -1, 0
    v_cndmask_b32 v166, v166, v184, s[6:7]
    buffer_load_dwordx4 v[172:175], v1, s[8:11], s62 offen offset:1024 sc1
    v_cndmask_b32 v167, v167, v185, s[6:7]
    v_fma_f32 v186, v102, v184, v186
    v_fma_f32 v187, v102, v185, v187
    v_fma_f32 v186, -v103, v185, v186
    v_fma_f32 v187, v103, v184, v187
    s_cmp_eq_u32 s5, 3
    s_cselect_b64 s[6:7], -1, 0
    v_cndmask_b32 v166, v166, v186, s[6:7]
    v_cndmask_b32 v167, v167, v187, s[6:7]
    v_fma_f32 v104, v102, v186, v104
    s_add_u32 s62, s15, 0
    buffer_load_dwordx4 a[0:3], v1, s[8:11], s62 offen offset:0 sc1
    v_fma_f32 v105, v102, v187, v105
    v_fma_f32 v104, -v103, v187, v104
    v_fma_f32 v105, v103, v186, v105
    s_cmp_eq_u32 s5, 2
    s_cselect_b64 s[6:7], -1, 0
    v_cndmask_b32 v166, v166, v104, s[6:7]
    v_cndmask_b32 v167, v167, v105, s[6:7]
    v_fma_f32 v106, v102, v104, v106
    v_fma_f32 v107, v102, v105, v107
    v_fma_f32 v106, -v103, v105, v106
    v_fma_f32 v107, v103, v104, v107
    s_cmp_eq_u32 s5, 1
    s_cselect_b64 s[6:7], -1, 0
    buffer_load_dwordx4 a[4:7], v1, s[8:11], s62 offen offset:1024 sc1
    v_cndmask_b32 v166, v166, v106, s[6:7]
    v_cndmask_b32 v167, v167, v107, s[6:7]
    v_fma_f32 v208, v102, v106, v208
    v_fma_f32 v209, v102, v107, v209
    v_fma_f32 v208, -v103, v107, v208
    v_fma_f32 v209, v103, v106, v209
    s_cmp_eq_u32 s5, 0
    s_cselect_b64 s[6:7], -1, 0
    v_cndmask_b32 v166, v166, v208, s[6:7]
    v_cndmask_b32 v167, v167, v209, s[6:7]
    s_lshl_b32 s6, s3, 12
    s_add_u32 s6, s6, 139264
    s_add_u32 s62, s15, 4096
    buffer_load_dwordx4 a[8:11], v1, s[8:11], s62 offen offset:0 sc1
    v_and_b32 v118, 15, v0
    v_lshrrev_b32 v7, 4, v0
    v_lshlrev_b32 v118, 5, v118
    v_lshl_add_u32 v118, v7, 3, v118
    v_add_u32 v118, s6, v118
    v_and_b32 v119, 15, v0
    v_lshlrev_b32 v119, 3, v119
    v_lshl_add_u32 v119, v7, 8, v119
    buffer_load_dwordx4 a[12:15], v1, s[8:11], s62 offen offset:1024 sc1
    v_add_u32 v119, s6, v119
    v_lshrrev_b32 v7, 5, v0
    v_and_b32 v9, 31, v0
    v_lshlrev_b32 v9, 4, v9
    v_lshl_add_u32 v9, v7, 12, v9
    s_waitcnt lgkmcnt(0)
    v_fma_f32 v124, v108, v164, v124
    v_fma_f32 v125, v108, v165, v125
    v_fma_f32 v124, -v109, v165, v124
    s_add_u32 s62, s15, 8192
    buffer_load_dwordx4 a[16:19], v1, s[8:11], s62 offen offset:0 sc1
    v_fma_f32 v125, v109, v164, v125
    v_fma_f32 v126, v110, v166, v126
    v_fma_f32 v127, v110, v167, v127
    v_fma_f32 v126, -v111, v167, v126
    v_fma_f32 v127, v111, v166, v127
    v_fma_f32 v16, v100, v124, v16
    v_fma_f32 v32, v100, v125, v32
    v_fma_f32 v24, v100, v126, v24
    v_fma_f32 v40, v100, v127, v40
    buffer_load_dwordx4 a[20:23], v1, s[8:11], s62 offen offset:1024 sc1
    v_fma_f32 v16, -v101, v125, v16
    v_fma_f32 v32, v101, v124, v32
    v_fma_f32 v24, -v101, v127, v24
    v_fma_f32 v40, v101, v126, v40
    v_fma_f32 v17, v100, v16, v17
    v_fma_f32 v33, v100, v32, v33
    v_fma_f32 v25, v100, v24, v25
    v_fma_f32 v41, v100, v40, v41
    s_add_u32 s62, s15, 12288
    buffer_load_dwordx4 a[24:27], v1, s[8:11], s62 offen offset:0 sc1
    v_fma_f32 v17, -v101, v32, v17
    v_fma_f32 v33, v101, v16, v33
    v_fma_f32 v25, -v101, v40, v25
    v_fma_f32 v41, v101, v24, v41
    v_fma_f32 v18, v100, v17, v18
    v_fma_f32 v34, v100, v33, v34
    v_fma_f32 v26, v100, v25, v26
    v_fma_f32 v42, v100, v41, v42
    buffer_load_dwordx4 a[28:31], v1, s[8:11], s62 offen offset:1024 sc1
    v_fma_f32 v18, -v101, v33, v18
    v_fma_f32 v34, v101, v17, v34
    v_fma_f32 v26, -v101, v41, v26
    v_fma_f32 v42, v101, v25, v42
    v_fma_f32 v19, v100, v18, v19
    v_fma_f32 v35, v100, v34, v35
    v_fma_f32 v27, v100, v26, v27
    v_fma_f32 v43, v100, v42, v43
    v_fma_f32 v19, -v101, v34, v19
    s_add_u32 s62, s15, 16384
    buffer_load_dwordx4 a[32:35], v1, s[8:11], s62 offen offset:0 sc1
    v_fma_f32 v35, v101, v18, v35
    v_fma_f32 v27, -v101, v42, v27
    v_fma_f32 v43, v101, v26, v43
    v_fma_f32 v20, v100, v19, v20
    v_fma_f32 v36, v100, v35, v36
    v_fma_f32 v28, v100, v27, v28
    v_fma_f32 v44, v100, v43, v44
    v_fma_f32 v20, -v101, v35, v20
    buffer_load_dwordx4 a[36:39], v1, s[8:11], s62 offen offset:1024 sc1
    v_fma_f32 v36, v101, v19, v36
    v_fma_f32 v28, -v101, v43, v28
    v_fma_f32 v44, v101, v27, v44
    v_fma_f32 v21, v100, v20, v21
    v_fma_f32 v37, v100, v36, v37
    v_fma_f32 v29, v100, v28, v29
    v_fma_f32 v45, v100, v44, v45
    v_fma_f32 v21, -v101, v36, v21
    s_add_u32 s62, s15, 20480
    buffer_load_dwordx4 a[40:43], v1, s[8:11], s62 offen offset:0 sc1
    v_fma_f32 v37, v101, v20, v37
    v_fma_f32 v29, -v101, v44, v29
    v_fma_f32 v45, v101, v28, v45
    v_fma_f32 v22, v100, v21, v22
    v_fma_f32 v38, v100, v37, v38
    v_fma_f32 v30, v100, v29, v30
    v_fma_f32 v46, v100, v45, v46
    v_fma_f32 v22, -v101, v37, v22
    buffer_load_dwordx4 a[44:47], v1, s[8:11], s62 offen offset:1024 sc1
    v_fma_f32 v38, v101, v21, v38
    v_fma_f32 v30, -v101, v45, v30
    v_fma_f32 v46, v101, v29, v46
    v_fma_f32 v23, v100, v22, v23
    v_fma_f32 v39, v100, v38, v39
    v_fma_f32 v31, v100, v30, v31
    v_fma_f32 v47, v100, v46, v47
    v_fma_f32 v23, -v101, v38, v23
    v_fma_f32 v39, v101, v22, v39
    s_add_u32 s62, s15, 24576
    buffer_load_dwordx4 a[48:51], v1, s[8:11], s62 offen offset:0 sc1
    v_fma_f32 v31, -v101, v46, v31
    v_fma_f32 v47, v101, v30, v47
    v_mul_f32 v252, v116, v16
    v_mul_f32 v184, v116, v32
    v_mul_f32 v253, v116, v17
    v_mul_f32 v185, v116, v33
    v_mul_f32 v254, v116, v18
    v_mul_f32 v186, v116, v34
    buffer_load_dwordx4 a[52:55], v1, s[8:11], s62 offen offset:1024 sc1
    v_mul_f32 v255, v116, v19
    v_mul_f32 v187, v116, v35
    v_fma_f32 v252, -v117, v32, v252
    v_fma_f32 v184, -v117, v16, -v184
    v_fma_f32 v253, -v117, v33, v253
    v_fma_f32 v185, -v117, v17, -v185
    v_fma_f32 v254, -v117, v34, v254
    v_fma_f32 v186, -v117, v18, -v186
    s_add_u32 s62, s15, 28672
    buffer_load_dwordx4 a[56:59], v1, s[8:11], s62 offen offset:0 sc1
    v_fma_f32 v255, -v117, v35, v255
    v_fma_f32 v187, -v117, v19, -v187
    v_cvt_pk_bf16_f32 v252, v252, v253
    v_cvt_pk_bf16_f32 v253, v254, v255
    ds_write_b64 v118, v[252:253] offset:0
    v_cvt_pk_bf16_f32 v184, v184, v185
    v_cvt_pk_bf16_f32 v185, v186, v187
    ds_write_b64 v118, v[184:185] offset:512
    v_mul_f32 v104, v116, v20
    v_mul_f32 v208, v116, v36
    v_mul_f32 v105, v116, v21
    buffer_load_dwordx4 a[60:63], v1, s[8:11], s62 offen offset:1024 sc1
    v_mul_f32 v209, v116, v37
    v_mul_f32 v106, v116, v22
    v_mul_f32 v210, v116, v38
    v_mul_f32 v107, v116, v23
    v_mul_f32 v211, v116, v39
    v_fma_f32 v104, -v117, v36, v104
    v_fma_f32 v208, -v117, v20, -v208
    v_fma_f32 v105, -v117, v37, v105
    s_add_u32 s62, s15, 32768
    buffer_load_dwordx4 a[128:131], v1, s[8:11], s62 offen offset:0 sc1
    v_fma_f32 v209, -v117, v21, -v209
    v_fma_f32 v106, -v117, v38, v106
    v_fma_f32 v210, -v117, v22, -v210
    v_fma_f32 v107, -v117, v39, v107
    v_fma_f32 v211, -v117, v23, -v211
    v_cvt_pk_bf16_f32 v104, v104, v105
    v_cvt_pk_bf16_f32 v105, v106, v107
    ds_write_b64 v118, v[104:105] offset:1024
    v_cvt_pk_bf16_f32 v208, v208, v209
    buffer_load_dwordx4 a[132:135], v1, s[8:11], s62 offen offset:1024 sc1
    v_cvt_pk_bf16_f32 v209, v210, v211
    ds_write_b64 v118, v[208:209] offset:1536
    v_mul_f32 v252, v116, v24
    v_mul_f32 v184, v116, v40
    v_mul_f32 v253, v116, v25
    v_mul_f32 v185, v116, v41
    v_mul_f32 v254, v116, v26
    v_mul_f32 v186, v116, v42
    v_mul_f32 v255, v116, v27
    s_add_u32 s62, s15, 36864
    buffer_load_dwordx4 a[212:215], v1, s[8:11], s62 offen offset:0 sc1
    v_mul_f32 v187, v116, v43
    v_fma_f32 v252, -v117, v40, v252
    v_fma_f32 v184, -v117, v24, -v184
    v_fma_f32 v253, -v117, v41, v253
    v_fma_f32 v185, -v117, v25, -v185
    v_fma_f32 v254, -v117, v42, v254
    v_fma_f32 v186, -v117, v26, -v186
    v_fma_f32 v255, -v117, v43, v255
    v_fma_f32 v187, -v117, v27, -v187
    buffer_load_dwordx4 a[216:219], v1, s[8:11], s62 offen offset:1024 sc1
    v_cvt_pk_bf16_f32 v252, v252, v253
    v_cvt_pk_bf16_f32 v253, v254, v255
    ds_write_b64 v118, v[252:253] offset:2048
    v_cvt_pk_bf16_f32 v184, v184, v185
    v_cvt_pk_bf16_f32 v185, v186, v187
    ds_write_b64 v118, v[184:185] offset:2560
    v_mul_f32 v104, v116, v28
    v_mul_f32 v208, v116, v44
    v_mul_f32 v105, v116, v29
    v_mul_f32 v209, v116, v45
    s_add_u32 s62, s15, 40960
    buffer_load_dwordx4 a[220:223], v1, s[8:11], s62 offen offset:0 sc1
    v_mul_f32 v106, v116, v30
    v_mul_f32 v210, v116, v46
    v_mul_f32 v107, v116, v31
    v_mul_f32 v211, v116, v47
    v_fma_f32 v104, -v117, v44, v104
    v_fma_f32 v208, -v117, v28, -v208
    v_fma_f32 v105, -v117, v45, v105
    v_fma_f32 v209, -v117, v29, -v209
    buffer_load_dwordx4 a[252:255], v1, s[8:11], s62 offen offset:1024 sc1
    v_fma_f32 v106, -v117, v46, v106
    v_fma_f32 v210, -v117, v30, -v210
    v_fma_f32 v107, -v117, v47, v107
    v_fma_f32 v211, -v117, v31, -v211
    v_cvt_pk_bf16_f32 v104, v104, v105
    v_cvt_pk_bf16_f32 v105, v106, v107
    ds_write_b64 v118, v[104:105] offset:3072
    v_cvt_pk_bf16_f32 v208, v208, v209
    v_cvt_pk_bf16_f32 v209, v210, v211
    ds_write_b64 v118, v[208:209] offset:3584
    s_and_b32 s6, s4, 6
    s_add_u32 s6, s6, 32
    s_and_b32 s7, s4, 7
    s_lshl_b32 s7, s7, 2
    s_sub_u32 s6, s6, s7
    s_lshl_b32 s6, s6, 12
    s_and_b32 s7, s4, 1
    s_lshl_b32 s7, s7, 9
    s_add_u32 s52, s6, s7
    s_waitcnt lgkmcnt(0)
    ds_read_b64_tr_b16 v[188:189], v119 offset:0
    ds_read_b64_tr_b16 v[190:191], v119 offset:128
    ds_read_b64_tr_b16 v[228:229], v119 offset:1024
    ds_read_b64_tr_b16 v[230:231], v119 offset:1152
    ds_read_b64_tr_b16 v[236:237], v119 offset:2048
    ds_read_b64_tr_b16 v[238:239], v119 offset:2176
    ds_read_b64_tr_b16 v[244:245], v119 offset:3072
    ds_read_b64_tr_b16 v[246:247], v119 offset:3200
    s_add_u32 s44, s40, s52
    s_waitcnt lgkmcnt(6)
    buffer_store_dwordx4 v[188:191], v9, s[8:11], s44 offen offset:0 sc1
    s_waitcnt lgkmcnt(4)
    buffer_store_dwordx4 v[228:231], v9, s[8:11], s44 offen offset:1024 sc1
    s_add_u32 s44, s41, s52
    s_waitcnt lgkmcnt(2)
    buffer_store_dwordx4 v[236:239], v9, s[8:11], s44 offen offset:0 sc1
    s_waitcnt lgkmcnt(0)
    buffer_store_dwordx4 v[244:247], v9, s[8:11], s44 offen offset:1024 sc1
    s_mov_b32 s51, 1
    s_sub_u32 s45, 7, s5
    s_cmp_lg_u32 s45, 0
    s_cbranch_scc1 A_G0
A_LD:
    s_sub_u32 s51, 3, s3
    s_cmp_gt_u32 s51, 0
    s_cselect_b32 s6, 0, 0xff800000
    s_cmp_ge_u32 s51, 0
    s_cselect_b32 s7, 0, 0xff800000
    v_mov_b32 v7, s6
    v_mov_b32 v8, s7
    v_cndmask_b32 v232, v7, v8, s[64:65]
    v_cndmask_b32 v233, v7, v8, s[66:67]
    v_cndmask_b32 v234, v7, v8, s[68:69]
    v_cndmask_b32 v235, v7, v8, s[70:71]
    v_cndmask_b32 v248, v7, v8, s[72:73]
    v_cndmask_b32 v249, v7, v8, s[74:75]
    v_cndmask_b32 v250, v7, v8, s[76:77]
    v_cndmask_b32 v251, v7, v8, s[78:79]
    v_mfma_f32_16x16x32_bf16 v[160:163], a[144:147], v[56:59], v[232:235]
    s_mul_i32 s52, s3, 14336
    v_exp_f32 v96, v96
    v_cndmask_b32 v200, v7, v8, s[80:81]
    v_mfma_f32_16x16x32_bf16 v[176:179], a[144:147], v[60:63], v[248:251]
    s_sub_u32 s52, 8192, s52
    ds_read_b128 a[168:171], v5 offset:6144
    ds_read_b128 a[172:175], v5 offset:7168
    v_cndmask_b32 v201, v7, v8, s[82:83]
    v_mfma_f32_16x16x32_bf16 v[160:163], a[148:151], v[88:91], v[160:163]
    s_add_u32 m0, s49, s52
    v_exp_f32 v97, v97
    v_cndmask_b32 v202, v7, v8, s[84:85]
    v_mfma_f32_16x16x32_bf16 v[176:179], a[148:151], v[92:95], v[176:179]
    s_waitcnt lgkmcnt(4)
    ds_read_b128 a[144:147], v5 offset:8192
    v_cvt_pk_bf16_f32 v78, v96, v97
    v_cndmask_b32 v203, v7, v8, s[86:87]
    v_mfma_f32_16x16x32_bf16 v[160:163], a[152:155], v[148:151], v[160:163]
    s_add_u32 s44, s48, s52
    v_exp_f32 v98, v98
    v_cndmask_b32 v216, v7, v8, s[88:89]
    v_mfma_f32_16x16x32_bf16 v[176:179], a[152:155], v[156:159], v[176:179]
    v_exp_f32 v99, v99
    v_cndmask_b32 v217, v7, v8, s[90:91]
    v_cndmask_b32 v218, v7, v8, s[92:93]
    v_cndmask_b32 v219, v7, v8, s[94:95]
    v_mfma_f32_16x16x32_bf16 v[160:163], a[156:159], v[212:215], v[160:163]
    ds_read_b128 a[148:151], v5 offset:9216
    ds_read_b128 a[152:155], v5 offset:10240
    v_mfma_f32_16x16x32_bf16 v[176:179], a[156:159], v[220:223], v[176:179]
    s_waitcnt lgkmcnt(5)
    v_cvt_pk_bf16_f32 v79, v98, v99
    buffer_load_dwordx4 v1, s[8:11], s44 offen sc1 lds
    v_mfma_f32_16x16x32_bf16 v[192:195], a[160:163], v[56:59], v[200:203]
    s_cmp_gt_u32 s51, 1
    s_cselect_b32 s6, 0, 0xff800000
    ds_read_b128 a[156:159], v5 offset:11264
    buffer_load_dwordx4 v1, s[8:11], s44 offen offset:1024 sc1 lds
    v_mfma_f32_16x16x32_bf16 v[96:99], a[160:163], v[60:63], v[216:219]
    s_cmp_ge_u32 s51, 1
    s_cselect_b32 s7, 0, 0xff800000
    v_mov_b32 v7, s6
    v_mfma_f32_16x16x32_bf16 v[192:195], a[164:167], v[88:91], v[192:195]
    s_and_b32 s42, s49, 0x10000
    ds_read_b128 a[160:163], v5 offset:12288
    v_mov_b32 v8, s7
    v_mfma_f32_16x16x32_bf16 v[96:99], a[164:167], v[92:95], v[96:99]
    s_waitcnt lgkmcnt(5)
    v_exp_f32 v160, v160
    v_cndmask_b32 v232, v7, v8, s[64:65]
    v_mfma_f32_16x16x32_bf16 v[192:195], a[168:171], v[148:151], v[192:195]
    s_lshl_b32 s44, s3, 11
    v_exp_f32 v161, v161
    v_mfma_f32_16x16x32_bf16 v[96:99], a[168:171], v[156:159], v[96:99]
    s_add_u32 s42, s42, s44
    ds_read_b128 a[164:167], v5 offset:13312
    v_cvt_pk_bf16_f32 v64, v160, v161
    v_mfma_f32_16x16x32_bf16 v[192:195], a[172:175], v[212:215], v[192:195]
    s_add_u32 s62, s15, 151552
    v_exp_f32 v162, v162
    buffer_load_dwordx4 v[180:183], v1, s[8:11], s62 offen offset:0 sc1
    v_mfma_f32_16x16x32_bf16 v[96:99], a[172:175], v[220:223], v[96:99]
    s_waitcnt lgkmcnt(4)
    ds_read_b128 a[168:171], v5 offset:14336
    v_cndmask_b32 v233, v7, v8, s[66:67]
    buffer_load_dwordx4 v[16:19], v1, s[8:11], s62 offen offset:1024 sc1
    v_mfma_f32_16x16x32_bf16 a[64:67], a[144:147], v[72:75], a[64:67]
    s_add_u32 s62, s15, 155648
    v_exp_f32 v163, v163
    v_cndmask_b32 v234, v7, v8, s[68:69]
    v_mfma_f32_16x16x32_bf16 a[68:71], a[144:147], v[76:79], a[68:71]
    ds_read_b128 a[172:175], v5 offset:15360
    v_cvt_pk_bf16_f32 v65, v162, v163
    buffer_load_dwordx4 v[20:23], v1, s[8:11], s62 offen offset:0 sc1
    v_mfma_f32_16x16x32_bf16 a[72:75], a[148:151], v[72:75], a[72:75]
    v_exp_f32 v176, v176
    v_cndmask_b32 v235, v7, v8, s[70:71]
    v_mfma_f32_16x16x32_bf16 a[76:79], a[148:151], v[76:79], a[76:79]
    s_waitcnt lgkmcnt(4)
    v_exp_f32 v177, v177
    buffer_load_dwordx4 v[24:27], v1, s[8:11], s62 offen offset:1024 sc1
    v_mfma_f32_16x16x32_bf16 a[80:83], a[152:155], v[72:75], a[80:83]
    s_add_u32 s62, s15, 159744
    ds_read_b128 a[144:147], v5 offset:16384
    ds_read_b128 a[148:151], v5 offset:17408
    buffer_load_dwordx4 v[28:31], v1, s[8:11], s62 offen offset:0 sc1
    v_mfma_f32_16x16x32_bf16 a[84:87], a[152:155], v[76:79], a[84:87]
    v_exp_f32 v178, v178
    v_cndmask_b32 v248, v7, v8, s[72:73]
    v_mfma_f32_16x16x32_bf16 a[88:91], a[156:159], v[72:75], a[88:91]
    ds_read_b128 a[152:155], v5 offset:18432
    v_cvt_pk_bf16_f32 v68, v176, v177
    buffer_load_dwordx4 v[32:35], v1, s[8:11], s62 offen offset:1024 sc1
    v_mfma_f32_16x16x32_bf16 a[92:95], a[156:159], v[76:79], a[92:95]
    s_waitcnt lgkmcnt(5)
    v_exp_f32 v179, v179
    v_mfma_f32_16x16x32_bf16 a[96:99], a[160:163], v[72:75], a[96:99]
    s_waitcnt vmcnt(8)
    ds_read_b128 a[156:159], v5 offset:19456
    v_cvt_pk_bf16_f32 v69, v178, v179
    v_cndmask_b32 v249, v7, v8, s[74:75]
    v_mfma_f32_16x16x32_bf16 a[100:103], a[160:163], v[76:79], a[100:103]
    v_exp_f32 v192, v192
    v_cmp_gt_u32 vcc, 1, v13
    v_mfma_f32_16x16x32_bf16 a[104:107], a[164:167], v[72:75], a[104:107]
    v_exp_f32 v193, v193
    v_cndmask_b32 v250, v7, v8, s[76:77]
    v_mfma_f32_16x16x32_bf16 a[108:111], a[164:167], v[76:79], a[108:111]
    s_waitcnt lgkmcnt(4)
    ds_read_b128 a[160:163], v5 offset:20480
    v_cvt_pk_bf16_f32 v66, v192, v193
    buffer_store_dword v15, off, s[8:11], s43 sc1
    v_mfma_f32_16x16x32_bf16 a[112:115], a[168:171], v[72:75], a[112:115]
    s_cmp_eq_u64 vcc, 0
    s_cselect_b32 s34, 75497472, 0
    s_cselect_b32 s63, 0, 1
    v_exp_f32 v194, v194
    v_mfma_f32_16x16x32_bf16 a[116:119], a[168:171], v[76:79], a[116:119]
    ds_read_b128 a[164:167], v5 offset:21504
    v_cndmask_b32 v251, v7, v8, s[78:79]
    v_mfma_f32_16x16x32_bf16 a[120:123], a[172:175], v[72:75], a[120:123]
    v_exp_f32 v195, v195
    v_mfma_f32_16x16x32_bf16 a[124:127], a[172:175], v[76:79], a[124:127]
    v_cvt_pk_bf16_f32 v67, v194, v195
    v_mfma_f32_16x16x32_bf16 a[136:139], a[176:179], v[72:75], a[136:139]
    v_mfma_f32_16x16x32_bf16 a[140:143], a[176:179], v[76:79], a[140:143]
    s_waitcnt lgkmcnt(3)
    v_mfma_f32_16x16x32_bf16 v[160:163], a[144:147], v[56:59], v[232:235]
    s_xor_b32 m0, s42, 0
    v_exp_f32 v96, v96
    v_cndmask_b32 v200, v7, v8, s[80:81]
    v_mfma_f32_16x16x32_bf16 v[176:179], a[144:147], v[60:63], v[248:251]
    s_add_u32 s44, s14, 0
    ds_read_b128 a[168:171], v5 offset:22528
    ds_read_b128 a[172:175], v5 offset:23552
    v_cndmask_b32 v201, v7, v8, s[82:83]
    buffer_load_dwordx4 v2, s[32:35], s44 offen sc1 lds
    v_mfma_f32_16x16x32_bf16 v[160:163], a[148:151], v[88:91], v[160:163]
    v_exp_f32 v97, v97
    v_cndmask_b32 v202, v7, v8, s[84:85]
    v_mfma_f32_16x16x32_bf16 v[176:179], a[148:151], v[92:95], v[176:179]
    s_waitcnt lgkmcnt(4)
    ds_read_b128 a[144:147], v5 offset:24576
    v_cvt_pk_bf16_f32 v70, v96, v97
    v_cndmask_b32 v203, v7, v8, s[86:87]
    v_mfma_f32_16x16x32_bf16 v[160:163], a[152:155], v[148:151], v[160:163]
    v_exp_f32 v98, v98
    v_cndmask_b32 v216, v7, v8, s[88:89]
    v_mfma_f32_16x16x32_bf16 v[176:179], a[152:155], v[156:159], v[176:179]
    v_exp_f32 v99, v99
    v_cndmask_b32 v217, v7, v8, s[90:91]
    v_cndmask_b32 v218, v7, v8, s[92:93]
    v_cndmask_b32 v219, v7, v8, s[94:95]
    v_mfma_f32_16x16x32_bf16 v[160:163], a[156:159], v[212:215], v[160:163]
    ds_read_b128 a[148:151], v5 offset:25600
    ds_read_b128 a[152:155], v5 offset:26624
    v_mfma_f32_16x16x32_bf16 v[176:179], a[156:159], v[220:223], v[176:179]
    s_waitcnt lgkmcnt(5)
    v_cvt_pk_bf16_f32 v71, v98, v99
    buffer_load_dwordx4 v3, s[32:35], s44 offen offset:1024 sc1 lds
    v_mfma_f32_16x16x32_bf16 v[192:195], a[160:163], v[56:59], v[200:203]
    s_cmp_gt_u32 s51, 2
    s_cselect_b32 s6, 0, 0xff800000
    ds_read_b128 a[156:159], v5 offset:27648
    v_mfma_f32_16x16x32_bf16 v[96:99], a[160:163], v[60:63], v[216:219]
    s_cmp_ge_u32 s51, 2
    s_cselect_b32 s7, 0, 0xff800000
    v_mov_b32 v7, s6
    v_mfma_f32_16x16x32_bf16 v[192:195], a[164:167], v[88:91], v[192:195]
    s_and_b32 s44, s42, 0xffff
    ds_read_b128 a[160:163], v5 offset:28672
    v_mov_b32 v8, s7
    v_mfma_f32_16x16x32_bf16 v[96:99], a[164:167], v[92:95], v[96:99]
    s_waitcnt lgkmcnt(5)
    v_exp_f32 v160, v160
    v_cndmask_b32 v232, v7, v8, s[64:65]
    v_mfma_f32_16x16x32_bf16 v[192:195], a[168:171], v[148:151], v[192:195]
    s_add_u32 m0, s44, 155648
    v_exp_f32 v161, v161
    v_mfma_f32_16x16x32_bf16 v[96:99], a[168:171], v[156:159], v[96:99]
    s_add_u32 s44, s14, 4096
    ds_read_b128 a[164:167], v5 offset:29696
    v_cvt_pk_bf16_f32 v72, v160, v161
    buffer_load_dwordx4 v2, s[32:35], s44 offen sc1 lds
    v_mfma_f32_16x16x32_bf16 v[192:195], a[172:175], v[212:215], v[192:195]
    v_exp_f32 v162, v162
    buffer_load_dwordx4 v3, s[32:35], s44 offen offset:1024 sc1 lds
    v_mfma_f32_16x16x32_bf16 v[96:99], a[172:175], v[220:223], v[96:99]
    s_waitcnt lgkmcnt(4)
    ds_read_b128 a[168:171], v5 offset:30720
    v_cndmask_b32 v233, v7, v8, s[66:67]
    v_mfma_f32_16x16x32_bf16 a[64:67], a[144:147], v[64:67], a[64:67]
    s_xor_b32 m0, s42, 16384
    v_exp_f32 v163, v163
    v_cndmask_b32 v234, v7, v8, s[68:69]
    v_mfma_f32_16x16x32_bf16 a[68:71], a[144:147], v[68:71], a[68:71]
    s_add_u32 s44, s14, 8192
    ds_read_b128 a[172:175], v5 offset:31744
    v_cvt_pk_bf16_f32 v73, v162, v163
    v_mfma_f32_16x16x32_bf16 a[72:75], a[148:151], v[64:67], a[72:75]
    v_exp_f32 v176, v176
    v_cndmask_b32 v235, v7, v8, s[70:71]
    v_mfma_f32_16x16x32_bf16 a[76:79], a[148:151], v[68:71], a[76:79]
    s_waitcnt lgkmcnt(4)
    v_exp_f32 v177, v177
    buffer_load_dwordx4 v2, s[32:35], s44 offen sc1 lds
    v_mfma_f32_16x16x32_bf16 a[80:83], a[152:155], v[64:67], a[80:83]
    ds_read_b128 a[144:147], v5 offset:32768
    ds_read_b128 a[148:151], v5 offset:33792
    v_mfma_f32_16x16x32_bf16 a[84:87], a[152:155], v[68:71], a[84:87]
    v_exp_f32 v178, v178
    v_cndmask_b32 v248, v7, v8, s[72:73]
    v_mfma_f32_16x16x32_bf16 a[88:91], a[156:159], v[64:67], a[88:91]
    ds_read_b128 a[152:155], v5 offset:34816
    v_cvt_pk_bf16_f32 v76, v176, v177
    v_mfma_f32_16x16x32_bf16 a[92:95], a[156:159], v[68:71], a[92:95]
    s_waitcnt lgkmcnt(5)
    v_exp_f32 v179, v179
    buffer_load_dwordx4 v3, s[32:35], s44 offen offset:1024 sc1 lds
    v_mfma_f32_16x16x32_bf16 a[96:99], a[160:163], v[64:67], a[96:99]
    ds_read_b128 a[156:159], v5 offset:35840
    v_cvt_pk_bf16_f32 v77, v178, v179
    v_cndmask_b32 v249, v7, v8, s[74:75]
    v_mfma_f32_16x16x32_bf16 a[100:103], a[160:163], v[68:71], a[100:103]
    v_exp_f32 v192, v192
    v_mfma_f32_16x16x32_bf16 a[104:107], a[164:167], v[64:67], a[104:107]
    v_exp_f32 v193, v193
    v_cndmask_b32 v250, v7, v8, s[76:77]
    v_mfma_f32_16x16x32_bf16 a[108:111], a[164:167], v[68:71], a[108:111]
    s_waitcnt lgkmcnt(4)
    ds_read_b128 a[160:163], v5 offset:36864
    v_cvt_pk_bf16_f32 v74, v192, v193
    v_mfma_f32_16x16x32_bf16 a[112:115], a[168:171], v[64:67], a[112:115]
    v_exp_f32 v194, v194
    v_mfma_f32_16x16x32_bf16 a[116:119], a[168:171], v[68:71], a[116:119]
    ds_read_b128 a[164:167], v5 offset:37888
    v_cndmask_b32 v251, v7, v8, s[78:79]
    v_mfma_f32_16x16x32_bf16 a[120:123], a[172:175], v[64:67], a[120:123]
    v_exp_f32 v195, v195
    v_mfma_f32_16x16x32_bf16 a[124:127], a[172:175], v[68:71], a[124:127]
    v_cvt_pk_bf16_f32 v75, v194, v195
    v_mfma_f32_16x16x32_bf16 a[136:139], a[176:179], v[64:67], a[136:139]
    v_mfma_f32_16x16x32_bf16 a[140:143], a[176:179], v[68:71], a[140:143]
    s_waitcnt lgkmcnt(3)
    v_mfma_f32_16x16x32_bf16 v[160:163], a[144:147], v[56:59], v[232:235]
    s_xor_b32 m0, s42, 24576
    v_exp_f32 v96, v96
    v_cndmask_b32 v200, v7, v8, s[80:81]
    v_mfma_f32_16x16x32_bf16 v[176:179], a[144:147], v[60:63], v[248:251]
    s_add_u32 s44, s14, 12288
    ds_read_b128 a[168:171], v5 offset:38912
    ds_read_b128 a[172:175], v5 offset:39936
    v_cndmask_b32 v201, v7, v8, s[82:83]
    buffer_load_dwordx4 v2, s[32:35], s44 offen sc1 lds
    v_mfma_f32_16x16x32_bf16 v[160:163], a[148:151], v[88:91], v[160:163]
    v_exp_f32 v97, v97
    v_cndmask_b32 v202, v7, v8, s[84:85]
    v_mfma_f32_16x16x32_bf16 v[176:179], a[148:151], v[92:95], v[176:179]
    s_waitcnt lgkmcnt(4)
    ds_read_b128 a[144:147], v5 offset:40960
    v_cvt_pk_bf16_f32 v78, v96, v97
    v_cndmask_b32 v203, v7, v8, s[86:87]
    v_mfma_f32_16x16x32_bf16 v[160:163], a[152:155], v[148:151], v[160:163]
    v_exp_f32 v98, v98
    v_cndmask_b32 v216, v7, v8, s[88:89]
    v_mfma_f32_16x16x32_bf16 v[176:179], a[152:155], v[156:159], v[176:179]
    v_exp_f32 v99, v99
    v_cndmask_b32 v217, v7, v8, s[90:91]
    v_cndmask_b32 v218, v7, v8, s[92:93]
    v_cndmask_b32 v219, v7, v8, s[94:95]
    v_mfma_f32_16x16x32_bf16 v[160:163], a[156:159], v[212:215], v[160:163]
    ds_read_b128 a[148:151], v5 offset:41984
    ds_read_b128 a[152:155], v5 offset:43008
    v_mfma_f32_16x16x32_bf16 v[176:179], a[156:159], v[220:223], v[176:179]
    s_waitcnt lgkmcnt(5)
    v_cvt_pk_bf16_f32 v79, v98, v99
    buffer_load_dwordx4 v3, s[32:35], s44 offen offset:1024 sc1 lds
    v_mfma_f32_16x16x32_bf16 v[192:195], a[160:163], v[56:59], v[200:203]
    s_cmp_gt_u32 s51, 3
    s_cselect_b32 s6, 0, 0xff800000
    ds_read_b128 a[156:159], v5 offset:44032
    v_mfma_f32_16x16x32_bf16 v[96:99], a[160:163], v[60:63], v[216:219]
    s_cmp_ge_u32 s51, 3
    s_cselect_b32 s7, 0, 0xff800000
    v_mov_b32 v7, s6
    v_mfma_f32_16x16x32_bf16 v[192:195], a[164:167], v[88:91], v[192:195]
    s_xor_b32 m0, s42, 32768
    ds_read_b128 a[160:163], v5 offset:45056
    v_mov_b32 v8, s7
    v_mfma_f32_16x16x32_bf16 v[96:99], a[164:167], v[92:95], v[96:99]
    s_waitcnt lgkmcnt(5)
    v_exp_f32 v160, v160
    v_cndmask_b32 v232, v7, v8, s[64:65]
    v_mfma_f32_16x16x32_bf16 v[192:195], a[168:171], v[148:151], v[192:195]
    s_add_u32 s44, s14, 16384
    v_exp_f32 v161, v161
    buffer_load_dwordx4 v2, s[32:35], s44 offen sc1 lds
    v_mfma_f32_16x16x32_bf16 v[96:99], a[168:171], v[156:159], v[96:99]
    ds_read_b128 a[164:167], v5 offset:46080
    v_cvt_pk_bf16_f32 v64, v160, v161
    v_mfma_f32_16x16x32_bf16 v[192:195], a[172:175], v[212:215], v[192:195]
    v_exp_f32 v162, v162
    buffer_load_dwordx4 v3, s[32:35], s44 offen offset:1024 sc1 lds
    v_mfma_f32_16x16x32_bf16 v[96:99], a[172:175], v[220:223], v[96:99]
    s_waitcnt lgkmcnt(4)
    ds_read_b128 a[168:171], v5 offset:47104
    v_cndmask_b32 v233, v7, v8, s[66:67]
    v_mfma_f32_16x16x32_bf16 a[64:67], a[144:147], v[72:75], a[64:67]
    s_xor_b32 m0, s42, 40960
    v_exp_f32 v163, v163
    v_cndmask_b32 v234, v7, v8, s[68:69]
    v_mfma_f32_16x16x32_bf16 a[68:71], a[144:147], v[76:79], a[68:71]
    s_add_u32 s44, s14, 20480
    ds_read_b128 a[172:175], v5 offset:48128
    v_cvt_pk_bf16_f32 v65, v162, v163
    v_mfma_f32_16x16x32_bf16 a[72:75], a[148:151], v[72:75], a[72:75]
    v_exp_f32 v176, v176
    v_cndmask_b32 v235, v7, v8, s[70:71]
    v_mfma_f32_16x16x32_bf16 a[76:79], a[148:151], v[76:79], a[76:79]
    s_waitcnt lgkmcnt(4)
    v_exp_f32 v177, v177
    buffer_load_dwordx4 v2, s[32:35], s44 offen sc1 lds
    v_mfma_f32_16x16x32_bf16 a[80:83], a[152:155], v[72:75], a[80:83]
    ds_read_b128 a[144:147], v5 offset:49152
    ds_read_b128 a[148:151], v5 offset:50176
    v_mfma_f32_16x16x32_bf16 a[84:87], a[152:155], v[76:79], a[84:87]
    v_exp_f32 v178, v178
    v_cndmask_b32 v248, v7, v8, s[72:73]
    v_mfma_f32_16x16x32_bf16 a[88:91], a[156:159], v[72:75], a[88:91]
    ds_read_b128 a[152:155], v5 offset:51200
    v_cvt_pk_bf16_f32 v68, v176, v177
    v_mfma_f32_16x16x32_bf16 a[92:95], a[156:159], v[76:79], a[92:95]
    s_waitcnt lgkmcnt(5)
    v_exp_f32 v179, v179
    buffer_load_dwordx4 v3, s[32:35], s44 offen offset:1024 sc1 lds
    v_mfma_f32_16x16x32_bf16 a[96:99], a[160:163], v[72:75], a[96:99]
    ds_read_b128 a[156:159], v5 offset:52224
    v_cvt_pk_bf16_f32 v69, v178, v179
    v_cndmask_b32 v249, v7, v8, s[74:75]
    v_mfma_f32_16x16x32_bf16 a[100:103], a[160:163], v[76:79], a[100:103]
    v_exp_f32 v192, v192
    v_mfma_f32_16x16x32_bf16 a[104:107], a[164:167], v[72:75], a[104:107]
    v_exp_f32 v193, v193
    v_cndmask_b32 v250, v7, v8, s[76:77]
    v_mfma_f32_16x16x32_bf16 a[108:111], a[164:167], v[76:79], a[108:111]
    s_waitcnt lgkmcnt(4)
    ds_read_b128 a[160:163], v5 offset:53248
    v_cvt_pk_bf16_f32 v66, v192, v193
    v_mfma_f32_16x16x32_bf16 a[112:115], a[168:171], v[72:75], a[112:115]
    v_exp_f32 v194, v194
    v_mfma_f32_16x16x32_bf16 a[116:119], a[168:171], v[76:79], a[116:119]
    ds_read_b128 a[164:167], v5 offset:54272
    v_cndmask_b32 v251, v7, v8, s[78:79]
    v_mfma_f32_16x16x32_bf16 a[120:123], a[172:175], v[72:75], a[120:123]
    v_exp_f32 v195, v195
    v_mfma_f32_16x16x32_bf16 a[124:127], a[172:175], v[76:79], a[124:127]
    v_cvt_pk_bf16_f32 v67, v194, v195
    v_mfma_f32_16x16x32_bf16 a[136:139], a[176:179], v[72:75], a[136:139]
    v_mfma_f32_16x16x32_bf16 a[140:143], a[176:179], v[76:79], a[140:143]
    s_waitcnt lgkmcnt(3)
    v_mfma_f32_16x16x32_bf16 v[160:163], a[144:147], v[56:59], v[232:235]
    v_exp_f32 v96, v96
    v_cndmask_b32 v200, v7, v8, s[80:81]
    buffer_load_dword v13, v14, s[8:11], s61 offen sc1
    v_mfma_f32_16x16x32_bf16 v[176:179], a[144:147], v[60:63], v[248:251]
    s_xor_b32 m0, s42, 49152
    ds_read_b128 a[168:171], v5 offset:55296
    ds_read_b128 a[172:175], v5 offset:56320
    v_cndmask_b32 v201, v7, v8, s[82:83]
    v_mfma_f32_16x16x32_bf16 v[160:163], a[148:151], v[88:91], v[160:163]
    s_add_u32 s44, s14, 24576
    v_exp_f32 v97, v97
    v_cndmask_b32 v202, v7, v8, s[84:85]
    v_mfma_f32_16x16x32_bf16 v[176:179], a[148:151], v[92:95], v[176:179]
    s_waitcnt lgkmcnt(4)
    ds_read_b128 a[144:147], v5 offset:57344
    v_cvt_pk_bf16_f32 v70, v96, v97
    v_cndmask_b32 v203, v7, v8, s[86:87]
    v_mfma_f32_16x16x32_bf16 v[160:163], a[152:155], v[148:151], v[160:163]
    v_exp_f32 v98, v98
    v_cndmask_b32 v216, v7, v8, s[88:89]
    v_mfma_f32_16x16x32_bf16 v[176:179], a[152:155], v[156:159], v[176:179]
    v_exp_f32 v99, v99
    v_cndmask_b32 v217, v7, v8, s[90:91]
    v_cndmask_b32 v218, v7, v8, s[92:93]
    v_cndmask_b32 v219, v7, v8, s[94:95]
    v_mfma_f32_16x16x32_bf16 v[160:163], a[156:159], v[212:215], v[160:163]
    ds_read_b128 a[148:151], v5 offset:58368
    ds_read_b128 a[152:155], v5 offset:59392
    v_mfma_f32_16x16x32_bf16 v[176:179], a[156:159], v[220:223], v[176:179]
    s_waitcnt lgkmcnt(5)
    v_cvt_pk_bf16_f32 v71, v98, v99
    buffer_load_dwordx4 v2, s[32:35], s44 offen sc1 lds
    v_mfma_f32_16x16x32_bf16 v[192:195], a[160:163], v[56:59], v[200:203]
    ds_read_b128 a[156:159], v5 offset:60416
    v_mfma_f32_16x16x32_bf16 v[96:99], a[160:163], v[60:63], v[216:219]
    v_mfma_f32_16x16x32_bf16 v[192:195], a[164:167], v[88:91], v[192:195]
    ds_read_b128 a[160:163], v5 offset:61440
    v_mfma_f32_16x16x32_bf16 v[96:99], a[164:167], v[92:95], v[96:99]
    s_waitcnt lgkmcnt(5)
    v_exp_f32 v160, v160
    buffer_load_dwordx4 v3, s[32:35], s44 offen offset:1024 sc1 lds
    v_mfma_f32_16x16x32_bf16 v[192:195], a[168:171], v[148:151], v[192:195]
    s_xor_b32 m0, s42, 57344
    v_exp_f32 v161, v161
    v_mfma_f32_16x16x32_bf16 v[96:99], a[168:171], v[156:159], v[96:99]
    s_add_u32 s44, s14, 28672
    v_exp_f32 v162, v162
    v_cvt_pk_bf16_f32 v72, v160, v161
    v_mfma_f32_16x16x32_bf16 v[192:195], a[172:175], v[212:215], v[192:195]
    v_exp_f32 v163, v163
    v_mfma_f32_16x16x32_bf16 v[96:99], a[172:175], v[220:223], v[96:99]
    s_waitcnt lgkmcnt(3)
    ds_read_b128 a[164:167], v5 offset:62464
    ds_read_b128 a[168:171], v5 offset:63488
    ds_read_b128 a[172:175], v5 offset:64512
    v_mfma_f32_16x16x32_bf16 a[64:67], a[144:147], v[64:67], a[64:67]
    v_exp_f32 v176, v176
    v_cvt_pk_bf16_f32 v73, v162, v163
    v_mfma_f32_16x16x32_bf16 a[68:71], a[144:147], v[68:71], a[68:71]
    v_exp_f32 v177, v177
    buffer_load_dwordx4 v2, s[32:35], s44 offen sc1 lds
    v_mfma_f32_16x16x32_bf16 a[72:75], a[148:151], v[64:67], a[72:75]
    v_exp_f32 v178, v178
    v_mfma_f32_16x16x32_bf16 a[76:79], a[148:151], v[68:71], a[76:79]
    s_waitcnt vmcnt(23) lgkmcnt(0)
    v_xor_b32 v5, 0x10000, v5
    v_cvt_pk_bf16_f32 v76, v176, v177
    v_mfma_f32_16x16x32_bf16 a[80:83], a[152:155], v[64:67], a[80:83]
    s_barrier
    v_exp_f32 v179, v179
    v_mfma_f32_16x16x32_bf16 a[84:87], a[152:155], v[68:71], a[84:87]
    v_exp_f32 v192, v192
    v_cvt_pk_bf16_f32 v77, v178, v179
    v_mfma_f32_16x16x32_bf16 a[88:91], a[156:159], v[64:67], a[88:91]
    v_exp_f32 v193, v193
    buffer_load_dwordx4 v3, s[32:35], s44 offen offset:1024 sc1 lds
    v_mfma_f32_16x16x32_bf16 a[92:95], a[156:159], v[68:71], a[92:95]
    ds_read_b128 a[180:183], v5 offset:8192
    ds_read_b128 a[184:187], v5 offset:9216
    v_cvt_pk_bf16_f32 v74, v192, v193
    v_mfma_f32_16x16x32_bf16 a[96:99], a[160:163], v[64:67], a[96:99]
    v_exp_f32 v194, v194
    v_mfma_f32_16x16x32_bf16 a[100:103], a[160:163], v[68:71], a[100:103]
    v_exp_f32 v195, v195
    v_mfma_f32_16x16x32_bf16 a[104:107], a[164:167], v[64:67], a[104:107]
    v_exp_f32 v96, v96
    v_cvt_pk_bf16_f32 v75, v194, v195
    v_mfma_f32_16x16x32_bf16 a[108:111], a[164:167], v[68:71], a[108:111]
    ds_read_b128 a[188:191], v5 offset:10240
    ds_read_b128 a[192:195], v5 offset:11264
    v_mfma_f32_16x16x32_bf16 a[112:115], a[168:171], v[64:67], a[112:115]
    v_exp_f32 v97, v97
    v_mfma_f32_16x16x32_bf16 a[116:119], a[168:171], v[68:71], a[116:119]
    v_exp_f32 v98, v98
    v_cvt_pk_bf16_f32 v78, v96, v97
    v_mfma_f32_16x16x32_bf16 a[120:123], a[172:175], v[64:67], a[120:123]
    v_exp_f32 v99, v99
    v_mfma_f32_16x16x32_bf16 a[124:127], a[172:175], v[68:71], a[124:127]
    ds_read_b128 a[196:199], v5 offset:12288
    ds_read_b128 a[200:203], v5 offset:13312
    v_mfma_f32_16x16x32_bf16 a[136:139], a[176:179], v[64:67], a[136:139]
    ds_read_b128 a[204:207], v5 offset:14336
    ds_read_b128 a[208:211], v5 offset:15360
    v_mfma_f32_16x16x32_bf16 a[140:143], a[176:179], v[68:71], a[140:143]
    v_cvt_pk_bf16_f32 v79, v98, v99
A_LDe:
    s_waitcnt lgkmcnt(6)
    v_mfma_f32_16x16x32_bf16 a[64:67], a[180:183], v[72:75], a[64:67]
    v_mfma_f32_16x16x32_bf16 a[68:71], a[180:183], v[76:79], a[68:71]
    v_mfma_f32_16x16x32_bf16 a[72:75], a[184:187], v[72:75], a[72:75]
    v_mfma_f32_16x16x32_bf16 a[76:79], a[184:187], v[76:79], a[76:79]
    s_waitcnt lgkmcnt(4)
    v_mfma_f32_16x16x32_bf16 a[80:83], a[188:191], v[72:75], a[80:83]
    v_mfma_f32_16x16x32_bf16 a[84:87], a[188:191], v[76:79], a[84:87]
    v_mfma_f32_16x16x32_bf16 a[88:91], a[192:195], v[72:75], a[88:91]
    v_mfma_f32_16x16x32_bf16 a[92:95], a[192:195], v[76:79], a[92:95]
    s_waitcnt lgkmcnt(2)
    v_mfma_f32_16x16x32_bf16 a[96:99], a[196:199], v[72:75], a[96:99]
    v_mfma_f32_16x16x32_bf16 a[100:103], a[196:199], v[76:79], a[100:103]
    v_mfma_f32_16x16x32_bf16 a[104:107], a[200:203], v[72:75], a[104:107]
    v_mfma_f32_16x16x32_bf16 a[108:111], a[200:203], v[76:79], a[108:111]
    s_waitcnt lgkmcnt(0)
    v_mfma_f32_16x16x32_bf16 a[112:115], a[204:207], v[72:75], a[112:115]
    v_mfma_f32_16x16x32_bf16 a[116:119], a[204:207], v[76:79], a[116:119]
    v_mfma_f32_16x16x32_bf16 a[120:123], a[208:211], v[72:75], a[120:123]
    v_mfma_f32_16x16x32_bf16 a[124:127], a[208:211], v[76:79], a[124:127]
    v_mfma_f32_16x16x32_bf16 a[136:139], a[176:179], v[72:75], a[136:139]
    v_mfma_f32_16x16x32_bf16 a[140:143], a[176:179], v[76:79], a[140:143]
    s_nop 6
    v_accvgpr_read_b32 v100, a136
    v_accvgpr_read_b32 v101, a140
    v_min_f32 v102, v100, v101
    v_add_f32 v103, v100, v101
    v_cmp_nle_f32 vcc, 0x2b800000, v102
    s_mov_b64 s[6:7], vcc
    v_cmp_nge_f32 vcc, 0x53800000, v103
    s_or_b64 s[6:7], vcc, s[6:7]
    s_cmp_lg_u64 s[6:7], 0
    s_cbranch_scc1 A_fb
    s_cmp_eq_u32 s56, 0
    s_cbranch_scc1 A_fb
    s_cmp_eq_u32 s63, 0
    s_cbranch_scc0 A_l2
A_ret4:
    s_load_dwordx2 s[74:75], s[0:1], 112
    s_load_dwordx2 s[64:65], s[0:1], 128
    v_xor_b32 v6, 0x10000, v5
    v_add_u32 v8, 155648, v1
    v_mov_b32 v15, 1
    s_cmp_eq_u32 s63, 0
    s_waitcnt vmcnt(8) lgkmcnt(0)
    s_cbranch_scc0 B_spin1
B_ret1:
    s_barrier
    ds_read_b128 a[144:147], v5 offset:0
    ds_read_b128 a[148:151], v5 offset:1024
    ds_read_b128 a[152:155], v5 offset:2048
    ds_read_b128 a[156:159], v5 offset:3072
    ds_read_b128 a[160:163], v5 offset:4096
    ds_read_b128 a[164:167], v5 offset:5120
    ds_read_b128 a[168:171], v5 offset:6144
    ds_read_b128 a[172:175], v5 offset:7168
    v_mov_b32 v15, 2
    v_rcp_f32 v232, v100
    v_rcp_f32 v233, v101
    v_and_b32 v4, 12, v0
    v_and_b32 v7, 15, v0
    v_add_u32 v4, v4, v7
    v_lshrrev_b32 v7, 4, v0
    v_lshlrev_b32 v7, 3, v7
    v_lshl_add_u32 v11, v4, 10, v7
    v_lshlrev_b32 v12, 1, v11
    v_lshlrev_b32 v4, 2, v4
    s_mul_i32 s6, s17, 20
    s_and_b32 s6, s6, 36
    s_lshl_b32 s66, s16, 6
    s_sub_u32 s67, 1984, s66
    s_and_b32 s73, s4, 3
    s_lshl_b32 s73, s73, 2
    s_add_u32 s73, s73, s3
    s_lshl_b32 s73, s73, 6
    s_add_u32 s66, s66, s6
    s_lshl_b32 s68, s66, 10
    s_add_u32 s68, s68, s73
    s_lshl_b32 s76, s68, 1
    s_lshl_b32 s66, s66, 2
    s_add_u32 s66, s66, 60817408
    s_add_u32 s67, s67, s6
    s_lshl_b32 s69, s67, 10
    s_add_u32 s69, s69, s73
    s_lshl_b32 s77, s69, 1
    s_lshl_b32 s67, s67, 2
    s_add_u32 s67, s67, 60817408
    s_mov_b32 s32, s74
    s_mov_b32 s33, s75
    s_mov_b32 s34, 0x400
    s_mov_b32 s35, 0x20000
    s_mov_b32 s36, s64
    s_mov_b32 s37, s65
    s_mov_b32 s38, 0x400000
    s_mov_b32 s39, 0x20000
    s_waitcnt lgkmcnt(6)
    v_mfma_f32_16x16x32_bf16 v[48:51], v[224:227], a[144:147], 0
    s_xor_b32 m0, s42, 65536
    ds_read_b128 a[176:179], v8 offset:0
    v_accvgpr_read_b32 v160, a64
    v_mfma_f32_16x16x32_bf16 v[80:83], v[240:243], a[144:147], 0
    s_add_u32 s44, s12, 0
    ds_read_b128 a[180:183], v8 offset:1024
    v_accvgpr_read_b32 v161, a65
    v_mfma_f32_16x16x32_bf16 v[132:135], v[224:227], a[148:151], 0
    buffer_load_dwordx4 v2, s[8:11], s44 offen sc1 lds
    v_accvgpr_read_b32 v162, a66
    v_mfma_f32_16x16x32_bf16 v[196:199], v[240:243], a[148:151], 0
    s_waitcnt lgkmcnt(6)
    ds_read_b128 a[184:187], v8 offset:2048
    v_accvgpr_read_b32 v163, a67
    v_mfma_f32_16x16x32_bf16 v[52:55], v[224:227], a[152:155], 0
    ds_read_b128 a[188:191], v8 offset:3072
    v_accvgpr_read_b32 v176, a72
    v_mfma_f32_16x16x32_bf16 v[84:87], v[240:243], a[152:155], 0
    buffer_load_dwordx4 v3, s[8:11], s44 offen offset:1024 sc1 lds
    v_accvgpr_read_b32 v177, a73
    v_mfma_f32_16x16x32_bf16 v[140:143], v[224:227], a[156:159], 0
    s_xor_b32 m0, s42, 73728
    ds_read_b128 a[192:195], v8 offset:4096
    v_accvgpr_read_b32 v178, a74
    v_mfma_f32_16x16x32_bf16 v[204:207], v[240:243], a[156:159], 0
    s_waitcnt lgkmcnt(7)
    v_accvgpr_read_b32 v179, a75
    v_mul_f32 v160, v232, v160
    v_mfma_f32_16x16x32_bf16 v[56:59], v[224:227], a[160:163], 0
    s_add_u32 s44, s12, 8192
    ds_read_b128 a[196:199], v8 offset:5120
    buffer_load_dwordx4 v2, s[8:11], s44 offen sc1 lds
    v_mfma_f32_16x16x32_bf16 v[88:91], v[240:243], a[160:163], 0
    ds_read_b128 a[200:203], v8 offset:6144
    v_mul_f32 v161, v232, v161
    v_mfma_f32_16x16x32_bf16 v[148:151], v[224:227], a[164:167], 0
    v_mul_f32 v162, v232, v162
    v_mul_f32 v163, v232, v163
    v_mfma_f32_16x16x32_bf16 v[212:215], v[240:243], a[164:167], 0
    s_waitcnt lgkmcnt(7)
    ds_read_b128 a[204:207], v8 offset:7168
    v_mul_f32 v176, v232, v176
    v_mfma_f32_16x16x32_bf16 v[60:63], v[224:227], a[168:171], 0
    buffer_load_dwordx4 v3, s[8:11], s44 offen offset:1024 sc1 lds
    v_mul_f32 v177, v232, v177
    v_mfma_f32_16x16x32_bf16 v[92:95], v[240:243], a[168:171], 0
    s_add_u32 s44, s41, 0
    v_mul_f32 v178, v232, v178
    v_mul_f32 v179, v232, v179
    v_mfma_f32_16x16x32_bf16 v[156:159], v[224:227], a[172:175], 0
    v_cvt_pk_bf16_f32 v160, v160, v161
    v_cvt_pk_bf16_f32 v161, v162, v163
    v_mfma_f32_16x16x32_bf16 v[220:223], v[240:243], a[172:175], 0
    s_waitcnt lgkmcnt(6)
    v_cvt_pk_bf16_f32 v162, v176, v177
    v_cvt_pk_bf16_f32 v163, v178, v179
    v_mfma_f32_16x16x32_bf16 v[48:51], v[112:115], a[176:179], v[48:51]
    ds_read_b128 a[144:147], v5 offset:16384
    buffer_store_dwordx4 v[160:163], v1, s[8:11], s44 offen offset:0 sc1
    v_mfma_f32_16x16x32_bf16 v[80:83], v[144:147], a[176:179], v[80:83]
    s_xor_b32 m0, s42, 81920
    ds_read_b128 a[148:151], v5 offset:17408
    v_accvgpr_read_b32 v192, a68
    v_mfma_f32_16x16x32_bf16 v[132:135], v[112:115], a[180:183], v[132:135]
    s_add_u32 s44, s12, 16384
    v_accvgpr_read_b32 v193, a69
    v_accvgpr_read_b32 v194, a70
    v_mfma_f32_16x16x32_bf16 v[196:199], v[144:147], a[180:183], v[196:199]
    s_waitcnt lgkmcnt(6)
    ds_read_b128 a[152:155], v5 offset:18432
    buffer_load_dwordx4 v2, s[8:11], s44 offen sc1 lds
    v_mfma_f32_16x16x32_bf16 v[52:55], v[112:115], a[184:187], v[52:55]
    ds_read_b128 a[156:159], v5 offset:19456
    v_accvgpr_read_b32 v195, a71
    v_mfma_f32_16x16x32_bf16 v[84:87], v[144:147], a[184:187], v[84:87]
    v_accvgpr_read_b32 v96, a76
    v_accvgpr_read_b32 v97, a77
    v_mfma_f32_16x16x32_bf16 v[140:143], v[112:115], a[188:191], v[140:143]
    ds_read_b128 a[160:163], v5 offset:20480
    v_accvgpr_read_b32 v98, a78
    v_mfma_f32_16x16x32_bf16 v[204:207], v[144:147], a[188:191], v[204:207]
    s_waitcnt lgkmcnt(7)
    buffer_load_dwordx4 v3, s[8:11], s44 offen offset:1024 sc1 lds
    v_accvgpr_read_b32 v99, a79
    v_mfma_f32_16x16x32_bf16 v[56:59], v[112:115], a[192:195], v[56:59]
    s_xor_b32 m0, s42, 90112
    ds_read_b128 a[164:167], v5 offset:21504
    v_mul_f32 v192, v233, v192
    v_mfma_f32_16x16x32_bf16 v[88:91], v[144:147], a[192:195], v[88:91]
    s_add_u32 s44, s12, 24576
    ds_read_b128 a[168:171], v5 offset:22528
    v_mul_f32 v193, v233, v193
    v_mfma_f32_16x16x32_bf16 v[148:151], v[112:115], a[196:199], v[148:151]
    v_mul_f32 v194, v233, v194
    v_mul_f32 v195, v233, v195
    v_mfma_f32_16x16x32_bf16 v[212:215], v[144:147], a[196:199], v[212:215]
    s_waitcnt lgkmcnt(7)
    ds_read_b128 a[172:175], v5 offset:23552
    v_mul_f32 v96, v233, v96
    v_mfma_f32_16x16x32_bf16 v[60:63], v[112:115], a[200:203], v[60:63]
    buffer_load_dwordx4 v2, s[8:11], s44 offen sc1 lds
    v_mul_f32 v97, v233, v97
    v_mfma_f32_16x16x32_bf16 v[92:95], v[144:147], a[200:203], v[92:95]
    v_mul_f32 v98, v233, v98
    v_mul_f32 v99, v233, v99
    v_mfma_f32_16x16x32_bf16 v[156:159], v[112:115], a[204:207], v[156:159]
    buffer_load_dwordx4 v3, s[8:11], s44 offen offset:1024 sc1 lds
    v_cvt_pk_bf16_f32 v192, v192, v193
    v_mfma_f32_16x16x32_bf16 v[220:223], v[144:147], a[204:207], v[220:223]
    s_waitcnt lgkmcnt(6)
    v_cvt_pk_bf16_f32 v193, v194, v195
    v_cvt_pk_bf16_f32 v194, v96, v97
    v_mfma_f32_16x16x32_bf16 v[48:51], v[136:139], a[144:147], v[48:51]
    s_add_u32 s44, s41, 0
    ds_read_b128 a[176:179], v5 offset:24576
    v_cvt_pk_bf16_f32 v195, v98, v99
    v_mfma_f32_16x16x32_bf16 v[80:83], v[152:155], a[144:147], v[80:83]
    ds_read_b128 a[180:183], v5 offset:25600
    v_accvgpr_read_b32 v64, a80
    v_mfma_f32_16x16x32_bf16 v[132:135], v[136:139], a[148:151], v[132:135]
    buffer_store_dwordx4 v[192:195], v1, s[8:11], s44 offen offset:1024 sc1
    v_accvgpr_read_b32 v65, a81
    v_mfma_f32_16x16x32_bf16 v[196:199], v[152:155], a[148:151], v[196:199]
    s_waitcnt lgkmcnt(6)
    ds_read_b128 a[184:187], v5 offset:26624
    v_accvgpr_read_b32 v66, a82
    v_mfma_f32_16x16x32_bf16 v[52:55], v[136:139], a[152:155], v[52:55]
    s_xor_b32 m0, s42, 98304
    ds_read_b128 a[188:191], v5 offset:27648
    v_accvgpr_read_b32 v67, a83
    v_mfma_f32_16x16x32_bf16 v[84:87], v[152:155], a[152:155], v[84:87]
    s_add_u32 s44, s12, 32768
    v_accvgpr_read_b32 v68, a88
    v_accvgpr_read_b32 v69, a89
    v_mfma_f32_16x16x32_bf16 v[140:143], v[136:139], a[156:159], v[140:143]
    ds_read_b128 a[192:195], v5 offset:28672
    v_accvgpr_read_b32 v70, a90
    v_accvgpr_read_b32 v71, a91
    v_mfma_f32_16x16x32_bf16 v[204:207], v[152:155], a[156:159], v[204:207]
    s_waitcnt lgkmcnt(7)
    buffer_load_dwordx4 v2, s[8:11], s44 offen sc1 lds
    v_mul_f32 v64, v232, v64
    v_mul_f32 v65, v232, v65
    v_mfma_f32_16x16x32_bf16 v[56:59], v[136:139], a[160:163], v[56:59]
    ds_read_b128 a[196:199], v5 offset:29696
    v_mul_f32 v66, v232, v66
    v_mul_f32 v67, v232, v67
    v_mfma_f32_16x16x32_bf16 v[88:91], v[152:155], a[160:163], v[88:91]
    ds_read_b128 a[200:203], v5 offset:30720
    v_mul_f32 v68, v232, v68
    v_mul_f32 v69, v232, v69
    v_mfma_f32_16x16x32_bf16 v[148:151], v[136:139], a[164:167], v[148:151]
    buffer_load_dwordx4 v3, s[8:11], s44 offen offset:1024 sc1 lds
    v_mul_f32 v70, v232, v70
    v_mul_f32 v71, v232, v71
    v_mfma_f32_16x16x32_bf16 v[212:215], v[152:155], a[164:167], v[212:215]
    s_waitcnt lgkmcnt(7)
    ds_read_b128 a[204:207], v5 offset:31744
    v_cvt_pk_bf16_f32 v64, v64, v65
    v_cvt_pk_bf16_f32 v65, v66, v67
    v_mfma_f32_16x16x32_bf16 v[60:63], v[136:139], a[168:171], v[60:63]
    s_add_u32 s44, s41, 4096
    v_cvt_pk_bf16_f32 v66, v68, v69
    v_cvt_pk_bf16_f32 v67, v70, v71
    v_mfma_f32_16x16x32_bf16 v[92:95], v[152:155], a[168:171], v[92:95]
    buffer_store_dwordx4 v[64:67], v1, s[8:11], s44 offen offset:0 sc1
    v_accvgpr_read_b32 v72, a84
    v_mfma_f32_16x16x32_bf16 v[156:159], v[136:139], a[172:175], v[156:159]
    s_xor_b32 m0, s42, 106496
    v_accvgpr_read_b32 v73, a85
    v_accvgpr_read_b32 v74, a86
    v_mfma_f32_16x16x32_bf16 v[220:223], v[152:155], a[172:175], v[220:223]
    s_waitcnt lgkmcnt(6)
    v_accvgpr_read_b32 v75, a87
    v_accvgpr_read_b32 v76, a92
    v_mfma_f32_16x16x32_bf16 v[48:51], v[168:171], a[176:179], v[48:51]
    s_waitcnt lgkmcnt(0)
    v_accvgpr_read_b32 v77, a93
    v_accvgpr_read_b32 v78, a94
    v_mfma_f32_16x16x32_bf16 v[80:83], v[120:123], a[176:179], v[80:83]
    s_waitcnt vmcnt(13)
    v_mfma_f32_16x16x32_bf16 v[132:135], v[168:171], a[180:183], v[132:135]
    s_barrier
    v_mfma_f32_16x16x32_bf16 v[196:199], v[120:123], a[180:183], v[196:199]
    s_add_u32 s44, s12, 40960
    ds_read_b128 a[144:147], v5 offset:32768
    buffer_load_dwordx4 v2, s[8:11], s44 offen sc1 lds
    v_mfma_f32_16x16x32_bf16 v[52:55], v[168:171], a[184:187], v[52:55]
    ds_read_b128 a[148:151], v5 offset:33792
    v_accvgpr_read_b32 v79, a95
    v_mfma_f32_16x16x32_bf16 v[84:87], v[120:123], a[184:187], v[84:87]
    ds_read_b128 a[152:155], v5 offset:34816
    v_mul_f32 v72, v233, v72
    v_mfma_f32_16x16x32_bf16 v[140:143], v[168:171], a[188:191], v[140:143]
    ds_read_b128 a[156:159], v5 offset:35840
    v_mul_f32 v73, v233, v73
    v_mfma_f32_16x16x32_bf16 v[204:207], v[120:123], a[188:191], v[204:207]
    buffer_load_dwordx4 v3, s[8:11], s44 offen offset:1024 sc1 lds
    v_mul_f32 v74, v233, v74
    v_mfma_f32_16x16x32_bf16 v[56:59], v[168:171], a[192:195], v[56:59]
    s_xor_b32 m0, s42, 114688
    ds_read_b128 a[160:163], v5 offset:36864
    v_mul_f32 v75, v233, v75
    v_mfma_f32_16x16x32_bf16 v[88:91], v[120:123], a[192:195], v[88:91]
    s_add_u32 s44, s12, 49152
    ds_read_b128 a[164:167], v5 offset:37888
    v_mul_f32 v76, v233, v76
    v_mfma_f32_16x16x32_bf16 v[148:151], v[168:171], a[196:199], v[148:151]
    ds_read_b128 a[168:171], v5 offset:38912
    buffer_load_dwordx4 v2, s[8:11], s44 offen sc1 lds
    v_mfma_f32_16x16x32_bf16 v[212:215], v[120:123], a[196:199], v[212:215]
    ds_read_b128 a[172:175], v5 offset:39936
    v_mul_f32 v77, v233, v77
    v_mfma_f32_16x16x32_bf16 v[60:63], v[168:171], a[200:203], v[60:63]
    v_mul_f32 v78, v233, v78
    v_mul_f32 v79, v233, v79
    v_mfma_f32_16x16x32_bf16 v[92:95], v[120:123], a[200:203], v[92:95]
    v_cvt_pk_bf16_f32 v72, v72, v73
    v_cvt_pk_bf16_f32 v73, v74, v75
    v_mfma_f32_16x16x32_bf16 v[156:159], v[168:171], a[204:207], v[156:159]
    buffer_load_dwordx4 v3, s[8:11], s44 offen offset:1024 sc1 lds
    v_cvt_pk_bf16_f32 v74, v76, v77
    v_mfma_f32_16x16x32_bf16 v[220:223], v[120:123], a[204:207], v[220:223]
    s_waitcnt lgkmcnt(6)
    v_cvt_pk_bf16_f32 v75, v78, v79
    v_accvgpr_read_b32 v160, a96
    v_mfma_f32_16x16x32_bf16 v[48:51], v[128:131], a[144:147], v[48:51]
    s_add_u32 s44, s41, 4096
    ds_read_b128 a[176:179], v5 offset:40960
    v_accvgpr_read_b32 v161, a97
    v_mfma_f32_16x16x32_bf16 v[80:83], v[172:175], a[144:147], v[80:83]
    ds_read_b128 a[180:183], v5 offset:41984
    v_accvgpr_read_b32 v162, a98
    v_mfma_f32_16x16x32_bf16 v[132:135], v[128:131], a[148:151], v[132:135]
    buffer_store_dwordx4 v[72:75], v1, s[8:11], s44 offen offset:1024 sc1
    v_accvgpr_read_b32 v163, a99
    v_mfma_f32_16x16x32_bf16 v[196:199], v[172:175], a[148:151], v[196:199]
    s_waitcnt lgkmcnt(6)
    ds_read_b128 a[184:187], v5 offset:43008
    v_accvgpr_read_b32 v176, a104
    v_mfma_f32_16x16x32_bf16 v[52:55], v[128:131], a[152:155], v[52:55]
    s_xor_b32 m0, s42, 122880
    ds_read_b128 a[188:191], v5 offset:44032
    v_accvgpr_read_b32 v177, a105
    v_mfma_f32_16x16x32_bf16 v[84:87], v[172:175], a[152:155], v[84:87]
    s_add_u32 s44, s12, 57344
    buffer_load_dwordx4 v2, s[8:11], s44 offen sc1 lds
    v_accvgpr_read_b32 v178, a106
    v_accvgpr_read_b32 v179, a107
    v_mfma_f32_16x16x32_bf16 v[140:143], v[128:131], a[156:159], v[140:143]
    ds_read_b128 a[192:195], v5 offset:45056
    v_mul_f32 v160, v232, v160
    v_mul_f32 v161, v232, v161
    v_mfma_f32_16x16x32_bf16 v[204:207], v[172:175], a[156:159], v[204:207]
    s_waitcnt lgkmcnt(7)
    v_mul_f32 v162, v232, v162
    v_mul_f32 v163, v232, v163
    v_mfma_f32_16x16x32_bf16 v[56:59], v[128:131], a[160:163], v[56:59]
    ds_read_b128 a[196:199], v5 offset:46080
    v_mul_f32 v176, v232, v176
    v_mul_f32 v177, v232, v177
    v_mfma_f32_16x16x32_bf16 v[88:91], v[172:175], a[160:163], v[88:91]
    ds_read_b128 a[200:203], v5 offset:47104
    v_mul_f32 v178, v232, v178
    v_mul_f32 v179, v232, v179
    v_mfma_f32_16x16x32_bf16 v[148:151], v[128:131], a[164:167], v[148:151]
    buffer_load_dwordx4 v3, s[8:11], s44 offen offset:1024 sc1 lds
    v_cvt_pk_bf16_f32 v160, v160, v161
    v_cvt_pk_bf16_f32 v161, v162, v163
    v_mfma_f32_16x16x32_bf16 v[212:215], v[172:175], a[164:167], v[212:215]
    s_waitcnt lgkmcnt(7)
    ds_read_b128 a[204:207], v5 offset:48128
    v_cvt_pk_bf16_f32 v162, v176, v177
    v_cvt_pk_bf16_f32 v163, v178, v179
    v_mfma_f32_16x16x32_bf16 v[60:63], v[128:131], a[168:171], v[60:63]
    s_add_u32 s44, s41, 8192
    buffer_store_dwordx4 v[160:163], v1, s[8:11], s44 offen offset:0 sc1
    v_accvgpr_read_b32 v192, a100
    v_mfma_f32_16x16x32_bf16 v[92:95], v[172:175], a[168:171], v[92:95]
    s_xor_b32 m0, s42, 0
    v_accvgpr_read_b32 v193, a101
    v_accvgpr_read_b32 v194, a102
    v_mfma_f32_16x16x32_bf16 v[156:159], v[128:131], a[172:175], v[156:159]
    s_add_u32 s44, s12, 65536
    v_accvgpr_read_b32 v195, a103
    v_accvgpr_read_b32 v96, a108
    v_mfma_f32_16x16x32_bf16 v[220:223], v[172:175], a[172:175], v[220:223]
    s_waitcnt lgkmcnt(6)
    v_accvgpr_read_b32 v97, a109
    v_accvgpr_read_b32 v98, a110
    v_mfma_f32_16x16x32_bf16 v[48:51], v[180:183], a[176:179], v[48:51]
    ds_read_b128 a[144:147], v5 offset:49152
    buffer_load_dwordx4 v2, s[8:11], s44 offen sc1 lds
    v_mfma_f32_16x16x32_bf16 v[80:83], v[16:19], a[176:179], v[80:83]
    ds_read_b128 a[148:151], v5 offset:50176
    v_accvgpr_read_b32 v99, a111
    v_mfma_f32_16x16x32_bf16 v[132:135], v[180:183], a[180:183], v[132:135]
    v_mul_f32 v192, v233, v192
    v_mul_f32 v193, v233, v193
    v_mfma_f32_16x16x32_bf16 v[196:199], v[16:19], a[180:183], v[196:199]
    s_waitcnt lgkmcnt(6)
    ds_read_b128 a[152:155], v5 offset:51200
    v_mul_f32 v194, v233, v194
    v_mfma_f32_16x16x32_bf16 v[52:55], v[180:183], a[184:187], v[52:55]
    ds_read_b128 a[156:159], v5 offset:52224
    v_mul_f32 v195, v233, v195
    v_mfma_f32_16x16x32_bf16 v[84:87], v[16:19], a[184:187], v[84:87]
    buffer_load_dwordx4 v3, s[8:11], s44 offen offset:1024 sc1 lds
    v_mul_f32 v96, v233, v96
    v_mfma_f32_16x16x32_bf16 v[140:143], v[180:183], a[188:191], v[140:143]
    s_xor_b32 m0, s42, 8192
    ds_read_b128 a[160:163], v5 offset:53248
    v_mul_f32 v97, v233, v97
    v_mfma_f32_16x16x32_bf16 v[204:207], v[16:19], a[188:191], v[204:207]
    s_waitcnt lgkmcnt(7)
    v_mul_f32 v98, v233, v98
    v_mul_f32 v99, v233, v99
    v_mfma_f32_16x16x32_bf16 v[56:59], v[180:183], a[192:195], v[56:59]
    s_add_u32 s44, s12, 73728
    ds_read_b128 a[164:167], v5 offset:54272
    buffer_load_dwordx4 v2, s[8:11], s44 offen sc1 lds
    v_mfma_f32_16x16x32_bf16 v[88:91], v[16:19], a[192:195], v[88:91]
    ds_read_b128 a[168:171], v5 offset:55296
    v_cvt_pk_bf16_f32 v192, v192, v193
    v_mfma_f32_16x16x32_bf16 v[148:151], v[180:183], a[196:199], v[148:151]
    v_cvt_pk_bf16_f32 v193, v194, v195
    v_cvt_pk_bf16_f32 v194, v96, v97
    v_mfma_f32_16x16x32_bf16 v[212:215], v[16:19], a[196:199], v[212:215]
    s_waitcnt lgkmcnt(7)
    ds_read_b128 a[172:175], v5 offset:56320
    v_cvt_pk_bf16_f32 v195, v98, v99
    v_mfma_f32_16x16x32_bf16 v[60:63], v[180:183], a[200:203], v[60:63]
    buffer_load_dwordx4 v3, s[8:11], s44 offen offset:1024 sc1 lds
    v_accvgpr_read_b32 v64, a112
    v_mfma_f32_16x16x32_bf16 v[92:95], v[16:19], a[200:203], v[92:95]
    s_add_u32 s44, s41, 8192
    v_accvgpr_read_b32 v65, a113
    v_accvgpr_read_b32 v66, a114
    v_mfma_f32_16x16x32_bf16 v[156:159], v[180:183], a[204:207], v[156:159]
    v_accvgpr_read_b32 v67, a115
    v_accvgpr_read_b32 v68, a120
    v_mfma_f32_16x16x32_bf16 v[220:223], v[16:19], a[204:207], v[220:223]
    s_waitcnt lgkmcnt(6)
    v_accvgpr_read_b32 v69, a121
    v_accvgpr_read_b32 v70, a122
    v_mfma_f32_16x16x32_bf16 v[48:51], v[20:23], a[144:147], v[48:51]
    ds_read_b128 a[176:179], v5 offset:57344
    buffer_store_dwordx4 v[192:195], v1, s[8:11], s44 offen offset:1024 sc1
    v_mfma_f32_16x16x32_bf16 v[80:83], v[24:27], a[144:147], v[80:83]
    s_xor_b32 m0, s42, 16384
    ds_read_b128 a[180:183], v5 offset:58368
    v_accvgpr_read_b32 v71, a123
    v_mfma_f32_16x16x32_bf16 v[132:135], v[20:23], a[148:151], v[132:135]
    s_add_u32 s44, s12, 81920
    v_mul_f32 v64, v232, v64
    v_mul_f32 v65, v232, v65
    v_mfma_f32_16x16x32_bf16 v[196:199], v[24:27], a[148:151], v[196:199]
    s_waitcnt lgkmcnt(6)
    ds_read_b128 a[184:187], v5 offset:59392
    buffer_load_dwordx4 v2, s[8:11], s44 offen sc1 lds
    v_mfma_f32_16x16x32_bf16 v[52:55], v[20:23], a[152:155], v[52:55]
    ds_read_b128 a[188:191], v5 offset:60416
    v_mul_f32 v66, v232, v66
    v_mfma_f32_16x16x32_bf16 v[84:87], v[24:27], a[152:155], v[84:87]
    v_mul_f32 v67, v232, v67
    v_mul_f32 v68, v232, v68
    v_mfma_f32_16x16x32_bf16 v[140:143], v[20:23], a[156:159], v[140:143]
    ds_read_b128 a[192:195], v5 offset:61440
    v_mul_f32 v69, v232, v69
    v_mfma_f32_16x16x32_bf16 v[204:207], v[24:27], a[156:159], v[204:207]
    s_waitcnt lgkmcnt(7)
    buffer_load_dwordx4 v3, s[8:11], s44 offen offset:1024 sc1 lds
    v_mul_f32 v70, v232, v70
    v_mfma_f32_16x16x32_bf16 v[56:59], v[20:23], a[160:163], v[56:59]
    s_add_u32 s44, s41, 12288
    ds_read_b128 a[196:199], v5 offset:62464
    v_mul_f32 v71, v232, v71
    v_mfma_f32_16x16x32_bf16 v[88:91], v[24:27], a[160:163], v[88:91]
    ds_read_b128 a[200:203], v5 offset:63488
    v_cvt_pk_bf16_f32 v64, v64, v65
    v_mfma_f32_16x16x32_bf16 v[148:151], v[20:23], a[164:167], v[148:151]
    v_cvt_pk_bf16_f32 v65, v66, v67
    v_cvt_pk_bf16_f32 v66, v68, v69
    v_mfma_f32_16x16x32_bf16 v[212:215], v[24:27], a[164:167], v[212:215]
    s_waitcnt lgkmcnt(7)
    ds_read_b128 a[204:207], v5 offset:64512
    v_cvt_pk_bf16_f32 v67, v70, v71
    v_mfma_f32_16x16x32_bf16 v[60:63], v[20:23], a[168:171], v[60:63]
    buffer_store_dwordx4 v[64:67], v1, s[8:11], s44 offen offset:0 sc1
    v_accvgpr_read_b32 v72, a116
    v_mfma_f32_16x16x32_bf16 v[92:95], v[24:27], a[168:171], v[92:95]
    s_xor_b32 m0, s42, 24576
    v_accvgpr_read_b32 v73, a117
    v_accvgpr_read_b32 v74, a118
    v_mfma_f32_16x16x32_bf16 v[156:159], v[20:23], a[172:175], v[156:159]
    s_add_u32 s44, s12, 90112
    buffer_load_dwordx4 v2, s[8:11], s44 offen sc1 lds
    v_accvgpr_read_b32 v75, a119
    v_mfma_f32_16x16x32_bf16 v[220:223], v[24:27], a[172:175], v[220:223]
    s_waitcnt lgkmcnt(6)
    v_accvgpr_read_b32 v76, a124
    v_accvgpr_read_b32 v77, a125
    v_mfma_f32_16x16x32_bf16 v[48:51], v[28:31], a[176:179], v[48:51]
    s_waitcnt lgkmcnt(0)
    v_accvgpr_read_b32 v78, a126
    v_accvgpr_read_b32 v79, a127
    v_mfma_f32_16x16x32_bf16 v[80:83], v[32:35], a[176:179], v[80:83]
    s_waitcnt vmcnt(21)
    v_mfma_f32_16x16x32_bf16 v[132:135], v[28:31], a[180:183], v[132:135]
    s_barrier
    v_mfma_f32_16x16x32_bf16 v[196:199], v[32:35], a[180:183], v[196:199]
    ds_read_b128 a[144:147], v6 offset:0
    buffer_load_dwordx4 v3, s[8:11], s44 offen offset:1024 sc1 lds
    v_mfma_f32_16x16x32_bf16 v[52:55], v[28:31], a[184:187], v[52:55]
    s_add_u32 s62, s15, 45056
    ds_read_b128 a[148:151], v6 offset:1024
    v_mul_f32 v72, v233, v72
    v_mfma_f32_16x16x32_bf16 v[84:87], v[32:35], a[184:187], v[84:87]
    ds_read_b128 a[152:155], v6 offset:2048
    v_mul_f32 v73, v233, v73
    v_mfma_f32_16x16x32_bf16 v[140:143], v[28:31], a[188:191], v[140:143]
    ds_read_b128 a[156:159], v6 offset:3072
    v_mul_f32 v74, v233, v74
    v_mfma_f32_16x16x32_bf16 v[204:207], v[32:35], a[188:191], v[204:207]
    buffer_load_dwordx4 v[36:39], v1, s[8:11], s62 offen offset:0 sc1
    v_mul_f32 v75, v233, v75
    v_mfma_f32_16x16x32_bf16 v[56:59], v[28:31], a[192:195], v[56:59]
    ds_read_b128 a[160:163], v6 offset:4096
    v_mul_f32 v76, v233, v76
    v_mul_f32 v77, v233, v77
    v_mfma_f32_16x16x32_bf16 v[88:91], v[32:35], a[192:195], v[88:91]
    ds_read_b128 a[164:167], v6 offset:5120
    buffer_load_dwordx4 v[40:43], v1, s[8:11], s62 offen offset:1024 sc1
    v_mfma_f32_16x16x32_bf16 v[148:151], v[28:31], a[196:199], v[148:151]
    s_add_u32 s44, s41, 12288
    ds_read_b128 a[168:171], v6 offset:6144
    v_mul_f32 v78, v233, v78
    v_mul_f32 v79, v233, v79
    v_mfma_f32_16x16x32_bf16 v[212:215], v[32:35], a[196:199], v[212:215]
    ds_read_b128 a[172:175], v6 offset:7168
    v_cvt_pk_bf16_f32 v72, v72, v73
    v_cvt_pk_bf16_f32 v73, v74, v75
    v_mfma_f32_16x16x32_bf16 v[60:63], v[28:31], a[200:203], v[60:63]
    v_cvt_pk_bf16_f32 v74, v76, v77
    v_cvt_pk_bf16_f32 v75, v78, v79
    v_mfma_f32_16x16x32_bf16 v[92:95], v[32:35], a[200:203], v[92:95]
    buffer_store_dwordx4 v[72:75], v1, s[8:11], s44 offen offset:1024 sc1
    v_mfma_f32_16x16x32_bf16 v[156:159], v[28:31], a[204:207], v[156:159]
    s_add_u32 s62, s15, 49152
    v_mfma_f32_16x16x32_bf16 v[220:223], v[32:35], a[204:207], v[220:223]
    s_waitcnt lgkmcnt(6)
    v_mfma_f32_16x16x32_bf16 v[224:227], a[0:3], a[144:147], v[48:51]
    ds_read_b128 a[176:179], v6 offset:8192
    v_mfma_f32_16x16x32_bf16 v[240:243], a[4:7], a[144:147], v[80:83]
    ds_read_b128 a[180:183], v6 offset:9216
    v_mfma_f32_16x16x32_bf16 v[112:115], a[0:3], a[148:151], v[132:135]
    buffer_load_dwordx4 v[44:47], v1, s[8:11], s62 offen offset:0 sc1
    v_mfma_f32_16x16x32_bf16 v[144:147], a[4:7], a[148:151], v[196:199]
    s_waitcnt lgkmcnt(6)
    ds_read_b128 a[184:187], v6 offset:10240
    v_mfma_f32_16x16x32_bf16 v[136:139], a[0:3], a[152:155], v[52:55]
    ds_read_b128 a[188:191], v6 offset:11264
    v_mfma_f32_16x16x32_bf16 v[152:155], a[4:7], a[152:155], v[84:87]
    buffer_load_dwordx4 v[116:119], v1, s[8:11], s62 offen offset:1024 sc1
    v_mfma_f32_16x16x32_bf16 v[168:171], a[0:3], a[156:159], v[140:143]
    s_add_u32 s62, s15, 53248
    ds_read_b128 a[192:195], v6 offset:12288
    v_mfma_f32_16x16x32_bf16 v[120:123], a[4:7], a[156:159], v[204:207]
    s_waitcnt lgkmcnt(7)
    v_mfma_f32_16x16x32_bf16 v[224:227], a[8:11], a[160:163], v[224:227]
    ds_read_b128 a[196:199], v6 offset:13312
    buffer_load_dwordx4 v[124:127], v1, s[8:11], s62 offen offset:0 sc1
    v_mfma_f32_16x16x32_bf16 v[240:243], a[12:15], a[160:163], v[240:243]
    ds_read_b128 a[200:203], v6 offset:14336
    v_mfma_f32_16x16x32_bf16 v[112:115], a[8:11], a[164:167], v[112:115]
    v_mfma_f32_16x16x32_bf16 v[144:147], a[12:15], a[164:167], v[144:147]
    s_waitcnt lgkmcnt(7)
    ds_read_b128 a[204:207], v6 offset:15360
    v_mfma_f32_16x16x32_bf16 v[136:139], a[8:11], a[168:171], v[136:139]
    buffer_load_dwordx4 v[164:167], v1, s[8:11], s62 offen offset:1024 sc1
    v_mfma_f32_16x16x32_bf16 v[152:155], a[12:15], a[168:171], v[152:155]
    s_add_u32 s62, s15, 57344
    v_mfma_f32_16x16x32_bf16 v[168:171], a[8:11], a[172:175], v[168:171]
    v_mfma_f32_16x16x32_bf16 v[120:123], a[12:15], a[172:175], v[120:123]
    s_waitcnt lgkmcnt(6)
    buffer_load_dwordx4 v[188:191], v1, s[8:11], s62 offen offset:0 sc1
    v_mfma_f32_16x16x32_bf16 v[224:227], a[16:19], a[176:179], v[224:227]
    ds_read_b128 a[64:67], v6 offset:16384
    v_mfma_f32_16x16x32_bf16 v[240:243], a[20:23], a[176:179], v[240:243]
    ds_read_b128 a[68:71], v6 offset:17408
    v_mfma_f32_16x16x32_bf16 v[112:115], a[16:19], a[180:183], v[112:115]
    v_mfma_f32_16x16x32_bf16 v[144:147], a[20:23], a[180:183], v[144:147]
    s_waitcnt lgkmcnt(6)
    ds_read_b128 a[72:75], v6 offset:18432
    buffer_load_dwordx4 v[228:231], v1, s[8:11], s62 offen offset:1024 sc1
    v_mfma_f32_16x16x32_bf16 v[136:139], a[16:19], a[184:187], v[136:139]
    s_add_u32 s62, s15, 61440
    ds_read_b128 a[76:79], v6 offset:19456
    v_mfma_f32_16x16x32_bf16 v[152:155], a[20:23], a[184:187], v[152:155]
    v_mfma_f32_16x16x32_bf16 v[168:171], a[16:19], a[188:191], v[168:171]
    ds_read_b128 a[80:83], v6 offset:20480
    v_mfma_f32_16x16x32_bf16 v[120:123], a[20:23], a[188:191], v[120:123]
    s_waitcnt lgkmcnt(7)
    buffer_load_dwordx4 v[236:239], v1, s[8:11], s62 offen offset:0 sc1
    v_mfma_f32_16x16x32_bf16 v[224:227], a[24:27], a[192:195], v[224:227]
    ds_read_b128 a[84:87], v6 offset:21504
    v_mfma_f32_16x16x32_bf16 v[240:243], a[28:31], a[192:195], v[240:243]
    ds_read_b128 a[88:91], v6 offset:22528
    v_mfma_f32_16x16x32_bf16 v[112:115], a[24:27], a[196:199], v[112:115]
    buffer_load_dwordx4 v[244:247], v1, s[8:11], s62 offen offset:1024 sc1
    v_mfma_f32_16x16x32_bf16 v[144:147], a[28:31], a[196:199], v[144:147]
    s_waitcnt lgkmcnt(7)
    ds_read_b128 a[92:95], v6 offset:23552
    v_mfma_f32_16x16x32_bf16 v[136:139], a[24:27], a[200:203], v[136:139]
    s_add_u32 s62, s15, 65536
    v_mfma_f32_16x16x32_bf16 v[152:155], a[28:31], a[200:203], v[152:155]
    v_mfma_f32_16x16x32_bf16 v[168:171], a[24:27], a[204:207], v[168:171]
    buffer_load_dwordx4 v[252:255], v1, s[8:11], s62 offen offset:0 sc1
    v_mfma_f32_16x16x32_bf16 v[120:123], a[28:31], a[204:207], v[120:123]
    s_waitcnt lgkmcnt(6)
    v_mfma_f32_16x16x32_bf16 v[224:227], a[32:35], a[64:67], v[224:227]
    ds_read_b128 a[96:99], v6 offset:24576
    v_mfma_f32_16x16x32_bf16 v[240:243], a[36:39], a[64:67], v[240:243]
    ds_read_b128 a[100:103], v6 offset:25600
    v_mfma_f32_16x16x32_bf16 v[112:115], a[32:35], a[68:71], v[112:115]
    buffer_load_dwordx4 v[184:187], v1, s[8:11], s62 offen offset:1024 sc1
    v_mfma_f32_16x16x32_bf16 v[144:147], a[36:39], a[68:71], v[144:147]
    s_waitcnt lgkmcnt(6)
    ds_read_b128 a[104:107], v6 offset:26624
    v_mfma_f32_16x16x32_bf16 v[136:139], a[32:35], a[72:75], v[136:139]
    s_add_u32 s62, s15, 69632
    ds_read_b128 a[108:111], v6 offset:27648
    v_mfma_f32_16x16x32_bf16 v[152:155], a[36:39], a[72:75], v[152:155]
    buffer_load_dwordx4 v[104:107], v1, s[8:11], s62 offen offset:0 sc1
    v_mfma_f32_16x16x32_bf16 v[168:171], a[32:35], a[76:79], v[168:171]
    ds_read_b128 a[112:115], v6 offset:28672
    v_mfma_f32_16x16x32_bf16 v[120:123], a[36:39], a[76:79], v[120:123]
    s_waitcnt lgkmcnt(7)
    v_mfma_f32_16x16x32_bf16 v[224:227], a[40:43], a[80:83], v[224:227]
    ds_read_b128 a[116:119], v6 offset:29696
    v_mfma_f32_16x16x32_bf16 v[240:243], a[44:47], a[80:83], v[240:243]
    ds_read_b128 a[120:123], v6 offset:30720
    v_mfma_f32_16x16x32_bf16 v[112:115], a[40:43], a[84:87], v[112:115]
    buffer_load_dwordx4 v[208:211], v1, s[8:11], s62 offen offset:1024 sc1
    v_mfma_f32_16x16x32_bf16 v[144:147], a[44:47], a[84:87], v[144:147]
    s_waitcnt lgkmcnt(7)
    ds_read_b128 a[124:127], v6 offset:31744
    v_mfma_f32_16x16x32_bf16 v[136:139], a[40:43], a[88:91], v[136:139]
    s_add_u32 s62, s15, 73728
    v_mfma_f32_16x16x32_bf16 v[152:155], a[44:47], a[88:91], v[152:155]
    s_waitcnt vmcnt(12)
    buffer_store_dword v15, off, s[8:11], s43 sc1
    v_mfma_f32_16x16x32_bf16 v[168:171], a[40:43], a[92:95], v[168:171]
    v_mfma_f32_16x16x32_bf16 v[120:123], a[44:47], a[92:95], v[120:123]
    s_waitcnt lgkmcnt(6)
    buffer_load_dwordx4 a[240:243], v1, s[8:11], s62 offen offset:0 sc1
    v_mfma_f32_16x16x32_bf16 v[224:227], a[48:51], a[96:99], v[224:227]
    s_waitcnt lgkmcnt(0)
    v_mfma_f32_16x16x32_bf16 v[240:243], a[52:55], a[96:99], v[240:243]
    s_waitcnt vmcnt(28)
    v_mfma_f32_16x16x32_bf16 v[112:115], a[48:51], a[100:103], v[112:115]
    s_barrier
    v_mfma_f32_16x16x32_bf16 v[144:147], a[52:55], a[100:103], v[144:147]
    ds_read_b128 a[64:67], v6 offset:32768
    buffer_load_dwordx4 a[244:247], v1, s[8:11], s62 offen offset:1024 sc1
    v_mfma_f32_16x16x32_bf16 v[136:139], a[48:51], a[104:107], v[136:139]
    s_xor_b32 m0, s42, 32768
    ds_read_b128 a[68:71], v6 offset:33792
    v_mfma_f32_16x16x32_bf16 v[152:155], a[52:55], a[104:107], v[152:155]
    s_add_u32 s44, s12, 98304
    ds_read_b128 a[72:75], v6 offset:34816
    v_mfma_f32_16x16x32_bf16 v[168:171], a[48:51], a[108:111], v[168:171]
    ds_read_b128 a[76:79], v6 offset:35840
    v_mfma_f32_16x16x32_bf16 v[120:123], a[52:55], a[108:111], v[120:123]
    buffer_load_dwordx4 v2, s[8:11], s44 offen sc1 lds
    v_mfma_f32_16x16x32_bf16 v[224:227], a[56:59], a[112:115], v[224:227]
    ds_read_b128 a[80:83], v6 offset:36864
    v_mfma_f32_16x16x32_bf16 v[240:243], a[60:63], a[112:115], v[240:243]
    ds_read_b128 a[84:87], v6 offset:37888
    v_mfma_f32_16x16x32_bf16 v[112:115], a[56:59], a[116:119], v[112:115]
    ds_read_b128 a[88:91], v6 offset:38912
    buffer_load_dwordx4 v3, s[8:11], s44 offen offset:1024 sc1 lds
    v_mfma_f32_16x16x32_bf16 v[144:147], a[60:63], a[116:119], v[144:147]
    s_xor_b32 m0, s42, 40960
    ds_read_b128 a[92:95], v6 offset:39936
    v_mfma_f32_16x16x32_bf16 v[136:139], a[56:59], a[120:123], v[136:139]
    s_add_u32 s44, s12, 106496
    v_mfma_f32_16x16x32_bf16 v[152:155], a[60:63], a[120:123], v[152:155]
    buffer_load_dwordx4 v2, s[8:11], s44 offen sc1 lds
    v_mfma_f32_16x16x32_bf16 v[168:171], a[56:59], a[124:127], v[168:171]
    v_mfma_f32_16x16x32_bf16 v[120:123], a[60:63], a[124:127], v[120:123]
    s_waitcnt lgkmcnt(6)
    v_mfma_f32_16x16x32_bf16 v[224:227], a[128:131], a[64:67], v[224:227]
    ds_read_b128 a[96:99], v6 offset:40960
    v_mfma_f32_16x16x32_bf16 v[240:243], a[132:135], a[64:67], v[240:243]
    ds_read_b128 a[100:103], v6 offset:41984
    v_mfma_f32_16x16x32_bf16 v[112:115], a[128:131], a[68:71], v[112:115]
    buffer_load_dwordx4 v3, s[8:11], s44 offen offset:1024 sc1 lds
    v_mfma_f32_16x16x32_bf16 v[144:147], a[132:135], a[68:71], v[144:147]
    s_waitcnt lgkmcnt(6)
    ds_read_b128 a[104:107], v6 offset:43008
    v_mfma_f32_16x16x32_bf16 v[136:139], a[128:131], a[72:75], v[136:139]
    s_xor_b32 m0, s42, 49152
    ds_read_b128 a[108:111], v6 offset:44032
    v_mfma_f32_16x16x32_bf16 v[152:155], a[132:135], a[72:75], v[152:155]
    s_add_u32 s44, s12, 114688
    buffer_load_dwordx4 v2, s[8:11], s44 offen sc1 lds
    v_mfma_f32_16x16x32_bf16 v[168:171], a[128:131], a[76:79], v[168:171]
    ds_read_b128 a[112:115], v6 offset:45056
    v_mfma_f32_16x16x32_bf16 v[120:123], a[132:135], a[76:79], v[120:123]
    s_waitcnt lgkmcnt(7)
    v_mfma_f32_16x16x32_bf16 v[224:227], a[212:215], a[80:83], v[224:227]
    ds_read_b128 a[116:119], v6 offset:46080
    buffer_load_dwordx4 v3, s[8:11], s44 offen offset:1024 sc1 lds
    v_mfma_f32_16x16x32_bf16 v[240:243], a[216:219], a[80:83], v[240:243]
    s_xor_b32 m0, s42, 57344
    ds_read_b128 a[120:123], v6 offset:47104
    v_mfma_f32_16x16x32_bf16 v[112:115], a[212:215], a[84:87], v[112:115]
    s_add_u32 s44, s12, 122880
    v_mfma_f32_16x16x32_bf16 v[144:147], a[216:219], a[84:87], v[144:147]
    s_waitcnt lgkmcnt(7)
    ds_read_b128 a[124:127], v6 offset:48128
    v_mfma_f32_16x16x32_bf16 v[136:139], a[212:215], a[88:91], v[136:139]
    buffer_load_dwordx4 v2, s[8:11], s44 offen sc1 lds
    v_mfma_f32_16x16x32_bf16 v[152:155], a[216:219], a[88:91], v[152:155]
    v_mfma_f32_16x16x32_bf16 v[168:171], a[212:215], a[92:95], v[168:171]
    v_mfma_f32_16x16x32_bf16 v[120:123], a[216:219], a[92:95], v[120:123]
    s_waitcnt lgkmcnt(6)
    v_mfma_f32_16x16x32_bf16 v[224:227], a[220:223], a[96:99], v[224:227]
    ds_read_b128 a[64:67], v6 offset:49152
    buffer_load_dwordx4 v3, s[8:11], s44 offen offset:1024 sc1 lds
    v_mfma_f32_16x16x32_bf16 v[240:243], a[252:255], a[96:99], v[240:243]
    s_add_u32 s62, s15, 77824
    ds_read_b128 a[68:71], v6 offset:50176
    v_mfma_f32_16x16x32_bf16 v[112:115], a[220:223], a[100:103], v[112:115]
    v_mfma_f32_16x16x32_bf16 v[144:147], a[252:255], a[100:103], v[144:147]
    s_waitcnt lgkmcnt(6)
    ds_read_b128 a[72:75], v6 offset:51200
    buffer_load_dwordx4 a[248:251], v1, s[8:11], s62 offen offset:0 sc1
    v_mfma_f32_16x16x32_bf16 v[136:139], a[220:223], a[104:107], v[136:139]
    ds_read_b128 a[76:79], v6 offset:52224
    v_mfma_f32_16x16x32_bf16 v[152:155], a[252:255], a[104:107], v[152:155]
    v_mfma_f32_16x16x32_bf16 v[168:171], a[220:223], a[108:111], v[168:171]
    ds_read_b128 a[80:83], v6 offset:53248
    v_mfma_f32_16x16x32_bf16 v[120:123], a[252:255], a[108:111], v[120:123]
    s_waitcnt lgkmcnt(7)
    buffer_load_dwordx4 a[144:147], v1, s[8:11], s62 offen offset:1024 sc1
    v_mfma_f32_16x16x32_bf16 v[224:227], v[36:39], a[112:115], v[224:227]
    s_add_u32 s62, s15, 81920
    ds_read_b128 a[84:87], v6 offset:54272
    v_mfma_f32_16x16x32_bf16 v[240:243], v[40:43], a[112:115], v[240:243]
    ds_read_b128 a[88:91], v6 offset:55296
    v_mfma_f32_16x16x32_bf16 v[112:115], v[36:39], a[116:119], v[112:115]
    v_mfma_f32_16x16x32_bf16 v[144:147], v[40:43], a[116:119], v[144:147]
    s_waitcnt lgkmcnt(7)
    ds_read_b128 a[92:95], v6 offset:56320
    v_mfma_f32_16x16x32_bf16 v[136:139], v[36:39], a[120:123], v[136:139]
    buffer_load_dwordx4 a[148:151], v1, s[8:11], s62 offen offset:0 sc1
    v_mfma_f32_16x16x32_bf16 v[152:155], v[40:43], a[120:123], v[152:155]
    v_mfma_f32_16x16x32_bf16 v[168:171], v[36:39], a[124:127], v[168:171]
    buffer_load_dwordx4 a[152:155], v1, s[8:11], s62 offen offset:1024 sc1
    v_mfma_f32_16x16x32_bf16 v[120:123], v[40:43], a[124:127], v[120:123]
    s_waitcnt lgkmcnt(6)
    s_waitcnt vmcnt(25)
    v_mfma_f32_16x16x32_bf16 v[224:227], v[44:47], a[64:67], v[224:227]
    s_add_u32 s62, s15, 86016
    ds_read_b128 a[96:99], v6 offset:57344
    v_mfma_f32_16x16x32_bf16 v[240:243], v[116:119], a[64:67], v[240:243]
    ds_read_b128 a[100:103], v6 offset:58368
    v_mfma_f32_16x16x32_bf16 v[112:115], v[44:47], a[68:71], v[112:115]
    buffer_load_dwordx4 a[156:159], v1, s[8:11], s62 offen offset:0 sc1
    v_mfma_f32_16x16x32_bf16 v[144:147], v[116:119], a[68:71], v[144:147]
    s_waitcnt lgkmcnt(6)
    ds_read_b128 a[104:107], v6 offset:59392
    v_mfma_f32_16x16x32_bf16 v[136:139], v[44:47], a[72:75], v[136:139]
    ds_read_b128 a[108:111], v6 offset:60416
    v_mfma_f32_16x16x32_bf16 v[152:155], v[116:119], a[72:75], v[152:155]
    v_mfma_f32_16x16x32_bf16 v[168:171], v[44:47], a[76:79], v[168:171]
    ds_read_b128 a[112:115], v6 offset:61440
    v_mfma_f32_16x16x32_bf16 v[120:123], v[116:119], a[76:79], v[120:123]
    s_waitcnt lgkmcnt(7)
    s_waitcnt vmcnt(24)
    buffer_load_dwordx4 a[160:163], v1, s[8:11], s62 offen offset:1024 sc1
    v_mfma_f32_16x16x32_bf16 v[224:227], v[124:127], a[80:83], v[224:227]
    s_add_u32 s62, s15, 90112
    ds_read_b128 a[116:119], v6 offset:62464
    v_mfma_f32_16x16x32_bf16 v[240:243], v[164:167], a[80:83], v[240:243]
    ds_read_b128 a[120:123], v6 offset:63488
    v_mfma_f32_16x16x32_bf16 v[112:115], v[124:127], a[84:87], v[112:115]
    buffer_load_dwordx4 a[164:167], v1, s[8:11], s62 offen offset:0 sc1
    v_mfma_f32_16x16x32_bf16 v[144:147], v[164:167], a[84:87], v[144:147]
    s_waitcnt lgkmcnt(7)
    ds_read_b128 a[124:127], v6 offset:64512
    v_mfma_f32_16x16x32_bf16 v[136:139], v[124:127], a[88:91], v[136:139]
    v_mfma_f32_16x16x32_bf16 v[152:155], v[164:167], a[88:91], v[152:155]
    buffer_load_dwordx4 a[168:171], v1, s[8:11], s62 offen offset:1024 sc1
    v_mfma_f32_16x16x32_bf16 v[168:171], v[124:127], a[92:95], v[168:171]
    s_add_u32 s62, s15, 94208
    v_mfma_f32_16x16x32_bf16 v[120:123], v[164:167], a[92:95], v[120:123]
    s_waitcnt lgkmcnt(6)
    s_waitcnt vmcnt(25)
    v_mfma_f32_16x16x32_bf16 v[224:227], v[188:191], a[96:99], v[224:227]
    s_waitcnt lgkmcnt(0)
    v_mfma_f32_16x16x32_bf16 v[240:243], v[228:231], a[96:99], v[240:243]
    s_waitcnt vmcnt(34)
    v_mfma_f32_16x16x32_bf16 v[112:115], v[188:191], a[100:103], v[112:115]
    s_barrier
    v_mfma_f32_16x16x32_bf16 v[144:147], v[228:231], a[100:103], v[144:147]
    ds_read_b128 a[64:67], v5 offset:0
    buffer_load_dwordx4 a[172:175], v1, s[8:11], s62 offen offset:0 sc1
    v_mfma_f32_16x16x32_bf16 v[136:139], v[188:191], a[104:107], v[136:139]
    ds_read_b128 a[68:71], v5 offset:1024
    buffer_load_dwordx4 a[176:179], v1, s[8:11], s62 offen offset:1024 sc1
    v_mfma_f32_16x16x32_bf16 v[152:155], v[228:231], a[104:107], v[152:155]
    s_add_u32 s62, s15, 98304
    ds_read_b128 a[72:75], v5 offset:2048
    v_mfma_f32_16x16x32_bf16 v[168:171], v[188:191], a[108:111], v[168:171]
    ds_read_b128 a[76:79], v5 offset:3072
    v_mfma_f32_16x16x32_bf16 v[120:123], v[228:231], a[108:111], v[120:123]
    s_waitcnt vmcnt(25)
    v_mfma_f32_16x16x32_bf16 v[224:227], v[236:239], a[112:115], v[224:227]
    ds_read_b128 a[80:83], v5 offset:4096
    buffer_load_dwordx4 a[180:183], v1, s[8:11], s62 offen offset:0 sc1
    v_mfma_f32_16x16x32_bf16 v[240:243], v[244:247], a[112:115], v[240:243]
    ds_read_b128 a[84:87], v5 offset:5120
    v_mfma_f32_16x16x32_bf16 v[112:115], v[236:239], a[116:119], v[112:115]
    ds_read_b128 a[88:91], v5 offset:6144
    v_mfma_f32_16x16x32_bf16 v[144:147], v[244:247], a[116:119], v[144:147]
    ds_read_b128 a[92:95], v5 offset:7168
    v_mfma_f32_16x16x32_bf16 v[136:139], v[236:239], a[120:123], v[136:139]
    buffer_load_dwordx4 a[184:187], v1, s[8:11], s62 offen offset:1024 sc1
    v_mfma_f32_16x16x32_bf16 v[152:155], v[244:247], a[120:123], v[152:155]
    v_mfma_f32_16x16x32_bf16 v[168:171], v[236:239], a[124:127], v[168:171]
    s_add_u32 s62, s15, 102400
    v_mfma_f32_16x16x32_bf16 v[120:123], v[244:247], a[124:127], v[120:123]
    s_waitcnt lgkmcnt(6)
    s_waitcnt vmcnt(25)
    buffer_load_dword v13, v14, s[8:11], s61 offen sc1
    v_mfma_f32_16x16x32_bf16 v[224:227], v[252:255], a[64:67], v[224:227]
    ds_read_b128 a[96:99], v5 offset:8192
    v_mfma_f32_16x16x32_bf16 v[240:243], v[184:187], a[64:67], v[240:243]
    ds_read_b128 a[100:103], v5 offset:9216
    v_mfma_f32_16x16x32_bf16 v[112:115], v[252:255], a[68:71], v[112:115]
    buffer_load_dwordx4 a[188:191], v1, s[8:11], s62 offen offset:0 sc1
    v_mfma_f32_16x16x32_bf16 v[144:147], v[184:187], a[68:71], v[144:147]
    s_waitcnt lgkmcnt(6)
    ds_read_b128 a[104:107], v5 offset:10240
    v_mfma_f32_16x16x32_bf16 v[136:139], v[252:255], a[72:75], v[136:139]
    ds_read_b128 a[108:111], v5 offset:11264
    v_mfma_f32_16x16x32_bf16 v[152:155], v[184:187], a[72:75], v[152:155]
    buffer_load_dwordx4 a[192:195], v1, s[8:11], s62 offen offset:1024 sc1
    v_mfma_f32_16x16x32_bf16 v[168:171], v[252:255], a[76:79], v[168:171]
    s_add_u32 s62, s15, 106496
    ds_read_b128 a[112:115], v5 offset:12288
    v_mfma_f32_16x16x32_bf16 v[120:123], v[184:187], a[76:79], v[120:123]
    s_waitcnt lgkmcnt(7)
    s_waitcnt vmcnt(26)
    v_mfma_f32_16x16x32_bf16 v[224:227], v[104:107], a[80:83], v[224:227]
    ds_read_b128 a[116:119], v5 offset:13312
    v_mfma_f32_16x16x32_bf16 v[240:243], v[208:211], a[80:83], v[240:243]
    ds_read_b128 a[120:123], v5 offset:14336
    v_mfma_f32_16x16x32_bf16 v[112:115], v[104:107], a[84:87], v[112:115]
    buffer_load_dwordx4 a[196:199], v1, s[8:11], s62 offen offset:0 sc1
    v_mfma_f32_16x16x32_bf16 v[144:147], v[208:211], a[84:87], v[144:147]
    s_waitcnt lgkmcnt(7)
    ds_read_b128 a[124:127], v5 offset:15360
    v_mfma_f32_16x16x32_bf16 v[136:139], v[104:107], a[88:91], v[136:139]
    buffer_load_dwordx4 a[200:203], v1, s[8:11], s62 offen offset:1024 sc1
    v_mfma_f32_16x16x32_bf16 v[152:155], v[208:211], a[88:91], v[152:155]
    s_add_u32 s62, s15, 110592
    v_mfma_f32_16x16x32_bf16 v[168:171], v[104:107], a[92:95], v[168:171]
    v_mfma_f32_16x16x32_bf16 v[120:123], v[208:211], a[92:95], v[120:123]
    s_waitcnt lgkmcnt(6)
    s_waitcnt vmcnt(25)
    v_mfma_f32_16x16x32_bf16 v[224:227], a[240:243], a[96:99], v[224:227]
    ds_read_b128 a[64:67], v5 offset:16384
    buffer_load_dwordx4 a[204:207], v1, s[8:11], s62 offen offset:0 sc1
    v_mfma_f32_16x16x32_bf16 v[240:243], a[244:247], a[96:99], v[240:243]
    ds_read_b128 a[68:71], v5 offset:17408
    v_mfma_f32_16x16x32_bf16 v[112:115], a[240:243], a[100:103], v[112:115]
    v_mfma_f32_16x16x32_bf16 v[144:147], a[244:247], a[100:103], v[144:147]
    s_waitcnt lgkmcnt(6)
    ds_read_b128 a[72:75], v5 offset:18432
    v_mfma_f32_16x16x32_bf16 v[136:139], a[240:243], a[104:107], v[136:139]
    ds_read_b128 a[76:79], v5 offset:19456
    v_mfma_f32_16x16x32_bf16 v[152:155], a[244:247], a[104:107], v[152:155]
    buffer_load_dwordx4 a[208:211], v1, s[8:11], s62 offen offset:1024 sc1
    v_mfma_f32_16x16x32_bf16 v[168:171], a[240:243], a[108:111], v[168:171]
    s_add_u32 s62, s15, 114688
    ds_read_b128 a[80:83], v5 offset:20480
    v_mfma_f32_16x16x32_bf16 v[120:123], a[244:247], a[108:111], v[120:123]
    s_waitcnt lgkmcnt(7)
    s_waitcnt vmcnt(17)
    buffer_load_dwordx4 a[136:139], v1, s[8:11], s62 offen offset:0 sc1
    v_mfma_f32_16x16x32_bf16 v[224:227], a[248:251], a[112:115], v[224:227]
    ds_read_b128 a[84:87], v5 offset:21504
    v_mfma_f32_16x16x32_bf16 v[240:243], a[144:147], a[112:115], v[240:243]
    ds_read_b128 a[88:91], v5 offset:22528
    v_mfma_f32_16x16x32_bf16 v[112:115], a[248:251], a[116:119], v[112:115]
    v_mfma_f32_16x16x32_bf16 v[144:147], a[144:147], a[116:119], v[144:147]
    s_waitcnt lgkmcnt(7)
    ds_read_b128 a[92:95], v5 offset:23552
    v_mfma_f32_16x16x32_bf16 v[136:139], a[248:251], a[120:123], v[136:139]
    buffer_load_dwordx4 a[140:143], v1, s[8:11], s62 offen offset:1024 sc1
    v_mfma_f32_16x16x32_bf16 v[152:155], a[144:147], a[120:123], v[152:155]
    s_add_u32 s62, s15, 118784
    v_mfma_f32_16x16x32_bf16 v[168:171], a[248:251], a[124:127], v[168:171]
    v_mfma_f32_16x16x32_bf16 v[120:123], a[144:147], a[124:127], v[120:123]
    s_waitcnt lgkmcnt(6)
    s_waitcnt vmcnt(17)
    buffer_load_dwordx4 v[160:163], v1, s[8:11], s62 offen offset:0 sc1
    v_mfma_f32_16x16x32_bf16 v[224:227], a[148:151], a[64:67], v[224:227]
    ds_read_b128 a[96:99], v5 offset:24576
    v_mfma_f32_16x16x32_bf16 v[240:243], a[152:155], a[64:67], v[240:243]
    ds_read_b128 a[100:103], v5 offset:25600
    v_mfma_f32_16x16x32_bf16 v[112:115], a[148:151], a[68:71], v[112:115]
    buffer_load_dwordx4 v[176:179], v1, s[8:11], s62 offen offset:1024 sc1
    v_mfma_f32_16x16x32_bf16 v[144:147], a[152:155], a[68:71], v[144:147]
    s_waitcnt lgkmcnt(6)
    ds_read_b128 a[104:107], v5 offset:26624
    v_mfma_f32_16x16x32_bf16 v[136:139], a[148:151], a[72:75], v[136:139]
    s_add_u32 s62, s15, 122880
    ds_read_b128 a[108:111], v5 offset:27648
    v_mfma_f32_16x16x32_bf16 v[152:155], a[152:155], a[72:75], v[152:155]
    v_mfma_f32_16x16x32_bf16 v[168:171], a[148:151], a[76:79], v[168:171]
    ds_read_b128 a[112:115], v5 offset:28672
    v_mfma_f32_16x16x32_bf16 v[120:123], a[152:155], a[76:79], v[120:123]
    s_waitcnt lgkmcnt(7)
    s_waitcnt vmcnt(17)
    buffer_load_dwordx4 v[192:195], v1, s[8:11], s62 offen offset:0 sc1
    v_mfma_f32_16x16x32_bf16 v[224:227], a[156:159], a[80:83], v[224:227]
    ds_read_b128 a[116:119], v5 offset:29696
    v_mfma_f32_16x16x32_bf16 v[240:243], a[160:163], a[80:83], v[240:243]
    ds_read_b128 a[120:123], v5 offset:30720
    v_mfma_f32_16x16x32_bf16 v[112:115], a[156:159], a[84:87], v[112:115]
    buffer_load_dwordx4 v[96:99], v1, s[8:11], s62 offen offset:1024 sc1
    v_mfma_f32_16x16x32_bf16 v[144:147], a[160:163], a[84:87], v[144:147]
    s_waitcnt lgkmcnt(7)
    ds_read_b128 a[124:127], v5 offset:31744
    v_mfma_f32_16x16x32_bf16 v[136:139], a[156:159], a[88:91], v[136:139]
    v_mfma_f32_16x16x32_bf16 v[152:155], a[160:163], a[88:91], v[152:155]
    v_mfma_f32_16x16x32_bf16 v[168:171], a[156:159], a[92:95], v[168:171]
    v_mfma_f32_16x16x32_bf16 v[120:123], a[160:163], a[92:95], v[120:123]
    s_waitcnt lgkmcnt(6)
    s_waitcnt vmcnt(17)
    v_mfma_f32_16x16x32_bf16 v[224:227], a[164:167], a[96:99], v[224:227]
    s_waitcnt lgkmcnt(0)
    v_mfma_f32_16x16x32_bf16 v[240:243], a[168:171], a[96:99], v[240:243]
    s_waitcnt vmcnt(25)
    v_mfma_f32_16x16x32_bf16 v[112:115], a[164:167], a[100:103], v[112:115]
    s_barrier
    v_mfma_f32_16x16x32_bf16 v[144:147], a[168:171], a[100:103], v[144:147]
    s_waitcnt vmcnt(12)
    ds_read_b128 a[64:67], v5 offset:32768
    v_cmp_gt_u32 vcc, 2, v13
    v_mfma_f32_16x16x32_bf16 v[136:139], a[164:167], a[104:107], v[136:139]
    ds_read_b128 a[68:71], v5 offset:33792
    v_mfma_f32_16x16x32_bf16 v[152:155], a[168:171], a[104:107], v[152:155]
    s_cbranch_vccnz B_spin2
B_ret2:
    ds_read_b128 a[72:75], v5 offset:34816
    v_mfma_f32_16x16x32_bf16 v[168:171], a[164:167], a[108:111], v[168:171]
    s_xor_b32 m0, s42, 65536
    ds_read_b128 a[76:79], v5 offset:35840
    v_mfma_f32_16x16x32_bf16 v[120:123], a[168:171], a[108:111], v[120:123]
    s_add_u32 s44, s13, 0
    buffer_load_dwordx4 v2, s[8:11], s44 offen sc1 lds
    v_mfma_f32_16x16x32_bf16 v[224:227], a[172:175], a[112:115], v[224:227]
    ds_read_b128 a[80:83], v5 offset:36864
    v_mfma_f32_16x16x32_bf16 v[240:243], a[176:179], a[112:115], v[240:243]
    ds_read_b128 a[84:87], v5 offset:37888
    v_mfma_f32_16x16x32_bf16 v[112:115], a[172:175], a[116:119], v[112:115]
    ds_read_b128 a[88:91], v5 offset:38912
    v_mfma_f32_16x16x32_bf16 v[144:147], a[176:179], a[116:119], v[144:147]
    ds_read_b128 a[92:95], v5 offset:39936
    v_mfma_f32_16x16x32_bf16 v[136:139], a[172:175], a[120:123], v[136:139]
    buffer_load_dwordx4 v3, s[8:11], s44 offen offset:1024 sc1 lds
    v_mfma_f32_16x16x32_bf16 v[152:155], a[176:179], a[120:123], v[152:155]
    s_xor_b32 m0, s42, 73728
    v_mfma_f32_16x16x32_bf16 v[168:171], a[172:175], a[124:127], v[168:171]
    s_add_u32 s44, s13, 8192
    v_mfma_f32_16x16x32_bf16 v[120:123], a[176:179], a[124:127], v[120:123]
    s_waitcnt lgkmcnt(6)
    buffer_load_dwordx4 v2, s[8:11], s44 offen sc1 lds
    v_mfma_f32_16x16x32_bf16 v[224:227], a[180:183], a[64:67], v[224:227]
    ds_read_b128 a[96:99], v5 offset:40960
    v_mfma_f32_16x16x32_bf16 v[240:243], a[184:187], a[64:67], v[240:243]
    ds_read_b128 a[100:103], v5 offset:41984
    v_mfma_f32_16x16x32_bf16 v[112:115], a[180:183], a[68:71], v[112:115]
    buffer_load_dwordx4 v3, s[8:11], s44 offen offset:1024 sc1 lds
    v_mfma_f32_16x16x32_bf16 v[144:147], a[184:187], a[68:71], v[144:147]
    s_waitcnt lgkmcnt(6)
    ds_read_b128 a[104:107], v5 offset:43008
    v_mfma_f32_16x16x32_bf16 v[136:139], a[180:183], a[72:75], v[136:139]
    s_xor_b32 m0, s42, 81920
    ds_read_b128 a[108:111], v5 offset:44032
    v_mfma_f32_16x16x32_bf16 v[152:155], a[184:187], a[72:75], v[152:155]
    s_add_u32 s44, s13, 16384
    v_mfma_f32_16x16x32_bf16 v[168:171], a[180:183], a[76:79], v[168:171]
    ds_read_b128 a[112:115], v5 offset:45056
    v_mfma_f32_16x16x32_bf16 v[120:123], a[184:187], a[76:79], v[120:123]
    s_waitcnt lgkmcnt(7)
    s_waitcnt vmcnt(14)
    buffer_load_dwordx4 v2, s[8:11], s44 offen sc1 lds
    v_mfma_f32_16x16x32_bf16 v[224:227], a[188:191], a[80:83], v[224:227]
    ds_read_b128 a[116:119], v5 offset:46080
    v_mfma_f32_16x16x32_bf16 v[240:243], a[192:195], a[80:83], v[240:243]
    ds_read_b128 a[120:123], v5 offset:47104
    v_mfma_f32_16x16x32_bf16 v[112:115], a[188:191], a[84:87], v[112:115]
    buffer_load_dwordx4 v3, s[8:11], s44 offen offset:1024 sc1 lds
    v_mfma_f32_16x16x32_bf16 v[144:147], a[192:195], a[84:87], v[144:147]
    s_waitcnt lgkmcnt(7)
    ds_read_b128 a[124:127], v5 offset:48128
    v_mfma_f32_16x16x32_bf16 v[136:139], a[188:191], a[88:91], v[136:139]
    s_xor_b32 m0, s42, 90112
    v_mfma_f32_16x16x32_bf16 v[152:155], a[192:195], a[88:91], v[152:155]
    s_add_u32 s44, s13, 24576
    buffer_load_dwordx4 v2, s[8:11], s44 offen sc1 lds
    v_mfma_f32_16x16x32_bf16 v[168:171], a[188:191], a[92:95], v[168:171]
    v_mfma_f32_16x16x32_bf16 v[120:123], a[192:195], a[92:95], v[120:123]
    s_waitcnt lgkmcnt(6)
    s_waitcnt vmcnt(15)
    v_mfma_f32_16x16x32_bf16 v[224:227], a[196:199], a[96:99], v[224:227]
    ds_read_b128 a[64:67], v5 offset:49152
    v_mfma_f32_16x16x32_bf16 v[240:243], a[200:203], a[96:99], v[240:243]
    ds_read_b128 a[68:71], v5 offset:50176
    v_mfma_f32_16x16x32_bf16 v[112:115], a[196:199], a[100:103], v[112:115]
    buffer_load_dwordx4 v3, s[8:11], s44 offen offset:1024 sc1 lds
    v_mfma_f32_16x16x32_bf16 v[144:147], a[200:203], a[100:103], v[144:147]
    s_waitcnt lgkmcnt(6)
    ds_read_b128 a[72:75], v5 offset:51200
    v_mfma_f32_16x16x32_bf16 v[136:139], a[196:199], a[104:107], v[136:139]
    s_add_u32 s62, s15, 126976
    ds_read_b128 a[76:79], v5 offset:52224
    v_mfma_f32_16x16x32_bf16 v[152:155], a[200:203], a[104:107], v[152:155]
    buffer_load_dwordx4 v[64:67], v1, s[8:11], s62 offen offset:0 sc1
    v_mfma_f32_16x16x32_bf16 v[168:171], a[196:199], a[108:111], v[168:171]
    ds_read_b128 a[80:83], v5 offset:53248
    v_mfma_f32_16x16x32_bf16 v[120:123], a[200:203], a[108:111], v[120:123]
    s_waitcnt lgkmcnt(7)
    s_waitcnt vmcnt(15)
    v_mfma_f32_16x16x32_bf16 v[224:227], a[204:207], a[112:115], v[224:227]
    ds_read_b128 a[84:87], v5 offset:54272
    buffer_load_dwordx4 v[68:71], v1, s[8:11], s62 offen offset:1024 sc1
    v_mfma_f32_16x16x32_bf16 v[240:243], a[208:211], a[112:115], v[240:243]
    s_xor_b32 m0, s42, 98304
    ds_read_b128 a[88:91], v5 offset:55296
    v_mfma_f32_16x16x32_bf16 v[112:115], a[204:207], a[116:119], v[112:115]
    s_add_u32 s44, s13, 32768
    v_mfma_f32_16x16x32_bf16 v[144:147], a[208:211], a[116:119], v[144:147]
    s_waitcnt lgkmcnt(7)
    ds_read_b128 a[92:95], v5 offset:56320
    v_mfma_f32_16x16x32_bf16 v[136:139], a[204:207], a[120:123], v[136:139]
    buffer_load_dwordx4 v2, s[8:11], s44 offen sc1 lds
    v_mfma_f32_16x16x32_bf16 v[152:155], a[208:211], a[120:123], v[152:155]
    v_mfma_f32_16x16x32_bf16 v[168:171], a[204:207], a[124:127], v[168:171]
    v_mfma_f32_16x16x32_bf16 v[120:123], a[208:211], a[124:127], v[120:123]
    s_waitcnt lgkmcnt(6)
    s_waitcnt vmcnt(15)
    v_mfma_f32_16x16x32_bf16 v[224:227], a[136:139], a[64:67], v[224:227]
    ds_read_b128 a[96:99], v5 offset:57344
    buffer_load_dwordx4 v3, s[8:11], s44 offen offset:1024 sc1 lds
    v_mfma_f32_16x16x32_bf16 v[240:243], a[140:143], a[64:67], v[240:243]
    s_xor_b32 m0, s42, 106496
    ds_read_b128 a[100:103], v5 offset:58368
    v_mfma_f32_16x16x32_bf16 v[112:115], a[136:139], a[68:71], v[112:115]
    s_add_u32 s44, s13, 40960
    v_mfma_f32_16x16x32_bf16 v[144:147], a[140:143], a[68:71], v[144:147]
    s_waitcnt lgkmcnt(6)
    ds_read_b128 a[104:107], v5 offset:59392
    buffer_load_dwordx4 v2, s[8:11], s44 offen sc1 lds
    v_mfma_f32_16x16x32_bf16 v[136:139], a[136:139], a[72:75], v[136:139]
    s_xor_b32 s70, s60, 2097152
    ds_read_b128 a[108:111], v5 offset:60416
    v_mfma_f32_16x16x32_bf16 v[152:155], a[140:143], a[72:75], v[152:155]
    s_add_u32 s70, s70, 2048
    v_mfma_f32_16x16x32_bf16 v[168:171], a[136:139], a[76:79], v[168:171]
    ds_read_b128 a[112:115], v5 offset:61440
    v_mfma_f32_16x16x32_bf16 v[120:123], a[140:143], a[76:79], v[120:123]
    s_waitcnt lgkmcnt(7)
    s_waitcnt vmcnt(15)
    buffer_load_dwordx4 v3, s[8:11], s44 offen offset:1024 sc1 lds
    v_mfma_f32_16x16x32_bf16 v[224:227], v[160:163], a[80:83], v[224:227]
    s_xor_b32 m0, s42, 114688
    ds_read_b128 a[116:119], v5 offset:62464
    v_mfma_f32_16x16x32_bf16 v[240:243], v[176:179], a[80:83], v[240:243]
    s_add_u32 s44, s13, 49152
    ds_read_b128 a[120:123], v5 offset:63488
    v_mfma_f32_16x16x32_bf16 v[112:115], v[160:163], a[84:87], v[112:115]
    s_xor_b32 s71, s60, 4194304
    v_mfma_f32_16x16x32_bf16 v[144:147], v[176:179], a[84:87], v[144:147]
    s_waitcnt lgkmcnt(7)
    ds_read_b128 a[124:127], v5 offset:64512
    v_mfma_f32_16x16x32_bf16 v[136:139], v[160:163], a[88:91], v[136:139]
    s_add_u32 s71, s71, 4096
    buffer_load_dwordx4 v2, s[8:11], s44 offen sc1 lds
    v_mfma_f32_16x16x32_bf16 v[152:155], v[176:179], a[88:91], v[152:155]
    s_xor_b32 s72, s60, 6291456
    v_mfma_f32_16x16x32_bf16 v[168:171], v[160:163], a[92:95], v[168:171]
    s_add_u32 s72, s72, 6144
    buffer_load_dwordx4 v3, s[8:11], s44 offen offset:1024 sc1 lds
    v_mfma_f32_16x16x32_bf16 v[120:123], v[176:179], a[92:95], v[120:123]
    s_waitcnt lgkmcnt(6)
    s_waitcnt vmcnt(16)
    v_mfma_f32_16x16x32_bf16 v[224:227], v[192:195], a[96:99], v[224:227]
    s_waitcnt lgkmcnt(0)
    v_mfma_f32_16x16x32_bf16 v[240:243], v[96:99], a[96:99], v[240:243]
    s_waitcnt vmcnt(8)
    v_mfma_f32_16x16x32_bf16 v[112:115], v[192:195], a[100:103], v[112:115]
    s_barrier
    v_mfma_f32_16x16x32_bf16 v[144:147], v[96:99], a[100:103], v[144:147]
    s_xor_b32 m0, s42, 122880
    ds_read_b128 a[64:67], v6 offset:0
    v_mfma_f32_16x16x32_bf16 v[136:139], v[192:195], a[104:107], v[136:139]
    s_add_u32 s44, s13, 57344
    ds_read_b128 a[68:71], v6 offset:1024
    buffer_load_dwordx4 v2, s[8:11], s44 offen sc1 lds
    v_mfma_f32_16x16x32_bf16 v[152:155], v[96:99], a[104:107], v[152:155]
    ds_read_b128 a[72:75], v6 offset:2048
    v_mfma_f32_16x16x32_bf16 v[168:171], v[192:195], a[108:111], v[168:171]
    ds_read_b128 a[76:79], v6 offset:3072
    v_mfma_f32_16x16x32_bf16 v[120:123], v[96:99], a[108:111], v[120:123]
    s_waitcnt vmcnt(7)
    v_mfma_f32_16x16x32_bf16 v[224:227], v[64:67], a[112:115], v[224:227]
    ds_read_b128 a[80:83], v6 offset:4096
    v_mfma_f32_16x16x32_bf16 v[240:243], v[68:71], a[112:115], v[240:243]
    ds_read_b128 a[84:87], v6 offset:5120
    buffer_load_dwordx4 v3, s[8:11], s44 offen offset:1024 sc1 lds
    v_mfma_f32_16x16x32_bf16 v[112:115], v[64:67], a[116:119], v[112:115]
    ds_read_b128 a[88:91], v6 offset:6144
    v_mfma_f32_16x16x32_bf16 v[144:147], v[68:71], a[116:119], v[144:147]
    s_xor_b32 s6, s66, 0
    ds_read_b128 a[92:95], v6 offset:7168
    v_mfma_f32_16x16x32_bf16 v[136:139], v[64:67], a[120:123], v[136:139]
    v_mfma_f32_16x16x32_bf16 v[152:155], v[68:71], a[120:123], v[152:155]
    v_mfma_f32_16x16x32_bf16 v[168:171], v[64:67], a[124:127], v[168:171]
    buffer_load_dword v72, v4, s[8:11], s6 offen sc1
    v_mfma_f32_16x16x32_bf16 v[120:123], v[68:71], a[124:127], v[120:123]
    s_waitcnt lgkmcnt(6)
    v_mfma_f32_16x16x32_bf16 v[128:131], a[0:3], a[64:67], v[56:59]
    s_xor_b32 s6, s66, 16
    ds_read_b128 a[96:99], v6 offset:8192
    buffer_load_dword v74, v4, s[8:11], s6 offen sc1
    v_mfma_f32_16x16x32_bf16 v[172:175], a[4:7], a[64:67], v[88:91]
    s_xor_b32 s6, s66, 128
    ds_read_b128 a[100:103], v6 offset:9216
    v_mfma_f32_16x16x32_bf16 v[180:183], a[0:3], a[68:71], v[148:151]
    buffer_load_dword v76, v4, s[8:11], s6 offen sc1
    v_mfma_f32_16x16x32_bf16 v[16:19], a[4:7], a[68:71], v[212:215]
    s_waitcnt lgkmcnt(6)
    ds_read_b128 a[104:107], v6 offset:10240
    v_mfma_f32_16x16x32_bf16 v[20:23], a[0:3], a[72:75], v[60:63]
    s_xor_b32 s6, s66, 144
    ds_read_b128 a[108:111], v6 offset:11264
    v_mfma_f32_16x16x32_bf16 v[24:27], a[4:7], a[72:75], v[92:95]
    buffer_load_dword v78, v4, s[8:11], s6 offen sc1
    v_mfma_f32_16x16x32_bf16 v[28:31], a[0:3], a[76:79], v[156:159]
    s_xor_b32 s6, s67, 0
    ds_read_b128 a[112:115], v6 offset:12288
    v_mfma_f32_16x16x32_bf16 v[32:35], a[4:7], a[76:79], v[220:223]
    s_waitcnt lgkmcnt(7)
    buffer_load_dword v232, v4, s[8:11], s6 offen sc1
    v_mfma_f32_16x16x32_bf16 v[128:131], a[8:11], a[80:83], v[128:131]
    s_xor_b32 s6, s67, 16
    ds_read_b128 a[116:119], v6 offset:13312
    buffer_load_dword v234, v4, s[8:11], s6 offen sc1
    v_mfma_f32_16x16x32_bf16 v[172:175], a[12:15], a[80:83], v[172:175]
    s_xor_b32 s6, s67, 128
    ds_read_b128 a[120:123], v6 offset:14336
    v_mfma_f32_16x16x32_bf16 v[180:183], a[8:11], a[84:87], v[180:183]
    buffer_load_dword v248, v4, s[8:11], s6 offen sc1
    v_mfma_f32_16x16x32_bf16 v[16:19], a[12:15], a[84:87], v[16:19]
    s_waitcnt lgkmcnt(7)
    ds_read_b128 a[124:127], v6 offset:15360
    v_mfma_f32_16x16x32_bf16 v[20:23], a[8:11], a[88:91], v[20:23]
    s_xor_b32 s6, s67, 144
    buffer_load_dword v250, v4, s[8:11], s6 offen sc1
    v_mfma_f32_16x16x32_bf16 v[24:27], a[12:15], a[88:91], v[24:27]
    v_mfma_f32_16x16x32_bf16 v[28:31], a[8:11], a[92:95], v[28:31]
    buffer_load_dwordx2 v[200:201], v11, s[20:23], s68 offen offset:0
    v_mfma_f32_16x16x32_bf16 v[32:35], a[12:15], a[92:95], v[32:35]
    s_waitcnt lgkmcnt(6)
    v_mfma_f32_16x16x32_bf16 v[128:131], a[16:19], a[96:99], v[128:131]
    ds_read_b128 a[64:67], v6 offset:16384
    buffer_load_dwordx2 v[202:203], v11, s[20:23], s68 offen offset:32
    v_mfma_f32_16x16x32_bf16 v[172:175], a[20:23], a[96:99], v[172:175]
    ds_read_b128 a[68:71], v6 offset:17408
    v_mfma_f32_16x16x32_bf16 v[180:183], a[16:19], a[100:103], v[180:183]
    buffer_load_dwordx2 v[216:217], v11, s[20:23], s69 offen offset:0
    v_mfma_f32_16x16x32_bf16 v[16:19], a[20:23], a[100:103], v[16:19]
    s_waitcnt lgkmcnt(6)
    ds_read_b128 a[72:75], v6 offset:18432
    v_mfma_f32_16x16x32_bf16 v[20:23], a[16:19], a[104:107], v[20:23]
    ds_read_b128 a[76:79], v6 offset:19456
    v_mfma_f32_16x16x32_bf16 v[24:27], a[20:23], a[104:107], v[24:27]
    buffer_load_dwordx2 v[218:219], v11, s[20:23], s69 offen offset:32
    v_mfma_f32_16x16x32_bf16 v[28:31], a[16:19], a[108:111], v[28:31]
    ds_read_b128 a[80:83], v6 offset:20480
    v_mfma_f32_16x16x32_bf16 v[32:35], a[20:23], a[108:111], v[32:35]
    s_waitcnt lgkmcnt(7)
    buffer_load_dwordx2 v[100:101], v7, s[32:35], s73 offen offset:0
    v_mfma_f32_16x16x32_bf16 v[128:131], a[24:27], a[112:115], v[128:131]
    ds_read_b128 a[84:87], v6 offset:21504
    buffer_load_dwordx2 v[102:103], v7, s[32:35], s73 offen offset:32
    v_mfma_f32_16x16x32_bf16 v[172:175], a[28:31], a[112:115], v[172:175]
    s_xor_b32 m0, s42, 0
    ds_read_b128 a[88:91], v6 offset:22528
    v_mfma_f32_16x16x32_bf16 v[180:183], a[24:27], a[116:119], v[180:183]
    s_add_u32 s44, s13, 65536
    buffer_load_dwordx4 v2, s[8:11], s44 offen sc1 lds
    v_mfma_f32_16x16x32_bf16 v[16:19], a[28:31], a[116:119], v[16:19]
    s_waitcnt lgkmcnt(7)
    ds_read_b128 a[92:95], v6 offset:23552
    v_mfma_f32_16x16x32_bf16 v[20:23], a[24:27], a[120:123], v[20:23]
    v_mfma_f32_16x16x32_bf16 v[24:27], a[28:31], a[120:123], v[24:27]
    v_mfma_f32_16x16x32_bf16 v[28:31], a[24:27], a[124:127], v[28:31]
    v_mfma_f32_16x16x32_bf16 v[32:35], a[28:31], a[124:127], v[32:35]
    s_waitcnt lgkmcnt(6)
    buffer_load_dwordx4 v3, s[8:11], s44 offen offset:1024 sc1 lds
    v_mfma_f32_16x16x32_bf16 v[128:131], a[32:35], a[64:67], v[128:131]
    ds_read_b128 a[96:99], v6 offset:24576
    v_mfma_f32_16x16x32_bf16 v[172:175], a[36:39], a[64:67], v[172:175]
    s_xor_b32 m0, s42, 8192
    ds_read_b128 a[100:103], v6 offset:25600
    v_mfma_f32_16x16x32_bf16 v[180:183], a[32:35], a[68:71], v[180:183]
    s_add_u32 s44, s13, 73728
    v_mfma_f32_16x16x32_bf16 v[16:19], a[36:39], a[68:71], v[16:19]
    s_waitcnt lgkmcnt(6)
    ds_read_b128 a[104:107], v6 offset:26624
    v_mfma_f32_16x16x32_bf16 v[20:23], a[32:35], a[72:75], v[20:23]
    ds_read_b128 a[108:111], v6 offset:27648
    v_mfma_f32_16x16x32_bf16 v[24:27], a[36:39], a[72:75], v[24:27]
    buffer_load_dwordx4 v2, s[8:11], s44 offen sc1 lds
    v_mfma_f32_16x16x32_bf16 v[28:31], a[32:35], a[76:79], v[28:31]
    ds_read_b128 a[112:115], v6 offset:28672
    v_mfma_f32_16x16x32_bf16 v[32:35], a[36:39], a[76:79], v[32:35]
    s_waitcnt lgkmcnt(7)
    v_mfma_f32_16x16x32_bf16 v[128:131], a[40:43], a[80:83], v[128:131]
    ds_read_b128 a[116:119], v6 offset:29696
    v_mfma_f32_16x16x32_bf16 v[172:175], a[44:47], a[80:83], v[172:175]
    ds_read_b128 a[120:123], v6 offset:30720
    v_mfma_f32_16x16x32_bf16 v[180:183], a[40:43], a[84:87], v[180:183]
    buffer_load_dwordx4 v3, s[8:11], s44 offen offset:1024 sc1 lds
    v_mfma_f32_16x16x32_bf16 v[16:19], a[44:47], a[84:87], v[16:19]
    s_waitcnt lgkmcnt(7)
    ds_read_b128 a[124:127], v6 offset:31744
    v_mfma_f32_16x16x32_bf16 v[20:23], a[40:43], a[88:91], v[20:23]
    s_xor_b32 m0, s42, 16384
    v_mfma_f32_16x16x32_bf16 v[24:27], a[44:47], a[88:91], v[24:27]
    s_add_u32 s44, s13, 81920
    v_mfma_f32_16x16x32_bf16 v[28:31], a[40:43], a[92:95], v[28:31]
    buffer_load_dwordx4 v2, s[8:11], s44 offen sc1 lds
    v_mfma_f32_16x16x32_bf16 v[32:35], a[44:47], a[92:95], v[32:35]
    s_waitcnt lgkmcnt(6)
    v_mfma_f32_16x16x32_bf16 v[128:131], a[48:51], a[96:99], v[128:131]
    s_waitcnt lgkmcnt(0)
    v_mfma_f32_16x16x32_bf16 v[172:175], a[52:55], a[96:99], v[172:175]
    s_waitcnt vmcnt(19)
    v_mfma_f32_16x16x32_bf16 v[180:183], a[48:51], a[100:103], v[180:183]
    s_barrier
    v_mfma_f32_16x16x32_bf16 v[16:19], a[52:55], a[100:103], v[16:19]
    ds_read_b128 a[64:67], v6 offset:32768
    buffer_load_dwordx4 v3, s[8:11], s44 offen offset:1024 sc1 lds
    v_mfma_f32_16x16x32_bf16 v[20:23], a[48:51], a[104:107], v[20:23]
    ds_read_b128 a[68:71], v6 offset:33792
    v_mfma_f32_16x16x32_bf16 v[24:27], a[52:55], a[104:107], v[24:27]
    s_xor_b32 m0, s42, 24576
    ds_read_b128 a[72:75], v6 offset:34816
    v_mfma_f32_16x16x32_bf16 v[28:31], a[48:51], a[108:111], v[28:31]
    s_add_u32 s44, s13, 90112
    ds_read_b128 a[76:79], v6 offset:35840
    v_mfma_f32_16x16x32_bf16 v[32:35], a[52:55], a[108:111], v[32:35]
    v_mfma_f32_16x16x32_bf16 v[128:131], a[56:59], a[112:115], v[128:131]
    ds_read_b128 a[80:83], v6 offset:36864
    buffer_load_dwordx4 v2, s[8:11], s44 offen sc1 lds
    v_mfma_f32_16x16x32_bf16 v[172:175], a[60:63], a[112:115], v[172:175]
    ds_read_b128 a[84:87], v6 offset:37888
    v_mfma_f32_16x16x32_bf16 v[180:183], a[56:59], a[116:119], v[180:183]
    ds_read_b128 a[88:91], v6 offset:38912
    v_mfma_f32_16x16x32_bf16 v[16:19], a[60:63], a[116:119], v[16:19]
    ds_read_b128 a[92:95], v6 offset:39936
    v_mfma_f32_16x16x32_bf16 v[20:23], a[56:59], a[120:123], v[20:23]
    v_mfma_f32_16x16x32_bf16 v[24:27], a[60:63], a[120:123], v[24:27]
    buffer_load_dwordx4 v3, s[8:11], s44 offen offset:1024 sc1 lds
    v_mfma_f32_16x16x32_bf16 v[28:31], a[56:59], a[124:127], v[28:31]
    v_mfma_f32_16x16x32_bf16 v[32:35], a[60:63], a[124:127], v[32:35]
    s_waitcnt lgkmcnt(6)
    v_mfma_f32_16x16x32_bf16 v[128:131], a[128:131], a[64:67], v[128:131]
    s_xor_b32 m0, s42, 32768
    ds_read_b128 a[96:99], v6 offset:40960
    v_mfma_f32_16x16x32_bf16 v[172:175], a[132:135], a[64:67], v[172:175]
    s_add_u32 s44, s13, 98304
    ds_read_b128 a[100:103], v6 offset:41984
    v_mfma_f32_16x16x32_bf16 v[180:183], a[128:131], a[68:71], v[180:183]
    buffer_load_dwordx4 v2, s[8:11], s44 offen sc1 lds
    v_mfma_f32_16x16x32_bf16 v[16:19], a[132:135], a[68:71], v[16:19]
    s_waitcnt lgkmcnt(6)
    ds_read_b128 a[104:107], v6 offset:43008
    v_mfma_f32_16x16x32_bf16 v[20:23], a[128:131], a[72:75], v[20:23]
    s_waitcnt vmcnt(9)
    ds_read_b128 a[108:111], v6 offset:44032
    v_mfma_f32_16x16x32_bf16 v[24:27], a[132:135], a[72:75], v[24:27]
    v_fma_f32 v112, v112, v74, -v132
    v_fma_f32 v113, v113, v74, -v133
    v_mfma_f32_16x16x32_bf16 v[28:31], a[128:131], a[76:79], v[28:31]
    ds_read_b128 a[112:115], v6 offset:45056
    v_fma_f32 v114, v114, v74, -v134
    v_mfma_f32_16x16x32_bf16 v[32:35], a[132:135], a[76:79], v[32:35]
    s_waitcnt lgkmcnt(7)
    buffer_load_dwordx4 v3, s[8:11], s44 offen offset:1024 sc1 lds
    v_fma_f32 v115, v115, v74, -v135
    v_mfma_f32_16x16x32_bf16 v[128:131], a[212:215], a[80:83], v[128:131]
    ds_read_b128 a[116:119], v6 offset:46080
    v_fma_f32 v144, v144, v74, -v196
    v_mfma_f32_16x16x32_bf16 v[172:175], a[216:219], a[80:83], v[172:175]
    s_xor_b32 m0, s42, 40960
    ds_read_b128 a[120:123], v6 offset:47104
    v_mfma_f32_16x16x32_bf16 v[180:183], a[212:215], a[84:87], v[180:183]
    s_add_u32 s44, s13, 106496
    v_fma_f32 v145, v145, v74, -v197
    v_fma_f32 v146, v146, v74, -v198
    v_mfma_f32_16x16x32_bf16 v[16:19], a[216:219], a[84:87], v[16:19]
    s_waitcnt lgkmcnt(7)
    ds_read_b128 a[124:127], v6 offset:48128
    v_fma_f32 v147, v147, v74, -v199
    v_mfma_f32_16x16x32_bf16 v[20:23], a[212:215], a[88:91], v[20:23]
    buffer_load_dwordx4 v2, s[8:11], s44 offen sc1 lds
    v_mfma_f32_16x16x32_bf16 v[24:27], a[216:219], a[88:91], v[24:27]
    v_cvt_pk_bf16_f32 v132, v112, v113
    v_mfma_f32_16x16x32_bf16 v[28:31], a[212:215], a[92:95], v[28:31]
    v_cvt_pk_bf16_f32 v133, v114, v115
    v_mfma_f32_16x16x32_bf16 v[32:35], a[216:219], a[92:95], v[32:35]
    s_waitcnt lgkmcnt(6)
    v_cvt_pk_bf16_f32 v134, v144, v145
    v_cvt_pk_bf16_f32 v135, v146, v147
    v_mfma_f32_16x16x32_bf16 v[128:131], a[220:223], a[96:99], v[128:131]
    ds_read_b128 a[64:67], v6 offset:49152
    v_min_u32 v132, -2, v132
    v_mfma_f32_16x16x32_bf16 v[172:175], a[252:255], a[96:99], v[172:175]
    ds_read_b128 a[68:71], v6 offset:50176
    v_min_u32 v133, -2, v133
    v_mfma_f32_16x16x32_bf16 v[180:183], a[220:223], a[100:103], v[180:183]
    buffer_load_dwordx4 v3, s[8:11], s44 offen offset:1024 sc1 lds
    v_min_u32 v134, -2, v134
    v_mfma_f32_16x16x32_bf16 v[16:19], a[252:255], a[100:103], v[16:19]
    s_waitcnt lgkmcnt(6)
    ds_read_b128 a[72:75], v6 offset:51200
    v_min_u32 v135, -2, v135
    v_mfma_f32_16x16x32_bf16 v[20:23], a[220:223], a[104:107], v[20:23]
    s_xor_b32 m0, s42, 49152
    ds_read_b128 a[76:79], v6 offset:52224
    v_mfma_f32_16x16x32_bf16 v[24:27], a[252:255], a[104:107], v[24:27]
    s_add_u32 s44, s13, 114688
    buffer_store_dwordx4 v[132:135], v1, s[8:11], s70 offen offset:0 sc1
    v_fma_f32 v136, v136, v76, -v52
    v_mfma_f32_16x16x32_bf16 v[28:31], a[220:223], a[108:111], v[28:31]
    ds_read_b128 a[80:83], v6 offset:53248
    v_fma_f32 v137, v137, v76, -v53
    v_mfma_f32_16x16x32_bf16 v[32:35], a[252:255], a[108:111], v[32:35]
    s_waitcnt lgkmcnt(7)
    buffer_load_dwordx4 v2, s[8:11], s44 offen sc1 lds
    v_fma_f32 v138, v138, v76, -v54
    v_mfma_f32_16x16x32_bf16 v[128:131], v[36:39], a[112:115], v[128:131]
    ds_read_b128 a[84:87], v6 offset:54272
    v_fma_f32 v139, v139, v76, -v55
    v_mfma_f32_16x16x32_bf16 v[172:175], v[40:43], a[112:115], v[172:175]
    ds_read_b128 a[88:91], v6 offset:55296
    v_mfma_f32_16x16x32_bf16 v[180:183], v[36:39], a[116:119], v[180:183]
    v_fma_f32 v152, v152, v76, -v84
    v_fma_f32 v153, v153, v76, -v85
    v_mfma_f32_16x16x32_bf16 v[16:19], v[40:43], a[116:119], v[16:19]
    s_waitcnt lgkmcnt(7)
    ds_read_b128 a[92:95], v6 offset:56320
    v_fma_f32 v154, v154, v76, -v86
    v_mfma_f32_16x16x32_bf16 v[20:23], v[36:39], a[120:123], v[20:23]
    buffer_load_dwordx4 v3, s[8:11], s44 offen offset:1024 sc1 lds
    v_mfma_f32_16x16x32_bf16 v[24:27], v[40:43], a[120:123], v[24:27]
    s_xor_b32 m0, s42, 57344
    v_fma_f32 v155, v155, v76, -v87
    v_mfma_f32_16x16x32_bf16 v[28:31], v[36:39], a[124:127], v[28:31]
    s_add_u32 s44, s13, 122880
    v_cvt_pk_bf16_f32 v52, v136, v137
    v_mfma_f32_16x16x32_bf16 v[32:35], v[40:43], a[124:127], v[32:35]
    s_waitcnt lgkmcnt(6)
    v_cvt_pk_bf16_f32 v53, v138, v139
    v_cvt_pk_bf16_f32 v54, v152, v153
    v_mfma_f32_16x16x32_bf16 v[128:131], v[44:47], a[64:67], v[128:131]
    ds_read_b128 a[96:99], v6 offset:57344
    buffer_load_dwordx4 v2, s[8:11], s44 offen sc1 lds
    v_mfma_f32_16x16x32_bf16 v[172:175], v[116:119], a[64:67], v[172:175]
    ds_read_b128 a[100:103], v6 offset:58368
    v_cvt_pk_bf16_f32 v55, v154, v155
    v_mfma_f32_16x16x32_bf16 v[180:183], v[44:47], a[68:71], v[180:183]
    v_min_u32 v52, -2, v52
    v_min_u32 v53, -2, v53
    v_mfma_f32_16x16x32_bf16 v[16:19], v[116:119], a[68:71], v[16:19]
    s_waitcnt lgkmcnt(6)
    ds_read_b128 a[104:107], v6 offset:59392
    v_min_u32 v54, -2, v54
    v_mfma_f32_16x16x32_bf16 v[20:23], v[44:47], a[72:75], v[20:23]
    ds_read_b128 a[108:111], v6 offset:60416
    v_min_u32 v55, -2, v55
    v_mfma_f32_16x16x32_bf16 v[24:27], v[116:119], a[72:75], v[24:27]
    buffer_load_dwordx4 v3, s[8:11], s44 offen offset:1024 sc1 lds
    buffer_store_dwordx4 v[52:55], v1, s[8:11], s71 offen offset:0 sc1
    v_mfma_f32_16x16x32_bf16 v[28:31], v[44:47], a[76:79], v[28:31]
    ds_read_b128 a[112:115], v6 offset:61440
    v_mfma_f32_16x16x32_bf16 v[32:35], v[116:119], a[76:79], v[32:35]
    s_waitcnt lgkmcnt(7)
    v_fma_f32 v168, v168, v78, -v140
    v_fma_f32 v169, v169, v78, -v141
    v_mfma_f32_16x16x32_bf16 v[128:131], v[124:127], a[80:83], v[128:131]
    ds_read_b128 a[116:119], v6 offset:62464
    v_fma_f32 v170, v170, v78, -v142
    v_mfma_f32_16x16x32_bf16 v[172:175], v[164:167], a[80:83], v[172:175]
    ds_read_b128 a[120:123], v6 offset:63488
    v_mfma_f32_16x16x32_bf16 v[180:183], v[124:127], a[84:87], v[180:183]
    v_fma_f32 v171, v171, v78, -v143
    v_mfma_f32_16x16x32_bf16 v[16:19], v[164:167], a[84:87], v[16:19]
    s_waitcnt lgkmcnt(7)
    ds_read_b128 a[124:127], v6 offset:64512
    v_mfma_f32_16x16x32_bf16 v[20:23], v[124:127], a[88:91], v[20:23]
    v_fma_f32 v120, v120, v78, -v204
    v_mfma_f32_16x16x32_bf16 v[24:27], v[164:167], a[88:91], v[24:27]
    v_fma_f32 v121, v121, v78, -v205
    v_mfma_f32_16x16x32_bf16 v[28:31], v[124:127], a[92:95], v[28:31]
    v_fma_f32 v122, v122, v78, -v206
    v_mfma_f32_16x16x32_bf16 v[32:35], v[164:167], a[92:95], v[32:35]
    s_waitcnt lgkmcnt(6)
    v_fma_f32 v123, v123, v78, -v207
    v_mfma_f32_16x16x32_bf16 v[128:131], v[188:191], a[96:99], v[128:131]
    s_waitcnt lgkmcnt(0)
    v_cvt_pk_bf16_f32 v140, v168, v169
    v_cvt_pk_bf16_f32 v141, v170, v171
    v_mfma_f32_16x16x32_bf16 v[172:175], v[228:231], a[96:99], v[172:175]
    s_waitcnt vmcnt(10)
    v_mfma_f32_16x16x32_bf16 v[180:183], v[188:191], a[100:103], v[180:183]
    s_barrier
    v_mfma_f32_16x16x32_bf16 v[16:19], v[228:231], a[100:103], v[16:19]
    ds_read_b128 a[64:67], v5 offset:1024
    v_cvt_pk_bf16_f32 v142, v120, v121
    v_mfma_f32_16x16x32_bf16 v[20:23], v[188:191], a[104:107], v[20:23]
    ds_read_b128 a[68:71], v5 offset:2048
    v_cvt_pk_bf16_f32 v143, v122, v123
    v_mfma_f32_16x16x32_bf16 v[24:27], v[228:231], a[104:107], v[24:27]
    ds_read_b128 a[72:75], v5 offset:3072
    v_min_u32 v140, -2, v140
    v_mfma_f32_16x16x32_bf16 v[28:31], v[188:191], a[108:111], v[28:31]
    ds_read_b128 a[76:79], v5 offset:5120
    v_mfma_f32_16x16x32_bf16 v[32:35], v[228:231], a[108:111], v[32:35]
    v_min_u32 v141, -2, v141
    v_min_u32 v142, -2, v142
    v_mfma_f32_16x16x32_bf16 v[128:131], v[236:239], a[112:115], v[128:131]
    ds_read_b128 a[80:83], v5 offset:6144
    v_min_u32 v143, -2, v143
    v_mfma_f32_16x16x32_bf16 v[172:175], v[244:247], a[112:115], v[172:175]
    ds_read_b128 a[84:87], v5 offset:7168
    buffer_store_dwordx4 v[140:143], v1, s[8:11], s72 offen offset:0 sc1
    v_mfma_f32_16x16x32_bf16 v[180:183], v[236:239], a[116:119], v[180:183]
    ds_read_b128 a[88:91], v5 offset:9216
    v_add_f32 v73, -1.0, v72
    v_mfma_f32_16x16x32_bf16 v[16:19], v[244:247], a[116:119], v[16:19]
    ds_read_b128 a[92:95], v5 offset:10240
    v_mfma_f32_16x16x32_bf16 v[20:23], v[236:239], a[120:123], v[20:23]
    v_add_f32 v233, -1.0, v232
    v_mfma_f32_16x16x32_bf16 v[24:27], v[244:247], a[120:123], v[24:27]
    v_lshlrev_b32 v8, 16, v100
    v_mfma_f32_16x16x32_bf16 v[28:31], v[236:239], a[124:127], v[28:31]
    v_and_b32 v100, 0xffff0000, v100
    v_mfma_f32_16x16x32_bf16 v[32:35], v[244:247], a[124:127], v[32:35]
    s_waitcnt lgkmcnt(6)
    v_lshlrev_b32 v9, 16, v200
    v_and_b32 v200, 0xffff0000, v200
    v_mfma_f32_16x16x32_bf16 v[180:183], v[252:255], a[64:67], v[180:183]
    ds_read_b128 a[96:99], v5 offset:11264
    v_mul_f32 v9, v8, v9
    v_mfma_f32_16x16x32_bf16 v[16:19], v[184:187], a[64:67], v[16:19]
    ds_read_b128 a[100:103], v5 offset:13312
    v_mfma_f32_16x16x32_bf16 v[20:23], v[252:255], a[68:71], v[20:23]
    v_mul_f32 v200, v100, v200
    v_fmac_f32 v48, v73, v9
    v_mfma_f32_16x16x32_bf16 v[24:27], v[184:187], a[68:71], v[24:27]
    s_waitcnt lgkmcnt(6)
    ds_read_b128 a[104:107], v5 offset:14336
    v_fmac_f32 v49, v73, v200
    v_mfma_f32_16x16x32_bf16 v[28:31], v[252:255], a[72:75], v[28:31]
    ds_read_b128 a[108:111], v5 offset:15360
    v_mfma_f32_16x16x32_bf16 v[32:35], v[184:187], a[72:75], v[32:35]
    v_lshlrev_b32 v10, 16, v216
    v_mfma_f32_16x16x32_bf16 v[180:183], v[104:107], a[76:79], v[180:183]
    ds_read_b128 a[112:115], v5 offset:17408
    v_mfma_f32_16x16x32_bf16 v[16:19], v[208:211], a[76:79], v[16:19]
    s_waitcnt lgkmcnt(7)
    v_and_b32 v216, 0xffff0000, v216
    v_mul_f32 v10, v8, v10
    v_mfma_f32_16x16x32_bf16 v[20:23], v[104:107], a[80:83], v[20:23]
    ds_read_b128 a[116:119], v5 offset:18432
    v_mul_f32 v216, v100, v216
    v_mfma_f32_16x16x32_bf16 v[24:27], v[208:211], a[80:83], v[24:27]
    ds_read_b128 a[120:123], v5 offset:19456
    v_mfma_f32_16x16x32_bf16 v[28:31], v[104:107], a[84:87], v[28:31]
    v_fmac_f32 v56, v233, v10
    v_mfma_f32_16x16x32_bf16 v[32:35], v[208:211], a[84:87], v[32:35]
    s_waitcnt lgkmcnt(7)
    ds_read_b128 a[124:127], v5 offset:21504
    v_mfma_f32_16x16x32_bf16 v[180:183], a[240:243], a[88:91], v[180:183]
    v_fmac_f32 v57, v233, v216
    v_mfma_f32_16x16x32_bf16 v[16:19], a[244:247], a[88:91], v[16:19]
    v_lshlrev_b32 v8, 16, v101
    v_mfma_f32_16x16x32_bf16 v[20:23], a[240:243], a[92:95], v[20:23]
    v_and_b32 v101, 0xffff0000, v101
    v_mfma_f32_16x16x32_bf16 v[24:27], a[244:247], a[92:95], v[24:27]
    s_waitcnt lgkmcnt(6)
    v_lshlrev_b32 v9, 16, v201
    v_and_b32 v201, 0xffff0000, v201
    v_mfma_f32_16x16x32_bf16 v[28:31], a[240:243], a[96:99], v[28:31]
    ds_read_b128 a[64:67], v5 offset:22528
    v_mul_f32 v9, v8, v9
    v_mfma_f32_16x16x32_bf16 v[32:35], a[244:247], a[96:99], v[32:35]
    ds_read_b128 a[68:71], v5 offset:23552
    v_mfma_f32_16x16x32_bf16 v[180:183], a[248:251], a[100:103], v[180:183]
    v_mul_f32 v201, v101, v201
    v_fmac_f32 v50, v73, v9
    v_mfma_f32_16x16x32_bf16 v[16:19], a[144:147], a[100:103], v[16:19]
    s_waitcnt lgkmcnt(6)
    ds_read_b128 a[72:75], v5 offset:25600
    v_fmac_f32 v51, v73, v201
    v_mfma_f32_16x16x32_bf16 v[20:23], a[248:251], a[104:107], v[20:23]
    ds_read_b128 a[76:79], v5 offset:26624
    v_mfma_f32_16x16x32_bf16 v[24:27], a[144:147], a[104:107], v[24:27]
    v_lshlrev_b32 v10, 16, v217
    v_mfma_f32_16x16x32_bf16 v[28:31], a[248:251], a[108:111], v[28:31]
    ds_read_b128 a[80:83], v5 offset:27648
    v_mfma_f32_16x16x32_bf16 v[32:35], a[144:147], a[108:111], v[32:35]
    s_waitcnt lgkmcnt(7)
    v_and_b32 v217, 0xffff0000, v217
    v_mul_f32 v10, v8, v10
    v_mfma_f32_16x16x32_bf16 v[180:183], a[148:151], a[112:115], v[180:183]
    ds_read_b128 a[84:87], v5 offset:29696
    v_mul_f32 v217, v101, v217
    v_mfma_f32_16x16x32_bf16 v[16:19], a[152:155], a[112:115], v[16:19]
    ds_read_b128 a[88:91], v5 offset:30720
    v_mfma_f32_16x16x32_bf16 v[20:23], a[148:151], a[116:119], v[20:23]
    v_fmac_f32 v58, v233, v10
    v_mfma_f32_16x16x32_bf16 v[24:27], a[152:155], a[116:119], v[24:27]
    s_waitcnt lgkmcnt(7)
    ds_read_b128 a[92:95], v5 offset:31744
    v_mfma_f32_16x16x32_bf16 v[28:31], a[148:151], a[120:123], v[28:31]
    v_fmac_f32 v59, v233, v217
    v_mfma_f32_16x16x32_bf16 v[32:35], a[152:155], a[120:123], v[32:35]
    v_lshlrev_b32 v8, 16, v102
    v_mfma_f32_16x16x32_bf16 v[180:183], a[156:159], a[124:127], v[180:183]
    v_and_b32 v102, 0xffff0000, v102
    v_mfma_f32_16x16x32_bf16 v[16:19], a[160:163], a[124:127], v[16:19]
    s_waitcnt lgkmcnt(6)
    v_lshlrev_b32 v9, 16, v202
    v_mfma_f32_16x16x32_bf16 v[20:23], a[156:159], a[64:67], v[20:23]
    s_waitcnt lgkmcnt(0)
    v_and_b32 v202, 0xffff0000, v202
    v_mul_f32 v9, v8, v9
    v_mfma_f32_16x16x32_bf16 v[24:27], a[160:163], a[64:67], v[24:27]
    s_waitcnt vmcnt(2)
    v_mfma_f32_16x16x32_bf16 v[28:31], a[156:159], a[68:71], v[28:31]
    s_barrier
    v_mfma_f32_16x16x32_bf16 v[32:35], a[160:163], a[68:71], v[32:35]
    ds_read_b128 a[96:99], v5 offset:33792
    v_mul_f32 v202, v102, v202
    v_mfma_f32_16x16x32_bf16 v[180:183], a[164:167], a[72:75], v[180:183]
    ds_read_b128 a[100:103], v5 offset:37888
    v_fmac_f32 v80, v73, v9
    v_mfma_f32_16x16x32_bf16 v[16:19], a[168:171], a[72:75], v[16:19]
    ds_read_b128 a[104:107], v5 offset:41984
    v_fmac_f32 v81, v73, v202
    v_mfma_f32_16x16x32_bf16 v[20:23], a[164:167], a[76:79], v[20:23]
    ds_read_b128 a[108:111], v5 offset:46080
    v_mfma_f32_16x16x32_bf16 v[24:27], a[168:171], a[76:79], v[24:27]
    v_lshlrev_b32 v10, 16, v218
    v_and_b32 v218, 0xffff0000, v218
    v_mfma_f32_16x16x32_bf16 v[28:31], a[164:167], a[80:83], v[28:31]
    ds_read_b128 a[112:115], v5 offset:50176
    v_mul_f32 v10, v8, v10
    v_mfma_f32_16x16x32_bf16 v[32:35], a[168:171], a[80:83], v[32:35]
    ds_read_b128 a[116:119], v5 offset:54272
    v_mul_f32 v218, v102, v218
    v_mfma_f32_16x16x32_bf16 v[180:183], a[172:175], a[84:87], v[180:183]
    ds_read_b128 a[120:123], v5 offset:58368
    v_fmac_f32 v88, v233, v10
    v_mfma_f32_16x16x32_bf16 v[16:19], a[176:179], a[84:87], v[16:19]
    ds_read_b128 a[124:127], v5 offset:62464
    v_mfma_f32_16x16x32_bf16 v[20:23], a[172:175], a[88:91], v[20:23]
    v_fmac_f32 v89, v233, v218
    v_mfma_f32_16x16x32_bf16 v[24:27], a[176:179], a[88:91], v[24:27]
    v_lshlrev_b32 v8, 16, v103
    v_mfma_f32_16x16x32_bf16 v[28:31], a[172:175], a[92:95], v[28:31]
    v_and_b32 v103, 0xffff0000, v103
    v_mfma_f32_16x16x32_bf16 v[32:35], a[176:179], a[92:95], v[32:35]
    s_waitcnt lgkmcnt(6)
    v_lshlrev_b32 v9, 16, v203
    v_and_b32 v203, 0xffff0000, v203
    v_mfma_f32_16x16x32_bf16 v[180:183], a[180:183], a[96:99], v[180:183]
    ds_read_b128 a[64:67], v5 offset:34816
    v_mul_f32 v9, v8, v9
    v_mfma_f32_16x16x32_bf16 v[16:19], a[184:187], a[96:99], v[16:19]
    ds_read_b128 a[68:71], v5 offset:38912
    v_mfma_f32_16x16x32_bf16 v[180:183], a[188:191], a[100:103], v[180:183]
    v_mul_f32 v203, v103, v203
    v_fmac_f32 v82, v73, v9
    v_mfma_f32_16x16x32_bf16 v[16:19], a[192:195], a[100:103], v[16:19]
    s_waitcnt lgkmcnt(6)
    ds_read_b128 a[72:75], v5 offset:43008
    v_fmac_f32 v83, v73, v203
    v_mfma_f32_16x16x32_bf16 v[180:183], a[196:199], a[104:107], v[180:183]
    ds_read_b128 a[76:79], v5 offset:47104
    v_mfma_f32_16x16x32_bf16 v[16:19], a[200:203], a[104:107], v[16:19]
    v_lshlrev_b32 v10, 16, v219
    v_mfma_f32_16x16x32_bf16 v[180:183], a[204:207], a[108:111], v[180:183]
    ds_read_b128 a[80:83], v5 offset:51200
    v_mfma_f32_16x16x32_bf16 v[16:19], a[208:211], a[108:111], v[16:19]
    s_waitcnt lgkmcnt(7)
    v_and_b32 v219, 0xffff0000, v219
    v_mul_f32 v10, v8, v10
    v_mfma_f32_16x16x32_bf16 v[180:183], a[136:139], a[112:115], v[180:183]
    ds_read_b128 a[84:87], v5 offset:55296
    v_mul_f32 v219, v103, v219
    v_mfma_f32_16x16x32_bf16 v[16:19], a[140:143], a[112:115], v[16:19]
    ds_read_b128 a[88:91], v5 offset:59392
    v_mfma_f32_16x16x32_bf16 v[180:183], v[160:163], a[116:119], v[180:183]
    v_fmac_f32 v90, v233, v10
    v_mfma_f32_16x16x32_bf16 v[16:19], v[176:179], a[116:119], v[16:19]
    s_waitcnt lgkmcnt(7)
    ds_read_b128 a[92:95], v5 offset:63488
    v_mfma_f32_16x16x32_bf16 v[180:183], v[192:195], a[120:123], v[180:183]
    v_fmac_f32 v91, v233, v219
    v_mfma_f32_16x16x32_bf16 v[16:19], v[96:99], a[120:123], v[16:19]
    v_fma_f32 v224, v224, v72, -v48
    v_mfma_f32_16x16x32_bf16 v[180:183], v[64:67], a[124:127], v[180:183]
    v_fma_f32 v225, v225, v72, -v49
    v_mfma_f32_16x16x32_bf16 v[16:19], v[68:71], a[124:127], v[16:19]
    s_waitcnt lgkmcnt(6)
    v_fma_f32 v226, v226, v72, -v50
    v_fma_f32 v227, v227, v72, -v51
    v_mfma_f32_16x16x32_bf16 v[20:23], a[180:183], a[64:67], v[20:23]
    s_add_u32 s6, s60, 4096
    ds_read_b128 a[96:99], v5 offset:35840
    v_fma_f32 v240, v240, v72, -v80
    v_mfma_f32_16x16x32_bf16 v[24:27], a[184:187], a[64:67], v[24:27]
    ds_read_b128 a[100:103], v5 offset:39936
    v_mfma_f32_16x16x32_bf16 v[20:23], a[188:191], a[68:71], v[20:23]
    v_fma_f32 v241, v241, v72, -v81
    v_fma_f32 v242, v242, v72, -v82
    v_mfma_f32_16x16x32_bf16 v[24:27], a[192:195], a[68:71], v[24:27]
    s_waitcnt lgkmcnt(6)
    ds_read_b128 a[104:107], v5 offset:44032
    v_fma_f32 v243, v243, v72, -v83
    v_mfma_f32_16x16x32_bf16 v[20:23], a[196:199], a[72:75], v[20:23]
    ds_read_b128 a[108:111], v5 offset:48128
    buffer_load_dwordx4 v[36:39], v1, s[8:11], s60 offen offset:2048 sc1
    v_mfma_f32_16x16x32_bf16 v[24:27], a[200:203], a[72:75], v[24:27]
    v_fma_f32 v180, v180, v234, -v148
    v_fma_f32 v181, v181, v234, -v149
    v_mfma_f32_16x16x32_bf16 v[20:23], a[204:207], a[76:79], v[20:23]
    ds_read_b128 a[112:115], v5 offset:52224
    v_fma_f32 v182, v182, v234, -v150
    v_mfma_f32_16x16x32_bf16 v[24:27], a[208:211], a[76:79], v[24:27]
    s_waitcnt lgkmcnt(7)
    v_fma_f32 v183, v183, v234, -v151
    v_fma_f32 v16, v16, v234, -v212
    v_mfma_f32_16x16x32_bf16 v[20:23], a[136:139], a[80:83], v[20:23]
    ds_read_b128 a[116:119], v5 offset:56320
    v_fma_f32 v17, v17, v234, -v213
    v_mfma_f32_16x16x32_bf16 v[24:27], a[140:143], a[80:83], v[24:27]
    ds_read_b128 a[120:123], v5 offset:60416
    v_fma_f32 v18, v18, v234, -v214
    v_mfma_f32_16x16x32_bf16 v[20:23], v[160:163], a[84:87], v[20:23]
    buffer_load_dwordx4 v[44:47], v1, s[8:11], s6 offen offset:0 sc1
    v_fma_f32 v19, v19, v234, -v215
    v_mfma_f32_16x16x32_bf16 v[24:27], v[176:179], a[84:87], v[24:27]
    s_waitcnt lgkmcnt(7)
    ds_read_b128 a[124:127], v5 offset:64512
    v_cvt_pk_bf16_f32 v148, v180, v181
    v_mfma_f32_16x16x32_bf16 v[20:23], v[192:195], a[88:91], v[20:23]
    v_cvt_pk_bf16_f32 v149, v182, v183
    v_cvt_pk_bf16_f32 v150, v16, v17
    v_mfma_f32_16x16x32_bf16 v[24:27], v[96:99], a[88:91], v[24:27]
    v_cvt_pk_bf16_f32 v151, v18, v19
    v_min_u32 v148, -2, v148
    v_mfma_f32_16x16x32_bf16 v[20:23], v[64:67], a[92:95], v[20:23]
    v_min_u32 v149, -2, v149
    v_min_u32 v150, -2, v150
    v_mfma_f32_16x16x32_bf16 v[24:27], v[68:71], a[92:95], v[24:27]
    s_waitcnt lgkmcnt(6)
    v_min_u32 v151, -2, v151
    buffer_store_dwordx4 v[148:151], v1, s[8:11], s70 offen offset:1024 sc1
    v_mfma_f32_16x16x32_bf16 v[28:31], a[180:183], a[96:99], v[28:31]
    ds_read_b128 a[64:67], v5 offset:0
    buffer_load_dwordx4 v[124:127], v1, s[8:11], s6 offen offset:2048 sc1
    v_mfma_f32_16x16x32_bf16 v[32:35], a[184:187], a[96:99], v[32:35]
    ds_read_b128 a[68:71], v5 offset:4096
    v_mfma_f32_16x16x32_bf16 v[28:31], a[188:191], a[100:103], v[28:31]
    v_fma_f32 v20, v20, v248, -v60
    v_fma_f32 v21, v21, v248, -v61
    v_mfma_f32_16x16x32_bf16 v[32:35], a[192:195], a[100:103], v[32:35]
    s_waitcnt lgkmcnt(6)
    ds_read_b128 a[72:75], v5 offset:8192
    v_fma_f32 v22, v22, v248, -v62
    v_mfma_f32_16x16x32_bf16 v[28:31], a[196:199], a[104:107], v[28:31]
    ds_read_b128 a[76:79], v5 offset:12288
    v_fma_f32 v23, v23, v248, -v63
    v_mfma_f32_16x16x32_bf16 v[32:35], a[200:203], a[104:107], v[32:35]
    v_fma_f32 v24, v24, v248, -v92
    v_fma_f32 v25, v25, v248, -v93
    v_mfma_f32_16x16x32_bf16 v[28:31], a[204:207], a[108:111], v[28:31]
    ds_read_b128 a[80:83], v5 offset:16384
    buffer_load_dwordx4 v[40:43], v1, s[8:11], s60 offen offset:3072 sc1
    v_mfma_f32_16x16x32_bf16 v[32:35], a[208:211], a[108:111], v[32:35]
    s_waitcnt lgkmcnt(7)
    v_fma_f32 v26, v26, v248, -v94
    v_fma_f32 v27, v27, v248, -v95
    v_mfma_f32_16x16x32_bf16 v[28:31], a[136:139], a[112:115], v[28:31]
    ds_read_b128 a[84:87], v5 offset:20480
    v_cvt_pk_bf16_f32 v60, v20, v21
    v_mfma_f32_16x16x32_bf16 v[32:35], a[140:143], a[112:115], v[32:35]
    ds_read_b128 a[88:91], v5 offset:24576
    v_cvt_pk_bf16_f32 v61, v22, v23
    v_mfma_f32_16x16x32_bf16 v[28:31], v[160:163], a[116:119], v[28:31]
    v_cvt_pk_bf16_f32 v62, v24, v25
    v_cvt_pk_bf16_f32 v63, v26, v27
    v_mfma_f32_16x16x32_bf16 v[32:35], v[176:179], a[116:119], v[32:35]
    s_waitcnt lgkmcnt(7)
    ds_read_b128 a[92:95], v5 offset:28672
    v_min_u32 v60, -2, v60
    v_mfma_f32_16x16x32_bf16 v[28:31], v[192:195], a[120:123], v[28:31]
    buffer_load_dwordx4 v[116:119], v1, s[8:11], s6 offen offset:1024 sc1
    v_min_u32 v61, -2, v61
    v_mfma_f32_16x16x32_bf16 v[32:35], v[96:99], a[120:123], v[32:35]
    v_min_u32 v62, -2, v62
    v_min_u32 v63, -2, v63
    v_mfma_f32_16x16x32_bf16 v[28:31], v[64:67], a[124:127], v[28:31]
    buffer_store_dwordx4 v[60:63], v1, s[8:11], s71 offen offset:1024 sc1
    v_mfma_f32_16x16x32_bf16 v[32:35], v[68:71], a[124:127], v[32:35]
    s_waitcnt lgkmcnt(6)
    v_mfma_f32_16x16x32_bf16 v[128:131], v[252:255], a[64:67], v[128:131]
    ds_read_b128 a[96:99], v5 offset:32768
    v_mfma_f32_16x16x32_bf16 v[172:175], v[184:187], a[64:67], v[172:175]
    ds_read_b128 a[100:103], v5 offset:36864
    v_mfma_f32_16x16x32_bf16 v[128:131], v[104:107], a[68:71], v[128:131]
    buffer_load_dwordx4 v[164:167], v1, s[8:11], s6 offen offset:3072 sc1
    v_fma_f32 v28, v28, v250, -v156
    v_mfma_f32_16x16x32_bf16 v[172:175], v[208:211], a[68:71], v[172:175]
    s_waitcnt lgkmcnt(6)
    ds_read_b128 a[104:107], v5 offset:40960
    v_fma_f32 v29, v29, v250, -v157
    v_mfma_f32_16x16x32_bf16 v[128:131], a[240:243], a[72:75], v[128:131]
    ds_read_b128 a[108:111], v5 offset:45056
    v_fma_f32 v30, v30, v250, -v158
    v_mfma_f32_16x16x32_bf16 v[172:175], a[244:247], a[72:75], v[172:175]
    v_fma_f32 v31, v31, v250, -v159
    v_fma_f32 v32, v32, v250, -v220
    v_mfma_f32_16x16x32_bf16 v[128:131], a[248:251], a[76:79], v[128:131]
    ds_read_b128 a[112:115], v5 offset:49152
    v_fma_f32 v33, v33, v250, -v221
    v_mfma_f32_16x16x32_bf16 v[172:175], a[144:147], a[76:79], v[172:175]
    s_waitcnt lgkmcnt(7)
    v_fma_f32 v34, v34, v250, -v222
    v_fma_f32 v35, v35, v250, -v223
    v_mfma_f32_16x16x32_bf16 v[128:131], a[148:151], a[80:83], v[128:131]
    ds_read_b128 a[116:119], v5 offset:53248
    v_cvt_pk_bf16_f32 v156, v28, v29
    v_mfma_f32_16x16x32_bf16 v[172:175], a[152:155], a[80:83], v[172:175]
    ds_read_b128 a[120:123], v5 offset:57344
    v_cvt_pk_bf16_f32 v157, v30, v31
    v_mfma_f32_16x16x32_bf16 v[128:131], a[156:159], a[84:87], v[128:131]
    v_cvt_pk_bf16_f32 v158, v32, v33
    v_cvt_pk_bf16_f32 v159, v34, v35
    v_mfma_f32_16x16x32_bf16 v[172:175], a[160:163], a[84:87], v[172:175]
    s_waitcnt lgkmcnt(7)
    ds_read_b128 a[124:127], v5 offset:61440
    v_min_u32 v156, -2, v156
    v_mfma_f32_16x16x32_bf16 v[128:131], a[164:167], a[88:91], v[128:131]
    v_min_u32 v157, -2, v157
    v_min_u32 v158, -2, v158
    v_mfma_f32_16x16x32_bf16 v[172:175], a[168:171], a[88:91], v[172:175]
    v_min_u32 v159, -2, v159
    buffer_store_dwordx4 v[156:159], v1, s[8:11], s72 offen offset:1024 sc1
    v_mfma_f32_16x16x32_bf16 v[128:131], a[172:175], a[92:95], v[128:131]
    v_mfma_f32_16x16x32_bf16 v[172:175], a[176:179], a[92:95], v[172:175]
    s_waitcnt lgkmcnt(6)
    v_mfma_f32_16x16x32_bf16 v[128:131], a[180:183], a[96:99], v[128:131]
    v_mfma_f32_16x16x32_bf16 v[172:175], a[184:187], a[96:99], v[172:175]
    v_mfma_f32_16x16x32_bf16 v[128:131], a[188:191], a[100:103], v[128:131]
    v_mfma_f32_16x16x32_bf16 v[172:175], a[192:195], a[100:103], v[172:175]
    s_waitcnt lgkmcnt(4)
    v_mfma_f32_16x16x32_bf16 v[128:131], a[196:199], a[104:107], v[128:131]
    v_mfma_f32_16x16x32_bf16 v[172:175], a[200:203], a[104:107], v[172:175]
    v_mfma_f32_16x16x32_bf16 v[128:131], a[204:207], a[108:111], v[128:131]
    v_mfma_f32_16x16x32_bf16 v[172:175], a[208:211], a[108:111], v[172:175]
    s_waitcnt lgkmcnt(2)
    v_mfma_f32_16x16x32_bf16 v[128:131], a[136:139], a[112:115], v[128:131]
    v_mfma_f32_16x16x32_bf16 v[172:175], a[140:143], a[112:115], v[172:175]
    v_mfma_f32_16x16x32_bf16 v[128:131], v[160:163], a[116:119], v[128:131]
    v_mfma_f32_16x16x32_bf16 v[172:175], v[176:179], a[116:119], v[172:175]
    s_waitcnt lgkmcnt(0)
    v_mfma_f32_16x16x32_bf16 v[128:131], v[192:195], a[120:123], v[128:131]
    v_mfma_f32_16x16x32_bf16 v[172:175], v[96:99], a[120:123], v[172:175]
    v_mfma_f32_16x16x32_bf16 v[128:131], v[64:67], a[124:127], v[128:131]
    v_mfma_f32_16x16x32_bf16 v[172:175], v[68:71], a[124:127], v[172:175]
    s_add_u32 s99, s99, 1
    s_cmp_lt_u32 s99, 0x100000
    s_cselect_b64 s[70:71], -1, 0
    s_waitcnt vmcnt(1)
B_rx1:
    v_max3_u32 v8, v36, v37, v38
    v_max3_u32 v9, v39, v44, v45
    v_max3_u32 v8, v8, v46, v47
    v_max3_u32 v9, v9, v124, v125
    v_max3_u32 v8, v8, v126, v127
    v_max_u32 v8, v8, v9
    v_cmp_eq_u32 vcc, -1, v8
    s_and_b64 vcc, vcc, s[70:71]
    s_cbranch_vccnz B_rx
    v_max3_u32 v8, v40, v41, v42
    v_max3_u32 v9, v43, v116, v117
    v_max3_u32 v8, v8, v118, v119
    v_max3_u32 v9, v9, v164, v165
    v_max3_u32 v8, v8, v166, v167
    v_max_u32 v8, v8, v9
    v_cmp_eq_u32 vcc, -1, v8
    s_and_b64 vcc, vcc, s[70:71]
    s_cbranch_vccnz B_rx4
    v_pk_fma_f32 v[128:129], v[128:129], v[232:233], v[56:57] op_sel_hi:[1,0,1] neg_lo:[0,0,1] neg_hi:[0,0,1]
    v_pk_fma_f32 v[130:131], v[130:131], v[232:233], v[58:59] op_sel_hi:[1,0,1] neg_lo:[0,0,1] neg_hi:[0,0,1]
    v_pk_fma_f32 v[172:173], v[172:173], v[232:233], v[88:89] op_sel_hi:[1,0,1] neg_lo:[0,0,1] neg_hi:[0,0,1]
    v_pk_fma_f32 v[174:175], v[174:175], v[232:233], v[90:91] op_sel_hi:[1,0,1] neg_lo:[0,0,1] neg_hi:[0,0,1]
    v_lshlrev_b32 v8, 16, v36
    v_and_b32 v9, 0xffff0000, v36
    v_pk_add_f32 v[224:225], v[224:225], v[8:9]
    v_lshlrev_b32 v10, 16, v37
    v_and_b32 v11, 0xffff0000, v37
    v_pk_add_f32 v[226:227], v[226:227], v[10:11]
    v_lshlrev_b32 v8, 16, v44
    v_and_b32 v9, 0xffff0000, v44
    v_pk_add_f32 v[224:225], v[224:225], v[8:9]
    v_lshlrev_b32 v10, 16, v45
    v_and_b32 v11, 0xffff0000, v45
    v_pk_add_f32 v[226:227], v[226:227], v[10:11]
    v_lshlrev_b32 v8, 16, v124
    v_and_b32 v9, 0xffff0000, v124
    v_pk_add_f32 v[224:225], v[224:225], v[8:9]
    v_lshlrev_b32 v10, 16, v125
    v_and_b32 v11, 0xffff0000, v125
    v_pk_add_f32 v[226:227], v[226:227], v[10:11]
    buffer_store_dwordx4 v[224:227], v12, s[36:39], s76 offen offset:0 sc1
    v_lshlrev_b32 v8, 16, v38
    v_and_b32 v9, 0xffff0000, v38
    v_pk_add_f32 v[240:241], v[240:241], v[8:9]
    v_lshlrev_b32 v10, 16, v39
    v_and_b32 v11, 0xffff0000, v39
    v_pk_add_f32 v[242:243], v[242:243], v[10:11]
    v_lshlrev_b32 v8, 16, v46
    v_and_b32 v9, 0xffff0000, v46
    v_pk_add_f32 v[240:241], v[240:241], v[8:9]
    v_lshlrev_b32 v10, 16, v47
    v_and_b32 v11, 0xffff0000, v47
    v_pk_add_f32 v[242:243], v[242:243], v[10:11]
    v_lshlrev_b32 v8, 16, v126
    v_and_b32 v9, 0xffff0000, v126
    v_pk_add_f32 v[240:241], v[240:241], v[8:9]
    v_lshlrev_b32 v10, 16, v127
    v_and_b32 v11, 0xffff0000, v127
    v_pk_add_f32 v[242:243], v[242:243], v[10:11]
    buffer_store_dwordx4 v[240:243], v12, s[36:39], s76 offen offset:64 sc1
B_rx5:
    v_lshlrev_b32 v8, 16, v40
    v_and_b32 v9, 0xffff0000, v40
    v_pk_add_f32 v[128:129], v[128:129], v[8:9]
    v_lshlrev_b32 v10, 16, v41
    v_and_b32 v11, 0xffff0000, v41
    v_pk_add_f32 v[130:131], v[130:131], v[10:11]
    v_lshlrev_b32 v8, 16, v116
    v_and_b32 v9, 0xffff0000, v116
    v_pk_add_f32 v[128:129], v[128:129], v[8:9]
    v_lshlrev_b32 v10, 16, v117
    v_and_b32 v11, 0xffff0000, v117
    v_pk_add_f32 v[130:131], v[130:131], v[10:11]
    v_lshlrev_b32 v8, 16, v164
    v_and_b32 v9, 0xffff0000, v164
    v_pk_add_f32 v[128:129], v[128:129], v[8:9]
    v_lshlrev_b32 v10, 16, v165
    v_and_b32 v11, 0xffff0000, v165
    v_pk_add_f32 v[130:131], v[130:131], v[10:11]
    buffer_store_dwordx4 v[128:131], v12, s[36:39], s77 offen offset:0 sc1
    v_lshlrev_b32 v8, 16, v42
    v_and_b32 v9, 0xffff0000, v42
    v_pk_add_f32 v[172:173], v[172:173], v[8:9]
    v_lshlrev_b32 v10, 16, v43
    v_and_b32 v11, 0xffff0000, v43
    v_pk_add_f32 v[174:175], v[174:175], v[10:11]
    v_lshlrev_b32 v8, 16, v118
    v_and_b32 v9, 0xffff0000, v118
    v_pk_add_f32 v[172:173], v[172:173], v[8:9]
    v_lshlrev_b32 v10, 16, v119
    v_and_b32 v11, 0xffff0000, v119
    v_pk_add_f32 v[174:175], v[174:175], v[10:11]
    v_lshlrev_b32 v8, 16, v166
    v_and_b32 v9, 0xffff0000, v166
    v_pk_add_f32 v[172:173], v[172:173], v[8:9]
    v_lshlrev_b32 v10, 16, v167
    v_and_b32 v11, 0xffff0000, v167
    v_pk_add_f32 v[174:175], v[174:175], v[10:11]
    buffer_store_dwordx4 v[172:175], v12, s[36:39], s77 offen offset:64 sc1
    s_endpgm
B_rx:
    buffer_load_dwordx4 v[36:39], v1, s[8:11], s60 offen offset:2048 sc1
    buffer_load_dwordx4 v[44:47], v1, s[8:11], s6 offen offset:0 sc1
    buffer_load_dwordx4 v[124:127], v1, s[8:11], s6 offen offset:2048 sc1
    buffer_load_dwordx4 v[40:43], v1, s[8:11], s60 offen offset:3072 sc1
    buffer_load_dwordx4 v[116:119], v1, s[8:11], s6 offen offset:1024 sc1
    buffer_load_dwordx4 v[164:167], v1, s[8:11], s6 offen offset:3072 sc1
    s_add_u32 s99, s99, 1
    s_cmp_lt_u32 s99, 0x100000
    s_cselect_b64 s[70:71], -1, 0
    s_waitcnt vmcnt(0)
    s_branch B_rx1
B_rx4:
    buffer_load_dwordx4 v[40:43], v1, s[8:11], s60 offen offset:3072 sc1
    buffer_load_dwordx4 v[116:119], v1, s[8:11], s6 offen offset:1024 sc1
    buffer_load_dwordx4 v[164:167], v1, s[8:11], s6 offen offset:3072 sc1
    v_pk_fma_f32 v[128:129], v[128:129], v[232:233], v[56:57] op_sel_hi:[1,0,1] neg_lo:[0,0,1] neg_hi:[0,0,1]
    v_pk_fma_f32 v[130:131], v[130:131], v[232:233], v[58:59] op_sel_hi:[1,0,1] neg_lo:[0,0,1] neg_hi:[0,0,1]
    v_pk_fma_f32 v[172:173], v[172:173], v[232:233], v[88:89] op_sel_hi:[1,0,1] neg_lo:[0,0,1] neg_hi:[0,0,1]
    v_pk_fma_f32 v[174:175], v[174:175], v[232:233], v[90:91] op_sel_hi:[1,0,1] neg_lo:[0,0,1] neg_hi:[0,0,1]
    v_lshlrev_b32 v8, 16, v36
    v_and_b32 v9, 0xffff0000, v36
    v_pk_add_f32 v[224:225], v[224:225], v[8:9]
    v_lshlrev_b32 v10, 16, v37
    v_and_b32 v11, 0xffff0000, v37
    v_pk_add_f32 v[226:227], v[226:227], v[10:11]
    v_lshlrev_b32 v8, 16, v44
    v_and_b32 v9, 0xffff0000, v44
    v_pk_add_f32 v[224:225], v[224:225], v[8:9]
    v_lshlrev_b32 v10, 16, v45
    v_and_b32 v11, 0xffff0000, v45
    v_pk_add_f32 v[226:227], v[226:227], v[10:11]
    v_lshlrev_b32 v8, 16, v124
    v_and_b32 v9, 0xffff0000, v124
    v_pk_add_f32 v[224:225], v[224:225], v[8:9]
    v_lshlrev_b32 v10, 16, v125
    v_and_b32 v11, 0xffff0000, v125
    v_pk_add_f32 v[226:227], v[226:227], v[10:11]
    buffer_store_dwordx4 v[224:227], v12, s[36:39], s76 offen offset:0 sc1
    v_lshlrev_b32 v8, 16, v38
    v_and_b32 v9, 0xffff0000, v38
    v_pk_add_f32 v[240:241], v[240:241], v[8:9]
    v_lshlrev_b32 v10, 16, v39
    v_and_b32 v11, 0xffff0000, v39
    v_pk_add_f32 v[242:243], v[242:243], v[10:11]
    v_lshlrev_b32 v8, 16, v46
    v_and_b32 v9, 0xffff0000, v46
    v_pk_add_f32 v[240:241], v[240:241], v[8:9]
    v_lshlrev_b32 v10, 16, v47
    v_and_b32 v11, 0xffff0000, v47
    v_pk_add_f32 v[242:243], v[242:243], v[10:11]
    v_lshlrev_b32 v8, 16, v126
    v_and_b32 v9, 0xffff0000, v126
    v_pk_add_f32 v[240:241], v[240:241], v[8:9]
    v_lshlrev_b32 v10, 16, v127
    v_and_b32 v11, 0xffff0000, v127
    v_pk_add_f32 v[242:243], v[242:243], v[10:11]
    buffer_store_dwordx4 v[240:243], v12, s[36:39], s76 offen offset:64 sc1
    s_waitcnt vmcnt(2)
B_rx2:
    v_max3_u32 v8, v40, v41, v42
    v_max3_u32 v9, v43, v116, v117
    v_max3_u32 v8, v8, v118, v119
    v_max3_u32 v9, v9, v164, v165
    v_max3_u32 v8, v8, v166, v167
    v_max_u32 v8, v8, v9
    v_cmp_eq_u32 vcc, -1, v8
    s_and_b64 vcc, vcc, s[70:71]
    s_cbranch_vccz B_rx5
    buffer_load_dwordx4 v[40:43], v1, s[8:11], s60 offen offset:3072 sc1
    buffer_load_dwordx4 v[116:119], v1, s[8:11], s6 offen offset:1024 sc1
    buffer_load_dwordx4 v[164:167], v1, s[8:11], s6 offen offset:3072 sc1
    s_add_u32 s99, s99, 1
    s_cmp_lt_u32 s99, 0x100000
    s_cselect_b64 s[70:71], -1, 0
    s_waitcnt vmcnt(0)
    s_branch B_rx2
A_pub1:
    s_cmp_eq_u32 s57, 0
    s_cbranch_scc1 A_rel0
    buffer_wbl2 sc1
    s_waitcnt vmcnt(0)
A_rel0:
    s_mov_b64 exec, 1
    buffer_atomic_add v15, v14, s[28:31], 0 offen sc1
    s_mov_b64 exec, -1
    s_branch A_ret0
A_spin1:
    buffer_load_dword v13, v14, s[28:31], 0 offen sc1
    s_waitcnt vmcnt(0)
    v_readfirstlane_b32 s52, v13
    s_cmp_ge_u32 s52, 0x8000000
    s_cbranch_scc1 A_ret1
    s_add_u32 s99, s99, 1
    s_cmp_lt_u32 s99, 0x100000
    s_cbranch_scc1 A_spin1
    s_branch A_ret1
A_eva:
    s_cmp_eq_u32 s50, 0
    s_cbranch_scc0 A_evwa
    s_lshl_b32 s52, s4, 11
    s_add_u32 s52, s52, 60882944
    buffer_load_dwordx4 v[188:191], v9, s[8:11], s52 offen offset:0 sc1
    buffer_load_dwordx4 v[228:231], v9, s[8:11], s52 offen offset:16 sc1
    buffer_load_dwordx4 v[236:239], v9, s[8:11], s52 offen offset:32 sc1
    buffer_load_dwordx4 v[244:247], v9, s[8:11], s52 offen offset:48 sc1
    buffer_load_dwordx4 v[252:255], v9, s[8:11], s52 offen offset:64 sc1
    buffer_load_dwordx4 v[184:187], v9, s[8:11], s52 offen offset:80 sc1
    buffer_load_dwordx4 v[104:107], v9, s[8:11], s52 offen offset:96 sc1
    buffer_load_dwordx4 v[208:211], v9, s[8:11], s52 offen offset:112 sc1
    s_mov_b32 s50, 4
    s_add_u32 s47, s47, 0x20000
    s_branch A_evra
A_evwa:
    s_add_u32 s47, s47, 0x10000
    s_cmp_eq_u32 s50, 3
    s_cbranch_scc1 A_evca
    s_cmp_eq_u32 s50, 1
    s_cbranch_scc0 A_evpa
    s_cmp_eq_u32 s57, 0
    s_cbranch_scc1 A_rela
    buffer_wbl2 sc1
    s_waitcnt vmcnt(0)
A_rela:
    s_mov_b64 exec, 1
    buffer_atomic_add v15, v14, s[28:31], 0 offen sc1
    s_mov_b64 exec, -1
    s_mov_b32 s50, 2
    s_add_u32 s47, s47, 0x30000
    s_branch A_evra
A_evpa:
    buffer_load_dword v13, v14, s[28:31], 0 offen sc1
    s_mov_b32 s50, 3
    s_branch A_evra
A_evca:
    s_mov_b32 s50, 0
    v_cmp_gt_u32 vcc, 8, v13
    s_nop 0
    s_cbranch_vccz A_evra
    buffer_load_dword v13, v14, s[28:31], 0 offen sc1
    s_add_u32 s99, s99, 1
    s_cmp_lt_u32 s99, 0x100000
    s_waitcnt vmcnt(0)
    s_cbranch_scc1 A_evca
    s_branch A_evra
A_evb:
    s_cmp_eq_u32 s50, 0
    s_cbranch_scc0 A_evwb
    s_lshl_b32 s52, s4, 11
    s_add_u32 s52, s52, 60882944
    buffer_load_dwordx4 v[188:191], v9, s[8:11], s52 offen offset:0 sc1
    buffer_load_dwordx4 v[228:231], v9, s[8:11], s52 offen offset:16 sc1
    buffer_load_dwordx4 v[236:239], v9, s[8:11], s52 offen offset:32 sc1
    buffer_load_dwordx4 v[244:247], v9, s[8:11], s52 offen offset:48 sc1
    buffer_load_dwordx4 v[252:255], v9, s[8:11], s52 offen offset:64 sc1
    buffer_load_dwordx4 v[184:187], v9, s[8:11], s52 offen offset:80 sc1
    buffer_load_dwordx4 v[104:107], v9, s[8:11], s52 offen offset:96 sc1
    buffer_load_dwordx4 v[208:211], v9, s[8:11], s52 offen offset:112 sc1
    s_mov_b32 s50, 4
    s_add_u32 s47, s47, 0x20000
    s_branch A_evrb
A_evwb:
    s_add_u32 s47, s47, 0x10000
    s_cmp_eq_u32 s50, 3
    s_cbranch_scc1 A_evcb
    s_cmp_eq_u32 s50, 1
    s_cbranch_scc0 A_evpb
    s_cmp_eq_u32 s57, 0
    s_cbranch_scc1 A_relb
    buffer_wbl2 sc1
    s_waitcnt vmcnt(0)
A_relb:
    s_mov_b64 exec, 1
    buffer_atomic_add v15, v14, s[28:31], 0 offen sc1
    s_mov_b64 exec, -1
    s_mov_b32 s50, 2
    s_add_u32 s47, s47, 0x30000
    s_branch A_evrb
A_evpb:
    buffer_load_dword v13, v14, s[28:31], 0 offen sc1
    s_mov_b32 s50, 3
    s_branch A_evrb
A_evcb:
    s_mov_b32 s50, 0
    v_cmp_gt_u32 vcc, 8, v13
    s_nop 0
    s_cbranch_vccz A_evrb
    buffer_load_dword v13, v14, s[28:31], 0 offen sc1
    s_add_u32 s99, s99, 1
    s_cmp_lt_u32 s99, 0x100000
    s_waitcnt vmcnt(0)
    s_cbranch_scc1 A_evcb
    s_branch A_evrb
A_evc:
    s_cmp_eq_u32 s50, 0
    s_cbranch_scc0 A_evwc
    s_lshl_b32 s52, s4, 11
    s_add_u32 s52, s52, 60882944
    buffer_load_dwordx4 v[188:191], v9, s[8:11], s52 offen offset:0 sc1
    buffer_load_dwordx4 v[228:231], v9, s[8:11], s52 offen offset:16 sc1
    buffer_load_dwordx4 v[236:239], v9, s[8:11], s52 offen offset:32 sc1
    buffer_load_dwordx4 v[244:247], v9, s[8:11], s52 offen offset:48 sc1
    buffer_load_dwordx4 v[252:255], v9, s[8:11], s52 offen offset:64 sc1
    buffer_load_dwordx4 v[184:187], v9, s[8:11], s52 offen offset:80 sc1
    buffer_load_dwordx4 v[104:107], v9, s[8:11], s52 offen offset:96 sc1
    buffer_load_dwordx4 v[208:211], v9, s[8:11], s52 offen offset:112 sc1
    s_mov_b32 s50, 4
    s_add_u32 s47, s47, 0x20000
    s_branch A_evrc
A_evwc:
    s_cmp_eq_u32 s50, 4
    s_cbranch_scc0 A_evx
    buffer_store_dword v15, off, s[8:11], s43 sc1
    s_mov_b32 s50, 5
    s_cmp_lt_u32 s5, 4
    s_cselect_b32 s52, 2, 1
    s_lshl_b32 s52, s52, 16
    s_add_u32 s47, s47, s52
    s_branch A_evrc
A_evx:
    s_cmp_eq_u32 s50, 5
    s_cbranch_scc0 A_evy
    buffer_load_dword v13, v14, s[8:11], s61 offen sc1
    s_branch A_evrc
A_evy:
    s_add_u32 s47, s47, 0x10000
    s_cmp_eq_u32 s50, 3
    s_cbranch_scc1 A_evcc
    buffer_load_dword v13, v14, s[28:31], 0 offen sc1
    s_mov_b32 s50, 3
    s_branch A_evrc
A_evcc:
    s_mov_b32 s50, 0
    v_cmp_gt_u32 vcc, 8, v13
    s_nop 0
    s_cbranch_vccz A_evrc
    buffer_load_dword v13, v14, s[28:31], 0 offen sc1
    s_add_u32 s99, s99, 1
    s_cmp_lt_u32 s99, 0x100000
    s_waitcnt vmcnt(0)
    s_cbranch_scc1 A_evcc
    s_branch A_evrc
B_spin1:
    s_waitcnt vmcnt(0)
    buffer_store_dword v15, off, s[8:11], s43 sc1
B_spl1:
    buffer_load_dword v13, v14, s[8:11], s61 offen sc1
    s_add_u32 s99, s99, 1
    s_waitcnt vmcnt(0)
    v_cmp_gt_u32 vcc, 1, v13
    s_nop 0
    s_cbranch_vccz B_spe1
    s_cmp_lt_u32 s99, 0x100000
    s_cbranch_scc1 B_spl1
B_spe1:
    s_xor_b32 m0, s42, 0
    s_add_u32 s44, s14, 0
    buffer_load_dwordx4 v2, s[8:11], s44 offen sc1 lds
    buffer_load_dwordx4 v3, s[8:11], s44 offen offset:1024 sc1 lds
    s_and_b32 s44, s42, 0xffff
    s_add_u32 m0, s44, 155648
    s_add_u32 s44, s14, 4096
    buffer_load_dwordx4 v2, s[8:11], s44 offen sc1 lds
    buffer_load_dwordx4 v3, s[8:11], s44 offen offset:1024 sc1 lds
    s_xor_b32 m0, s42, 16384
    s_add_u32 s44, s14, 8192
    buffer_load_dwordx4 v2, s[8:11], s44 offen sc1 lds
    buffer_load_dwordx4 v3, s[8:11], s44 offen offset:1024 sc1 lds
    s_xor_b32 m0, s42, 24576
    s_add_u32 s44, s14, 12288
    buffer_load_dwordx4 v2, s[8:11], s44 offen sc1 lds
    buffer_load_dwordx4 v3, s[8:11], s44 offen offset:1024 sc1 lds
    s_xor_b32 m0, s42, 32768
    s_add_u32 s44, s14, 16384
    buffer_load_dwordx4 v2, s[8:11], s44 offen sc1 lds
    buffer_load_dwordx4 v3, s[8:11], s44 offen offset:1024 sc1 lds
    s_xor_b32 m0, s42, 40960
    s_add_u32 s44, s14, 20480
    buffer_load_dwordx4 v2, s[8:11], s44 offen sc1 lds
    buffer_load_dwordx4 v3, s[8:11], s44 offen offset:1024 sc1 lds
    s_xor_b32 m0, s42, 49152
    s_add_u32 s44, s14, 24576
    buffer_load_dwordx4 v2, s[8:11], s44 offen sc1 lds
    buffer_load_dwordx4 v3, s[8:11], s44 offen offset:1024 sc1 lds
    s_xor_b32 m0, s42, 57344
    s_add_u32 s44, s14, 28672
    buffer_load_dwordx4 v2, s[8:11], s44 offen sc1 lds
    buffer_load_dwordx4 v3, s[8:11], s44 offen offset:1024 sc1 lds
    s_waitcnt vmcnt(0)
    s_branch B_ret1
B_spin2:
B_spl2:
    buffer_load_dword v13, v14, s[8:11], s61 offen sc1
    s_add_u32 s99, s99, 1
    s_waitcnt vmcnt(0)
    v_cmp_gt_u32 vcc, 2, v13
    s_nop 0
    s_cbranch_vccz B_spe2
    s_cmp_lt_u32 s99, 0x100000
    s_cbranch_scc1 B_spl2
B_spe2:
    s_branch B_ret2
A_l2:
    s_waitcnt vmcnt(4)
    v_cmp_gt_u32 vcc, 1, v13
    s_nop 0
    s_cbranch_vccnz A_ret4
    s_mov_b32 s63, 0
    s_xor_b32 m0, s42, 0
    s_add_u32 s44, s14, 0
    buffer_load_dwordx4 v2, s[8:11], s44 offen sc1 lds
    buffer_load_dwordx4 v3, s[8:11], s44 offen offset:1024 sc1 lds
    s_and_b32 s44, s42, 0xffff
    s_add_u32 m0, s44, 155648
    s_add_u32 s44, s14, 4096
    buffer_load_dwordx4 v2, s[8:11], s44 offen sc1 lds
    buffer_load_dwordx4 v3, s[8:11], s44 offen offset:1024 sc1 lds
    s_xor_b32 m0, s42, 16384
    s_add_u32 s44, s14, 8192
    buffer_load_dwordx4 v2, s[8:11], s44 offen sc1 lds
    buffer_load_dwordx4 v3, s[8:11], s44 offen offset:1024 sc1 lds
    s_xor_b32 m0, s42, 24576
    s_add_u32 s44, s14, 12288
    buffer_load_dwordx4 v2, s[8:11], s44 offen sc1 lds
    buffer_load_dwordx4 v3, s[8:11], s44 offen offset:1024 sc1 lds
    s_xor_b32 m0, s42, 32768
    s_add_u32 s44, s14, 16384
    buffer_load_dwordx4 v2, s[8:11], s44 offen sc1 lds
    buffer_load_dwordx4 v3, s[8:11], s44 offen offset:1024 sc1 lds
    s_xor_b32 m0, s42, 40960
    s_add_u32 s44, s14, 20480
    buffer_load_dwordx4 v2, s[8:11], s44 offen sc1 lds
    buffer_load_dwordx4 v3, s[8:11], s44 offen offset:1024 sc1 lds
    s_xor_b32 m0, s42, 49152
    s_add_u32 s44, s14, 24576
    buffer_load_dwordx4 v2, s[8:11], s44 offen sc1 lds
    buffer_load_dwordx4 v3, s[8:11], s44 offen offset:1024 sc1 lds
    s_xor_b32 m0, s42, 57344
    s_add_u32 s44, s14, 28672
    buffer_load_dwordx4 v2, s[8:11], s44 offen sc1 lds
    buffer_load_dwordx4 v3, s[8:11], s44 offen offset:1024 sc1 lds
    s_branch A_ret4
A_chain:
    v_and_b32 v236, 31, v0
    v_mul_u32_u24 v236, 144, v236
    v_add_u32 v236, 131072, v236
    ds_read_b128 v[100:103], v236 offset:0
    ds_read_b128 v[108:111], v236 offset:16
    ds_read_b128 v[116:119], v236 offset:32
    ds_read_b128 v[124:127], v236 offset:48
    ds_read_b128 v[164:167], v236 offset:64
    ds_read_b128 v[172:175], v236 offset:80
    ds_read_b128 v[180:183], v236 offset:96
    ds_read_b128 v[188:191], v236 offset:112
    v_accvgpr_read_b32 v228, a242
    v_accvgpr_read_b32 v229, a243
    v_mov_b32 v230, 0
    v_mov_b32 v231, 0
    s_sub_u32 s6, 15, s5
    v_mov_b32 v237, s6
    v_mov_b32 v238, s5
    v_cmp_gt_u32 vcc, 16, v0
    v_and_b32 v239, 15, v0
    v_lshlrev_b32 v239, 7, v239
    v_cndmask_b32 v237, v237, v238, vcc
    v_lshl_add_u32 v237, v237, 3, v239
    s_lshl_b32 s6, s4, 11
    s_add_u32 s6, s6, 60882944
    s_waitcnt lgkmcnt(0)
    s_mov_b32 exec_hi, 0
    ds_write_b64 v236, v[230:231]
    ds_write_b64 v236, v[100:101] offset:8
    v_fma_f32 v102, v228, v100, v102
    v_fma_f32 v103, v228, v101, v103
    v_fma_f32 v102, -v229, v101, v102
    v_fma_f32 v103, v229, v100, v103
    ds_write_b64 v236, v[102:103] offset:16
    v_fma_f32 v108, v228, v102, v108
    v_fma_f32 v109, v228, v103, v109
    v_fma_f32 v108, -v229, v103, v108
    v_fma_f32 v109, v229, v102, v109
    ds_write_b64 v236, v[108:109] offset:24
    v_fma_f32 v110, v228, v108, v110
    v_fma_f32 v111, v228, v109, v111
    v_fma_f32 v110, -v229, v109, v110
    v_fma_f32 v111, v229, v108, v111
    ds_write_b64 v236, v[110:111] offset:32
    v_fma_f32 v116, v228, v110, v116
    v_fma_f32 v117, v228, v111, v117
    v_fma_f32 v116, -v229, v111, v116
    v_fma_f32 v117, v229, v110, v117
    ds_write_b64 v236, v[116:117] offset:40
    v_fma_f32 v118, v228, v116, v118
    v_fma_f32 v119, v228, v117, v119
    v_fma_f32 v118, -v229, v117, v118
    v_fma_f32 v119, v229, v116, v119
    ds_write_b64 v236, v[118:119] offset:48
    v_fma_f32 v124, v228, v118, v124
    v_fma_f32 v125, v228, v119, v125
    v_fma_f32 v124, -v229, v119, v124
    v_fma_f32 v125, v229, v118, v125
    ds_write_b64 v236, v[124:125] offset:56
    v_fma_f32 v126, v228, v124, v126
    v_fma_f32 v127, v228, v125, v127
    v_fma_f32 v126, -v229, v125, v126
    v_fma_f32 v127, v229, v124, v127
    ds_write_b64 v236, v[126:127] offset:64
    v_fma_f32 v164, v228, v126, v164
    v_fma_f32 v165, v228, v127, v165
    v_fma_f32 v164, -v229, v127, v164
    v_fma_f32 v165, v229, v126, v165
    ds_write_b64 v236, v[164:165] offset:72
    v_fma_f32 v166, v228, v164, v166
    v_fma_f32 v167, v228, v165, v167
    v_fma_f32 v166, -v229, v165, v166
    v_fma_f32 v167, v229, v164, v167
    ds_write_b64 v236, v[166:167] offset:80
    v_fma_f32 v172, v228, v166, v172
    v_fma_f32 v173, v228, v167, v173
    v_fma_f32 v172, -v229, v167, v172
    v_fma_f32 v173, v229, v166, v173
    ds_write_b64 v236, v[172:173] offset:88
    v_fma_f32 v174, v228, v172, v174
    v_fma_f32 v175, v228, v173, v175
    v_fma_f32 v174, -v229, v173, v174
    v_fma_f32 v175, v229, v172, v175
    ds_write_b64 v236, v[174:175] offset:96
    v_fma_f32 v180, v228, v174, v180
    v_fma_f32 v181, v228, v175, v181
    v_fma_f32 v180, -v229, v175, v180
    v_fma_f32 v181, v229, v174, v181
    ds_write_b64 v236, v[180:181] offset:104
    v_fma_f32 v182, v228, v180, v182
    v_fma_f32 v183, v228, v181, v183
    v_fma_f32 v182, -v229, v181, v182
    v_fma_f32 v183, v229, v180, v183
    ds_write_b64 v236, v[182:183] offset:112
    v_fma_f32 v188, v228, v182, v188
    v_fma_f32 v189, v228, v183, v189
    v_fma_f32 v188, -v229, v183, v188
    v_fma_f32 v189, v229, v182, v189
    ds_write_b64 v236, v[188:189] offset:120
    v_fma_f32 v190, v228, v188, v190
    v_fma_f32 v191, v228, v189, v191
    v_fma_f32 v190, -v229, v189, v190
    v_fma_f32 v191, v229, v188, v191
    buffer_store_dwordx2 v[190:191], v237, s[8:11], s6 offen sc1
    s_mov_b64 exec, -1
    s_branch A_ret2
A_fb:
    s_waitcnt vmcnt(0)
    v_mov_b32 v108, 0xff800000
    v_mov_b32 v116, 0
    v_mov_b32 v128, 0
    v_mov_b32 v109, 0xff800000
    v_mov_b32 v117, 0
    v_mov_b32 v129, 0
    v_mov_b32 v110, 0xff800000
    v_mov_b32 v118, 0
    v_mov_b32 v130, 0
    v_mov_b32 v111, 0xff800000
    v_mov_b32 v119, 0
    v_mov_b32 v131, 0
    v_mov_b32 v124, 0xff800000
    s_mov_b32 s50, 0
A_fbp:
    s_mov_b32 s45, 0
    s_mul_i32 s48, s4, 1064960
A_fbl:
    s_add_u32 s44, s48, 0
    buffer_load_dwordx4 a[144:147], v1, s[8:11], s44 offen offset:0 sc1
    buffer_load_dwordx4 a[148:151], v1, s[8:11], s44 offen offset:1024 sc1
    buffer_load_dwordx4 a[152:155], v1, s[8:11], s44 offen offset:2048 sc1
    buffer_load_dwordx4 a[156:159], v1, s[8:11], s44 offen offset:3072 sc1
    s_add_u32 s44, s48, 4096
    buffer_load_dwordx4 a[160:163], v1, s[8:11], s44 offen offset:0 sc1
    buffer_load_dwordx4 a[164:167], v1, s[8:11], s44 offen offset:1024 sc1
    buffer_load_dwordx4 a[168:171], v1, s[8:11], s44 offen offset:2048 sc1
    buffer_load_dwordx4 a[172:175], v1, s[8:11], s44 offen offset:3072 sc1
    s_add_u32 s44, s48, 24576
    buffer_load_dwordx4 a[180:183], v1, s[8:11], s44 offen offset:0 sc1
    buffer_load_dwordx4 a[184:187], v1, s[8:11], s44 offen offset:1024 sc1
    buffer_load_dwordx4 a[188:191], v1, s[8:11], s44 offen offset:2048 sc1
    buffer_load_dwordx4 a[192:195], v1, s[8:11], s44 offen offset:3072 sc1
    s_add_u32 s44, s48, 28672
    buffer_load_dwordx4 a[196:199], v1, s[8:11], s44 offen offset:0 sc1
    buffer_load_dwordx4 a[200:203], v1, s[8:11], s44 offen offset:1024 sc1
    buffer_load_dwordx4 a[204:207], v1, s[8:11], s44 offen offset:2048 sc1
    buffer_load_dwordx4 a[208:211], v1, s[8:11], s44 offen offset:3072 sc1
    s_cmp_lt_u32 s45, s96
    s_cselect_b64 s[6:7], -1, 0
    s_cmp_le_u32 s45, s96
    s_cselect_b64 vcc, -1, 0
    v_cndmask_b32 v7, v124, v116, s[6:7]
    v_cndmask_b32 v8, v124, v116, vcc
    v_cndmask_b32 v224, v7, v8, s[64:65]
    v_cndmask_b32 v225, v7, v8, s[66:67]
    v_cndmask_b32 v226, v7, v8, s[68:69]
    v_cndmask_b32 v227, v7, v8, s[70:71]
    v_cndmask_b32 v112, v7, v8, s[80:81]
    v_cndmask_b32 v113, v7, v8, s[82:83]
    v_cndmask_b32 v114, v7, v8, s[84:85]
    v_cndmask_b32 v115, v7, v8, s[86:87]
    v_cndmask_b32 v7, v124, v117, s[6:7]
    v_cndmask_b32 v8, v124, v117, vcc
    v_cndmask_b32 v240, v7, v8, s[72:73]
    v_cndmask_b32 v241, v7, v8, s[74:75]
    v_cndmask_b32 v242, v7, v8, s[76:77]
    v_cndmask_b32 v243, v7, v8, s[78:79]
    v_cndmask_b32 v144, v7, v8, s[88:89]
    v_cndmask_b32 v145, v7, v8, s[90:91]
    v_cndmask_b32 v146, v7, v8, s[92:93]
    v_cndmask_b32 v147, v7, v8, s[94:95]
    s_cmp_lt_u32 s45, s97
    s_cselect_b64 s[6:7], -1, 0
    s_cmp_le_u32 s45, s97
    s_cselect_b64 vcc, -1, 0
    v_cndmask_b32 v7, v124, v118, s[6:7]
    v_cndmask_b32 v8, v124, v118, vcc
    v_cndmask_b32 v160, v7, v8, s[64:65]
    v_cndmask_b32 v161, v7, v8, s[66:67]
    v_cndmask_b32 v162, v7, v8, s[68:69]
    v_cndmask_b32 v163, v7, v8, s[70:71]
    v_cndmask_b32 v192, v7, v8, s[80:81]
    v_cndmask_b32 v193, v7, v8, s[82:83]
    v_cndmask_b32 v194, v7, v8, s[84:85]
    v_cndmask_b32 v195, v7, v8, s[86:87]
    v_cndmask_b32 v7, v124, v119, s[6:7]
    v_cndmask_b32 v8, v124, v119, vcc
    v_cndmask_b32 v176, v7, v8, s[72:73]
    v_cndmask_b32 v177, v7, v8, s[74:75]
    v_cndmask_b32 v178, v7, v8, s[76:77]
    v_cndmask_b32 v179, v7, v8, s[78:79]
    v_cndmask_b32 v96, v7, v8, s[88:89]
    v_cndmask_b32 v97, v7, v8, s[90:91]
    v_cndmask_b32 v98, v7, v8, s[92:93]
    v_cndmask_b32 v99, v7, v8, s[94:95]
    s_waitcnt vmcnt(0)
    v_mfma_f32_16x16x32_bf16 v[224:227], a[144:147], v[48:51], v[224:227]
    v_mfma_f32_16x16x32_bf16 v[240:243], a[144:147], v[52:55], v[240:243]
    v_mfma_f32_16x16x32_bf16 v[160:163], a[144:147], v[56:59], v[160:163]
    v_mfma_f32_16x16x32_bf16 v[176:179], a[144:147], v[60:63], v[176:179]
    v_mfma_f32_16x16x32_bf16 v[224:227], a[148:151], v[80:83], v[224:227]
    v_mfma_f32_16x16x32_bf16 v[240:243], a[148:151], v[84:87], v[240:243]
    v_mfma_f32_16x16x32_bf16 v[160:163], a[148:151], v[88:91], v[160:163]
    v_mfma_f32_16x16x32_bf16 v[176:179], a[148:151], v[92:95], v[176:179]
    v_mfma_f32_16x16x32_bf16 v[224:227], a[152:155], v[132:135], v[224:227]
    v_mfma_f32_16x16x32_bf16 v[240:243], a[152:155], v[140:143], v[240:243]
    v_mfma_f32_16x16x32_bf16 v[160:163], a[152:155], v[148:151], v[160:163]
    v_mfma_f32_16x16x32_bf16 v[176:179], a[152:155], v[156:159], v[176:179]
    v_mfma_f32_16x16x32_bf16 v[224:227], a[156:159], v[196:199], v[224:227]
    v_mfma_f32_16x16x32_bf16 v[240:243], a[156:159], v[204:207], v[240:243]
    v_mfma_f32_16x16x32_bf16 v[160:163], a[156:159], v[212:215], v[160:163]
    v_mfma_f32_16x16x32_bf16 v[176:179], a[156:159], v[220:223], v[176:179]
    v_mfma_f32_16x16x32_bf16 v[112:115], a[160:163], v[48:51], v[112:115]
    v_mfma_f32_16x16x32_bf16 v[144:147], a[160:163], v[52:55], v[144:147]
    v_mfma_f32_16x16x32_bf16 v[192:195], a[160:163], v[56:59], v[192:195]
    v_mfma_f32_16x16x32_bf16 v[96:99], a[160:163], v[60:63], v[96:99]
    v_mfma_f32_16x16x32_bf16 v[112:115], a[164:167], v[80:83], v[112:115]
    v_mfma_f32_16x16x32_bf16 v[144:147], a[164:167], v[84:87], v[144:147]
    v_mfma_f32_16x16x32_bf16 v[192:195], a[164:167], v[88:91], v[192:195]
    v_mfma_f32_16x16x32_bf16 v[96:99], a[164:167], v[92:95], v[96:99]
    v_mfma_f32_16x16x32_bf16 v[112:115], a[168:171], v[132:135], v[112:115]
    v_mfma_f32_16x16x32_bf16 v[144:147], a[168:171], v[140:143], v[144:147]
    v_mfma_f32_16x16x32_bf16 v[192:195], a[168:171], v[148:151], v[192:195]
    v_mfma_f32_16x16x32_bf16 v[96:99], a[168:171], v[156:159], v[96:99]
    v_mfma_f32_16x16x32_bf16 v[112:115], a[172:175], v[196:199], v[112:115]
    v_mfma_f32_16x16x32_bf16 v[144:147], a[172:175], v[204:207], v[144:147]
    v_mfma_f32_16x16x32_bf16 v[192:195], a[172:175], v[212:215], v[192:195]
    v_mfma_f32_16x16x32_bf16 v[96:99], a[172:175], v[220:223], v[96:99]
    s_cmp_eq_u32 s50, 0
    s_cbranch_scc0 A_fb2
    v_max3_f32 v108, v224, v225, v108
    v_max3_f32 v108, v226, v227, v108
    v_max3_f32 v109, v240, v241, v109
    v_max3_f32 v109, v242, v243, v109
    v_max3_f32 v110, v160, v161, v110
    v_max3_f32 v110, v162, v163, v110
    v_max3_f32 v111, v176, v177, v111
    v_max3_f32 v111, v178, v179, v111
    v_max3_f32 v108, v112, v113, v108
    v_max3_f32 v108, v114, v115, v108
    v_max3_f32 v109, v144, v145, v109
    v_max3_f32 v109, v146, v147, v109
    v_max3_f32 v110, v192, v193, v110
    v_max3_f32 v110, v194, v195, v110
    v_max3_f32 v111, v96, v97, v111
    v_max3_f32 v111, v98, v99, v111
    s_branch A_fb3
A_fb2:
    v_exp_f32 v224, v224
    v_exp_f32 v225, v225
    v_exp_f32 v226, v226
    v_exp_f32 v227, v227
    v_cvt_pk_bf16_f32 v136, v224, v225
    v_cvt_pk_bf16_f32 v137, v226, v227
    v_exp_f32 v240, v240
    v_exp_f32 v241, v241
    v_exp_f32 v242, v242
    v_exp_f32 v243, v243
    v_cvt_pk_bf16_f32 v152, v240, v241
    v_cvt_pk_bf16_f32 v153, v242, v243
    v_exp_f32 v160, v160
    v_exp_f32 v161, v161
    v_exp_f32 v162, v162
    v_exp_f32 v163, v163
    v_cvt_pk_bf16_f32 v64, v160, v161
    v_cvt_pk_bf16_f32 v65, v162, v163
    v_exp_f32 v176, v176
    v_exp_f32 v177, v177
    v_exp_f32 v178, v178
    v_exp_f32 v179, v179
    v_cvt_pk_bf16_f32 v68, v176, v177
    v_cvt_pk_bf16_f32 v69, v178, v179
    v_exp_f32 v112, v112
    v_exp_f32 v113, v113
    v_exp_f32 v114, v114
    v_exp_f32 v115, v115
    v_cvt_pk_bf16_f32 v138, v112, v113
    v_cvt_pk_bf16_f32 v139, v114, v115
    v_exp_f32 v144, v144
    v_exp_f32 v145, v145
    v_exp_f32 v146, v146
    v_exp_f32 v147, v147
    v_cvt_pk_bf16_f32 v154, v144, v145
    v_cvt_pk_bf16_f32 v155, v146, v147
    v_exp_f32 v192, v192
    v_exp_f32 v193, v193
    v_exp_f32 v194, v194
    v_exp_f32 v195, v195
    v_cvt_pk_bf16_f32 v66, v192, v193
    v_cvt_pk_bf16_f32 v67, v194, v195
    v_exp_f32 v96, v96
    v_exp_f32 v97, v97
    v_exp_f32 v98, v98
    v_exp_f32 v99, v99
    v_cvt_pk_bf16_f32 v70, v96, v97
    v_cvt_pk_bf16_f32 v71, v98, v99
    v_mfma_f32_16x16x32_bf16 a[0:3], a[180:183], v[136:139], a[0:3]
    v_mfma_f32_16x16x32_bf16 a[4:7], a[180:183], v[152:155], a[4:7]
    v_mfma_f32_16x16x32_bf16 a[64:67], a[180:183], v[64:67], a[64:67]
    v_mfma_f32_16x16x32_bf16 a[68:71], a[180:183], v[68:71], a[68:71]
    v_mfma_f32_16x16x32_bf16 a[8:11], a[184:187], v[136:139], a[8:11]
    v_mfma_f32_16x16x32_bf16 a[12:15], a[184:187], v[152:155], a[12:15]
    v_mfma_f32_16x16x32_bf16 a[72:75], a[184:187], v[64:67], a[72:75]
    v_mfma_f32_16x16x32_bf16 a[76:79], a[184:187], v[68:71], a[76:79]
    v_mfma_f32_16x16x32_bf16 a[16:19], a[188:191], v[136:139], a[16:19]
    v_mfma_f32_16x16x32_bf16 a[20:23], a[188:191], v[152:155], a[20:23]
    v_mfma_f32_16x16x32_bf16 a[80:83], a[188:191], v[64:67], a[80:83]
    v_mfma_f32_16x16x32_bf16 a[84:87], a[188:191], v[68:71], a[84:87]
    v_mfma_f32_16x16x32_bf16 a[24:27], a[192:195], v[136:139], a[24:27]
    v_mfma_f32_16x16x32_bf16 a[28:31], a[192:195], v[152:155], a[28:31]
    v_mfma_f32_16x16x32_bf16 a[88:91], a[192:195], v[64:67], a[88:91]
    v_mfma_f32_16x16x32_bf16 a[92:95], a[192:195], v[68:71], a[92:95]
    v_mfma_f32_16x16x32_bf16 a[32:35], a[196:199], v[136:139], a[32:35]
    v_mfma_f32_16x16x32_bf16 a[36:39], a[196:199], v[152:155], a[36:39]
    v_mfma_f32_16x16x32_bf16 a[96:99], a[196:199], v[64:67], a[96:99]
    v_mfma_f32_16x16x32_bf16 a[100:103], a[196:199], v[68:71], a[100:103]
    v_mfma_f32_16x16x32_bf16 a[40:43], a[200:203], v[136:139], a[40:43]
    v_mfma_f32_16x16x32_bf16 a[44:47], a[200:203], v[152:155], a[44:47]
    v_mfma_f32_16x16x32_bf16 a[104:107], a[200:203], v[64:67], a[104:107]
    v_mfma_f32_16x16x32_bf16 a[108:111], a[200:203], v[68:71], a[108:111]
    v_mfma_f32_16x16x32_bf16 a[48:51], a[204:207], v[136:139], a[48:51]
    v_mfma_f32_16x16x32_bf16 a[52:55], a[204:207], v[152:155], a[52:55]
    v_mfma_f32_16x16x32_bf16 a[112:115], a[204:207], v[64:67], a[112:115]
    v_mfma_f32_16x16x32_bf16 a[116:119], a[204:207], v[68:71], a[116:119]
    v_mfma_f32_16x16x32_bf16 a[56:59], a[208:211], v[136:139], a[56:59]
    v_mfma_f32_16x16x32_bf16 a[60:63], a[208:211], v[152:155], a[60:63]
    v_mfma_f32_16x16x32_bf16 a[120:123], a[208:211], v[64:67], a[120:123]
    v_mfma_f32_16x16x32_bf16 a[124:127], a[208:211], v[68:71], a[124:127]
    v_mfma_f32_16x16x32_bf16 a[128:131], a[176:179], v[136:139], a[128:131]
    v_mfma_f32_16x16x32_bf16 a[132:135], a[176:179], v[152:155], a[132:135]
    v_mfma_f32_16x16x32_bf16 a[136:139], a[176:179], v[64:67], a[136:139]
    v_mfma_f32_16x16x32_bf16 a[140:143], a[176:179], v[68:71], a[140:143]
    s_nop 7
A_fb3:
    s_add_u32 s48, s48, 16384
    s_add_u32 s45, s45, 1
    s_cmp_le_u32 s45, s97
    s_cbranch_scc1 A_fbl
    s_cmp_eq_u32 s50, 0
    s_cbranch_scc0 A_fb4
    v_mov_b32 v116, v108
    v_mov_b32 v117, v109
    v_mov_b32 v118, v110
    v_mov_b32 v119, v111
    v_permlane16_swap_b32 v108, v116
    v_permlane16_swap_b32 v109, v117
    v_permlane16_swap_b32 v110, v118
    v_permlane16_swap_b32 v111, v119
    v_max_f32 v108, v108, v116
    v_max_f32 v109, v109, v117
    v_max_f32 v110, v110, v118
    v_max_f32 v111, v111, v119
    v_mov_b32 v116, v108
    v_mov_b32 v117, v109
    v_mov_b32 v118, v110
    v_mov_b32 v119, v111
    v_permlane32_swap_b32 v108, v116
    v_permlane32_swap_b32 v109, v117
    v_permlane32_swap_b32 v110, v118
    v_permlane32_swap_b32 v111, v119
    v_max_f32 v108, v108, v116
    v_max_f32 v109, v109, v117
    v_max_f32 v110, v110, v118
    v_max_f32 v111, v111, v119
    v_sub_f32 v116, 0, v108
    v_sub_f32 v117, 0, v109
    v_sub_f32 v118, 0, v110
    v_sub_f32 v119, 0, v111
    v_mfma_f32_32x32x16_bf16 a[0:15], v[128:131], v[128:131], 0
    v_mfma_f32_32x32x16_bf16 a[16:31], v[128:131], v[128:131], 0
    v_mfma_f32_32x32x16_bf16 a[32:47], v[128:131], v[128:131], 0
    v_mfma_f32_32x32x16_bf16 a[48:63], v[128:131], v[128:131], 0
    v_mfma_f32_32x32x16_bf16 a[64:79], v[128:131], v[128:131], 0
    v_mfma_f32_32x32x16_bf16 a[80:95], v[128:131], v[128:131], 0
    v_mfma_f32_32x32x16_bf16 a[96:111], v[128:131], v[128:131], 0
    v_mfma_f32_32x32x16_bf16 a[112:127], v[128:131], v[128:131], 0
    v_mfma_f32_32x32x16_bf16 a[128:143], v[128:131], v[128:131], 0
    s_mov_b32 s50, 1
    s_branch A_fbp
A_fb4:
    s_cmp_eq_u32 s56, 0
    s_cbranch_scc0 A_fb5
    v_accvgpr_read_b32 v100, a128
    v_accvgpr_read_b32 v101, a132
    v_min_f32 v102, v100, v101
    v_add_f32 v103, v100, v101
    v_cmp_nle_f32 vcc, 0x2b800000, v102
    s_mov_b64 s[6:7], vcc
    v_cmp_nge_f32 vcc, 0x53800000, v103
    s_or_b64 s[6:7], vcc, s[6:7]
    s_cmp_lg_u64 s[6:7], 0
    v_rcp_f32 v108, v100
    v_rcp_f32 v110, v101
    s_add_u32 s44, s40, 0
    v_accvgpr_read_b32 v224, a0
    v_accvgpr_read_b32 v240, a8
    v_accvgpr_read_b32 v225, a1
    v_accvgpr_read_b32 v241, a9
    v_accvgpr_read_b32 v226, a2
    v_accvgpr_read_b32 v242, a10
    v_accvgpr_read_b32 v227, a3
    v_accvgpr_read_b32 v243, a11
    v_pk_mul_f32 v[224:225], v[224:225], v[108:109] op_sel_hi:[1,0]
    v_pk_mul_f32 v[226:227], v[226:227], v[108:109] op_sel_hi:[1,0]
    v_pk_mul_f32 v[240:241], v[240:241], v[108:109] op_sel_hi:[1,0]
    v_pk_mul_f32 v[242:243], v[242:243], v[108:109] op_sel_hi:[1,0]
    v_cvt_pk_bf16_f32 v224, v224, v225
    v_cvt_pk_bf16_f32 v225, v226, v227
    v_cvt_pk_bf16_f32 v226, v240, v241
    v_cvt_pk_bf16_f32 v227, v242, v243
    buffer_store_dwordx4 v[224:227], v1, s[8:11], s44 offen offset:0 sc1
    v_accvgpr_read_b32 v112, a4
    v_accvgpr_read_b32 v144, a12
    v_accvgpr_read_b32 v113, a5
    v_accvgpr_read_b32 v145, a13
    v_accvgpr_read_b32 v114, a6
    v_accvgpr_read_b32 v146, a14
    v_accvgpr_read_b32 v115, a7
    v_accvgpr_read_b32 v147, a15
    v_pk_mul_f32 v[112:113], v[112:113], v[110:111] op_sel_hi:[1,0]
    v_pk_mul_f32 v[114:115], v[114:115], v[110:111] op_sel_hi:[1,0]
    v_pk_mul_f32 v[144:145], v[144:145], v[110:111] op_sel_hi:[1,0]
    v_pk_mul_f32 v[146:147], v[146:147], v[110:111] op_sel_hi:[1,0]
    v_cvt_pk_bf16_f32 v112, v112, v113
    v_cvt_pk_bf16_f32 v113, v114, v115
    v_cvt_pk_bf16_f32 v114, v144, v145
    v_cvt_pk_bf16_f32 v115, v146, v147
    buffer_store_dwordx4 v[112:115], v1, s[8:11], s44 offen offset:1024 sc1
    s_add_u32 s44, s40, 4096
    v_accvgpr_read_b32 v136, a16
    v_accvgpr_read_b32 v152, a24
    v_accvgpr_read_b32 v137, a17
    v_accvgpr_read_b32 v153, a25
    v_accvgpr_read_b32 v138, a18
    v_accvgpr_read_b32 v154, a26
    v_accvgpr_read_b32 v139, a19
    v_accvgpr_read_b32 v155, a27
    v_pk_mul_f32 v[136:137], v[136:137], v[108:109] op_sel_hi:[1,0]
    v_pk_mul_f32 v[138:139], v[138:139], v[108:109] op_sel_hi:[1,0]
    v_pk_mul_f32 v[152:153], v[152:153], v[108:109] op_sel_hi:[1,0]
    v_pk_mul_f32 v[154:155], v[154:155], v[108:109] op_sel_hi:[1,0]
    v_cvt_pk_bf16_f32 v136, v136, v137
    v_cvt_pk_bf16_f32 v137, v138, v139
    v_cvt_pk_bf16_f32 v138, v152, v153
    v_cvt_pk_bf16_f32 v139, v154, v155
    buffer_store_dwordx4 v[136:139], v1, s[8:11], s44 offen offset:0 sc1
    v_accvgpr_read_b32 v168, a20
    v_accvgpr_read_b32 v120, a28
    v_accvgpr_read_b32 v169, a21
    v_accvgpr_read_b32 v121, a29
    v_accvgpr_read_b32 v170, a22
    v_accvgpr_read_b32 v122, a30
    v_accvgpr_read_b32 v171, a23
    v_accvgpr_read_b32 v123, a31
    v_pk_mul_f32 v[168:169], v[168:169], v[110:111] op_sel_hi:[1,0]
    v_pk_mul_f32 v[170:171], v[170:171], v[110:111] op_sel_hi:[1,0]
    v_pk_mul_f32 v[120:121], v[120:121], v[110:111] op_sel_hi:[1,0]
    v_pk_mul_f32 v[122:123], v[122:123], v[110:111] op_sel_hi:[1,0]
    v_cvt_pk_bf16_f32 v168, v168, v169
    v_cvt_pk_bf16_f32 v169, v170, v171
    v_cvt_pk_bf16_f32 v170, v120, v121
    v_cvt_pk_bf16_f32 v171, v122, v123
    buffer_store_dwordx4 v[168:171], v1, s[8:11], s44 offen offset:1024 sc1
    s_add_u32 s44, s40, 8192
    v_accvgpr_read_b32 v224, a32
    v_accvgpr_read_b32 v240, a40
    v_accvgpr_read_b32 v225, a33
    v_accvgpr_read_b32 v241, a41
    v_accvgpr_read_b32 v226, a34
    v_accvgpr_read_b32 v242, a42
    v_accvgpr_read_b32 v227, a35
    v_accvgpr_read_b32 v243, a43
    v_pk_mul_f32 v[224:225], v[224:225], v[108:109] op_sel_hi:[1,0]
    v_pk_mul_f32 v[226:227], v[226:227], v[108:109] op_sel_hi:[1,0]
    v_pk_mul_f32 v[240:241], v[240:241], v[108:109] op_sel_hi:[1,0]
    v_pk_mul_f32 v[242:243], v[242:243], v[108:109] op_sel_hi:[1,0]
    v_cvt_pk_bf16_f32 v224, v224, v225
    v_cvt_pk_bf16_f32 v225, v226, v227
    v_cvt_pk_bf16_f32 v226, v240, v241
    v_cvt_pk_bf16_f32 v227, v242, v243
    buffer_store_dwordx4 v[224:227], v1, s[8:11], s44 offen offset:0 sc1
    v_accvgpr_read_b32 v112, a36
    v_accvgpr_read_b32 v144, a44
    v_accvgpr_read_b32 v113, a37
    v_accvgpr_read_b32 v145, a45
    v_accvgpr_read_b32 v114, a38
    v_accvgpr_read_b32 v146, a46
    v_accvgpr_read_b32 v115, a39
    v_accvgpr_read_b32 v147, a47
    v_pk_mul_f32 v[112:113], v[112:113], v[110:111] op_sel_hi:[1,0]
    v_pk_mul_f32 v[114:115], v[114:115], v[110:111] op_sel_hi:[1,0]
    v_pk_mul_f32 v[144:145], v[144:145], v[110:111] op_sel_hi:[1,0]
    v_pk_mul_f32 v[146:147], v[146:147], v[110:111] op_sel_hi:[1,0]
    v_cvt_pk_bf16_f32 v112, v112, v113
    v_cvt_pk_bf16_f32 v113, v114, v115
    v_cvt_pk_bf16_f32 v114, v144, v145
    v_cvt_pk_bf16_f32 v115, v146, v147
    buffer_store_dwordx4 v[112:115], v1, s[8:11], s44 offen offset:1024 sc1
    s_add_u32 s44, s40, 12288
    v_accvgpr_read_b32 v136, a48
    v_accvgpr_read_b32 v152, a56
    v_accvgpr_read_b32 v137, a49
    v_accvgpr_read_b32 v153, a57
    v_accvgpr_read_b32 v138, a50
    v_accvgpr_read_b32 v154, a58
    v_accvgpr_read_b32 v139, a51
    v_accvgpr_read_b32 v155, a59
    v_pk_mul_f32 v[136:137], v[136:137], v[108:109] op_sel_hi:[1,0]
    v_pk_mul_f32 v[138:139], v[138:139], v[108:109] op_sel_hi:[1,0]
    v_pk_mul_f32 v[152:153], v[152:153], v[108:109] op_sel_hi:[1,0]
    v_pk_mul_f32 v[154:155], v[154:155], v[108:109] op_sel_hi:[1,0]
    v_cvt_pk_bf16_f32 v136, v136, v137
    v_cvt_pk_bf16_f32 v137, v138, v139
    v_cvt_pk_bf16_f32 v138, v152, v153
    v_cvt_pk_bf16_f32 v139, v154, v155
    buffer_store_dwordx4 v[136:139], v1, s[8:11], s44 offen offset:0 sc1
    v_accvgpr_read_b32 v168, a52
    v_accvgpr_read_b32 v120, a60
    v_accvgpr_read_b32 v169, a53
    v_accvgpr_read_b32 v121, a61
    v_accvgpr_read_b32 v170, a54
    v_accvgpr_read_b32 v122, a62
    v_accvgpr_read_b32 v171, a55
    v_accvgpr_read_b32 v123, a63
    v_pk_mul_f32 v[168:169], v[168:169], v[110:111] op_sel_hi:[1,0]
    v_pk_mul_f32 v[170:171], v[170:171], v[110:111] op_sel_hi:[1,0]
    v_pk_mul_f32 v[120:121], v[120:121], v[110:111] op_sel_hi:[1,0]
    v_pk_mul_f32 v[122:123], v[122:123], v[110:111] op_sel_hi:[1,0]
    v_cvt_pk_bf16_f32 v168, v168, v169
    v_cvt_pk_bf16_f32 v169, v170, v171
    v_cvt_pk_bf16_f32 v170, v120, v121
    v_cvt_pk_bf16_f32 v171, v122, v123
    buffer_store_dwordx4 v[168:171], v1, s[8:11], s44 offen offset:1024 sc1
A_fb5:
    s_add_u32 s62, s15, 131072
    buffer_load_dwordx4 v[224:227], v1, s[8:11], s62 offen offset:0 sc1
    buffer_load_dwordx4 v[240:243], v1, s[8:11], s62 offen offset:1024 sc1
    s_add_u32 s62, s15, 135168
    buffer_load_dwordx4 v[112:115], v1, s[8:11], s62 offen offset:0 sc1
    buffer_load_dwordx4 v[144:147], v1, s[8:11], s62 offen offset:1024 sc1
    s_add_u32 s62, s15, 139264
    buffer_load_dwordx4 v[136:139], v1, s[8:11], s62 offen offset:0 sc1
    buffer_load_dwordx4 v[152:155], v1, s[8:11], s62 offen offset:1024 sc1
    s_add_u32 s62, s15, 143360
    buffer_load_dwordx4 v[168:171], v1, s[8:11], s62 offen offset:0 sc1
    buffer_load_dwordx4 v[120:123], v1, s[8:11], s62 offen offset:1024 sc1
    s_add_u32 s62, s15, 147456
    buffer_load_dwordx4 v[128:131], v1, s[8:11], s62 offen offset:0 sc1
    buffer_load_dwordx4 v[172:175], v1, s[8:11], s62 offen offset:1024 sc1
    s_add_u32 s62, s15, 0
    buffer_load_dwordx4 a[0:3], v1, s[8:11], s62 offen offset:0 sc1
    buffer_load_dwordx4 a[4:7], v1, s[8:11], s62 offen offset:1024 sc1
    s_add_u32 s62, s15, 4096
    buffer_load_dwordx4 a[8:11], v1, s[8:11], s62 offen offset:0 sc1
    buffer_load_dwordx4 a[12:15], v1, s[8:11], s62 offen offset:1024 sc1
    s_add_u32 s62, s15, 8192
    buffer_load_dwordx4 a[16:19], v1, s[8:11], s62 offen offset:0 sc1
    buffer_load_dwordx4 a[20:23], v1, s[8:11], s62 offen offset:1024 sc1
    s_add_u32 s62, s15, 12288
    buffer_load_dwordx4 a[24:27], v1, s[8:11], s62 offen offset:0 sc1
    buffer_load_dwordx4 a[28:31], v1, s[8:11], s62 offen offset:1024 sc1
    s_add_u32 s62, s15, 16384
    buffer_load_dwordx4 a[32:35], v1, s[8:11], s62 offen offset:0 sc1
    buffer_load_dwordx4 a[36:39], v1, s[8:11], s62 offen offset:1024 sc1
    s_add_u32 s62, s15, 20480
    buffer_load_dwordx4 a[40:43], v1, s[8:11], s62 offen offset:0 sc1
    buffer_load_dwordx4 a[44:47], v1, s[8:11], s62 offen offset:1024 sc1
    s_add_u32 s62, s15, 24576
    buffer_load_dwordx4 a[48:51], v1, s[8:11], s62 offen offset:0 sc1
    buffer_load_dwordx4 a[52:55], v1, s[8:11], s62 offen offset:1024 sc1
    s_add_u32 s62, s15, 28672
    buffer_load_dwordx4 a[56:59], v1, s[8:11], s62 offen offset:0 sc1
    buffer_load_dwordx4 a[60:63], v1, s[8:11], s62 offen offset:1024 sc1
    s_add_u32 s62, s15, 32768
    buffer_load_dwordx4 a[128:131], v1, s[8:11], s62 offen offset:0 sc1
    buffer_load_dwordx4 a[132:135], v1, s[8:11], s62 offen offset:1024 sc1
    s_add_u32 s62, s15, 36864
    buffer_load_dwordx4 a[212:215], v1, s[8:11], s62 offen offset:0 sc1
    buffer_load_dwordx4 a[216:219], v1, s[8:11], s62 offen offset:1024 sc1
    s_add_u32 s62, s15, 40960
    buffer_load_dwordx4 a[220:223], v1, s[8:11], s62 offen offset:0 sc1
    buffer_load_dwordx4 a[252:255], v1, s[8:11], s62 offen offset:1024 sc1
    s_add_u32 s62, s15, 151552
    buffer_load_dwordx4 v[180:183], v1, s[8:11], s62 offen offset:0 sc1
    buffer_load_dwordx4 v[16:19], v1, s[8:11], s62 offen offset:1024 sc1
    s_add_u32 s62, s15, 155648
    buffer_load_dwordx4 v[20:23], v1, s[8:11], s62 offen offset:0 sc1
    buffer_load_dwordx4 v[24:27], v1, s[8:11], s62 offen offset:1024 sc1
    s_add_u32 s62, s15, 159744
    buffer_load_dwordx4 v[28:31], v1, s[8:11], s62 offen offset:0 sc1
    buffer_load_dwordx4 v[32:35], v1, s[8:11], s62 offen offset:1024 sc1
    v_accvgpr_read_b32 v100, a136
    v_accvgpr_read_b32 v101, a140
    v_min_f32 v102, v100, v101
    v_add_f32 v103, v100, v101
    v_cmp_nle_f32 vcc, 0x2b800000, v102
    s_mov_b64 s[6:7], vcc
    v_cmp_nge_f32 vcc, 0x53800000, v103
    s_or_b64 s[6:7], vcc, s[6:7]
    s_cmp_lg_u64 s[6:7], 0
    s_waitcnt vmcnt(0)
    s_branch A_ret4
A_end:
    s_endpgm

.section .rodata,"a"
.p2align 6
.amdhsa_kernel gated_mix__compressed_kv_cla__ssm_conv_s5__prompt_kernel
  .amdhsa_next_free_vgpr 512
  .amdhsa_next_free_sgpr 102
  .amdhsa_accum_offset 256
  .amdhsa_group_segment_fixed_size 0
  .amdhsa_kernarg_size 152
  .amdhsa_user_sgpr_count 2
  .amdhsa_user_sgpr_kernarg_segment_ptr 1
  .amdhsa_system_sgpr_workgroup_id_x 1
.end_amdhsa_kernel
```
